```python
import torch

def _softmax(x, axis=-1):
    return torch.softmax(x, dim=axis)
def _gelu(x):
    return torch.nn.functional.gelu(x, approximate="tanh")
def _silu(x):
    return torch.nn.functional.silu(x)
def _sigmoid(x):
    return torch.sigmoid(x)
def _layernorm(x, axis=-1, eps=1e-5):
    m = x.mean(dim=axis, keepdim=True)
    v = x.var(dim=axis, keepdim=True, unbiased=False)
    return (x - m) / torch.sqrt(v + eps)
def _scatter_add(tgt, idx, src, axis=0):
    return tgt.clone().index_add_(axis, idx, src)
def _segment_sum(src, seg, n):
    out = torch.zeros((n,) + src.shape[1:], dtype=src.dtype)
    return out.index_add_(0, seg, src)
def _pad(x, pw):
    flat = tuple(v for pair in reversed(pw) for v in pair)
    return torch.nn.functional.pad(x, flat)

kernel_name = 'standalone__gqa_softmax__near_ridge'

def setup_inputs():

    _w = (lambda a: (lambda t: t.to(torch.bfloat16) if t.is_floating_point() else t)(torch.as_tensor(a)))
    B, Hq, Hkv, Sq, Sk, D = 32, 32, 8, 368, 512, 128
    return {
        "q": _w((lambda *s: torch.randn(*s, dtype=torch.bfloat16) * 0.8)(B, Hq, Sq, D)),
        "k": _w((lambda *s: torch.randn(*s, dtype=torch.bfloat16) * 0.8)(B, Hkv, Sk, D)),
        "v": _w((lambda *s: torch.randn(*s, dtype=torch.bfloat16) * 0.05)(B, Hkv, Sk, D)),
    }

def reference(q, k, v):
    B, Hq, Sq, D = q.shape
    Hkv = k.shape[1]
    rep = Hq // Hkv
    k = (lambda x, n, axis: torch.repeat_interleave(x, n, dim=axis))(k, rep, axis=1)
    v = (lambda x, n, axis: torch.repeat_interleave(x, n, dim=axis))(v, rep, axis=1)
    scale = D ** -0.5
    scores = torch.einsum("bhqd,bhkd->bhqk", q, k) * scale
    p = _softmax(scores, axis=-1)
    return torch.einsum("bhqk,bhkd->bhqd", p, v)
```

```asm
; @launch grid=(256,1,1) block=(256,1,1) lds=163840
.amdgcn_target "amdgcn-amd-amdhsa--gfx950"
.text
.globl standalone__gqa_softmax__near_ridge_kernel
.p2align 8
.type standalone__gqa_softmax__near_ridge_kernel,@function
standalone__gqa_softmax__near_ridge_kernel:
    s_cmp_ge_u32 s2, 256
    s_cbranch_scc1 L_end
    s_bitcmp1_b32 s2, 0
    s_cbranch_scc0 L_entry_b
    s_getpc_b64 s[62:63]
L_pc:
    s_lshr_b32 s40, s2, 3
    s_lshl_b32 s40, s40, 8
    v_add_u32 v249, s40, v0
    v_lshlrev_b32 v249, 6, v249
    v_and_b32 v249, 0xffff, v249
    v_min_u32 v249, L_last-L_pc-4, v249
    global_load_dword v248, v249, s[62:63]
    s_load_dwordx4 s[28:31], s[0:1], 0
    s_load_dwordx4 s[32:35], s[0:1], 16
    v_lshrrev_b32 v20, 6, v0
    v_and_b32 v21, 63, v0
    v_readfirstlane_b32 s20, v20
    v_lshrrev_b32 v22, 4, v21
    v_and_b32 v23, 15, v21
    v_lshlrev_b32 v24, 4, v21
    s_mul_i32 s26, s2, 376832
    s_lshl_b32 s27, s2, 17
    s_mul_i32 s23, s20, 39168
    s_lshl_b32 s40, s20, 2
    v_add_u32 v25, s40, v22
    v_xor_b32 v26, v25, v23
    v_lshlrev_b32 v26, 4, v26
    v_lshl_add_u32 v9, v25, 8, v26
    v_add_u32 v10, 45056, v9
    v_lshlrev_b32 v30, 8, v23
    v_lshl_add_u32 v30, v22, 4, v30
    v_lshrrev_b32 v31, 2, v21
    v_lshlrev_b32 v31, 8, v31
    v_and_b32 v25, 3, v21
    v_lshl_add_u32 v31, v25, 4, v31
    s_lshl_b32 s40, s20, 6
    v_add_u32 v31, s40, v31
    v_add_u32 v11, s40, v30
    v_and_b32 v25, 1, v23
    v_and_b32 v26, 2, v23
    v_and_b32 v30, 12, v23
    v_lshl_add_u32 v30, v25, 1, v30
    v_lshl_add_u32 v30, v26, 3, v30
    v_lshlrev_b32 v30, 8, v30
    v_lshl_add_u32 v30, v22, 4, v30
    s_xor_b32 s56, s20, 0
    s_lshl_b32 s56, s56, 15
    s_xor_b32 s57, s20, 1
    s_lshl_b32 s57, s57, 15
    s_and_b32 s58, s20, 2
    s_xor_b32 s58, s58, 2
    s_lshl_b32 s58, s58, 15
    s_and_b32 s59, s20, 2
    s_xor_b32 s59, s59, 3
    s_lshl_b32 s59, s59, 15
    s_mov_b32 s6, 376832
    s_mov_b32 s7, 0x00020000
    s_mov_b32 s10, 376832
    s_mov_b32 s11, 0x00020000
    s_mov_b32 s14, 131072
    s_mov_b32 s15, 0x00020000
    s_mov_b32 s18, 131072
    s_mov_b32 s19, 0x00020000
    s_waitcnt lgkmcnt(0)
    s_add_u32 s4, s28, s26
    s_addc_u32 s5, s29, 0
    s_add_u32 s12, s30, s27
    s_addc_u32 s13, s31, 0
    s_add_u32 s16, s32, s27
    s_addc_u32 s17, s33, 0
    s_add_u32 s8, s34, s26
    s_addc_u32 s9, s35, 0
    s_xor_b32 s27, s56, 0
    buffer_load_dwordx4 a[0:3], v30, s[12:15], s27 offen offset:0 nt
    s_xor_b32 s27, s56, 0
    buffer_load_dwordx4 a[4:7], v30, s[12:15], s27 offen offset:64 nt
    s_xor_b32 s27, s56, 0
    buffer_load_dwordx4 a[8:11], v30, s[12:15], s27 offen offset:128 nt
    s_xor_b32 s27, s56, 0
    buffer_load_dwordx4 a[12:15], v30, s[12:15], s27 offen offset:192 nt
    s_xor_b32 s27, s56, 256
    buffer_load_dwordx4 a[16:19], v30, s[12:15], s27 offen offset:0 nt
    s_xor_b32 s27, s56, 256
    buffer_load_dwordx4 a[20:23], v30, s[12:15], s27 offen offset:64 nt
    s_xor_b32 s27, s56, 256
    buffer_load_dwordx4 a[24:27], v30, s[12:15], s27 offen offset:128 nt
    s_xor_b32 s27, s56, 256
    buffer_load_dwordx4 a[28:31], v30, s[12:15], s27 offen offset:192 nt
    s_branch L_al
.p2align 12
L_al:
    s_mov_b32 s22, 49152
    s_mov_b32 s24, 0
    s_mov_b32 s29, 0x20000000
    v_lshrrev_b32 v25, 5, v21
    v_mul_u32_u24 v25, 6176, v25
    v_and_b32 v26, 31, v21
    v_lshl_add_u32 v25, v26, 4, v25
    s_add_u32 s26, s23, 14848
    v_add_u32 v1, s26, v25
    v_and_b32 v25, 1, v23
    v_mul_u32_u24 v24, 6176, v25
    v_bfe_u32 v25, v23, 1, 1
    v_mul_u32_u24 v25, 12416, v25
    v_add_u32 v24, v24, v25
    v_lshrrev_b32 v25, 2, v23
    v_lshl_add_u32 v24, v25, 6, v24
    v_lshl_add_u32 v24, v22, 4, v24
    s_add_u32 s26, s23, 14336
    v_add_u32 v0, s26, v24
    s_xor_b32 s26, s20, 1
    s_mul_i32 s26, s26, 39168
    s_add_u32 s26, s26, 14336
    v_add_u32 v2, s26, v24
    s_and_b32 s26, s20, 2
    s_xor_b32 s26, s26, 2
    s_mul_i32 s26, s26, 39168
    s_add_u32 s26, s26, 14336
    v_add_u32 v3, s26, v24
    s_and_b32 s26, s20, 2
    s_xor_b32 s26, s26, 3
    s_mul_i32 s26, s26, 39168
    s_add_u32 s26, s26, 14336
    v_add_u32 v4, s26, v24
    v_lshrrev_b32 v26, 2, v23
    v_mul_u32_u24 v26, 39168, v26
    v_and_b32 v25, 3, v23
    v_lshl_add_u32 v26, v25, 8, v26
    v_add_u32 v25, 0, v22
    v_xor_b32 v25, v25, v23
    v_lshl_add_u32 v5, v25, 4, v26
    v_add_u32 v25, 4, v22
    v_xor_b32 v25, v25, v23
    v_lshl_add_u32 v6, v25, 4, v26
    v_add_u32 v25, 8, v22
    v_xor_b32 v25, v25, v23
    v_lshl_add_u32 v7, v25, 4, v26
    v_add_u32 v25, 12, v22
    v_xor_b32 v25, v25, v23
    v_lshl_add_u32 v8, v25, 4, v26
    v_lshrrev_b32 v25, 1, v22
    v_lshl_add_u32 v25, v25, 4, v23
    v_lshlrev_b32 v25, 4, v25
    v_add_u32 v18, 156672, v25
    s_lshl_b32 s26, s20, 2
    s_add_u32 s26, s26, 156672
    v_add_u32 v12, s26, v25
    v_and_b32 v25, 1, v22
    v_mul_u32_u24 v26, 1536, v25
    v_lshlrev_b32 v25, 2, v25
    v_xor_b32 v12, v12, v25
    v_add_u32 v12, v12, v26
    s_mov_b32 s49, 0x07060302
    s_mov_b32 s50, 0xffff
    s_mov_b32 s51, 0xffff
    v_lshlrev_b32 v25, 4, v23
    v_add_u32 v13, 156672, v25
    v_lshlrev_b32 v25, 2, v21
    s_lshl_b32 s26, s20, 8
    s_add_u32 s26, s26, 159744
    v_add_u32 v14, s26, v25
    v_and_b32 v26, 3, v21
    v_lshl_add_u32 v26, v26, 8, v25
    v_add_u32 v15, 159744, v26
    v_mov_b32 v16, 1
    v_mov_b32 v26, 0
    ds_write_b32 v14, v26
    v_mov_b32 v25, 0x3f803f80
    v_and_b32 v26, 6, v23
    v_cmp_eq_u32 vcc, 0, v26
    s_nop 1
    v_cndmask_b32 v25, 0, v25, vcc
    v_cmp_gt_u32 vcc, 8, v23
    s_nop 1
    v_cndmask_b32 v32, 0, v25, vcc
    v_cndmask_b32 v36, v25, 0, vcc
    v_mov_b32 v33, v32
    v_mov_b32 v34, v32
    v_mov_b32 v35, v32
    v_mov_b32 v37, v36
    v_mov_b32 v38, v36
    v_mov_b32 v39, v36
    s_mov_b32 s36, 0x3e0293ee
    s_mov_b32 s37, 0x3e0293ee
    s_mov_b32 s38, 0xffff0000
    s_mov_b32 s39, 0x7b800000
    v_mov_b32 v17, 0x40000000
    s_mov_b32 s25, -6
    v_mov_b32 v252, 0xc2300000
    v_mov_b32 v253, 0xc2300000
    v_mov_b32 v254, 0xc2300000
    v_mov_b32 v255, 0xc2300000
    v_lshrrev_b32 v40, 2, v23
    v_cmp_eq_u32 vcc, v40, v22
    v_and_b32 v41, 1, v23
    v_lshlrev_b32 v41, 4, v41
    v_mov_b32 v42, 0x3e03
    v_mov_b32 v43, 0xb9d8
    v_lshlrev_b32 v42, v41, v42
    v_lshlrev_b32 v43, v41, v43
    v_cndmask_b32 v42, 0, v42, vcc
    v_cndmask_b32 v43, 0, v43, vcc
    v_and_b32 v41, 2, v23
    v_cmp_eq_u32 vcc, 0, v41
    v_mov_b32 v20, 0
    v_mov_b32 v21, 0
    v_mov_b32 v24, 0
    v_cndmask_b32 v22, 0, v42, vcc
    v_cndmask_b32 v23, v42, 0, vcc
    v_cndmask_b32 v26, 0, v43, vcc
    v_cndmask_b32 v27, v43, 0, vcc
    v_mov_b32 v25, 0
    v_mov_b32 v28, 0
    v_mov_b32 v29, 0
    s_mov_b64 exec, 0
    s_cmp_eq_u32 s20, 0
    s_cbranch_scc1 L_pad0
    s_cmp_eq_u32 s20, 1
    s_cbranch_scc1 L_pad1
    s_cmp_eq_u32 s20, 2
    s_cbranch_scc1 L_pad2
    s_branch L_pad3
L_hret:
    s_mov_b64 exec, -1
    s_nop 3
    s_waitcnt vmcnt(7)
    v_mfma_f32_16x16x32_bf16 v[184:187], v[22:25], a[0:3], 0
    v_mfma_f32_16x16x32_bf16 v[184:187], v[26:29], a[0:3], v[184:187]
    s_mov_b32 s21, 0
    s_add_u32 m0, s23, 0
    s_nop 0
    buffer_load_dwordx4 v9, s[4:7], s21 offen nt lds
    v_mfma_f32_16x16x32_bf16 v[188:191], v[20:23], a[0:3], 0
    v_mfma_f32_16x16x32_bf16 v[188:191], v[24:27], a[0:3], v[188:191]
    s_waitcnt vmcnt(7)
    v_mfma_f32_16x16x32_bf16 v[192:195], v[22:25], a[4:7], 0
    v_cvt_pk_bf16_f32 v184, v184, v185
    v_cvt_pk_bf16_f32 v186, v186, v187
    v_mfma_f32_16x16x32_bf16 v[192:195], v[26:29], a[4:7], v[192:195]
    s_mov_b32 s21, 4096
    s_add_u32 m0, s23, 1024
    s_nop 0
    buffer_load_dwordx4 v9, s[4:7], s21 offen nt lds
    v_accvgpr_write_b32 a0, v184
    v_accvgpr_write_b32 a1, v186
    v_mfma_f32_16x16x32_bf16 v[196:199], v[20:23], a[4:7], 0
    v_cvt_pk_bf16_f32 v188, v188, v189
    v_cvt_pk_bf16_f32 v190, v190, v191
    v_mfma_f32_16x16x32_bf16 v[196:199], v[24:27], a[4:7], v[196:199]
    v_accvgpr_write_b32 a2, v188
    v_accvgpr_write_b32 a3, v190
    s_waitcnt vmcnt(7)
    v_mfma_f32_16x16x32_bf16 v[184:187], v[22:25], a[8:11], 0
    v_cvt_pk_bf16_f32 v192, v192, v193
    v_cvt_pk_bf16_f32 v194, v194, v195
    v_mfma_f32_16x16x32_bf16 v[184:187], v[26:29], a[8:11], v[184:187]
    s_mov_b32 s21, 8192
    s_add_u32 m0, s23, 2048
    s_nop 0
    buffer_load_dwordx4 v9, s[4:7], s21 offen nt lds
    v_accvgpr_write_b32 a4, v192
    v_accvgpr_write_b32 a5, v194
    v_mfma_f32_16x16x32_bf16 v[188:191], v[20:23], a[8:11], 0
    v_cvt_pk_bf16_f32 v196, v196, v197
    v_cvt_pk_bf16_f32 v198, v198, v199
    v_mfma_f32_16x16x32_bf16 v[188:191], v[24:27], a[8:11], v[188:191]
    v_accvgpr_write_b32 a6, v196
    v_accvgpr_write_b32 a7, v198
    s_waitcnt vmcnt(7)
    v_mfma_f32_16x16x32_bf16 v[192:195], v[22:25], a[12:15], 0
    v_cvt_pk_bf16_f32 v184, v184, v185
    v_cvt_pk_bf16_f32 v186, v186, v187
    v_mfma_f32_16x16x32_bf16 v[192:195], v[26:29], a[12:15], v[192:195]
    s_mov_b32 s21, 12288
    s_add_u32 m0, s23, 3072
    s_nop 0
    buffer_load_dwordx4 v9, s[4:7], s21 offen nt lds
    v_accvgpr_write_b32 a8, v184
    v_accvgpr_write_b32 a9, v186
    v_mfma_f32_16x16x32_bf16 v[196:199], v[20:23], a[12:15], 0
    v_cvt_pk_bf16_f32 v188, v188, v189
    v_cvt_pk_bf16_f32 v190, v190, v191
    v_mfma_f32_16x16x32_bf16 v[196:199], v[24:27], a[12:15], v[196:199]
    v_accvgpr_write_b32 a10, v188
    v_accvgpr_write_b32 a11, v190
    s_waitcnt vmcnt(7)
    v_mfma_f32_16x16x32_bf16 v[184:187], v[22:25], a[16:19], 0
    v_cvt_pk_bf16_f32 v192, v192, v193
    v_cvt_pk_bf16_f32 v194, v194, v195
    v_mfma_f32_16x16x32_bf16 v[184:187], v[26:29], a[16:19], v[184:187]
    s_mov_b32 s21, 16384
    s_add_u32 m0, s23, 4096
    s_nop 0
    buffer_load_dwordx4 v9, s[4:7], s21 offen nt lds
    v_accvgpr_write_b32 a12, v192
    v_accvgpr_write_b32 a13, v194
    v_mfma_f32_16x16x32_bf16 v[188:191], v[20:23], a[16:19], 0
    v_cvt_pk_bf16_f32 v196, v196, v197
    v_cvt_pk_bf16_f32 v198, v198, v199
    v_mfma_f32_16x16x32_bf16 v[188:191], v[24:27], a[16:19], v[188:191]
    v_accvgpr_write_b32 a14, v196
    v_accvgpr_write_b32 a15, v198
    s_waitcnt vmcnt(7)
    v_mfma_f32_16x16x32_bf16 v[192:195], v[22:25], a[20:23], 0
    v_cvt_pk_bf16_f32 v184, v184, v185
    v_cvt_pk_bf16_f32 v186, v186, v187
    v_mfma_f32_16x16x32_bf16 v[192:195], v[26:29], a[20:23], v[192:195]
    s_mov_b32 s21, 20480
    s_add_u32 m0, s23, 5120
    s_nop 0
    buffer_load_dwordx4 v9, s[4:7], s21 offen nt lds
    v_accvgpr_write_b32 a16, v184
    v_accvgpr_write_b32 a17, v186
    v_mfma_f32_16x16x32_bf16 v[196:199], v[20:23], a[20:23], 0
    v_cvt_pk_bf16_f32 v188, v188, v189
    v_cvt_pk_bf16_f32 v190, v190, v191
    v_mfma_f32_16x16x32_bf16 v[196:199], v[24:27], a[20:23], v[196:199]
    v_accvgpr_write_b32 a18, v188
    v_accvgpr_write_b32 a19, v190
    s_waitcnt vmcnt(7)
    v_mfma_f32_16x16x32_bf16 v[184:187], v[22:25], a[24:27], 0
    v_cvt_pk_bf16_f32 v192, v192, v193
    v_cvt_pk_bf16_f32 v194, v194, v195
    v_mfma_f32_16x16x32_bf16 v[184:187], v[26:29], a[24:27], v[184:187]
    s_mov_b32 s21, 24576
    s_add_u32 m0, s23, 6144
    s_nop 0
    buffer_load_dwordx4 v9, s[4:7], s21 offen nt lds
    v_accvgpr_write_b32 a20, v192
    v_accvgpr_write_b32 a21, v194
    v_mfma_f32_16x16x32_bf16 v[188:191], v[20:23], a[24:27], 0
    v_cvt_pk_bf16_f32 v196, v196, v197
    v_cvt_pk_bf16_f32 v198, v198, v199
    v_mfma_f32_16x16x32_bf16 v[188:191], v[24:27], a[24:27], v[188:191]
    v_accvgpr_write_b32 a22, v196
    v_accvgpr_write_b32 a23, v198
    s_waitcnt vmcnt(7)
    v_mfma_f32_16x16x32_bf16 v[192:195], v[22:25], a[28:31], 0
    v_cvt_pk_bf16_f32 v184, v184, v185
    v_cvt_pk_bf16_f32 v186, v186, v187
    v_mfma_f32_16x16x32_bf16 v[192:195], v[26:29], a[28:31], v[192:195]
    s_mov_b32 s21, 28672
    s_add_u32 m0, s23, 7168
    s_nop 0
    buffer_load_dwordx4 v9, s[4:7], s21 offen nt lds
    v_accvgpr_write_b32 a24, v184
    v_accvgpr_write_b32 a25, v186
    v_mfma_f32_16x16x32_bf16 v[196:199], v[20:23], a[28:31], 0
    v_cvt_pk_bf16_f32 v188, v188, v189
    v_cvt_pk_bf16_f32 v190, v190, v191
    v_mfma_f32_16x16x32_bf16 v[196:199], v[24:27], a[28:31], v[196:199]
    v_accvgpr_write_b32 a26, v188
    v_accvgpr_write_b32 a27, v190
    v_cvt_pk_bf16_f32 v192, v192, v193
    v_cvt_pk_bf16_f32 v194, v194, v195
    v_accvgpr_write_b32 a28, v192
    v_accvgpr_write_b32 a29, v194
    s_nop 1
    v_cvt_pk_bf16_f32 v196, v196, v197
    v_cvt_pk_bf16_f32 v198, v198, v199
    v_accvgpr_write_b32 a30, v196
    v_accvgpr_write_b32 a31, v198
    s_waitcnt vmcnt(7)
    s_mov_b32 s21, 32768
    s_add_u32 m0, s23, 8192
    s_nop 0
    buffer_load_dwordx4 v9, s[4:7], s21 offen nt lds
    s_waitcnt vmcnt(7)
    s_mov_b32 s21, 36864
    s_add_u32 m0, s23, 9216
    s_nop 0
    buffer_load_dwordx4 v9, s[4:7], s21 offen nt lds
    s_waitcnt vmcnt(7)
    s_mov_b32 s21, 40960
    s_add_u32 m0, s23, 10240
    s_nop 0
    buffer_load_dwordx4 v9, s[4:7], s21 offen nt lds
    s_waitcnt vmcnt(7)
    s_mov_b32 s21, 45056
    s_add_u32 m0, s23, 11264
    s_nop 0
    buffer_load_dwordx4 v9, s[4:7], s21 offen nt lds
    s_waitcnt lgkmcnt(0)
    s_waitcnt vmcnt(4)
    s_barrier
    ds_read_b128 v[72:75], v5 offset:0
    ds_read_b128 v[76:79], v6 offset:0
    ds_read_b128 v[80:83], v7 offset:0
    ds_read_b128 v[84:87], v8 offset:0
    s_waitcnt lgkmcnt(3)
    v_mfma_f32_16x16x32_bf16 v[184:187], v[72:75], a[0:3], v[252:255]
    s_waitcnt lgkmcnt(2)
    v_mfma_f32_16x16x32_bf16 v[184:187], v[76:79], a[4:7], v[184:187]
    s_waitcnt lgkmcnt(1)
    ds_read_b128 v[88:91], v5 offset:1024
    v_mfma_f32_16x16x32_bf16 v[184:187], v[80:83], a[8:11], v[184:187]
    s_waitcnt lgkmcnt(1)
    ds_read_b128 v[92:95], v6 offset:1024
    v_mfma_f32_16x16x32_bf16 v[184:187], v[84:87], a[12:15], v[184:187]
    ds_read_b128 v[96:99], v7 offset:1024
    ds_read_b128 v[100:103], v8 offset:1024
    s_xor_b32 s27, s56, 8192
    buffer_load_dwordx4 a[32:35], v30, s[12:15], s27 offen offset:0 nt
    v_mfma_f32_16x16x32_bf16 v[188:191], v[72:75], a[16:19], v[252:255]
    v_mfma_f32_16x16x32_bf16 v[188:191], v[76:79], a[20:23], v[188:191]
    v_mfma_f32_16x16x32_bf16 v[188:191], v[80:83], a[24:27], v[188:191]
    v_mfma_f32_16x16x32_bf16 v[188:191], v[84:87], a[28:31], v[188:191]
    s_waitcnt lgkmcnt(3)
    v_mfma_f32_16x16x32_bf16 v[64:67], v[88:91], a[0:3], v[252:255]
    s_waitcnt lgkmcnt(2)
    v_exp_f32 v184, v184
    v_mfma_f32_16x16x32_bf16 v[64:67], v[92:95], a[4:7], v[64:67]
    s_waitcnt lgkmcnt(1)
    v_exp_f32 v185, v185
    ds_read_b128 v[72:75], v5 offset:2048
    v_mfma_f32_16x16x32_bf16 v[64:67], v[96:99], a[8:11], v[64:67]
    s_waitcnt lgkmcnt(1)
    v_exp_f32 v186, v186
    ds_read_b128 v[76:79], v6 offset:2048
    v_mfma_f32_16x16x32_bf16 v[64:67], v[100:103], a[12:15], v[64:67]
    v_exp_f32 v187, v187
    ds_read_b128 v[80:83], v7 offset:2048
    ds_read_b128 v[84:87], v8 offset:2048
    buffer_load_dwordx4 a[36:39], v30, s[12:15], s27 offen offset:64 nt
    v_mfma_f32_16x16x32_bf16 v[68:71], v[88:91], a[16:19], v[252:255]
    v_exp_f32 v188, v188
    v_mfma_f32_16x16x32_bf16 v[68:71], v[92:95], a[20:23], v[68:71]
    v_exp_f32 v189, v189
    v_perm_b32 v108, v188, v184, s49
    v_mfma_f32_16x16x32_bf16 v[68:71], v[96:99], a[24:27], v[68:71]
    ds_write_addtid_b32 v108 offset:3072
    v_exp_f32 v190, v190
    v_perm_b32 v109, v189, v185, s49
    v_mfma_f32_16x16x32_bf16 v[68:71], v[100:103], a[28:31], v[68:71]
    ds_write_addtid_b32 v109 offset:9248
    v_exp_f32 v191, v191
    v_perm_b32 v110, v190, v186, s49
    s_waitcnt lgkmcnt(5)
    ds_write_addtid_b32 v110 offset:15488
    v_perm_b32 v111, v191, v187, s49
    v_mfma_f32_16x16x32_bf16 v[184:187], v[72:75], a[0:3], v[252:255]
    s_waitcnt lgkmcnt(5)
    ds_write_addtid_b32 v111 offset:21664
    ds_read_b128 v[104:107], v0 offset:0
    v_exp_f32 v64, v64
    v_mfma_f32_16x16x32_bf16 v[184:187], v[76:79], a[4:7], v[184:187]
    s_waitcnt lgkmcnt(6)
    v_exp_f32 v65, v65
    ds_read_b128 v[88:91], v5 offset:3072
    v_mfma_f32_16x16x32_bf16 v[184:187], v[80:83], a[8:11], v[184:187]
    s_waitcnt lgkmcnt(6)
    v_exp_f32 v66, v66
    ds_read_b128 v[92:95], v6 offset:3072
    v_mfma_f32_16x16x32_bf16 v[184:187], v[84:87], a[12:15], v[184:187]
    v_exp_f32 v67, v67
    ds_read_b128 v[96:99], v7 offset:3072
    ds_read_b128 v[100:103], v8 offset:3072
    buffer_load_dwordx4 a[40:43], v30, s[12:15], s27 offen offset:128 nt
    v_mfma_f32_16x16x32_bf16 v[188:191], v[72:75], a[16:19], v[252:255]
    v_exp_f32 v68, v68
    v_mfma_f32_16x16x32_bf16 v[188:191], v[76:79], a[20:23], v[188:191]
    v_exp_f32 v69, v69
    v_perm_b32 v108, v68, v64, s49
    v_mfma_f32_16x16x32_bf16 v[188:191], v[80:83], a[24:27], v[188:191]
    ds_write_addtid_b32 v108 offset:3328
    v_exp_f32 v70, v70
    v_perm_b32 v109, v69, v65, s49
    v_mfma_f32_16x16x32_bf16 v[188:191], v[84:87], a[28:31], v[188:191]
    s_waitcnt lgkmcnt(5)
    ds_write_addtid_b32 v109 offset:9504
    v_exp_f32 v71, v71
    v_perm_b32 v110, v70, v66, s49
    v_mfma_f32_16x16x32_bf16 v[40:43], v[32:35], v[104:107], 0
    s_waitcnt lgkmcnt(5)
    ds_write_addtid_b32 v110 offset:15744
    v_perm_b32 v111, v71, v67, s49
    v_mfma_f32_16x16x32_bf16 v[64:67], v[88:91], a[0:3], v[252:255]
    s_waitcnt lgkmcnt(5)
    ds_write_addtid_b32 v111 offset:21920
    ds_read_b128 v[104:107], v0 offset:256
    v_exp_f32 v184, v184
    v_mfma_f32_16x16x32_bf16 v[64:67], v[92:95], a[4:7], v[64:67]
    s_waitcnt lgkmcnt(6)
    v_exp_f32 v185, v185
    ds_read_b128 v[72:75], v5 offset:4096
    v_mfma_f32_16x16x32_bf16 v[64:67], v[96:99], a[8:11], v[64:67]
    s_waitcnt lgkmcnt(6)
    v_exp_f32 v186, v186
    ds_read_b128 v[76:79], v6 offset:4096
    v_mfma_f32_16x16x32_bf16 v[64:67], v[100:103], a[12:15], v[64:67]
    v_exp_f32 v187, v187
    ds_read_b128 v[80:83], v7 offset:4096
    ds_read_b128 v[84:87], v8 offset:4096
    v_mfma_f32_16x16x32_bf16 v[68:71], v[88:91], a[16:19], v[252:255]
    v_exp_f32 v188, v188
    v_mfma_f32_16x16x32_bf16 v[68:71], v[92:95], a[20:23], v[68:71]
    v_exp_f32 v189, v189
    v_perm_b32 v108, v188, v184, s49
    v_mfma_f32_16x16x32_bf16 v[68:71], v[96:99], a[24:27], v[68:71]
    ds_write_addtid_b32 v108 offset:3584
    v_exp_f32 v190, v190
    v_perm_b32 v109, v189, v185, s49
    v_mfma_f32_16x16x32_bf16 v[68:71], v[100:103], a[28:31], v[68:71]
    s_waitcnt lgkmcnt(5)
    ds_write_addtid_b32 v109 offset:9760
    v_exp_f32 v191, v191
    v_perm_b32 v110, v190, v186, s49
    v_mfma_f32_16x16x32_bf16 v[40:43], v[36:39], v[104:107], v[40:43]
    s_waitcnt lgkmcnt(5)
    ds_write_addtid_b32 v110 offset:16000
    v_perm_b32 v111, v191, v187, s49
    buffer_load_dwordx4 a[44:47], v30, s[12:15], s27 offen offset:192 nt
    v_mfma_f32_16x16x32_bf16 v[184:187], v[72:75], a[0:3], v[252:255]
    s_waitcnt lgkmcnt(5)
    ds_write_addtid_b32 v111 offset:22176
    ds_read_b128 v[104:107], v0 offset:512
    v_exp_f32 v64, v64
    v_mfma_f32_16x16x32_bf16 v[184:187], v[76:79], a[4:7], v[184:187]
    s_waitcnt lgkmcnt(6)
    v_exp_f32 v65, v65
    ds_read_b128 v[88:91], v5 offset:5120
    v_mfma_f32_16x16x32_bf16 v[184:187], v[80:83], a[8:11], v[184:187]
    s_waitcnt lgkmcnt(6)
    v_exp_f32 v66, v66
    ds_read_b128 v[92:95], v6 offset:5120
    v_mfma_f32_16x16x32_bf16 v[184:187], v[84:87], a[12:15], v[184:187]
    v_exp_f32 v67, v67
    ds_read_b128 v[96:99], v7 offset:5120
    ds_read_b128 v[100:103], v8 offset:5120
    v_mfma_f32_16x16x32_bf16 v[188:191], v[72:75], a[16:19], v[252:255]
    v_exp_f32 v68, v68
    v_mfma_f32_16x16x32_bf16 v[188:191], v[76:79], a[20:23], v[188:191]
    v_exp_f32 v69, v69
    v_perm_b32 v108, v68, v64, s49
    v_mfma_f32_16x16x32_bf16 v[188:191], v[80:83], a[24:27], v[188:191]
    ds_write_addtid_b32 v108 offset:3840
    v_exp_f32 v70, v70
    v_perm_b32 v109, v69, v65, s49
    v_mfma_f32_16x16x32_bf16 v[188:191], v[84:87], a[28:31], v[188:191]
    s_waitcnt lgkmcnt(5)
    ds_write_addtid_b32 v109 offset:10016
    v_exp_f32 v71, v71
    v_perm_b32 v110, v70, v66, s49
    v_mfma_f32_16x16x32_bf16 v[44:47], v[32:35], v[104:107], 0
    s_waitcnt lgkmcnt(5)
    ds_write_addtid_b32 v110 offset:16256
    v_perm_b32 v111, v71, v67, s49
    s_xor_b32 s27, s56, 8448
    buffer_load_dwordx4 a[48:51], v30, s[12:15], s27 offen offset:0 nt
    v_mfma_f32_16x16x32_bf16 v[64:67], v[88:91], a[0:3], v[252:255]
    s_waitcnt lgkmcnt(5)
    ds_write_addtid_b32 v111 offset:22432
    ds_read_b128 v[104:107], v0 offset:768
    v_exp_f32 v184, v184
    v_mfma_f32_16x16x32_bf16 v[64:67], v[92:95], a[4:7], v[64:67]
    s_waitcnt lgkmcnt(6)
    v_exp_f32 v185, v185
    ds_read_b128 v[72:75], v5 offset:6144
    v_mfma_f32_16x16x32_bf16 v[64:67], v[96:99], a[8:11], v[64:67]
    s_waitcnt lgkmcnt(6)
    v_exp_f32 v186, v186
    ds_read_b128 v[76:79], v6 offset:6144
    v_mfma_f32_16x16x32_bf16 v[64:67], v[100:103], a[12:15], v[64:67]
    v_exp_f32 v187, v187
    ds_read_b128 v[80:83], v7 offset:6144
    ds_read_b128 v[84:87], v8 offset:6144
    v_mfma_f32_16x16x32_bf16 v[68:71], v[88:91], a[16:19], v[252:255]
    v_exp_f32 v188, v188
    v_mfma_f32_16x16x32_bf16 v[68:71], v[92:95], a[20:23], v[68:71]
    v_exp_f32 v189, v189
    v_perm_b32 v108, v188, v184, s49
    v_mfma_f32_16x16x32_bf16 v[68:71], v[96:99], a[24:27], v[68:71]
    ds_write_addtid_b32 v108 offset:4096
    v_exp_f32 v190, v190
    v_perm_b32 v109, v189, v185, s49
    v_mfma_f32_16x16x32_bf16 v[68:71], v[100:103], a[28:31], v[68:71]
    s_waitcnt lgkmcnt(5)
    ds_write_addtid_b32 v109 offset:10272
    v_exp_f32 v191, v191
    v_perm_b32 v110, v190, v186, s49
    v_mfma_f32_16x16x32_bf16 v[44:47], v[36:39], v[104:107], v[44:47]
    s_waitcnt vmcnt(5) lgkmcnt(5)
    ds_write_addtid_b32 v110 offset:16512
    v_perm_b32 v111, v191, v187, s49
    ds_add_u32 v14, v16
    s_add_u32 s24, s24, 1
    v_mfma_f32_16x16x32_bf16 v[184:187], v[72:75], a[0:3], v[252:255]
    s_waitcnt lgkmcnt(6)
    ds_write_addtid_b32 v111 offset:22688
    ds_read_b128 v[104:107], v0 offset:1024
    v_exp_f32 v64, v64
    v_mfma_f32_16x16x32_bf16 v[184:187], v[76:79], a[4:7], v[184:187]
    s_waitcnt lgkmcnt(7)
    v_exp_f32 v65, v65
    ds_read_b128 v[88:91], v5 offset:7168
    v_mfma_f32_16x16x32_bf16 v[184:187], v[80:83], a[8:11], v[184:187]
    s_waitcnt lgkmcnt(7)
    v_exp_f32 v66, v66
    ds_read_b128 v[92:95], v6 offset:7168
    v_mfma_f32_16x16x32_bf16 v[184:187], v[84:87], a[12:15], v[184:187]
    v_exp_f32 v67, v67
    ds_read_b128 v[96:99], v7 offset:7168
    ds_read_b32 v19, v15
    ds_read_b128 v[100:103], v8 offset:7168
    buffer_load_dwordx4 a[52:55], v30, s[12:15], s27 offen offset:64 nt
    v_mfma_f32_16x16x32_bf16 v[188:191], v[72:75], a[16:19], v[252:255]
    v_exp_f32 v68, v68
    v_mfma_f32_16x16x32_bf16 v[188:191], v[76:79], a[20:23], v[188:191]
    v_exp_f32 v69, v69
    v_perm_b32 v108, v68, v64, s49
    v_mfma_f32_16x16x32_bf16 v[188:191], v[80:83], a[24:27], v[188:191]
    s_waitcnt lgkmcnt(1)
    ds_write_addtid_b32 v108 offset:4352
    v_exp_f32 v70, v70
    v_perm_b32 v109, v69, v65, s49
    v_cmp_gt_u32 vcc, s24, v19
    v_mfma_f32_16x16x32_bf16 v[188:191], v[84:87], a[28:31], v[188:191]
    ds_write_addtid_b32 v109 offset:10528
    v_exp_f32 v71, v71
    v_perm_b32 v110, v70, v66, s49
    v_mfma_f32_16x16x32_bf16 v[48:51], v[32:35], v[104:107], 0
    ds_write_addtid_b32 v110 offset:16768
    v_perm_b32 v111, v71, v67, s49
    s_cbranch_vccnz L_retry97
L_back97:
    v_mfma_f32_16x16x32_bf16 v[64:67], v[88:91], a[0:3], v[252:255]
    ds_write_addtid_b32 v111 offset:22944
    ds_read_b128 v[104:107], v0 offset:1280
    v_exp_f32 v184, v184
    v_mfma_f32_16x16x32_bf16 v[64:67], v[92:95], a[4:7], v[64:67]
    v_exp_f32 v185, v185
    ds_read_b128 v[72:75], v5 offset:8192
    v_mfma_f32_16x16x32_bf16 v[64:67], v[96:99], a[8:11], v[64:67]
    s_waitcnt lgkmcnt(6)
    v_exp_f32 v186, v186
    ds_read_b128 v[76:79], v6 offset:8192
    v_mfma_f32_16x16x32_bf16 v[64:67], v[100:103], a[12:15], v[64:67]
    v_exp_f32 v187, v187
    ds_read_b128 v[80:83], v7 offset:8192
    ds_read_b128 v[84:87], v8 offset:8192
    buffer_load_dwordx4 a[56:59], v30, s[12:15], s27 offen offset:128 nt
    v_mfma_f32_16x16x32_bf16 v[68:71], v[88:91], a[16:19], v[252:255]
    v_exp_f32 v188, v188
    v_mfma_f32_16x16x32_bf16 v[68:71], v[92:95], a[20:23], v[68:71]
    v_exp_f32 v189, v189
    v_perm_b32 v108, v188, v184, s49
    v_mfma_f32_16x16x32_bf16 v[68:71], v[96:99], a[24:27], v[68:71]
    ds_write_addtid_b32 v108 offset:4608
    v_exp_f32 v190, v190
    v_perm_b32 v109, v189, v185, s49
    v_mfma_f32_16x16x32_bf16 v[68:71], v[100:103], a[28:31], v[68:71]
    s_waitcnt lgkmcnt(5)
    ds_write_addtid_b32 v109 offset:10784
    v_exp_f32 v191, v191
    v_perm_b32 v110, v190, v186, s49
    v_mfma_f32_16x16x32_bf16 v[48:51], v[36:39], v[104:107], v[48:51]
    s_waitcnt lgkmcnt(5)
    ds_write_addtid_b32 v110 offset:17024
    v_perm_b32 v111, v191, v187, s49
    v_mfma_f32_16x16x32_bf16 v[184:187], v[72:75], a[0:3], v[252:255]
    s_waitcnt lgkmcnt(5)
    ds_write_addtid_b32 v111 offset:23200
    ds_read_b128 v[104:107], v0 offset:1536
    v_exp_f32 v64, v64
    v_mfma_f32_16x16x32_bf16 v[184:187], v[76:79], a[4:7], v[184:187]
    s_waitcnt lgkmcnt(6)
    v_exp_f32 v65, v65
    ds_read_b128 v[88:91], v5 offset:9216
    v_mfma_f32_16x16x32_bf16 v[184:187], v[80:83], a[8:11], v[184:187]
    s_waitcnt lgkmcnt(6)
    v_exp_f32 v66, v66
    ds_read_b128 v[92:95], v6 offset:9216
    v_mfma_f32_16x16x32_bf16 v[184:187], v[84:87], a[12:15], v[184:187]
    v_exp_f32 v67, v67
    ds_read_b128 v[96:99], v7 offset:9216
    ds_read_b128 v[100:103], v8 offset:9216
    buffer_load_dwordx4 a[60:63], v30, s[12:15], s27 offen offset:192 nt
    v_mfma_f32_16x16x32_bf16 v[188:191], v[72:75], a[16:19], v[252:255]
    v_exp_f32 v68, v68
    v_mfma_f32_16x16x32_bf16 v[188:191], v[76:79], a[20:23], v[188:191]
    v_exp_f32 v69, v69
    v_perm_b32 v108, v68, v64, s49
    v_mfma_f32_16x16x32_bf16 v[188:191], v[80:83], a[24:27], v[188:191]
    ds_write_addtid_b32 v108 offset:4864
    v_exp_f32 v70, v70
    v_perm_b32 v109, v69, v65, s49
    v_mfma_f32_16x16x32_bf16 v[188:191], v[84:87], a[28:31], v[188:191]
    s_waitcnt lgkmcnt(5)
    ds_write_addtid_b32 v109 offset:11040
    v_exp_f32 v71, v71
    v_perm_b32 v110, v70, v66, s49
    v_mfma_f32_16x16x32_bf16 v[52:55], v[32:35], v[104:107], 0
    s_waitcnt lgkmcnt(5)
    ds_write_addtid_b32 v110 offset:17280
    v_perm_b32 v111, v71, v67, s49
    v_mfma_f32_16x16x32_bf16 v[64:67], v[88:91], a[0:3], v[252:255]
    s_waitcnt lgkmcnt(5)
    ds_write_addtid_b32 v111 offset:23456
    ds_read_b128 v[104:107], v0 offset:1792
    v_exp_f32 v184, v184
    v_mfma_f32_16x16x32_bf16 v[64:67], v[92:95], a[4:7], v[64:67]
    s_waitcnt lgkmcnt(6)
    v_exp_f32 v185, v185
    ds_read_b128 v[72:75], v5 offset:10240
    v_mfma_f32_16x16x32_bf16 v[64:67], v[96:99], a[8:11], v[64:67]
    s_waitcnt lgkmcnt(6)
    v_exp_f32 v186, v186
    ds_read_b128 v[76:79], v6 offset:10240
    v_mfma_f32_16x16x32_bf16 v[64:67], v[100:103], a[12:15], v[64:67]
    v_exp_f32 v187, v187
    ds_read_b128 v[80:83], v7 offset:10240
    ds_read_b128 v[84:87], v8 offset:10240
    v_mfma_f32_16x16x32_bf16 v[68:71], v[88:91], a[16:19], v[252:255]
    v_exp_f32 v188, v188
    v_mfma_f32_16x16x32_bf16 v[68:71], v[92:95], a[20:23], v[68:71]
    v_exp_f32 v189, v189
    v_perm_b32 v108, v188, v184, s49
    v_mfma_f32_16x16x32_bf16 v[68:71], v[96:99], a[24:27], v[68:71]
    ds_write_addtid_b32 v108 offset:5120
    v_exp_f32 v190, v190
    v_perm_b32 v109, v189, v185, s49
L_pad0:
    s_cbranch_execz L_pad4
    v_mfma_f32_16x16x32_bf16 v[68:71], v[100:103], a[28:31], v[68:71]
    s_waitcnt lgkmcnt(5)
    ds_write_addtid_b32 v109 offset:11296
    v_exp_f32 v191, v191
    v_perm_b32 v110, v190, v186, s49
    v_mfma_f32_16x16x32_bf16 v[52:55], v[36:39], v[104:107], v[52:55]
    s_waitcnt lgkmcnt(5)
    ds_write_addtid_b32 v110 offset:17536
    v_perm_b32 v111, v191, v187, s49
    ds_add_u32 v14, v16
    s_add_u32 s24, s24, 1
    s_xor_b32 s27, s56, 0
    s_xor_b32 s26, s56, 4096
    buffer_load_dwordx4 a[128:131], v31, s[16:19], s27 offen
    v_mfma_f32_16x16x32_bf16 v[184:187], v[72:75], a[0:3], v[252:255]
    s_waitcnt lgkmcnt(6)
    ds_write_addtid_b32 v111 offset:23712
    ds_read_b128 v[104:107], v0 offset:2048
    v_exp_f32 v64, v64
    v_mfma_f32_16x16x32_bf16 v[184:187], v[76:79], a[4:7], v[184:187]
    s_waitcnt lgkmcnt(7)
    v_exp_f32 v65, v65
    ds_read_b128 v[88:91], v5 offset:11264
    ds_read_b128 v[168:171], v0 offset:0
    v_mfma_f32_16x16x32_bf16 v[184:187], v[80:83], a[8:11], v[184:187]
    s_waitcnt lgkmcnt(8)
    v_exp_f32 v66, v66
    ds_read_b128 v[92:95], v6 offset:11264
    v_mfma_f32_16x16x32_bf16 v[184:187], v[84:87], a[12:15], v[184:187]
    v_exp_f32 v67, v67
    ds_read_b128 v[96:99], v7 offset:11264
    ds_read_b128 v[100:103], v8 offset:11264
    v_mfma_f32_16x16x32_bf16 v[188:191], v[72:75], a[16:19], v[252:255]
    v_exp_f32 v68, v68
    v_mfma_f32_16x16x32_bf16 v[188:191], v[76:79], a[20:23], v[188:191]
    v_exp_f32 v69, v69
    v_perm_b32 v108, v68, v64, s49
    ds_read_b128 v[172:175], v0 offset:256
    v_mfma_f32_16x16x32_bf16 v[188:191], v[80:83], a[24:27], v[188:191]
    ds_write_addtid_b32 v108 offset:5376
    v_exp_f32 v70, v70
    v_perm_b32 v109, v69, v65, s49
    v_mfma_f32_16x16x32_bf16 v[188:191], v[84:87], a[28:31], v[188:191]
    s_waitcnt lgkmcnt(7)
    ds_write_addtid_b32 v109 offset:11552
    v_exp_f32 v71, v71
    v_perm_b32 v110, v70, v66, s49
    v_mfma_f32_16x16x32_bf16 v[56:59], v[32:35], v[104:107], 0
    s_waitcnt lgkmcnt(7)
    ds_write_addtid_b32 v110 offset:17792
    v_perm_b32 v111, v71, v67, s49
    buffer_load_dwordx4 a[132:135], v31, s[16:19], s26 offen
    v_mfma_f32_16x16x32_bf16 v[64:67], v[88:91], a[0:3], v[252:255]
    s_waitcnt lgkmcnt(6)
    ds_write_addtid_b32 v111 offset:23968
    ds_read_b128 v[104:107], v0 offset:2304
    v_exp_f32 v184, v184
    v_mfma_f32_16x16x32_bf16 v[64:67], v[92:95], a[4:7], v[64:67]
    s_waitcnt lgkmcnt(7)
    v_exp_f32 v185, v185
    ds_read_b128 v[72:75], v5 offset:0
    ds_read_b128 v[176:179], v0 offset:512
    v_mfma_f32_16x16x32_bf16 v[64:67], v[96:99], a[8:11], v[64:67]
    s_waitcnt lgkmcnt(8)
    v_exp_f32 v186, v186
    ds_read_b128 v[76:79], v6 offset:0
    v_mfma_f32_16x16x32_bf16 v[64:67], v[100:103], a[12:15], v[64:67]
    v_exp_f32 v187, v187
    ds_read_b128 v[80:83], v7 offset:0
    ds_read_b128 v[84:87], v8 offset:0
    v_mfma_f32_16x16x32_bf16 v[68:71], v[88:91], a[16:19], v[252:255]
    v_exp_f32 v188, v188
    v_mfma_f32_16x16x32_bf16 v[68:71], v[92:95], a[20:23], v[68:71]
    v_exp_f32 v189, v189
    v_perm_b32 v108, v188, v184, s49
    ds_read_b128 v[180:183], v0 offset:768
    v_mfma_f32_16x16x32_bf16 v[68:71], v[96:99], a[24:27], v[68:71]
    ds_write_addtid_b32 v108 offset:5632
    v_exp_f32 v190, v190
    v_perm_b32 v109, v189, v185, s49
    v_mfma_f32_16x16x32_bf16 v[68:71], v[100:103], a[28:31], v[68:71]
    s_waitcnt lgkmcnt(7)
    ds_write_addtid_b32 v109 offset:11808
    v_exp_f32 v191, v191
    v_perm_b32 v110, v190, v186, s49
    v_mfma_f32_16x16x32_bf16 v[56:59], v[36:39], v[104:107], v[56:59]
    ds_write_addtid_b32 v110 offset:18048
    v_perm_b32 v111, v191, v187, s49
    ds_read_b32 v19, v15
    ds_write_addtid_b32 v111 offset:24224
    ds_read_b128 v[104:107], v0 offset:2560
    v_exp_f32 v64, v64
    v_exp_f32 v65, v65
    v_exp_f32 v66, v66
    v_exp_f32 v67, v67
    v_exp_f32 v68, v68
    s_nop 0
    v_perm_b32 v108, v68, v64, s49
    s_waitcnt lgkmcnt(2)
    ds_write_addtid_b32 v108 offset:5888
    v_cmp_gt_u32 vcc, s24, v19
    s_waitcnt lgkmcnt(1)
    v_mfma_f32_16x16x32_bf16 v[60:63], v[32:35], v[104:107], 0
    s_cbranch_vccnz L_retry99
L_back99:
    s_waitcnt vmcnt(9)
    v_mfma_f32_16x16x32_bf16 v[184:187], v[22:25], a[32:35], 0
    v_mfma_f32_16x16x32_bf16 v[184:187], v[26:29], a[32:35], v[184:187]
    s_xor_b32 s27, s57, 0
    s_xor_b32 s26, s57, 4096
    buffer_load_dwordx4 a[160:163], v31, s[16:19], s27 offen
    v_mfma_f32_16x16x32_bf16 v[188:191], v[20:23], a[32:35], 0
    v_mfma_f32_16x16x32_bf16 v[188:191], v[24:27], a[32:35], v[188:191]
    s_waitcnt vmcnt(9)
    v_mfma_f32_16x16x32_bf16 v[192:195], v[22:25], a[36:39], 0
    v_cvt_pk_bf16_f32 v184, v184, v185
    v_cvt_pk_bf16_f32 v186, v186, v187
    v_mfma_f32_16x16x32_bf16 v[192:195], v[26:29], a[36:39], v[192:195]
    buffer_load_dwordx4 a[164:167], v31, s[16:19], s26 offen
    v_accvgpr_write_b32 a32, v184
    v_accvgpr_write_b32 a33, v186
    v_mfma_f32_16x16x32_bf16 v[196:199], v[20:23], a[36:39], 0
    v_cvt_pk_bf16_f32 v188, v188, v189
    v_cvt_pk_bf16_f32 v190, v190, v191
    v_mfma_f32_16x16x32_bf16 v[196:199], v[24:27], a[36:39], v[196:199]
    v_accvgpr_write_b32 a34, v188
    v_accvgpr_write_b32 a35, v190
    s_waitcnt vmcnt(9)
    v_mfma_f32_16x16x32_bf16 v[184:187], v[22:25], a[40:43], 0
    v_cvt_pk_bf16_f32 v192, v192, v193
    v_cvt_pk_bf16_f32 v194, v194, v195
    v_mfma_f32_16x16x32_bf16 v[184:187], v[26:29], a[40:43], v[184:187]
    s_xor_b32 s27, s58, 0
    s_xor_b32 s26, s58, 4096
    buffer_load_dwordx4 a[192:195], v31, s[16:19], s27 offen
    v_accvgpr_write_b32 a36, v192
    v_accvgpr_write_b32 a37, v194
    v_mfma_f32_16x16x32_bf16 v[188:191], v[20:23], a[40:43], 0
    v_cvt_pk_bf16_f32 v196, v196, v197
    v_cvt_pk_bf16_f32 v198, v198, v199
    v_mfma_f32_16x16x32_bf16 v[188:191], v[24:27], a[40:43], v[188:191]
    v_accvgpr_write_b32 a38, v196
    v_accvgpr_write_b32 a39, v198
    s_waitcnt vmcnt(9)
    v_mfma_f32_16x16x32_bf16 v[192:195], v[22:25], a[44:47], 0
    v_cvt_pk_bf16_f32 v184, v184, v185
    v_cvt_pk_bf16_f32 v186, v186, v187
    v_mfma_f32_16x16x32_bf16 v[192:195], v[26:29], a[44:47], v[192:195]
    buffer_load_dwordx4 a[196:199], v31, s[16:19], s26 offen
    v_accvgpr_write_b32 a40, v184
    v_accvgpr_write_b32 a41, v186
    v_mfma_f32_16x16x32_bf16 v[196:199], v[20:23], a[44:47], 0
    v_cvt_pk_bf16_f32 v188, v188, v189
    v_cvt_pk_bf16_f32 v190, v190, v191
    v_mfma_f32_16x16x32_bf16 v[196:199], v[24:27], a[44:47], v[196:199]
    v_accvgpr_write_b32 a42, v188
    v_accvgpr_write_b32 a43, v190
    s_waitcnt vmcnt(9)
    v_mfma_f32_16x16x32_bf16 v[184:187], v[22:25], a[48:51], 0
    v_cvt_pk_bf16_f32 v192, v192, v193
    v_cvt_pk_bf16_f32 v194, v194, v195
    v_mfma_f32_16x16x32_bf16 v[184:187], v[26:29], a[48:51], v[184:187]
    s_xor_b32 s27, s59, 0
    s_xor_b32 s26, s59, 4096
    buffer_load_dwordx4 a[224:227], v31, s[16:19], s27 offen
    v_accvgpr_write_b32 a44, v192
    v_accvgpr_write_b32 a45, v194
    v_mfma_f32_16x16x32_bf16 v[188:191], v[20:23], a[48:51], 0
    v_cvt_pk_bf16_f32 v196, v196, v197
    v_cvt_pk_bf16_f32 v198, v198, v199
    v_mfma_f32_16x16x32_bf16 v[188:191], v[24:27], a[48:51], v[188:191]
    v_accvgpr_write_b32 a46, v196
    v_accvgpr_write_b32 a47, v198
    s_waitcnt vmcnt(9)
    v_mfma_f32_16x16x32_bf16 v[192:195], v[22:25], a[52:55], 0
    v_cvt_pk_bf16_f32 v184, v184, v185
    v_cvt_pk_bf16_f32 v186, v186, v187
    v_mfma_f32_16x16x32_bf16 v[192:195], v[26:29], a[52:55], v[192:195]
    buffer_load_dwordx4 a[228:231], v31, s[16:19], s26 offen
    v_accvgpr_write_b32 a48, v184
    v_accvgpr_write_b32 a49, v186
    v_mfma_f32_16x16x32_bf16 v[196:199], v[20:23], a[52:55], 0
    v_cvt_pk_bf16_f32 v188, v188, v189
    v_cvt_pk_bf16_f32 v190, v190, v191
    v_mfma_f32_16x16x32_bf16 v[196:199], v[24:27], a[52:55], v[196:199]
    v_accvgpr_write_b32 a50, v188
    v_accvgpr_write_b32 a51, v190
    s_waitcnt vmcnt(9)
    v_mfma_f32_16x16x32_bf16 v[184:187], v[22:25], a[56:59], 0
    v_cvt_pk_bf16_f32 v192, v192, v193
    v_cvt_pk_bf16_f32 v194, v194, v195
    v_mfma_f32_16x16x32_bf16 v[184:187], v[26:29], a[56:59], v[184:187]
    v_accvgpr_write_b32 a52, v192
    v_accvgpr_write_b32 a53, v194
    v_mfma_f32_16x16x32_bf16 v[188:191], v[20:23], a[56:59], 0
    v_cvt_pk_bf16_f32 v196, v196, v197
    v_cvt_pk_bf16_f32 v198, v198, v199
    v_mfma_f32_16x16x32_bf16 v[188:191], v[24:27], a[56:59], v[188:191]
    v_accvgpr_write_b32 a54, v196
    v_accvgpr_write_b32 a55, v198
    s_waitcnt vmcnt(8)
    v_mfma_f32_16x16x32_bf16 v[192:195], v[22:25], a[60:63], 0
    v_cvt_pk_bf16_f32 v184, v184, v185
    v_cvt_pk_bf16_f32 v186, v186, v187
    s_waitcnt vmcnt(7)
    ds_write_b128 v1, a[128:131] offset:3072
    v_mfma_f32_16x16x32_bf16 v[192:195], v[26:29], a[60:63], v[192:195]
    v_accvgpr_write_b32 a56, v184
    v_accvgpr_write_b32 a57, v186
    s_waitcnt vmcnt(6)
    ds_write_b128 v1, a[132:135] offset:15488
    v_mfma_f32_16x16x32_bf16 v[196:199], v[20:23], a[60:63], 0
    v_cvt_pk_bf16_f32 v188, v188, v189
    v_cvt_pk_bf16_f32 v190, v190, v191
    ds_read_b64_tr_b16 a[128:129], v1 offset:3072
    ds_read_b64_tr_b16 a[130:131], v1 offset:15488
    v_mfma_f32_16x16x32_bf16 v[196:199], v[24:27], a[60:63], v[196:199]
    v_accvgpr_write_b32 a58, v188
    v_accvgpr_write_b32 a59, v190
    s_waitcnt vmcnt(5)
    ds_read_b64_tr_b16 a[132:133], v1 offset:3080
    ds_read_b64_tr_b16 a[134:135], v1 offset:15496
    v_cvt_pk_bf16_f32 v192, v192, v193
    v_cvt_pk_bf16_f32 v194, v194, v195
    v_accvgpr_write_b32 a60, v192
    v_accvgpr_write_b32 a61, v194
    v_cvt_pk_bf16_f32 v196, v196, v197
    v_cvt_pk_bf16_f32 v198, v198, v199
    v_accvgpr_write_b32 a62, v196
    v_accvgpr_write_b32 a63, v198
    v_mfma_f32_16x16x32_bf16 v[112:115], v[72:75], a[32:35], v[252:255]
    s_xor_b32 s27, s56, 16384
    ds_write_b128 v1, a[160:163] offset:3072
    v_exp_f32 v69, v69
    v_mfma_f32_16x16x32_bf16 v[112:115], v[76:79], a[36:39], v[112:115]
    ds_read_b128 v[184:187], v2 offset:0
    v_perm_b32 v109, v69, v65, s49
    v_mfma_f32_16x16x32_bf16 v[112:115], v[80:83], a[40:43], v[112:115]
    s_waitcnt vmcnt(4)
    ds_write_b128 v1, a[164:167] offset:15488
    v_exp_f32 v70, v70
    v_mfma_f32_16x16x32_bf16 v[112:115], v[84:87], a[44:47], v[112:115]
    s_waitcnt lgkmcnt(5)
    ds_write_addtid_b32 v109 offset:12064
    v_perm_b32 v110, v70, v66, s49
    v_mfma_f32_16x16x32_bf16 v[120:123], a[128:131], v[168:171], 0
    buffer_load_dwordx4 a[64:67], v30, s[12:15], s27 offen offset:0 nt
    buffer_load_dwordx4 a[68:71], v30, s[12:15], s27 offen offset:64 nt
    ds_read_b64_tr_b16 a[160:161], v1 offset:3072
    ds_read_b64_tr_b16 a[162:163], v1 offset:15488
    ds_read_b64_tr_b16 a[164:165], v1 offset:3080
    v_exp_f32 v71, v71
    v_mfma_f32_16x16x32_bf16 v[128:131], a[128:131], v[172:175], 0
    s_waitcnt lgkmcnt(7)
    ds_write_addtid_b32 v110 offset:18304
    v_perm_b32 v111, v71, v67, s49
    v_mfma_f32_16x16x32_bf16 v[124:127], a[132:135], v[168:171], 0
    v_exp_f32 v112, v112
    v_mfma_f32_16x16x32_bf16 v[132:135], a[132:135], v[172:175], 0
    ds_write_addtid_b32 v111 offset:24480
    ds_read_b128 v[104:107], v0 offset:2816
    v_mfma_f32_16x16x32_bf16 v[68:71], v[72:75], a[48:51], v[252:255]
    v_exp_f32 v113, v113
    v_mfma_f32_16x16x32_bf16 v[68:71], v[76:79], a[52:55], v[68:71]
    ds_read_b128 v[88:91], v5 offset:1024
    ds_read_b128 v[92:95], v6 offset:1024
    v_mfma_f32_16x16x32_bf16 v[68:71], v[80:83], a[56:59], v[68:71]
    v_exp_f32 v114, v114
    v_mfma_f32_16x16x32_bf16 v[68:71], v[84:87], a[60:63], v[68:71]
    ds_read_b128 v[96:99], v7 offset:1024
    ds_read_b128 v[100:103], v8 offset:1024
    v_mfma_f32_16x16x32_bf16 v[136:139], a[128:131], v[176:179], 0
    v_exp_f32 v115, v115
    v_mfma_f32_16x16x32_bf16 v[144:147], a[128:131], v[180:183], 0
    ds_read_b128 v[188:191], v2 offset:256
    ds_read_b64_tr_b16 a[166:167], v1 offset:15496
    v_mfma_f32_16x16x32_bf16 v[140:143], a[132:135], v[176:179], 0
    v_exp_f32 v68, v68
    v_mfma_f32_16x16x32_bf16 v[148:151], a[132:135], v[180:183], 0
    s_waitcnt lgkmcnt(6)
    ds_read_b128 v[192:195], v2 offset:512
    v_perm_b32 v108, v68, v112, s49
    v_mfma_f32_16x16x32_bf16 v[60:63], v[36:39], v[104:107], v[60:63]
    s_waitcnt lgkmcnt(6)
    ds_write_addtid_b32 v108 offset:6144
    ds_read_b128 v[196:199], v2 offset:768
    v_mfma_f32_16x16x32_bf16 v[64:67], v[88:91], a[32:35], v[252:255]
    s_waitcnt vmcnt(5) lgkmcnt(7)
    ds_write_b128 v1, a[192:195] offset:3072
    v_exp_f32 v69, v69
    v_mfma_f32_16x16x32_bf16 v[64:67], v[92:95], a[36:39], v[64:67]
    s_waitcnt lgkmcnt(7)
    ds_read_b128 v[168:171], v3 offset:0
    v_perm_b32 v109, v69, v113, s49
    v_mfma_f32_16x16x32_bf16 v[64:67], v[96:99], a[40:43], v[64:67]
    s_waitcnt vmcnt(4) lgkmcnt(7)
    ds_write_b128 v1, a[196:199] offset:15488
    v_exp_f32 v70, v70
    v_mfma_f32_16x16x32_bf16 v[64:67], v[100:103], a[44:47], v[64:67]
    ds_write_addtid_b32 v109 offset:12320
    v_perm_b32 v110, v70, v114, s49
    v_mfma_f32_16x16x32_bf16 v[120:123], a[160:163], v[184:187], v[120:123]
    s_waitcnt lgkmcnt(8)
    v_exp_f32 v71, v71
    v_mfma_f32_16x16x32_bf16 v[128:131], a[160:163], v[188:191], v[128:131]
    s_waitcnt lgkmcnt(7)
    ds_write_addtid_b32 v110 offset:18560
    v_perm_b32 v111, v71, v115, s49
    v_mfma_f32_16x16x32_bf16 v[124:127], a[164:167], v[184:187], v[124:127]
    v_exp_f32 v64, v64
    v_mfma_f32_16x16x32_bf16 v[132:135], a[164:167], v[188:191], v[132:135]
    ds_write_addtid_b32 v111 offset:24736
    ds_read_b128 v[104:107], v0 offset:3072
    v_mfma_f32_16x16x32_bf16 v[68:71], v[88:91], a[48:51], v[252:255]
    v_exp_f32 v65, v65
    v_mfma_f32_16x16x32_bf16 v[68:71], v[92:95], a[52:55], v[68:71]
    buffer_load_dwordx4 a[72:75], v30, s[12:15], s27 offen offset:128 nt
    buffer_load_dwordx4 a[76:79], v30, s[12:15], s27 offen offset:192 nt
    ds_read_b128 v[72:75], v5 offset:2048
    ds_read_b128 v[76:79], v6 offset:2048
    ds_read_b64_tr_b16 a[192:193], v1 offset:3072
    ds_read_b64_tr_b16 a[194:195], v1 offset:15488
    ds_read_b64_tr_b16 a[196:197], v1 offset:3080
    v_mfma_f32_16x16x32_bf16 v[68:71], v[96:99], a[56:59], v[68:71]
    v_exp_f32 v66, v66
    v_mfma_f32_16x16x32_bf16 v[68:71], v[100:103], a[60:63], v[68:71]
    s_waitcnt lgkmcnt(14)
    ds_read_b128 v[80:83], v7 offset:2048
    ds_read_b128 v[84:87], v8 offset:2048
    v_mfma_f32_16x16x32_bf16 v[136:139], a[160:163], v[192:195], v[136:139]
    s_waitcnt lgkmcnt(14)
    v_exp_f32 v67, v67
    v_mfma_f32_16x16x32_bf16 v[144:147], a[160:163], v[196:199], v[144:147]
    ds_read_b128 v[172:175], v3 offset:256
    ds_read_b64_tr_b16 a[198:199], v1 offset:15496
    v_mfma_f32_16x16x32_bf16 v[140:143], a[164:167], v[192:195], v[140:143]
    v_exp_f32 v68, v68
    v_mfma_f32_16x16x32_bf16 v[148:151], a[164:167], v[196:199], v[148:151]
    s_waitcnt lgkmcnt(9)
    ds_read_b128 v[176:179], v3 offset:512
    v_perm_b32 v108, v68, v64, s49
    v_mfma_f32_16x16x32_bf16 v[40:43], v[32:35], v[104:107], v[40:43]
    s_waitcnt vmcnt(5) lgkmcnt(8)
    ds_write_addtid_b32 v108 offset:6400
    ds_read_b128 v[180:183], v3 offset:768
    v_mfma_f32_16x16x32_bf16 v[112:115], v[72:75], a[32:35], v[252:255]
    s_xor_b32 s27, s56, 16640
    ds_write_b128 v1, a[224:227] offset:3072
    v_exp_f32 v69, v69
    v_mfma_f32_16x16x32_bf16 v[112:115], v[76:79], a[36:39], v[112:115]
    s_waitcnt lgkmcnt(7)
    ds_read_b128 v[184:187], v4 offset:0
    v_perm_b32 v109, v69, v65, s49
    v_mfma_f32_16x16x32_bf16 v[112:115], v[80:83], a[40:43], v[112:115]
    s_waitcnt vmcnt(4) lgkmcnt(7)
    ds_write_b128 v1, a[228:231] offset:15488
    v_exp_f32 v70, v70
    v_mfma_f32_16x16x32_bf16 v[112:115], v[84:87], a[44:47], v[112:115]
    ds_write_addtid_b32 v109 offset:12576
    v_perm_b32 v110, v70, v66, s49
    v_mfma_f32_16x16x32_bf16 v[120:123], a[192:195], v[168:171], v[120:123]
    s_waitcnt lgkmcnt(8)
    v_exp_f32 v71, v71
    v_mfma_f32_16x16x32_bf16 v[128:131], a[192:195], v[172:175], v[128:131]
    s_waitcnt lgkmcnt(7)
    ds_write_addtid_b32 v110 offset:18816
    v_perm_b32 v111, v71, v67, s49
    v_mfma_f32_16x16x32_bf16 v[124:127], a[196:199], v[168:171], v[124:127]
    v_exp_f32 v112, v112
    v_mfma_f32_16x16x32_bf16 v[132:135], a[196:199], v[172:175], v[132:135]
    ds_write_addtid_b32 v111 offset:24992
    ds_read_b128 v[104:107], v0 offset:3328
    v_mfma_f32_16x16x32_bf16 v[68:71], v[72:75], a[48:51], v[252:255]
    v_exp_f32 v113, v113
    v_mfma_f32_16x16x32_bf16 v[68:71], v[76:79], a[52:55], v[68:71]
    ds_read_b128 v[88:91], v5 offset:3072
    ds_read_b128 v[92:95], v6 offset:3072
    v_mfma_f32_16x16x32_bf16 v[68:71], v[80:83], a[56:59], v[68:71]
    v_exp_f32 v114, v114
    v_mfma_f32_16x16x32_bf16 v[68:71], v[84:87], a[60:63], v[68:71]
    s_waitcnt lgkmcnt(11)
    ds_read_b128 v[96:99], v7 offset:3072
    ds_read_b128 v[100:103], v8 offset:3072
    v_mfma_f32_16x16x32_bf16 v[136:139], a[192:195], v[176:179], v[136:139]
    s_waitcnt lgkmcnt(11)
    v_exp_f32 v115, v115
    v_mfma_f32_16x16x32_bf16 v[144:147], a[192:195], v[180:183], v[144:147]
    ds_read_b128 v[188:191], v4 offset:256
    ds_read_b64_tr_b16 a[224:225], v1 offset:3072
    v_mfma_f32_16x16x32_bf16 v[140:143], a[196:199], v[176:179], v[140:143]
    buffer_load_dwordx4 a[80:83], v30, s[12:15], s27 offen offset:0 nt
    buffer_load_dwordx4 a[84:87], v30, s[12:15], s27 offen offset:64 nt
    ds_read_b64_tr_b16 a[226:227], v1 offset:15488
    ds_read_b64_tr_b16 a[228:229], v1 offset:3080
    ds_read_b64_tr_b16 a[230:231], v1 offset:15496
    v_exp_f32 v68, v68
    v_mfma_f32_16x16x32_bf16 v[148:151], a[196:199], v[180:183], v[148:151]
    s_waitcnt lgkmcnt(9)
    ds_read_b128 v[192:195], v4 offset:512
    v_perm_b32 v108, v68, v112, s49
    v_mfma_f32_16x16x32_bf16 v[40:43], v[36:39], v[104:107], v[40:43]
    s_waitcnt lgkmcnt(9)
    ds_write_addtid_b32 v108 offset:6656
    ds_read_b128 v[196:199], v4 offset:768
    v_mfma_f32_16x16x32_bf16 v[64:67], v[88:91], a[32:35], v[252:255]
    s_waitcnt lgkmcnt(10)
    v_exp_f32 v69, v69
    v_mfma_f32_16x16x32_bf16 v[64:67], v[92:95], a[36:39], v[64:67]
    s_waitcnt lgkmcnt(9)
    ds_read_b128 v[168:171], v0 offset:1024
    v_perm_b32 v109, v69, v113, s49
    v_mfma_f32_16x16x32_bf16 v[64:67], v[96:99], a[40:43], v[64:67]
    s_waitcnt lgkmcnt(9)
    v_exp_f32 v70, v70
    v_mfma_f32_16x16x32_bf16 v[64:67], v[100:103], a[44:47], v[64:67]
    s_waitcnt lgkmcnt(6)
    ds_write_addtid_b32 v109 offset:12832
    v_perm_b32 v110, v70, v114, s49
    v_mfma_f32_16x16x32_bf16 v[120:123], a[224:227], v[184:187], v[120:123]
    v_exp_f32 v71, v71
    v_mfma_f32_16x16x32_bf16 v[128:131], a[224:227], v[188:191], v[128:131]
    s_waitcnt lgkmcnt(5)
    ds_write_addtid_b32 v110 offset:19072
    v_perm_b32 v111, v71, v115, s49
    v_mfma_f32_16x16x32_bf16 v[124:127], a[228:231], v[184:187], v[124:127]
    v_exp_f32 v64, v64
    v_mfma_f32_16x16x32_bf16 v[132:135], a[228:231], v[188:191], v[132:135]
    ds_write_addtid_b32 v111 offset:25248
    ds_read_b128 v[104:107], v0 offset:3584
    v_mfma_f32_16x16x32_bf16 v[68:71], v[88:91], a[48:51], v[252:255]
    v_exp_f32 v65, v65
    v_mfma_f32_16x16x32_bf16 v[68:71], v[92:95], a[52:55], v[68:71]
    ds_read_b128 v[72:75], v5 offset:4096
    ds_read_b128 v[76:79], v6 offset:4096
    v_mfma_f32_16x16x32_bf16 v[68:71], v[96:99], a[56:59], v[68:71]
    v_exp_f32 v66, v66
    v_mfma_f32_16x16x32_bf16 v[68:71], v[100:103], a[60:63], v[68:71]
    s_waitcnt lgkmcnt(9)
    ds_read_b128 v[80:83], v7 offset:4096
    ds_read_b128 v[84:87], v8 offset:4096
    v_mfma_f32_16x16x32_bf16 v[136:139], a[224:227], v[192:195], v[136:139]
    s_waitcnt lgkmcnt(9)
    v_exp_f32 v67, v67
    v_mfma_f32_16x16x32_bf16 v[144:147], a[224:227], v[196:199], v[144:147]
    ds_read_b128 v[172:175], v0 offset:1280
    v_mfma_f32_16x16x32_bf16 v[140:143], a[228:231], v[192:195], v[140:143]
    v_exp_f32 v68, v68
    v_mfma_f32_16x16x32_bf16 v[148:151], a[228:231], v[196:199], v[148:151]
    s_waitcnt lgkmcnt(5)
    ds_read_b128 v[176:179], v0 offset:1536
    v_perm_b32 v108, v68, v64, s49
    v_mfma_f32_16x16x32_bf16 v[44:47], v[32:35], v[104:107], v[44:47]
    s_waitcnt lgkmcnt(5)
    ds_write_addtid_b32 v108 offset:6912
    ds_read_b128 v[180:183], v0 offset:1792
    v_mfma_f32_16x16x32_bf16 v[112:115], v[72:75], a[32:35], v[252:255]
    s_waitcnt lgkmcnt(6)
    v_exp_f32 v69, v69
    v_mfma_f32_16x16x32_bf16 v[112:115], v[76:79], a[36:39], v[112:115]
    s_waitcnt lgkmcnt(5)
    ds_read_b128 v[184:187], v2 offset:1024
    v_perm_b32 v109, v69, v65, s49
    v_mfma_f32_16x16x32_bf16 v[112:115], v[80:83], a[40:43], v[112:115]
    s_waitcnt lgkmcnt(5)
    v_exp_f32 v70, v70
    v_mfma_f32_16x16x32_bf16 v[112:115], v[84:87], a[44:47], v[112:115]
    ds_write_addtid_b32 v109 offset:13088
    v_perm_b32 v110, v70, v66, s49
    v_mfma_f32_16x16x32_bf16 v[152:155], a[128:131], v[168:171], 0
    s_waitcnt lgkmcnt(5)
    v_exp_f32 v71, v71
    v_mfma_f32_16x16x32_bf16 v[160:163], a[128:131], v[172:175], 0
    ds_write_addtid_b32 v110 offset:19328
    v_perm_b32 v111, v71, v67, s49
    v_mfma_f32_16x16x32_bf16 v[156:159], a[132:135], v[168:171], 0
    v_exp_f32 v112, v112
    v_mfma_f32_16x16x32_bf16 v[164:167], a[132:135], v[172:175], 0
    ds_write_addtid_b32 v111 offset:25504
    ds_read_b128 v[104:107], v0 offset:3840
    v_mfma_f32_16x16x32_bf16 v[68:71], v[72:75], a[48:51], v[252:255]
    v_exp_f32 v113, v113
    v_mfma_f32_16x16x32_bf16 v[68:71], v[76:79], a[52:55], v[68:71]
    buffer_load_dwordx4 a[88:91], v30, s[12:15], s27 offen offset:128 nt
    buffer_load_dwordx4 a[92:95], v30, s[12:15], s27 offen offset:192 nt
    ds_read_b128 v[88:91], v5 offset:5120
    ds_read_b128 v[92:95], v6 offset:5120
    v_mfma_f32_16x16x32_bf16 v[68:71], v[80:83], a[56:59], v[68:71]
    v_exp_f32 v114, v114
    v_mfma_f32_16x16x32_bf16 v[68:71], v[84:87], a[60:63], v[68:71]
    s_waitcnt lgkmcnt(9)
    ds_read_b128 v[96:99], v7 offset:5120
    ds_read_b128 v[100:103], v8 offset:5120
    v_mfma_f32_16x16x32_bf16 v[200:203], a[128:131], v[176:179], 0
    s_waitcnt lgkmcnt(9)
    v_exp_f32 v115, v115
    v_mfma_f32_16x16x32_bf16 v[208:211], a[128:131], v[180:183], 0
    ds_read_b128 v[188:191], v2 offset:1280
    v_mfma_f32_16x16x32_bf16 v[204:207], a[132:135], v[176:179], 0
    v_exp_f32 v68, v68
    v_mfma_f32_16x16x32_bf16 v[212:215], a[132:135], v[180:183], 0
    s_waitcnt lgkmcnt(5)
    ds_read_b128 v[192:195], v2 offset:1536
    v_perm_b32 v108, v68, v112, s49
    v_mfma_f32_16x16x32_bf16 v[44:47], v[36:39], v[104:107], v[44:47]
    s_waitcnt lgkmcnt(5)
    ds_write_addtid_b32 v108 offset:7168
    ds_read_b128 v[196:199], v2 offset:1792
    v_mfma_f32_16x16x32_bf16 v[64:67], v[88:91], a[32:35], v[252:255]
    s_waitcnt lgkmcnt(6)
    v_exp_f32 v69, v69
    v_mfma_f32_16x16x32_bf16 v[64:67], v[92:95], a[36:39], v[64:67]
    s_waitcnt lgkmcnt(5)
    ds_read_b128 v[168:171], v3 offset:1024
    v_perm_b32 v109, v69, v113, s49
    v_mfma_f32_16x16x32_bf16 v[64:67], v[96:99], a[40:43], v[64:67]
    s_waitcnt lgkmcnt(5)
    v_exp_f32 v70, v70
    v_mfma_f32_16x16x32_bf16 v[64:67], v[100:103], a[44:47], v[64:67]
    ds_write_addtid_b32 v109 offset:13344
    v_perm_b32 v110, v70, v114, s49
    v_mfma_f32_16x16x32_bf16 v[152:155], a[160:163], v[184:187], v[152:155]
    s_waitcnt lgkmcnt(5)
    v_exp_f32 v71, v71
    v_mfma_f32_16x16x32_bf16 v[160:163], a[160:163], v[188:191], v[160:163]
    s_xor_b32 s27, s56, 8192
    ds_write_addtid_b32 v110 offset:19584
    v_perm_b32 v111, v71, v115, s49
    v_mfma_f32_16x16x32_bf16 v[156:159], a[164:167], v[184:187], v[156:159]
    s_xor_b32 s26, s56, 12288
    v_exp_f32 v64, v64
    v_mfma_f32_16x16x32_bf16 v[164:167], a[164:167], v[188:191], v[164:167]
    ds_write_addtid_b32 v111 offset:25760
    ds_read_b128 v[104:107], v0 offset:4096
    v_mfma_f32_16x16x32_bf16 v[68:71], v[88:91], a[48:51], v[252:255]
    v_exp_f32 v65, v65
    v_mfma_f32_16x16x32_bf16 v[68:71], v[92:95], a[52:55], v[68:71]
    ds_read_b128 v[72:75], v5 offset:6144
    ds_read_b128 v[76:79], v6 offset:6144
    v_mfma_f32_16x16x32_bf16 v[68:71], v[96:99], a[56:59], v[68:71]
    v_exp_f32 v66, v66
    v_mfma_f32_16x16x32_bf16 v[68:71], v[100:103], a[60:63], v[68:71]
    s_waitcnt lgkmcnt(9)
    ds_read_b128 v[80:83], v7 offset:6144
    ds_read_b128 v[84:87], v8 offset:6144
    v_mfma_f32_16x16x32_bf16 v[200:203], a[160:163], v[192:195], v[200:203]
    s_waitcnt lgkmcnt(9)
    v_exp_f32 v67, v67
    v_mfma_f32_16x16x32_bf16 v[208:211], a[160:163], v[196:199], v[208:211]
    buffer_load_dwordx4 a[136:139], v31, s[16:19], s27 offen
    ds_read_b128 v[172:175], v3 offset:1280
    ds_add_u32 v14, v16
    v_mfma_f32_16x16x32_bf16 v[204:207], a[164:167], v[192:195], v[204:207]
    v_exp_f32 v68, v68
    v_mfma_f32_16x16x32_bf16 v[212:215], a[164:167], v[196:199], v[212:215]
    s_waitcnt lgkmcnt(6)
    ds_read_b128 v[176:179], v3 offset:1536
    v_perm_b32 v108, v68, v64, s49
    v_mfma_f32_16x16x32_bf16 v[48:51], v[32:35], v[104:107], v[48:51]
    s_waitcnt lgkmcnt(5)
    ds_write_addtid_b32 v108 offset:7424
    ds_read_b128 v[180:183], v3 offset:1792
    v_mfma_f32_16x16x32_bf16 v[112:115], v[72:75], a[32:35], v[252:255]
    s_add_u32 s24, s24, 1
    v_exp_f32 v69, v69
    v_mfma_f32_16x16x32_bf16 v[112:115], v[76:79], a[36:39], v[112:115]
    s_waitcnt lgkmcnt(6)
    ds_read_b128 v[184:187], v4 offset:1024
    v_perm_b32 v109, v69, v65, s49
    v_mfma_f32_16x16x32_bf16 v[112:115], v[80:83], a[40:43], v[112:115]
    s_waitcnt lgkmcnt(6)
    v_exp_f32 v70, v70
    v_mfma_f32_16x16x32_bf16 v[112:115], v[84:87], a[44:47], v[112:115]
    ds_write_addtid_b32 v109 offset:13600
    v_perm_b32 v110, v70, v66, s49
    v_mfma_f32_16x16x32_bf16 v[152:155], a[192:195], v[168:171], v[152:155]
    s_waitcnt lgkmcnt(6)
    v_exp_f32 v71, v71
    v_mfma_f32_16x16x32_bf16 v[160:163], a[192:195], v[172:175], v[160:163]
    ds_write_addtid_b32 v110 offset:19840
    v_perm_b32 v111, v71, v67, s49
    v_mfma_f32_16x16x32_bf16 v[156:159], a[196:199], v[168:171], v[156:159]
    v_exp_f32 v112, v112
    v_mfma_f32_16x16x32_bf16 v[164:167], a[196:199], v[172:175], v[164:167]
    ds_write_addtid_b32 v111 offset:26016
    ds_read_b128 v[104:107], v0 offset:4352
    v_mfma_f32_16x16x32_bf16 v[68:71], v[72:75], a[48:51], v[252:255]
    v_exp_f32 v113, v113
    v_mfma_f32_16x16x32_bf16 v[68:71], v[76:79], a[52:55], v[68:71]
    ds_read_b128 v[88:91], v5 offset:7168
    ds_read_b128 v[92:95], v6 offset:7168
    v_mfma_f32_16x16x32_bf16 v[68:71], v[80:83], a[56:59], v[68:71]
    v_exp_f32 v114, v114
L_pad1:
    s_cbranch_execz L_pad5
    v_mfma_f32_16x16x32_bf16 v[68:71], v[84:87], a[60:63], v[68:71]
    s_waitcnt lgkmcnt(9)
    ds_read_b128 v[96:99], v7 offset:7168
    ds_read_b128 v[100:103], v8 offset:7168
    v_mfma_f32_16x16x32_bf16 v[200:203], a[192:195], v[176:179], v[200:203]
    s_waitcnt lgkmcnt(9)
    v_exp_f32 v115, v115
    v_mfma_f32_16x16x32_bf16 v[208:211], a[192:195], v[180:183], v[208:211]
    buffer_load_dwordx4 a[140:143], v31, s[16:19], s26 offen
    ds_read_b128 v[188:191], v4 offset:1280
    v_mfma_f32_16x16x32_bf16 v[204:207], a[196:199], v[176:179], v[204:207]
    v_exp_f32 v68, v68
    v_mfma_f32_16x16x32_bf16 v[212:215], a[196:199], v[180:183], v[212:215]
    s_waitcnt lgkmcnt(5)
    ds_read_b128 v[192:195], v4 offset:1536
    v_perm_b32 v108, v68, v112, s49
    v_mfma_f32_16x16x32_bf16 v[48:51], v[36:39], v[104:107], v[48:51]
    s_waitcnt lgkmcnt(5)
    ds_write_addtid_b32 v108 offset:7680
    ds_read_b128 v[196:199], v4 offset:1792
    ds_read_b32 v19, v15
    v_mfma_f32_16x16x32_bf16 v[64:67], v[88:91], a[32:35], v[252:255]
    s_waitcnt lgkmcnt(7)
    v_exp_f32 v69, v69
    v_mfma_f32_16x16x32_bf16 v[64:67], v[92:95], a[36:39], v[64:67]
    s_waitcnt lgkmcnt(6)
    ds_read_b128 v[168:171], v0 offset:2048
    v_perm_b32 v109, v69, v113, s49
    v_mfma_f32_16x16x32_bf16 v[64:67], v[96:99], a[40:43], v[64:67]
    s_waitcnt lgkmcnt(6)
    v_exp_f32 v70, v70
    v_mfma_f32_16x16x32_bf16 v[64:67], v[100:103], a[44:47], v[64:67]
    ds_write_addtid_b32 v109 offset:13856
    v_perm_b32 v110, v70, v114, s49
    v_mfma_f32_16x16x32_bf16 v[152:155], a[224:227], v[184:187], v[152:155]
    s_waitcnt lgkmcnt(6)
    v_exp_f32 v71, v71
    v_mfma_f32_16x16x32_bf16 v[160:163], a[224:227], v[188:191], v[160:163]
    ds_write_addtid_b32 v110 offset:20096
    v_perm_b32 v111, v71, v115, s49
    v_mfma_f32_16x16x32_bf16 v[156:159], a[228:231], v[184:187], v[156:159]
    v_exp_f32 v64, v64
    v_mfma_f32_16x16x32_bf16 v[164:167], a[228:231], v[188:191], v[164:167]
    ds_write_addtid_b32 v111 offset:26272
    ds_read_b128 v[104:107], v0 offset:4608
    v_mfma_f32_16x16x32_bf16 v[68:71], v[88:91], a[48:51], v[252:255]
    v_exp_f32 v65, v65
    v_mfma_f32_16x16x32_bf16 v[68:71], v[92:95], a[52:55], v[68:71]
    ds_read_b128 v[72:75], v5 offset:8192
    ds_read_b128 v[76:79], v6 offset:8192
    v_mfma_f32_16x16x32_bf16 v[68:71], v[96:99], a[56:59], v[68:71]
    v_exp_f32 v66, v66
    v_mfma_f32_16x16x32_bf16 v[68:71], v[100:103], a[60:63], v[68:71]
    s_waitcnt lgkmcnt(7)
    ds_read_b128 v[80:83], v7 offset:8192
    ds_read_b128 v[84:87], v8 offset:8192
    v_cmp_gt_u32 vcc, s24, v19
    v_mfma_f32_16x16x32_bf16 v[200:203], a[224:227], v[192:195], v[200:203]
    v_exp_f32 v67, v67
    v_mfma_f32_16x16x32_bf16 v[208:211], a[224:227], v[196:199], v[208:211]
    ds_read_b128 v[172:175], v0 offset:2304
    v_mfma_f32_16x16x32_bf16 v[204:207], a[228:231], v[192:195], v[204:207]
    v_exp_f32 v68, v68
    v_mfma_f32_16x16x32_bf16 v[212:215], a[228:231], v[196:199], v[212:215]
    s_waitcnt lgkmcnt(5)
    ds_read_b128 v[176:179], v0 offset:2560
    v_perm_b32 v108, v68, v64, s49
    v_mfma_f32_16x16x32_bf16 v[52:55], v[32:35], v[104:107], v[52:55]
    s_waitcnt lgkmcnt(3)
    ds_write_addtid_b32 v108 offset:7936
    ds_read_b128 v[180:183], v0 offset:2816
    s_cbranch_vccnz L_retry101
L_back101:
    v_mfma_f32_16x16x32_bf16 v[112:115], v[72:75], a[32:35], v[252:255]
    s_xor_b32 s27, s57, 8192
    v_exp_f32 v69, v69
    v_mfma_f32_16x16x32_bf16 v[112:115], v[76:79], a[36:39], v[112:115]
    s_xor_b32 s26, s57, 12288
    ds_read_b128 v[184:187], v2 offset:2048
    v_perm_b32 v109, v69, v65, s49
    v_mfma_f32_16x16x32_bf16 v[112:115], v[80:83], a[40:43], v[112:115]
    s_waitcnt lgkmcnt(5)
    v_exp_f32 v70, v70
    v_mfma_f32_16x16x32_bf16 v[112:115], v[84:87], a[44:47], v[112:115]
    ds_write_addtid_b32 v109 offset:14112
    v_perm_b32 v110, v70, v66, s49
    v_mfma_f32_16x16x32_bf16 v[216:219], a[128:131], v[168:171], 0
    s_waitcnt lgkmcnt(5)
    v_exp_f32 v71, v71
    v_mfma_f32_16x16x32_bf16 v[224:227], a[128:131], v[172:175], 0
    ds_write_addtid_b32 v110 offset:20352
    v_perm_b32 v111, v71, v67, s49
    v_mfma_f32_16x16x32_bf16 v[220:223], a[132:135], v[168:171], 0
    v_exp_f32 v112, v112
    v_mfma_f32_16x16x32_bf16 v[228:231], a[132:135], v[172:175], 0
    ds_write_addtid_b32 v111 offset:26528
    ds_read_b128 v[104:107], v0 offset:4864
    v_mfma_f32_16x16x32_bf16 v[68:71], v[72:75], a[48:51], v[252:255]
    v_exp_f32 v113, v113
    v_mfma_f32_16x16x32_bf16 v[68:71], v[76:79], a[52:55], v[68:71]
    buffer_load_dwordx4 a[168:171], v31, s[16:19], s27 offen
    buffer_load_dwordx4 a[172:175], v31, s[16:19], s26 offen
    ds_read_b128 v[88:91], v5 offset:9216
    ds_read_b128 v[92:95], v6 offset:9216
    v_mfma_f32_16x16x32_bf16 v[68:71], v[80:83], a[56:59], v[68:71]
    v_exp_f32 v114, v114
    v_mfma_f32_16x16x32_bf16 v[68:71], v[84:87], a[60:63], v[68:71]
    s_waitcnt lgkmcnt(9)
    ds_read_b128 v[96:99], v7 offset:9216
    ds_read_b128 v[100:103], v8 offset:9216
    v_mfma_f32_16x16x32_bf16 v[232:235], a[128:131], v[176:179], 0
    s_waitcnt lgkmcnt(9)
    v_exp_f32 v115, v115
    v_mfma_f32_16x16x32_bf16 v[240:243], a[128:131], v[180:183], 0
    ds_read_b128 v[188:191], v2 offset:2304
    v_mfma_f32_16x16x32_bf16 v[236:239], a[132:135], v[176:179], 0
    v_exp_f32 v68, v68
    v_mfma_f32_16x16x32_bf16 v[244:247], a[132:135], v[180:183], 0
    s_waitcnt lgkmcnt(5)
    ds_read_b128 v[192:195], v2 offset:2560
    v_perm_b32 v108, v68, v112, s49
    v_mfma_f32_16x16x32_bf16 v[52:55], v[36:39], v[104:107], v[52:55]
    s_waitcnt lgkmcnt(5)
    ds_write_addtid_b32 v108 offset:8192
    ds_read_b128 v[196:199], v2 offset:2816
    v_mfma_f32_16x16x32_bf16 v[64:67], v[88:91], a[32:35], v[252:255]
    s_waitcnt lgkmcnt(6)
    v_exp_f32 v69, v69
    v_mfma_f32_16x16x32_bf16 v[64:67], v[92:95], a[36:39], v[64:67]
    s_waitcnt lgkmcnt(5)
    ds_read_b128 v[168:171], v3 offset:2048
    v_perm_b32 v109, v69, v113, s49
    v_mfma_f32_16x16x32_bf16 v[64:67], v[96:99], a[40:43], v[64:67]
    s_waitcnt lgkmcnt(5)
    v_exp_f32 v70, v70
    v_mfma_f32_16x16x32_bf16 v[64:67], v[100:103], a[44:47], v[64:67]
    ds_write_addtid_b32 v109 offset:14368
    v_perm_b32 v110, v70, v114, s49
    v_mfma_f32_16x16x32_bf16 v[216:219], a[160:163], v[184:187], v[216:219]
    s_waitcnt lgkmcnt(5)
    v_exp_f32 v71, v71
    v_mfma_f32_16x16x32_bf16 v[224:227], a[160:163], v[188:191], v[224:227]
    s_xor_b32 s27, s58, 8192
    ds_write_addtid_b32 v110 offset:20608
    v_perm_b32 v111, v71, v115, s49
    v_mfma_f32_16x16x32_bf16 v[220:223], a[164:167], v[184:187], v[220:223]
    s_xor_b32 s26, s58, 12288
    v_exp_f32 v64, v64
    v_mfma_f32_16x16x32_bf16 v[228:231], a[164:167], v[188:191], v[228:231]
    ds_write_addtid_b32 v111 offset:26784
    ds_read_b128 v[104:107], v0 offset:5120
    v_mfma_f32_16x16x32_bf16 v[68:71], v[88:91], a[48:51], v[252:255]
    v_exp_f32 v65, v65
    v_mfma_f32_16x16x32_bf16 v[68:71], v[92:95], a[52:55], v[68:71]
    ds_read_b128 v[72:75], v5 offset:10240
    ds_read_b128 v[76:79], v6 offset:10240
    v_mfma_f32_16x16x32_bf16 v[68:71], v[96:99], a[56:59], v[68:71]
    v_exp_f32 v66, v66
    v_mfma_f32_16x16x32_bf16 v[68:71], v[100:103], a[60:63], v[68:71]
    s_waitcnt lgkmcnt(9)
    ds_read_b128 v[80:83], v7 offset:10240
    ds_read_b128 v[84:87], v8 offset:10240
    v_mfma_f32_16x16x32_bf16 v[232:235], a[160:163], v[192:195], v[232:235]
    s_waitcnt lgkmcnt(9)
    v_exp_f32 v67, v67
    v_mfma_f32_16x16x32_bf16 v[240:243], a[160:163], v[196:199], v[240:243]
    buffer_load_dwordx4 a[200:203], v31, s[16:19], s27 offen
    ds_read_b128 v[172:175], v3 offset:2304
    v_mfma_f32_16x16x32_bf16 v[236:239], a[164:167], v[192:195], v[236:239]
    v_exp_f32 v68, v68
    v_mfma_f32_16x16x32_bf16 v[244:247], a[164:167], v[196:199], v[244:247]
    s_waitcnt lgkmcnt(5)
    ds_read_b128 v[176:179], v3 offset:2560
    v_perm_b32 v108, v68, v64, s49
    v_mfma_f32_16x16x32_bf16 v[56:59], v[32:35], v[104:107], v[56:59]
    s_waitcnt lgkmcnt(5)
    ds_write_addtid_b32 v108 offset:8448
    ds_read_b128 v[180:183], v3 offset:2816
    v_mfma_f32_16x16x32_bf16 v[112:115], v[72:75], a[32:35], v[252:255]
    s_waitcnt lgkmcnt(6)
    v_exp_f32 v69, v69
    v_mfma_f32_16x16x32_bf16 v[112:115], v[76:79], a[36:39], v[112:115]
    s_waitcnt lgkmcnt(5)
    ds_read_b128 v[184:187], v4 offset:2048
    v_perm_b32 v109, v69, v65, s49
    v_mfma_f32_16x16x32_bf16 v[112:115], v[80:83], a[40:43], v[112:115]
    s_waitcnt lgkmcnt(5)
    v_exp_f32 v70, v70
    v_mfma_f32_16x16x32_bf16 v[112:115], v[84:87], a[44:47], v[112:115]
    ds_write_addtid_b32 v109 offset:14624
    v_perm_b32 v110, v70, v66, s49
    v_mfma_f32_16x16x32_bf16 v[216:219], a[192:195], v[168:171], v[216:219]
    s_waitcnt lgkmcnt(5)
    v_exp_f32 v71, v71
    v_mfma_f32_16x16x32_bf16 v[224:227], a[192:195], v[172:175], v[224:227]
    ds_write_addtid_b32 v110 offset:20864
    v_perm_b32 v111, v71, v67, s49
    v_mfma_f32_16x16x32_bf16 v[220:223], a[196:199], v[168:171], v[220:223]
    v_exp_f32 v112, v112
    v_mfma_f32_16x16x32_bf16 v[228:231], a[196:199], v[172:175], v[228:231]
    ds_write_addtid_b32 v111 offset:27040
    ds_read_b128 v[104:107], v0 offset:5376
    v_mfma_f32_16x16x32_bf16 v[68:71], v[72:75], a[48:51], v[252:255]
    v_exp_f32 v113, v113
    v_mfma_f32_16x16x32_bf16 v[68:71], v[76:79], a[52:55], v[68:71]
    ds_read_b128 v[88:91], v5 offset:11264
    ds_read_b128 v[92:95], v6 offset:11264
    v_mfma_f32_16x16x32_bf16 v[68:71], v[80:83], a[56:59], v[68:71]
    v_exp_f32 v114, v114
    v_mfma_f32_16x16x32_bf16 v[68:71], v[84:87], a[60:63], v[68:71]
    s_waitcnt lgkmcnt(9)
    ds_read_b128 v[96:99], v7 offset:11264
    ds_read_b128 v[100:103], v8 offset:11264
    v_mfma_f32_16x16x32_bf16 v[232:235], a[192:195], v[176:179], v[232:235]
    s_waitcnt lgkmcnt(9)
    v_exp_f32 v115, v115
    v_mfma_f32_16x16x32_bf16 v[240:243], a[192:195], v[180:183], v[240:243]
    buffer_load_dwordx4 a[204:207], v31, s[16:19], s26 offen
    ds_read_b128 v[188:191], v4 offset:2304
    v_mfma_f32_16x16x32_bf16 v[236:239], a[196:199], v[176:179], v[236:239]
    v_exp_f32 v68, v68
    v_mfma_f32_16x16x32_bf16 v[244:247], a[196:199], v[180:183], v[244:247]
    s_waitcnt lgkmcnt(5)
    ds_read_b128 v[192:195], v4 offset:2560
    v_perm_b32 v108, v68, v112, s49
    v_mfma_f32_16x16x32_bf16 v[56:59], v[36:39], v[104:107], v[56:59]
    s_waitcnt lgkmcnt(5)
    ds_write_addtid_b32 v108 offset:8704
    ds_read_b128 v[196:199], v4 offset:2816
    v_mfma_f32_16x16x32_bf16 v[64:67], v[88:91], a[32:35], v[252:255]
    s_waitcnt lgkmcnt(6)
    v_exp_f32 v69, v69
    v_mfma_f32_16x16x32_bf16 v[64:67], v[92:95], a[36:39], v[64:67]
    s_waitcnt lgkmcnt(5)
    ds_read_b128 v[168:171], v0 offset:3072
    v_perm_b32 v109, v69, v113, s49
    v_mfma_f32_16x16x32_bf16 v[64:67], v[96:99], a[40:43], v[64:67]
    s_waitcnt lgkmcnt(5)
    v_exp_f32 v70, v70
    v_mfma_f32_16x16x32_bf16 v[64:67], v[100:103], a[44:47], v[64:67]
    ds_write_addtid_b32 v109 offset:14880
    v_perm_b32 v110, v70, v114, s49
    v_mfma_f32_16x16x32_bf16 v[216:219], a[224:227], v[184:187], v[216:219]
    s_waitcnt lgkmcnt(5)
    v_exp_f32 v71, v71
    v_mfma_f32_16x16x32_bf16 v[224:227], a[224:227], v[188:191], v[224:227]
    ds_write_addtid_b32 v110 offset:21120
    v_perm_b32 v111, v71, v115, s49
    v_mfma_f32_16x16x32_bf16 v[220:223], a[228:231], v[184:187], v[220:223]
    v_exp_f32 v64, v64
    v_mfma_f32_16x16x32_bf16 v[228:231], a[228:231], v[188:191], v[228:231]
    ds_write_addtid_b32 v111 offset:27296
    ds_read_b128 v[104:107], v0 offset:5632
    v_mfma_f32_16x16x32_bf16 v[68:71], v[88:91], a[48:51], v[252:255]
    v_exp_f32 v65, v65
    v_mfma_f32_16x16x32_bf16 v[68:71], v[92:95], a[52:55], v[68:71]
    ds_read_b128 v[72:75], v5 offset:0
    ds_read_b128 v[76:79], v6 offset:0
    v_mfma_f32_16x16x32_bf16 v[68:71], v[96:99], a[56:59], v[68:71]
    v_exp_f32 v66, v66
    v_mfma_f32_16x16x32_bf16 v[68:71], v[100:103], a[60:63], v[68:71]
    s_waitcnt lgkmcnt(9)
    ds_read_b128 v[80:83], v7 offset:0
    ds_read_b128 v[84:87], v8 offset:0
    v_mfma_f32_16x16x32_bf16 v[232:235], a[224:227], v[192:195], v[232:235]
    s_waitcnt lgkmcnt(9)
    v_exp_f32 v67, v67
    v_mfma_f32_16x16x32_bf16 v[240:243], a[224:227], v[196:199], v[240:243]
    ds_read_b128 v[172:175], v0 offset:3328
    v_mfma_f32_16x16x32_bf16 v[236:239], a[228:231], v[192:195], v[236:239]
    v_exp_f32 v68, v68
    v_mfma_f32_16x16x32_bf16 v[244:247], a[228:231], v[196:199], v[244:247]
    s_waitcnt lgkmcnt(5)
    ds_read_b128 v[176:179], v0 offset:3584
    v_perm_b32 v108, v68, v64, s49
    v_mfma_f32_16x16x32_bf16 v[60:63], v[32:35], v[104:107], v[60:63]
    ds_write_addtid_b32 v108 offset:8960
    ds_read_b128 v[180:183], v0 offset:3840
    s_waitcnt vmcnt(13)
    v_mfma_f32_16x16x32_bf16 v[184:187], v[22:25], a[64:67], 0
    v_mfma_f32_16x16x32_bf16 v[184:187], v[26:29], a[64:67], v[184:187]
    s_xor_b32 s27, s59, 8192
    s_xor_b32 s26, s59, 12288
    buffer_load_dwordx4 a[232:235], v31, s[16:19], s27 offen
    v_mfma_f32_16x16x32_bf16 v[188:191], v[20:23], a[64:67], 0
    v_mfma_f32_16x16x32_bf16 v[188:191], v[24:27], a[64:67], v[188:191]
    s_waitcnt vmcnt(13)
    v_mfma_f32_16x16x32_bf16 v[192:195], v[22:25], a[68:71], 0
    v_cvt_pk_bf16_f32 v184, v184, v185
    v_cvt_pk_bf16_f32 v186, v186, v187
    v_mfma_f32_16x16x32_bf16 v[192:195], v[26:29], a[68:71], v[192:195]
    buffer_load_dwordx4 a[236:239], v31, s[16:19], s26 offen
    v_accvgpr_write_b32 a64, v184
    v_accvgpr_write_b32 a65, v186
    v_mfma_f32_16x16x32_bf16 v[196:199], v[20:23], a[68:71], 0
    v_cvt_pk_bf16_f32 v188, v188, v189
    v_cvt_pk_bf16_f32 v190, v190, v191
    v_mfma_f32_16x16x32_bf16 v[196:199], v[24:27], a[68:71], v[196:199]
    v_accvgpr_write_b32 a66, v188
    v_accvgpr_write_b32 a67, v190
    s_waitcnt vmcnt(13)
    v_mfma_f32_16x16x32_bf16 v[184:187], v[22:25], a[72:75], 0
    v_cvt_pk_bf16_f32 v192, v192, v193
    v_cvt_pk_bf16_f32 v194, v194, v195
    v_mfma_f32_16x16x32_bf16 v[184:187], v[26:29], a[72:75], v[184:187]
    s_xor_b32 s27, s56, 24576
    buffer_load_dwordx4 a[96:99], v30, s[12:15], s27 offen offset:0 nt
    v_accvgpr_write_b32 a68, v192
    v_accvgpr_write_b32 a69, v194
    v_mfma_f32_16x16x32_bf16 v[188:191], v[20:23], a[72:75], 0
    v_cvt_pk_bf16_f32 v196, v196, v197
    v_cvt_pk_bf16_f32 v198, v198, v199
    v_mfma_f32_16x16x32_bf16 v[188:191], v[24:27], a[72:75], v[188:191]
    v_accvgpr_write_b32 a70, v196
    v_accvgpr_write_b32 a71, v198
    s_waitcnt vmcnt(13)
    v_mfma_f32_16x16x32_bf16 v[192:195], v[22:25], a[76:79], 0
    v_cvt_pk_bf16_f32 v184, v184, v185
    v_cvt_pk_bf16_f32 v186, v186, v187
    v_mfma_f32_16x16x32_bf16 v[192:195], v[26:29], a[76:79], v[192:195]
    buffer_load_dwordx4 a[100:103], v30, s[12:15], s27 offen offset:64 nt
    v_accvgpr_write_b32 a72, v184
    v_accvgpr_write_b32 a73, v186
    v_mfma_f32_16x16x32_bf16 v[196:199], v[20:23], a[76:79], 0
    v_cvt_pk_bf16_f32 v188, v188, v189
    v_cvt_pk_bf16_f32 v190, v190, v191
    v_mfma_f32_16x16x32_bf16 v[196:199], v[24:27], a[76:79], v[196:199]
    v_accvgpr_write_b32 a74, v188
    v_accvgpr_write_b32 a75, v190
    s_waitcnt vmcnt(13)
    v_mfma_f32_16x16x32_bf16 v[184:187], v[22:25], a[80:83], 0
    v_cvt_pk_bf16_f32 v192, v192, v193
    v_cvt_pk_bf16_f32 v194, v194, v195
    v_mfma_f32_16x16x32_bf16 v[184:187], v[26:29], a[80:83], v[184:187]
    v_accvgpr_write_b32 a76, v192
    v_accvgpr_write_b32 a77, v194
    v_mfma_f32_16x16x32_bf16 v[188:191], v[20:23], a[80:83], 0
    v_cvt_pk_bf16_f32 v196, v196, v197
    v_cvt_pk_bf16_f32 v198, v198, v199
    v_mfma_f32_16x16x32_bf16 v[188:191], v[24:27], a[80:83], v[188:191]
    v_accvgpr_write_b32 a78, v196
    v_accvgpr_write_b32 a79, v198
    s_waitcnt vmcnt(12)
    v_mfma_f32_16x16x32_bf16 v[192:195], v[22:25], a[84:87], 0
    v_cvt_pk_bf16_f32 v184, v184, v185
    v_cvt_pk_bf16_f32 v186, v186, v187
    v_mfma_f32_16x16x32_bf16 v[192:195], v[26:29], a[84:87], v[192:195]
    v_accvgpr_write_b32 a80, v184
    v_accvgpr_write_b32 a81, v186
    v_mfma_f32_16x16x32_bf16 v[196:199], v[20:23], a[84:87], 0
    v_cvt_pk_bf16_f32 v188, v188, v189
    v_cvt_pk_bf16_f32 v190, v190, v191
    v_mfma_f32_16x16x32_bf16 v[196:199], v[24:27], a[84:87], v[196:199]
    v_accvgpr_write_b32 a82, v188
    v_accvgpr_write_b32 a83, v190
    s_waitcnt vmcnt(11)
    v_mfma_f32_16x16x32_bf16 v[184:187], v[22:25], a[88:91], 0
    v_cvt_pk_bf16_f32 v192, v192, v193
    v_cvt_pk_bf16_f32 v194, v194, v195
    v_mfma_f32_16x16x32_bf16 v[184:187], v[26:29], a[88:91], v[184:187]
    v_accvgpr_write_b32 a84, v192
    v_accvgpr_write_b32 a85, v194
    v_mfma_f32_16x16x32_bf16 v[188:191], v[20:23], a[88:91], 0
    v_cvt_pk_bf16_f32 v196, v196, v197
    v_cvt_pk_bf16_f32 v198, v198, v199
    v_mfma_f32_16x16x32_bf16 v[188:191], v[24:27], a[88:91], v[188:191]
    v_accvgpr_write_b32 a86, v196
    v_accvgpr_write_b32 a87, v198
    s_waitcnt vmcnt(10)
    v_mfma_f32_16x16x32_bf16 v[192:195], v[22:25], a[92:95], 0
    v_cvt_pk_bf16_f32 v184, v184, v185
    v_cvt_pk_bf16_f32 v186, v186, v187
    s_waitcnt vmcnt(9)
    ds_write_b128 v1, a[136:139] offset:0
    v_mfma_f32_16x16x32_bf16 v[192:195], v[26:29], a[92:95], v[192:195]
    v_accvgpr_write_b32 a88, v184
    v_accvgpr_write_b32 a89, v186
    s_waitcnt vmcnt(8)
    ds_write_b128 v1, a[140:143] offset:12416
    v_mfma_f32_16x16x32_bf16 v[196:199], v[20:23], a[92:95], 0
    v_cvt_pk_bf16_f32 v188, v188, v189
    v_cvt_pk_bf16_f32 v190, v190, v191
    ds_read_b64_tr_b16 a[136:137], v1 offset:0
    ds_read_b64_tr_b16 a[138:139], v1 offset:12416
    v_mfma_f32_16x16x32_bf16 v[196:199], v[24:27], a[92:95], v[196:199]
    v_accvgpr_write_b32 a90, v188
    v_accvgpr_write_b32 a91, v190
    s_waitcnt lgkmcnt(11)
    ds_read_b64_tr_b16 a[140:141], v1 offset:8
    ds_read_b64_tr_b16 a[142:143], v1 offset:12424
    v_cvt_pk_bf16_f32 v192, v192, v193
    v_cvt_pk_bf16_f32 v194, v194, v195
    v_accvgpr_write_b32 a92, v192
    v_accvgpr_write_b32 a93, v194
    v_cvt_pk_bf16_f32 v196, v196, v197
    v_cvt_pk_bf16_f32 v198, v198, v199
    v_accvgpr_write_b32 a94, v196
    v_accvgpr_write_b32 a95, v198
    v_mfma_f32_16x16x32_bf16 v[112:115], v[72:75], a[64:67], v[252:255]
    s_waitcnt vmcnt(7) lgkmcnt(12)
    ds_write_b128 v1, a[168:171] offset:0
    v_exp_f32 v69, v69
    v_mfma_f32_16x16x32_bf16 v[112:115], v[76:79], a[68:71], v[112:115]
    s_waitcnt lgkmcnt(12)
    ds_read_b128 v[184:187], v2 offset:3072
    v_perm_b32 v109, v69, v65, s49
    v_mfma_f32_16x16x32_bf16 v[112:115], v[80:83], a[72:75], v[112:115]
    s_waitcnt vmcnt(6) lgkmcnt(12)
    ds_write_b128 v1, a[172:175] offset:12416
    v_exp_f32 v70, v70
    v_mfma_f32_16x16x32_bf16 v[112:115], v[84:87], a[76:79], v[112:115]
    s_waitcnt lgkmcnt(5)
    ds_write_addtid_b32 v109 offset:15136
    v_perm_b32 v110, v70, v66, s49
    v_mfma_f32_16x16x32_bf16 v[120:123], a[136:139], v[168:171], v[120:123]
    v_exp_f32 v71, v71
    v_mfma_f32_16x16x32_bf16 v[128:131], a[136:139], v[172:175], v[128:131]
    s_waitcnt lgkmcnt(4)
    ds_write_addtid_b32 v110 offset:21376
    v_perm_b32 v111, v71, v67, s49
    v_mfma_f32_16x16x32_bf16 v[124:127], a[140:143], v[168:171], v[124:127]
    buffer_load_dwordx4 a[104:107], v30, s[12:15], s27 offen offset:128 nt
    buffer_load_dwordx4 a[108:111], v30, s[12:15], s27 offen offset:192 nt
    ds_read_b64_tr_b16 a[168:169], v1 offset:0
    ds_read_b64_tr_b16 a[170:171], v1 offset:12416
    ds_read_b64_tr_b16 a[172:173], v1 offset:8
    v_exp_f32 v112, v112
    v_mfma_f32_16x16x32_bf16 v[132:135], a[140:143], v[172:175], v[132:135]
    ds_write_addtid_b32 v111 offset:27552
    ds_read_b128 v[104:107], v0 offset:5888
    v_mfma_f32_16x16x32_bf16 v[68:71], v[72:75], a[80:83], v[252:255]
    v_exp_f32 v113, v113
    v_mfma_f32_16x16x32_bf16 v[68:71], v[76:79], a[84:87], v[68:71]
    ds_read_b128 v[88:91], v5 offset:1024
    ds_read_b128 v[92:95], v6 offset:1024
    v_mfma_f32_16x16x32_bf16 v[68:71], v[80:83], a[88:91], v[68:71]
    v_exp_f32 v114, v114
    v_mfma_f32_16x16x32_bf16 v[68:71], v[84:87], a[92:95], v[68:71]
    ds_read_b128 v[96:99], v7 offset:1024
    ds_read_b128 v[100:103], v8 offset:1024
    v_mfma_f32_16x16x32_bf16 v[136:139], a[136:139], v[176:179], v[136:139]
    v_exp_f32 v115, v115
    v_mfma_f32_16x16x32_bf16 v[144:147], a[136:139], v[180:183], v[144:147]
    ds_read_b128 v[188:191], v2 offset:3328
    ds_read_b64_tr_b16 a[174:175], v1 offset:12424
    v_mfma_f32_16x16x32_bf16 v[140:143], a[140:143], v[176:179], v[140:143]
    v_exp_f32 v68, v68
    v_mfma_f32_16x16x32_bf16 v[148:151], a[140:143], v[180:183], v[148:151]
    s_waitcnt lgkmcnt(6)
    ds_read_b128 v[192:195], v2 offset:3584
    v_perm_b32 v108, v68, v112, s49
    v_mfma_f32_16x16x32_bf16 v[60:63], v[36:39], v[104:107], v[60:63]
    s_waitcnt vmcnt(7) lgkmcnt(5)
    ds_write_addtid_b32 v108 offset:3072
    ds_read_b128 v[196:199], v2 offset:3840
    v_mfma_f32_16x16x32_bf16 v[64:67], v[88:91], a[64:67], v[252:255]
    s_xor_b32 s27, s56, 24832
    ds_write_b128 v1, a[200:203] offset:0
    v_exp_f32 v69, v69
    v_mfma_f32_16x16x32_bf16 v[64:67], v[92:95], a[68:71], v[64:67]
    s_waitcnt lgkmcnt(7)
    ds_read_b128 v[168:171], v3 offset:3072
    v_perm_b32 v109, v69, v113, s49
    v_mfma_f32_16x16x32_bf16 v[64:67], v[96:99], a[72:75], v[64:67]
    s_waitcnt vmcnt(6) lgkmcnt(7)
    ds_write_b128 v1, a[204:207] offset:12416
    v_exp_f32 v70, v70
    v_mfma_f32_16x16x32_bf16 v[64:67], v[100:103], a[76:79], v[64:67]
    buffer_load_dwordx4 a[112:115], v30, s[12:15], s27 offen offset:0 nt
    ds_write_addtid_b32 v109 offset:9248
    ds_read_b64_tr_b16 a[200:201], v1 offset:0
    ds_read_b64_tr_b16 a[202:203], v1 offset:12416
    ds_read_b64_tr_b16 a[204:205], v1 offset:8
    ds_read_b64_tr_b16 a[206:207], v1 offset:12424
    v_perm_b32 v110, v70, v114, s49
    v_mfma_f32_16x16x32_bf16 v[120:123], a[168:171], v[184:187], v[120:123]
    s_waitcnt lgkmcnt(12)
    v_exp_f32 v71, v71
    v_mfma_f32_16x16x32_bf16 v[128:131], a[168:171], v[188:191], v[128:131]
    s_waitcnt lgkmcnt(11)
    ds_write_addtid_b32 v110 offset:15488
    v_perm_b32 v111, v71, v115, s49
    v_mfma_f32_16x16x32_bf16 v[124:127], a[172:175], v[184:187], v[124:127]
    v_exp_f32 v64, v64
    v_mfma_f32_16x16x32_bf16 v[132:135], a[172:175], v[188:191], v[132:135]
    ds_write_addtid_b32 v111 offset:21664
    ds_read_b128 v[104:107], v0 offset:0
    v_mfma_f32_16x16x32_bf16 v[68:71], v[88:91], a[80:83], v[252:255]
    v_exp_f32 v65, v65
    v_mfma_f32_16x16x32_bf16 v[68:71], v[92:95], a[84:87], v[68:71]
    ds_read_b128 v[72:75], v5 offset:2048
    ds_read_b128 v[76:79], v6 offset:2048
    v_mfma_f32_16x16x32_bf16 v[68:71], v[96:99], a[88:91], v[68:71]
    v_exp_f32 v66, v66
    v_mfma_f32_16x16x32_bf16 v[68:71], v[100:103], a[92:95], v[68:71]
    s_waitcnt lgkmcnt(15)
    ds_read_b128 v[80:83], v7 offset:2048
    ds_read_b128 v[84:87], v8 offset:2048
    v_mfma_f32_16x16x32_bf16 v[136:139], a[168:171], v[192:195], v[136:139]
    s_waitcnt lgkmcnt(15)
    v_exp_f32 v67, v67
    v_mfma_f32_16x16x32_bf16 v[144:147], a[168:171], v[196:199], v[144:147]
    ds_read_b128 v[172:175], v3 offset:3328
    ds_add_u32 v14, v16
    v_mfma_f32_16x16x32_bf16 v[140:143], a[172:175], v[192:195], v[140:143]
    v_exp_f32 v68, v68
    v_mfma_f32_16x16x32_bf16 v[148:151], a[172:175], v[196:199], v[148:151]
    s_waitcnt lgkmcnt(6)
    ds_read_b128 v[176:179], v3 offset:3584
    v_perm_b32 v108, v68, v64, s49
    v_mfma_f32_16x16x32_bf16 v[40:43], v[32:35], v[104:107], v[40:43]
    s_waitcnt vmcnt(6) lgkmcnt(5)
    ds_write_addtid_b32 v108 offset:3328
    ds_read_b128 v[180:183], v3 offset:3840
    v_mfma_f32_16x16x32_bf16 v[112:115], v[72:75], a[64:67], v[252:255]
    s_add_u32 s24, s24, 1
    ds_write_b128 v1, a[232:235] offset:0
    v_exp_f32 v69, v69
    v_mfma_f32_16x16x32_bf16 v[112:115], v[76:79], a[68:71], v[112:115]
    s_waitcnt lgkmcnt(7)
    ds_read_b128 v[184:187], v4 offset:3072
    v_perm_b32 v109, v69, v65, s49
    v_mfma_f32_16x16x32_bf16 v[112:115], v[80:83], a[72:75], v[112:115]
    s_waitcnt vmcnt(5) lgkmcnt(7)
    ds_write_b128 v1, a[236:239] offset:12416
    v_exp_f32 v70, v70
    v_mfma_f32_16x16x32_bf16 v[112:115], v[84:87], a[76:79], v[112:115]
    ds_write_addtid_b32 v109 offset:9504
    v_perm_b32 v110, v70, v66, s49
    v_mfma_f32_16x16x32_bf16 v[120:123], a[200:203], v[168:171], v[120:123]
    s_waitcnt lgkmcnt(8)
    v_exp_f32 v71, v71
    v_mfma_f32_16x16x32_bf16 v[128:131], a[200:203], v[172:175], v[128:131]
    ds_write_addtid_b32 v110 offset:15744
    v_perm_b32 v111, v71, v67, s49
    v_mfma_f32_16x16x32_bf16 v[124:127], a[204:207], v[168:171], v[124:127]
    v_exp_f32 v112, v112
    v_mfma_f32_16x16x32_bf16 v[132:135], a[204:207], v[172:175], v[132:135]
    ds_write_addtid_b32 v111 offset:21920
    ds_read_b128 v[104:107], v0 offset:256
    v_mfma_f32_16x16x32_bf16 v[68:71], v[72:75], a[80:83], v[252:255]
    v_exp_f32 v113, v113
    v_mfma_f32_16x16x32_bf16 v[68:71], v[76:79], a[84:87], v[68:71]
    ds_read_b128 v[88:91], v5 offset:3072
    ds_read_b128 v[92:95], v6 offset:3072
    v_mfma_f32_16x16x32_bf16 v[68:71], v[80:83], a[88:91], v[68:71]
    v_exp_f32 v114, v114
    v_mfma_f32_16x16x32_bf16 v[68:71], v[84:87], a[92:95], v[68:71]
    s_waitcnt lgkmcnt(11)
    ds_read_b128 v[96:99], v7 offset:3072
    ds_read_b128 v[100:103], v8 offset:3072
    v_mfma_f32_16x16x32_bf16 v[136:139], a[200:203], v[176:179], v[136:139]
    s_waitcnt lgkmcnt(11)
    buffer_load_dwordx4 a[116:119], v30, s[12:15], s27 offen offset:64 nt
    buffer_load_dwordx4 a[120:123], v30, s[12:15], s27 offen offset:128 nt
    ds_read_b64_tr_b16 a[232:233], v1 offset:0
    ds_read_b64_tr_b16 a[234:235], v1 offset:12416
    ds_read_b64_tr_b16 a[236:237], v1 offset:8
    v_exp_f32 v115, v115
    v_mfma_f32_16x16x32_bf16 v[144:147], a[200:203], v[180:183], v[144:147]
    ds_read_b128 v[188:191], v4 offset:3328
    ds_read_b64_tr_b16 a[238:239], v1 offset:12424
    v_mfma_f32_16x16x32_bf16 v[140:143], a[204:207], v[176:179], v[140:143]
    v_exp_f32 v68, v68
    v_mfma_f32_16x16x32_bf16 v[148:151], a[204:207], v[180:183], v[148:151]
    s_waitcnt lgkmcnt(9)
    ds_read_b128 v[192:195], v4 offset:3584
    v_perm_b32 v108, v68, v112, s49
    v_mfma_f32_16x16x32_bf16 v[40:43], v[36:39], v[104:107], v[40:43]
    s_waitcnt lgkmcnt(9)
    ds_write_addtid_b32 v108 offset:3584
    ds_read_b128 v[196:199], v4 offset:3840
    ds_read_b32 v19, v15
    v_mfma_f32_16x16x32_bf16 v[64:67], v[88:91], a[64:67], v[252:255]
    s_waitcnt lgkmcnt(11)
    v_exp_f32 v69, v69
    v_mfma_f32_16x16x32_bf16 v[64:67], v[92:95], a[68:71], v[64:67]
    s_waitcnt lgkmcnt(10)
    ds_read_b128 v[168:171], v0 offset:4096
    v_perm_b32 v109, v69, v113, s49
    v_mfma_f32_16x16x32_bf16 v[64:67], v[96:99], a[72:75], v[64:67]
    s_waitcnt lgkmcnt(10)
    v_exp_f32 v70, v70
    v_mfma_f32_16x16x32_bf16 v[64:67], v[100:103], a[76:79], v[64:67]
    s_waitcnt lgkmcnt(8)
    ds_write_addtid_b32 v109 offset:9760
    v_perm_b32 v110, v70, v114, s49
L_pad2:
    s_cbranch_execz L_pad6
    v_mfma_f32_16x16x32_bf16 v[120:123], a[232:235], v[184:187], v[120:123]
    s_waitcnt lgkmcnt(7)
    v_exp_f32 v71, v71
    v_mfma_f32_16x16x32_bf16 v[128:131], a[232:235], v[188:191], v[128:131]
    s_waitcnt lgkmcnt(6)
    ds_write_addtid_b32 v110 offset:16000
    v_perm_b32 v111, v71, v115, s49
    v_mfma_f32_16x16x32_bf16 v[124:127], a[236:239], v[184:187], v[124:127]
    v_exp_f32 v64, v64
    v_mfma_f32_16x16x32_bf16 v[132:135], a[236:239], v[188:191], v[132:135]
    ds_write_addtid_b32 v111 offset:22176
    ds_read_b128 v[104:107], v0 offset:512
    v_mfma_f32_16x16x32_bf16 v[68:71], v[88:91], a[80:83], v[252:255]
    v_exp_f32 v65, v65
    v_mfma_f32_16x16x32_bf16 v[68:71], v[92:95], a[84:87], v[68:71]
    ds_read_b128 v[72:75], v5 offset:4096
    ds_read_b128 v[76:79], v6 offset:4096
    v_mfma_f32_16x16x32_bf16 v[68:71], v[96:99], a[88:91], v[68:71]
    v_exp_f32 v66, v66
    v_mfma_f32_16x16x32_bf16 v[68:71], v[100:103], a[92:95], v[68:71]
    s_waitcnt lgkmcnt(7)
    ds_read_b128 v[80:83], v7 offset:4096
    ds_read_b128 v[84:87], v8 offset:4096
    v_cmp_gt_u32 vcc, s24, v19
    v_mfma_f32_16x16x32_bf16 v[136:139], a[232:235], v[192:195], v[136:139]
    v_exp_f32 v67, v67
    v_mfma_f32_16x16x32_bf16 v[144:147], a[232:235], v[196:199], v[144:147]
    ds_read_b128 v[172:175], v0 offset:4352
    v_mfma_f32_16x16x32_bf16 v[140:143], a[236:239], v[192:195], v[140:143]
    v_exp_f32 v68, v68
    v_mfma_f32_16x16x32_bf16 v[148:151], a[236:239], v[196:199], v[148:151]
    s_waitcnt lgkmcnt(5)
    ds_read_b128 v[176:179], v0 offset:4608
    v_perm_b32 v108, v68, v64, s49
    v_mfma_f32_16x16x32_bf16 v[44:47], v[32:35], v[104:107], v[44:47]
    s_waitcnt lgkmcnt(5)
    ds_write_addtid_b32 v108 offset:3840
    ds_read_b128 v[180:183], v0 offset:4864
    s_cbranch_vccnz L_retry103
L_back103:
    v_mfma_f32_16x16x32_bf16 v[112:115], v[72:75], a[64:67], v[252:255]
    s_waitcnt lgkmcnt(6)
    buffer_load_dwordx4 a[124:127], v30, s[12:15], s27 offen offset:192 nt
    v_exp_f32 v69, v69
    v_mfma_f32_16x16x32_bf16 v[112:115], v[76:79], a[68:71], v[112:115]
    s_waitcnt lgkmcnt(4)
    ds_read_b128 v[184:187], v2 offset:4096
    v_perm_b32 v109, v69, v65, s49
    v_mfma_f32_16x16x32_bf16 v[112:115], v[80:83], a[72:75], v[112:115]
    s_mov_b32 s21, 49152
    v_exp_f32 v70, v70
    v_mfma_f32_16x16x32_bf16 v[112:115], v[84:87], a[76:79], v[112:115]
    s_add_u32 m0, s23, 12288
    s_nop 0
    ds_write_addtid_b32 v109 offset:8992
    v_perm_b32 v110, v70, v66, s49
    v_mfma_f32_16x16x32_bf16 v[152:155], a[136:139], v[168:171], v[152:155]
    s_waitcnt lgkmcnt(5)
    v_exp_f32 v71, v71
    v_mfma_f32_16x16x32_bf16 v[160:163], a[136:139], v[172:175], v[160:163]
    ds_write_addtid_b32 v110 offset:15232
    v_perm_b32 v111, v71, v67, s49
    v_mfma_f32_16x16x32_bf16 v[156:159], a[140:143], v[168:171], v[156:159]
    v_exp_f32 v112, v112
    v_mfma_f32_16x16x32_bf16 v[164:167], a[140:143], v[172:175], v[164:167]
    ds_write_addtid_b32 v111 offset:21408
    ds_read_b128 v[104:107], v0 offset:768
    v_mfma_f32_16x16x32_bf16 v[68:71], v[72:75], a[80:83], v[252:255]
    v_exp_f32 v113, v113
    v_mfma_f32_16x16x32_bf16 v[68:71], v[76:79], a[84:87], v[68:71]
    ds_read_b128 v[88:91], v5 offset:5120
    ds_read_b128 v[92:95], v6 offset:5120
    v_mfma_f32_16x16x32_bf16 v[68:71], v[80:83], a[88:91], v[68:71]
    v_exp_f32 v114, v114
    v_mfma_f32_16x16x32_bf16 v[68:71], v[84:87], a[92:95], v[68:71]
    s_waitcnt lgkmcnt(9)
    ds_read_b128 v[96:99], v7 offset:5120
    ds_read_b128 v[100:103], v8 offset:5120
    v_mfma_f32_16x16x32_bf16 v[200:203], a[136:139], v[176:179], v[200:203]
    s_waitcnt lgkmcnt(9)
    v_exp_f32 v115, v115
    v_mfma_f32_16x16x32_bf16 v[208:211], a[136:139], v[180:183], v[208:211]
    buffer_load_dwordx4 v9, s[4:7], s21 offen nt lds
    ds_read_b128 v[188:191], v2 offset:4352
    v_mfma_f32_16x16x32_bf16 v[204:207], a[140:143], v[176:179], v[204:207]
    s_waitcnt lgkmcnt(4)
    v_exp_f32 v68, v68
    v_mfma_f32_16x16x32_bf16 v[212:215], a[140:143], v[180:183], v[212:215]
    s_mov_b32 s21, 53248
    ds_read_b128 v[192:195], v2 offset:4608
    v_perm_b32 v108, v68, v112, s49
    v_mfma_f32_16x16x32_bf16 v[44:47], v[36:39], v[104:107], v[44:47]
    s_add_u32 m0, s23, 13312
    s_nop 0
    ds_write_addtid_b32 v108 offset:2048
    ds_read_b128 v[196:199], v2 offset:4864
    v_mfma_f32_16x16x32_bf16 v[64:67], v[88:91], a[64:67], v[252:255]
    s_waitcnt lgkmcnt(6)
    v_exp_f32 v69, v69
    v_mfma_f32_16x16x32_bf16 v[64:67], v[92:95], a[68:71], v[64:67]
    s_waitcnt lgkmcnt(5)
    ds_read_b128 v[168:171], v3 offset:4096
    v_perm_b32 v109, v69, v113, s49
    v_mfma_f32_16x16x32_bf16 v[64:67], v[96:99], a[72:75], v[64:67]
    s_waitcnt lgkmcnt(5)
    v_exp_f32 v70, v70
    v_mfma_f32_16x16x32_bf16 v[64:67], v[100:103], a[76:79], v[64:67]
    ds_write_addtid_b32 v109 offset:8224
    v_perm_b32 v110, v70, v114, s49
    v_mfma_f32_16x16x32_bf16 v[152:155], a[168:171], v[184:187], v[152:155]
    s_waitcnt lgkmcnt(5)
    v_exp_f32 v71, v71
    v_mfma_f32_16x16x32_bf16 v[160:163], a[168:171], v[188:191], v[160:163]
    ds_write_addtid_b32 v110 offset:14464
    v_perm_b32 v111, v71, v115, s49
    v_mfma_f32_16x16x32_bf16 v[156:159], a[172:175], v[184:187], v[156:159]
    v_exp_f32 v64, v64
    v_mfma_f32_16x16x32_bf16 v[164:167], a[172:175], v[188:191], v[164:167]
    ds_write_addtid_b32 v111 offset:20640
    ds_read_b128 v[104:107], v0 offset:1024
    v_mfma_f32_16x16x32_bf16 v[68:71], v[88:91], a[80:83], v[252:255]
    v_exp_f32 v65, v65
    v_mfma_f32_16x16x32_bf16 v[68:71], v[92:95], a[84:87], v[68:71]
    ds_read_b128 v[72:75], v5 offset:6144
    ds_read_b128 v[76:79], v6 offset:6144
    v_mfma_f32_16x16x32_bf16 v[68:71], v[96:99], a[88:91], v[68:71]
    v_exp_f32 v66, v66
    v_mfma_f32_16x16x32_bf16 v[68:71], v[100:103], a[92:95], v[68:71]
    s_waitcnt lgkmcnt(9)
    ds_read_b128 v[80:83], v7 offset:6144
    ds_read_b128 v[84:87], v8 offset:6144
    v_mfma_f32_16x16x32_bf16 v[200:203], a[168:171], v[192:195], v[200:203]
    s_waitcnt lgkmcnt(9)
    v_exp_f32 v67, v67
    v_mfma_f32_16x16x32_bf16 v[208:211], a[168:171], v[196:199], v[208:211]
    s_waitcnt lgkmcnt(4)
    buffer_load_dwordx4 v9, s[4:7], s21 offen nt lds
    ds_read_b128 v[172:175], v3 offset:4352
    v_mfma_f32_16x16x32_bf16 v[204:207], a[172:175], v[192:195], v[204:207]
    s_xor_b32 s27, s56, 16384
    v_exp_f32 v68, v68
    v_mfma_f32_16x16x32_bf16 v[212:215], a[172:175], v[196:199], v[212:215]
    s_xor_b32 s26, s56, 20480
    ds_read_b128 v[176:179], v3 offset:4608
    v_perm_b32 v108, v68, v64, s49
    v_mfma_f32_16x16x32_bf16 v[48:51], v[32:35], v[104:107], v[48:51]
    s_waitcnt lgkmcnt(5)
    ds_write_addtid_b32 v108 offset:2304
    ds_read_b128 v[180:183], v3 offset:4864
    v_mfma_f32_16x16x32_bf16 v[112:115], v[72:75], a[64:67], v[252:255]
    s_waitcnt lgkmcnt(6)
    v_exp_f32 v69, v69
    v_mfma_f32_16x16x32_bf16 v[112:115], v[76:79], a[68:71], v[112:115]
    s_waitcnt lgkmcnt(5)
    ds_read_b128 v[184:187], v4 offset:4096
    v_perm_b32 v109, v69, v65, s49
    v_mfma_f32_16x16x32_bf16 v[112:115], v[80:83], a[72:75], v[112:115]
    s_waitcnt lgkmcnt(5)
    v_exp_f32 v70, v70
    v_mfma_f32_16x16x32_bf16 v[112:115], v[84:87], a[76:79], v[112:115]
    ds_write_addtid_b32 v109 offset:8480
    v_perm_b32 v110, v70, v66, s49
    v_mfma_f32_16x16x32_bf16 v[152:155], a[200:203], v[168:171], v[152:155]
    s_waitcnt lgkmcnt(5)
    v_exp_f32 v71, v71
    v_mfma_f32_16x16x32_bf16 v[160:163], a[200:203], v[172:175], v[160:163]
    ds_write_addtid_b32 v110 offset:14720
    v_perm_b32 v111, v71, v67, s49
    v_mfma_f32_16x16x32_bf16 v[156:159], a[204:207], v[168:171], v[156:159]
    v_exp_f32 v112, v112
    v_mfma_f32_16x16x32_bf16 v[164:167], a[204:207], v[172:175], v[164:167]
    ds_write_addtid_b32 v111 offset:20896
    ds_read_b128 v[104:107], v0 offset:1280
    v_mfma_f32_16x16x32_bf16 v[68:71], v[72:75], a[80:83], v[252:255]
    v_exp_f32 v113, v113
    v_mfma_f32_16x16x32_bf16 v[68:71], v[76:79], a[84:87], v[68:71]
    ds_read_b128 v[88:91], v5 offset:7168
    ds_read_b128 v[92:95], v6 offset:7168
    v_mfma_f32_16x16x32_bf16 v[68:71], v[80:83], a[88:91], v[68:71]
    v_exp_f32 v114, v114
    v_mfma_f32_16x16x32_bf16 v[68:71], v[84:87], a[92:95], v[68:71]
    s_waitcnt lgkmcnt(9)
    ds_read_b128 v[96:99], v7 offset:7168
    ds_read_b128 v[100:103], v8 offset:7168
    v_mfma_f32_16x16x32_bf16 v[200:203], a[200:203], v[176:179], v[200:203]
    s_waitcnt lgkmcnt(9)
    v_exp_f32 v115, v115
    v_mfma_f32_16x16x32_bf16 v[208:211], a[200:203], v[180:183], v[208:211]
    buffer_load_dwordx4 a[144:147], v31, s[16:19], s27 offen
    buffer_load_dwordx4 a[148:151], v31, s[16:19], s26 offen
    ds_read_b128 v[188:191], v4 offset:4352
    v_mfma_f32_16x16x32_bf16 v[204:207], a[204:207], v[176:179], v[204:207]
    v_exp_f32 v68, v68
    v_mfma_f32_16x16x32_bf16 v[212:215], a[204:207], v[180:183], v[212:215]
    s_waitcnt lgkmcnt(5)
    ds_read_b128 v[192:195], v4 offset:4608
    v_perm_b32 v108, v68, v112, s49
    v_mfma_f32_16x16x32_bf16 v[48:51], v[36:39], v[104:107], v[48:51]
    s_waitcnt lgkmcnt(5)
    ds_write_addtid_b32 v108 offset:2560
    ds_read_b128 v[196:199], v4 offset:4864
    v_mfma_f32_16x16x32_bf16 v[64:67], v[88:91], a[64:67], v[252:255]
    s_waitcnt lgkmcnt(6)
    v_exp_f32 v69, v69
    v_mfma_f32_16x16x32_bf16 v[64:67], v[92:95], a[68:71], v[64:67]
    s_waitcnt lgkmcnt(5)
    ds_read_b128 v[168:171], v0 offset:5120
    v_perm_b32 v109, v69, v113, s49
    v_mfma_f32_16x16x32_bf16 v[64:67], v[96:99], a[72:75], v[64:67]
    s_waitcnt lgkmcnt(5)
    v_exp_f32 v70, v70
    v_mfma_f32_16x16x32_bf16 v[64:67], v[100:103], a[76:79], v[64:67]
    ds_write_addtid_b32 v109 offset:8736
    v_perm_b32 v110, v70, v114, s49
    v_mfma_f32_16x16x32_bf16 v[152:155], a[232:235], v[184:187], v[152:155]
    s_waitcnt lgkmcnt(5)
    v_exp_f32 v71, v71
    v_mfma_f32_16x16x32_bf16 v[160:163], a[232:235], v[188:191], v[160:163]
    ds_write_addtid_b32 v110 offset:14976
    v_perm_b32 v111, v71, v115, s49
    v_mfma_f32_16x16x32_bf16 v[156:159], a[236:239], v[184:187], v[156:159]
    v_exp_f32 v64, v64
    v_mfma_f32_16x16x32_bf16 v[164:167], a[236:239], v[188:191], v[164:167]
    ds_write_addtid_b32 v111 offset:21152
    ds_read_b128 v[104:107], v0 offset:1536
    v_mfma_f32_16x16x32_bf16 v[68:71], v[88:91], a[80:83], v[252:255]
    v_exp_f32 v65, v65
    v_mfma_f32_16x16x32_bf16 v[68:71], v[92:95], a[84:87], v[68:71]
    ds_read_b128 v[72:75], v5 offset:8192
    ds_read_b128 v[76:79], v6 offset:8192
    v_mfma_f32_16x16x32_bf16 v[68:71], v[96:99], a[88:91], v[68:71]
    v_exp_f32 v66, v66
    v_mfma_f32_16x16x32_bf16 v[68:71], v[100:103], a[92:95], v[68:71]
    s_waitcnt lgkmcnt(9)
    ds_read_b128 v[80:83], v7 offset:8192
    ds_read_b128 v[84:87], v8 offset:8192
    v_mfma_f32_16x16x32_bf16 v[200:203], a[232:235], v[192:195], v[200:203]
    s_waitcnt lgkmcnt(9)
    v_exp_f32 v67, v67
    v_mfma_f32_16x16x32_bf16 v[208:211], a[232:235], v[196:199], v[208:211]
    ds_read_b128 v[172:175], v0 offset:5376
    v_mfma_f32_16x16x32_bf16 v[204:207], a[236:239], v[192:195], v[204:207]
    v_exp_f32 v68, v68
    v_mfma_f32_16x16x32_bf16 v[212:215], a[236:239], v[196:199], v[212:215]
    s_waitcnt lgkmcnt(5)
    ds_read_b128 v[176:179], v0 offset:5632
    v_perm_b32 v108, v68, v64, s49
    v_mfma_f32_16x16x32_bf16 v[52:55], v[32:35], v[104:107], v[52:55]
    s_waitcnt lgkmcnt(3)
    ds_write_addtid_b32 v108 offset:2816
    ds_read_b128 v[180:183], v0 offset:5888
    v_mfma_f32_16x16x32_bf16 v[112:115], v[72:75], a[64:67], v[252:255]
    s_xor_b32 s27, s57, 16384
    v_exp_f32 v69, v69
    v_mfma_f32_16x16x32_bf16 v[112:115], v[76:79], a[68:71], v[112:115]
    s_xor_b32 s26, s57, 20480
    ds_read_b128 v[184:187], v2 offset:5120
    v_perm_b32 v109, v69, v65, s49
    v_mfma_f32_16x16x32_bf16 v[112:115], v[80:83], a[72:75], v[112:115]
    s_waitcnt lgkmcnt(5)
    v_exp_f32 v70, v70
    v_mfma_f32_16x16x32_bf16 v[112:115], v[84:87], a[76:79], v[112:115]
    ds_write_addtid_b32 v109 offset:8992
    v_perm_b32 v110, v70, v66, s49
    v_mfma_f32_16x16x32_bf16 v[216:219], a[136:139], v[168:171], v[216:219]
    s_waitcnt lgkmcnt(5)
    v_exp_f32 v71, v71
    v_mfma_f32_16x16x32_bf16 v[224:227], a[136:139], v[172:175], v[224:227]
    ds_write_addtid_b32 v110 offset:15232
    v_perm_b32 v111, v71, v67, s49
    v_mfma_f32_16x16x32_bf16 v[220:223], a[140:143], v[168:171], v[220:223]
    buffer_load_dwordx4 a[176:179], v31, s[16:19], s27 offen
    buffer_load_dwordx4 a[180:183], v31, s[16:19], s26 offen
    v_exp_f32 v112, v112
    v_mfma_f32_16x16x32_bf16 v[228:231], a[140:143], v[172:175], v[228:231]
    ds_write_addtid_b32 v111 offset:21408
    ds_read_b128 v[104:107], v0 offset:1792
    v_mfma_f32_16x16x32_bf16 v[68:71], v[72:75], a[80:83], v[252:255]
    v_exp_f32 v113, v113
    v_mfma_f32_16x16x32_bf16 v[68:71], v[76:79], a[84:87], v[68:71]
    ds_read_b128 v[88:91], v5 offset:9216
    ds_read_b128 v[92:95], v6 offset:9216
    v_mfma_f32_16x16x32_bf16 v[68:71], v[80:83], a[88:91], v[68:71]
    v_exp_f32 v114, v114
    v_mfma_f32_16x16x32_bf16 v[68:71], v[84:87], a[92:95], v[68:71]
    s_waitcnt lgkmcnt(9)
    ds_read_b128 v[96:99], v7 offset:9216
    ds_read_b128 v[100:103], v8 offset:9216
    v_mfma_f32_16x16x32_bf16 v[232:235], a[136:139], v[176:179], v[232:235]
    s_waitcnt lgkmcnt(9)
    v_exp_f32 v115, v115
    v_mfma_f32_16x16x32_bf16 v[240:243], a[136:139], v[180:183], v[240:243]
    ds_read_b128 v[188:191], v2 offset:5376
    v_mfma_f32_16x16x32_bf16 v[236:239], a[140:143], v[176:179], v[236:239]
    s_waitcnt lgkmcnt(4)
    v_exp_f32 v68, v68
    v_mfma_f32_16x16x32_bf16 v[244:247], a[140:143], v[180:183], v[244:247]
    s_xor_b32 s27, s58, 16384
    ds_read_b128 v[192:195], v2 offset:5632
    v_perm_b32 v108, v68, v112, s49
    v_mfma_f32_16x16x32_bf16 v[52:55], v[36:39], v[104:107], v[52:55]
    s_xor_b32 s26, s58, 20480
    ds_write_addtid_b32 v108 offset:3072
    ds_read_b128 v[196:199], v2 offset:5888
    v_mfma_f32_16x16x32_bf16 v[64:67], v[88:91], a[64:67], v[252:255]
    s_waitcnt lgkmcnt(6)
    v_exp_f32 v69, v69
    v_mfma_f32_16x16x32_bf16 v[64:67], v[92:95], a[68:71], v[64:67]
    s_waitcnt lgkmcnt(5)
    ds_read_b128 v[168:171], v3 offset:5120
    v_perm_b32 v109, v69, v113, s49
    v_mfma_f32_16x16x32_bf16 v[64:67], v[96:99], a[72:75], v[64:67]
    s_waitcnt lgkmcnt(5)
    v_exp_f32 v70, v70
    v_mfma_f32_16x16x32_bf16 v[64:67], v[100:103], a[76:79], v[64:67]
    ds_write_addtid_b32 v109 offset:9248
    v_perm_b32 v110, v70, v114, s49
    v_mfma_f32_16x16x32_bf16 v[216:219], a[168:171], v[184:187], v[216:219]
    s_waitcnt lgkmcnt(5)
    v_exp_f32 v71, v71
    v_mfma_f32_16x16x32_bf16 v[224:227], a[168:171], v[188:191], v[224:227]
    ds_write_addtid_b32 v110 offset:15488
    v_perm_b32 v111, v71, v115, s49
    v_mfma_f32_16x16x32_bf16 v[220:223], a[172:175], v[184:187], v[220:223]
    v_exp_f32 v64, v64
    v_mfma_f32_16x16x32_bf16 v[228:231], a[172:175], v[188:191], v[228:231]
    ds_write_addtid_b32 v111 offset:21664
    ds_read_b128 v[104:107], v0 offset:2048
    v_mfma_f32_16x16x32_bf16 v[68:71], v[88:91], a[80:83], v[252:255]
    v_exp_f32 v65, v65
    v_mfma_f32_16x16x32_bf16 v[68:71], v[92:95], a[84:87], v[68:71]
    ds_read_b128 v[72:75], v5 offset:10240
    ds_read_b128 v[76:79], v6 offset:10240
    v_mfma_f32_16x16x32_bf16 v[68:71], v[96:99], a[88:91], v[68:71]
    v_exp_f32 v66, v66
    v_mfma_f32_16x16x32_bf16 v[68:71], v[100:103], a[92:95], v[68:71]
    s_waitcnt lgkmcnt(9)
    ds_read_b128 v[80:83], v7 offset:10240
    ds_read_b128 v[84:87], v8 offset:10240
    v_mfma_f32_16x16x32_bf16 v[232:235], a[168:171], v[192:195], v[232:235]
    s_waitcnt lgkmcnt(9)
    v_exp_f32 v67, v67
    v_mfma_f32_16x16x32_bf16 v[240:243], a[168:171], v[196:199], v[240:243]
    ds_read_b128 v[172:175], v3 offset:5376
    ds_add_u32 v14, v16
    v_mfma_f32_16x16x32_bf16 v[236:239], a[172:175], v[192:195], v[236:239]
    v_exp_f32 v68, v68
    v_mfma_f32_16x16x32_bf16 v[244:247], a[172:175], v[196:199], v[244:247]
    s_waitcnt lgkmcnt(6)
    ds_read_b128 v[176:179], v3 offset:5632
    v_perm_b32 v108, v68, v64, s49
    v_mfma_f32_16x16x32_bf16 v[56:59], v[32:35], v[104:107], v[56:59]
    s_waitcnt lgkmcnt(5)
    buffer_load_dwordx4 a[208:211], v31, s[16:19], s27 offen
    buffer_load_dwordx4 a[212:215], v31, s[16:19], s26 offen
    ds_write_addtid_b32 v108 offset:3328
    ds_read_b128 v[180:183], v3 offset:5888
    v_mfma_f32_16x16x32_bf16 v[112:115], v[72:75], a[64:67], v[252:255]
    s_add_u32 s24, s24, 1
    v_exp_f32 v69, v69
    v_mfma_f32_16x16x32_bf16 v[112:115], v[76:79], a[68:71], v[112:115]
    s_waitcnt lgkmcnt(6)
    ds_read_b128 v[184:187], v4 offset:5120
    v_perm_b32 v109, v69, v65, s49
    v_mfma_f32_16x16x32_bf16 v[112:115], v[80:83], a[72:75], v[112:115]
    s_waitcnt lgkmcnt(6)
    v_exp_f32 v70, v70
    v_mfma_f32_16x16x32_bf16 v[112:115], v[84:87], a[76:79], v[112:115]
    ds_write_addtid_b32 v109 offset:9504
    v_perm_b32 v110, v70, v66, s49
    v_mfma_f32_16x16x32_bf16 v[216:219], a[200:203], v[168:171], v[216:219]
    s_waitcnt lgkmcnt(6)
    v_exp_f32 v71, v71
    v_mfma_f32_16x16x32_bf16 v[224:227], a[200:203], v[172:175], v[224:227]
    ds_write_addtid_b32 v110 offset:15744
    v_perm_b32 v111, v71, v67, s49
    v_mfma_f32_16x16x32_bf16 v[220:223], a[204:207], v[168:171], v[220:223]
    v_exp_f32 v112, v112
    v_mfma_f32_16x16x32_bf16 v[228:231], a[204:207], v[172:175], v[228:231]
    ds_write_addtid_b32 v111 offset:21920
    ds_read_b128 v[104:107], v0 offset:2304
    v_mfma_f32_16x16x32_bf16 v[68:71], v[72:75], a[80:83], v[252:255]
    s_xor_b32 s27, s59, 16384
    v_exp_f32 v113, v113
    v_mfma_f32_16x16x32_bf16 v[68:71], v[76:79], a[84:87], v[68:71]
    s_xor_b32 s26, s59, 20480
    ds_read_b128 v[88:91], v5 offset:11264
    ds_read_b128 v[92:95], v6 offset:11264
    v_mfma_f32_16x16x32_bf16 v[68:71], v[80:83], a[88:91], v[68:71]
    v_exp_f32 v114, v114
    v_mfma_f32_16x16x32_bf16 v[68:71], v[84:87], a[92:95], v[68:71]
    s_waitcnt lgkmcnt(9)
    ds_read_b128 v[96:99], v7 offset:11264
    ds_read_b128 v[100:103], v8 offset:11264
    v_mfma_f32_16x16x32_bf16 v[232:235], a[200:203], v[176:179], v[232:235]
    s_waitcnt lgkmcnt(9)
    v_exp_f32 v115, v115
    v_mfma_f32_16x16x32_bf16 v[240:243], a[200:203], v[180:183], v[240:243]
    buffer_load_dwordx4 a[240:243], v31, s[16:19], s27 offen
    ds_read_b128 v[188:191], v4 offset:5376
    v_mfma_f32_16x16x32_bf16 v[236:239], a[204:207], v[176:179], v[236:239]
    v_exp_f32 v68, v68
    v_mfma_f32_16x16x32_bf16 v[244:247], a[204:207], v[180:183], v[244:247]
    s_waitcnt lgkmcnt(5)
    ds_read_b128 v[192:195], v4 offset:5632
    v_perm_b32 v108, v68, v112, s49
    v_mfma_f32_16x16x32_bf16 v[56:59], v[36:39], v[104:107], v[56:59]
    s_waitcnt lgkmcnt(5)
    ds_write_addtid_b32 v108 offset:3584
    ds_read_b128 v[196:199], v4 offset:5888
    ds_read_b32 v19, v15
    v_mfma_f32_16x16x32_bf16 v[64:67], v[88:91], a[64:67], v[252:255]
    s_waitcnt lgkmcnt(7)
    v_exp_f32 v69, v69
    v_mfma_f32_16x16x32_bf16 v[64:67], v[92:95], a[68:71], v[64:67]
    s_waitcnt lgkmcnt(6)
    ds_read_b128 v[168:171], v0 offset:0
    v_perm_b32 v109, v69, v113, s49
    v_mfma_f32_16x16x32_bf16 v[64:67], v[96:99], a[72:75], v[64:67]
    s_waitcnt lgkmcnt(6)
    v_exp_f32 v70, v70
    v_mfma_f32_16x16x32_bf16 v[64:67], v[100:103], a[76:79], v[64:67]
    ds_write_addtid_b32 v109 offset:9760
    v_perm_b32 v110, v70, v114, s49
    v_mfma_f32_16x16x32_bf16 v[216:219], a[232:235], v[184:187], v[216:219]
    s_waitcnt lgkmcnt(6)
    v_exp_f32 v71, v71
    v_mfma_f32_16x16x32_bf16 v[224:227], a[232:235], v[188:191], v[224:227]
    ds_write_addtid_b32 v110 offset:16000
    v_perm_b32 v111, v71, v115, s49
    v_mfma_f32_16x16x32_bf16 v[220:223], a[236:239], v[184:187], v[220:223]
    v_exp_f32 v64, v64
    v_mfma_f32_16x16x32_bf16 v[228:231], a[236:239], v[188:191], v[228:231]
    ds_write_addtid_b32 v111 offset:22176
    ds_read_b128 v[104:107], v0 offset:2560
    v_mfma_f32_16x16x32_bf16 v[68:71], v[88:91], a[80:83], v[252:255]
    v_exp_f32 v65, v65
    v_mfma_f32_16x16x32_bf16 v[68:71], v[92:95], a[84:87], v[68:71]
    ds_read_b128 v[72:75], v5 offset:0
    ds_read_b128 v[76:79], v6 offset:0
    v_mfma_f32_16x16x32_bf16 v[68:71], v[96:99], a[88:91], v[68:71]
    v_exp_f32 v66, v66
    v_mfma_f32_16x16x32_bf16 v[68:71], v[100:103], a[92:95], v[68:71]
    s_waitcnt lgkmcnt(7)
    ds_read_b128 v[80:83], v7 offset:0
    ds_read_b128 v[84:87], v8 offset:0
    v_cmp_gt_u32 vcc, s24, v19
    v_mfma_f32_16x16x32_bf16 v[232:235], a[232:235], v[192:195], v[232:235]
    v_exp_f32 v67, v67
    v_mfma_f32_16x16x32_bf16 v[240:243], a[232:235], v[196:199], v[240:243]
    ds_read_b128 v[172:175], v0 offset:256
    v_mfma_f32_16x16x32_bf16 v[236:239], a[236:239], v[192:195], v[236:239]
    v_exp_f32 v68, v68
    v_mfma_f32_16x16x32_bf16 v[244:247], a[236:239], v[196:199], v[244:247]
    s_waitcnt lgkmcnt(5)
    ds_read_b128 v[176:179], v0 offset:512
    v_perm_b32 v108, v68, v64, s49
    v_mfma_f32_16x16x32_bf16 v[60:63], v[32:35], v[104:107], v[60:63]
    ds_write_addtid_b32 v108 offset:3840
    ds_read_b128 v[180:183], v0 offset:768
    s_cbranch_vccnz L_retry105
L_back105:
    s_waitcnt vmcnt(16)
    v_mfma_f32_16x16x32_bf16 v[184:187], v[22:25], a[96:99], 0
    v_mfma_f32_16x16x32_bf16 v[184:187], v[26:29], a[96:99], v[184:187]
    buffer_load_dwordx4 a[244:247], v31, s[16:19], s26 offen
    v_mfma_f32_16x16x32_bf16 v[188:191], v[20:23], a[96:99], 0
    v_mfma_f32_16x16x32_bf16 v[188:191], v[24:27], a[96:99], v[188:191]
    s_waitcnt vmcnt(16)
    v_mfma_f32_16x16x32_bf16 v[192:195], v[22:25], a[100:103], 0
    v_cvt_pk_bf16_f32 v184, v184, v185
    v_cvt_pk_bf16_f32 v186, v186, v187
    v_mfma_f32_16x16x32_bf16 v[192:195], v[26:29], a[100:103], v[192:195]
    s_xor_b32 s27, s56, 24576
    s_xor_b32 s26, s56, 28672
    buffer_load_dwordx4 a[152:155], v31, s[16:19], s27 offen
    v_accvgpr_write_b32 a96, v184
    v_accvgpr_write_b32 a97, v186
    v_mfma_f32_16x16x32_bf16 v[196:199], v[20:23], a[100:103], 0
    v_cvt_pk_bf16_f32 v188, v188, v189
    v_cvt_pk_bf16_f32 v190, v190, v191
    v_mfma_f32_16x16x32_bf16 v[196:199], v[24:27], a[100:103], v[196:199]
    v_accvgpr_write_b32 a98, v188
    v_accvgpr_write_b32 a99, v190
    s_waitcnt vmcnt(16)
    v_mfma_f32_16x16x32_bf16 v[184:187], v[22:25], a[104:107], 0
    v_cvt_pk_bf16_f32 v192, v192, v193
    v_cvt_pk_bf16_f32 v194, v194, v195
    v_mfma_f32_16x16x32_bf16 v[184:187], v[26:29], a[104:107], v[184:187]
    buffer_load_dwordx4 a[156:159], v31, s[16:19], s26 offen
    v_accvgpr_write_b32 a100, v192
    v_accvgpr_write_b32 a101, v194
    v_mfma_f32_16x16x32_bf16 v[188:191], v[20:23], a[104:107], 0
    v_cvt_pk_bf16_f32 v196, v196, v197
    v_cvt_pk_bf16_f32 v198, v198, v199
    v_mfma_f32_16x16x32_bf16 v[188:191], v[24:27], a[104:107], v[188:191]
    v_accvgpr_write_b32 a102, v196
    v_accvgpr_write_b32 a103, v198
    s_waitcnt vmcnt(16)
    v_mfma_f32_16x16x32_bf16 v[192:195], v[22:25], a[108:111], 0
    v_cvt_pk_bf16_f32 v184, v184, v185
    v_cvt_pk_bf16_f32 v186, v186, v187
    v_mfma_f32_16x16x32_bf16 v[192:195], v[26:29], a[108:111], v[192:195]
    v_accvgpr_write_b32 a104, v184
    v_accvgpr_write_b32 a105, v186
    v_mfma_f32_16x16x32_bf16 v[196:199], v[20:23], a[108:111], 0
    v_cvt_pk_bf16_f32 v188, v188, v189
    v_cvt_pk_bf16_f32 v190, v190, v191
    v_mfma_f32_16x16x32_bf16 v[196:199], v[24:27], a[108:111], v[196:199]
    v_accvgpr_write_b32 a106, v188
    v_accvgpr_write_b32 a107, v190
    s_waitcnt vmcnt(15)
    v_mfma_f32_16x16x32_bf16 v[184:187], v[22:25], a[112:115], 0
    v_cvt_pk_bf16_f32 v192, v192, v193
    v_cvt_pk_bf16_f32 v194, v194, v195
    v_mfma_f32_16x16x32_bf16 v[184:187], v[26:29], a[112:115], v[184:187]
    v_accvgpr_write_b32 a108, v192
    v_accvgpr_write_b32 a109, v194
    v_mfma_f32_16x16x32_bf16 v[188:191], v[20:23], a[112:115], 0
    v_cvt_pk_bf16_f32 v196, v196, v197
    v_cvt_pk_bf16_f32 v198, v198, v199
    v_mfma_f32_16x16x32_bf16 v[188:191], v[24:27], a[112:115], v[188:191]
    v_accvgpr_write_b32 a110, v196
    v_accvgpr_write_b32 a111, v198
    s_waitcnt vmcnt(14)
    v_mfma_f32_16x16x32_bf16 v[192:195], v[22:25], a[116:119], 0
    v_cvt_pk_bf16_f32 v184, v184, v185
    v_cvt_pk_bf16_f32 v186, v186, v187
    v_mfma_f32_16x16x32_bf16 v[192:195], v[26:29], a[116:119], v[192:195]
    v_accvgpr_write_b32 a112, v184
    v_accvgpr_write_b32 a113, v186
    v_mfma_f32_16x16x32_bf16 v[196:199], v[20:23], a[116:119], 0
    v_cvt_pk_bf16_f32 v188, v188, v189
    v_cvt_pk_bf16_f32 v190, v190, v191
    v_mfma_f32_16x16x32_bf16 v[196:199], v[24:27], a[116:119], v[196:199]
    v_accvgpr_write_b32 a114, v188
    v_accvgpr_write_b32 a115, v190
    s_waitcnt vmcnt(13)
    v_mfma_f32_16x16x32_bf16 v[184:187], v[22:25], a[120:123], 0
    v_cvt_pk_bf16_f32 v192, v192, v193
    v_cvt_pk_bf16_f32 v194, v194, v195
    v_mfma_f32_16x16x32_bf16 v[184:187], v[26:29], a[120:123], v[184:187]
    v_accvgpr_write_b32 a116, v192
    v_accvgpr_write_b32 a117, v194
    v_mfma_f32_16x16x32_bf16 v[188:191], v[20:23], a[120:123], 0
    v_cvt_pk_bf16_f32 v196, v196, v197
    v_cvt_pk_bf16_f32 v198, v198, v199
    v_mfma_f32_16x16x32_bf16 v[188:191], v[24:27], a[120:123], v[188:191]
    v_accvgpr_write_b32 a118, v196
    v_accvgpr_write_b32 a119, v198
    s_waitcnt vmcnt(12)
    v_mfma_f32_16x16x32_bf16 v[192:195], v[22:25], a[124:127], 0
    v_cvt_pk_bf16_f32 v184, v184, v185
    v_cvt_pk_bf16_f32 v186, v186, v187
    s_waitcnt vmcnt(9)
    ds_write_b128 v1, a[144:147] offset:3072
    v_mfma_f32_16x16x32_bf16 v[192:195], v[26:29], a[124:127], v[192:195]
    v_accvgpr_write_b32 a120, v184
    v_accvgpr_write_b32 a121, v186
    s_waitcnt vmcnt(8)
    ds_write_b128 v1, a[148:151] offset:15488
    v_mfma_f32_16x16x32_bf16 v[196:199], v[20:23], a[124:127], 0
    v_cvt_pk_bf16_f32 v188, v188, v189
    v_cvt_pk_bf16_f32 v190, v190, v191
    ds_read_b64_tr_b16 a[144:145], v1 offset:3072
    ds_read_b64_tr_b16 a[146:147], v1 offset:15488
    v_mfma_f32_16x16x32_bf16 v[196:199], v[24:27], a[124:127], v[196:199]
    v_accvgpr_write_b32 a122, v188
    v_accvgpr_write_b32 a123, v190
    s_waitcnt vmcnt(7) lgkmcnt(10)
    ds_read_b64_tr_b16 a[148:149], v1 offset:3080
    ds_read_b64_tr_b16 a[150:151], v1 offset:15496
    v_cvt_pk_bf16_f32 v192, v192, v193
    v_cvt_pk_bf16_f32 v194, v194, v195
    v_accvgpr_write_b32 a124, v192
    v_accvgpr_write_b32 a125, v194
    v_cvt_pk_bf16_f32 v196, v196, v197
    v_cvt_pk_bf16_f32 v198, v198, v199
    v_accvgpr_write_b32 a126, v196
    v_accvgpr_write_b32 a127, v198
    v_mfma_f32_16x16x32_bf16 v[112:115], v[72:75], a[96:99], v[252:255]
    s_xor_b32 s27, s57, 24576
    ds_write_b128 v1, a[176:179] offset:3072
    v_exp_f32 v69, v69
    v_mfma_f32_16x16x32_bf16 v[112:115], v[76:79], a[100:103], v[112:115]
    s_waitcnt vmcnt(6) lgkmcnt(11)
    ds_read_b128 v[184:187], v2 offset:0
    v_perm_b32 v109, v69, v65, s49
    v_mfma_f32_16x16x32_bf16 v[112:115], v[80:83], a[104:107], v[112:115]
L_pad3:
    s_cbranch_execz L_pad7
    s_xor_b32 s26, s57, 28672
    ds_write_b128 v1, a[180:183] offset:15488
    v_exp_f32 v70, v70
    v_mfma_f32_16x16x32_bf16 v[112:115], v[84:87], a[108:111], v[112:115]
    s_waitcnt lgkmcnt(5)
    buffer_load_dwordx4 a[184:187], v31, s[16:19], s27 offen
    ds_write_addtid_b32 v109 offset:10016
    ds_read_b64_tr_b16 a[176:177], v1 offset:3072
    ds_read_b64_tr_b16 a[178:179], v1 offset:15488
    ds_read_b64_tr_b16 a[180:181], v1 offset:3080
    v_perm_b32 v110, v70, v66, s49
    v_mfma_f32_16x16x32_bf16 v[120:123], a[144:147], v[168:171], v[120:123]
    v_exp_f32 v71, v71
    v_mfma_f32_16x16x32_bf16 v[128:131], a[144:147], v[172:175], v[128:131]
    s_waitcnt lgkmcnt(7)
    ds_write_addtid_b32 v110 offset:16256
    v_perm_b32 v111, v71, v67, s49
    v_mfma_f32_16x16x32_bf16 v[124:127], a[148:151], v[168:171], v[124:127]
    v_exp_f32 v112, v112
    v_mfma_f32_16x16x32_bf16 v[132:135], a[148:151], v[172:175], v[132:135]
    ds_write_addtid_b32 v111 offset:22432
    ds_read_b128 v[104:107], v0 offset:2816
    v_mfma_f32_16x16x32_bf16 v[68:71], v[72:75], a[112:115], v[252:255]
    v_exp_f32 v113, v113
    v_mfma_f32_16x16x32_bf16 v[68:71], v[76:79], a[116:119], v[68:71]
    ds_read_b128 v[88:91], v5 offset:1024
    ds_read_b128 v[92:95], v6 offset:1024
    v_mfma_f32_16x16x32_bf16 v[68:71], v[80:83], a[120:123], v[68:71]
    v_exp_f32 v114, v114
    v_mfma_f32_16x16x32_bf16 v[68:71], v[84:87], a[124:127], v[68:71]
    ds_read_b128 v[96:99], v7 offset:1024
    ds_read_b128 v[100:103], v8 offset:1024
    v_mfma_f32_16x16x32_bf16 v[136:139], a[144:147], v[176:179], v[136:139]
    v_exp_f32 v115, v115
    v_mfma_f32_16x16x32_bf16 v[144:147], a[144:147], v[180:183], v[144:147]
    ds_read_b128 v[188:191], v2 offset:256
    ds_read_b64_tr_b16 a[182:183], v1 offset:15496
    v_mfma_f32_16x16x32_bf16 v[140:143], a[148:151], v[176:179], v[140:143]
    v_exp_f32 v68, v68
    v_mfma_f32_16x16x32_bf16 v[148:151], a[148:151], v[180:183], v[148:151]
    s_waitcnt lgkmcnt(6)
    ds_read_b128 v[192:195], v2 offset:512
    v_perm_b32 v108, v68, v112, s49
    v_mfma_f32_16x16x32_bf16 v[60:63], v[36:39], v[104:107], v[60:63]
    s_waitcnt lgkmcnt(6)
    ds_write_addtid_b32 v108 offset:4096
    ds_read_b128 v[196:199], v2 offset:768
    v_mfma_f32_16x16x32_bf16 v[64:67], v[88:91], a[96:99], v[252:255]
    s_waitcnt vmcnt(6) lgkmcnt(7)
    ds_write_b128 v1, a[208:211] offset:3072
    v_exp_f32 v69, v69
    v_mfma_f32_16x16x32_bf16 v[64:67], v[92:95], a[100:103], v[64:67]
    s_waitcnt lgkmcnt(7)
    ds_read_b128 v[168:171], v3 offset:0
    v_perm_b32 v109, v69, v113, s49
    v_mfma_f32_16x16x32_bf16 v[64:67], v[96:99], a[104:107], v[64:67]
    s_waitcnt vmcnt(5) lgkmcnt(7)
    ds_write_b128 v1, a[212:215] offset:15488
    v_exp_f32 v70, v70
    v_mfma_f32_16x16x32_bf16 v[64:67], v[100:103], a[108:111], v[64:67]
    buffer_load_dwordx4 a[188:191], v31, s[16:19], s26 offen
    ds_write_addtid_b32 v109 offset:10272
    ds_read_b64_tr_b16 a[208:209], v1 offset:3072
    ds_read_b64_tr_b16 a[210:211], v1 offset:15488
    ds_read_b64_tr_b16 a[212:213], v1 offset:3080
    v_perm_b32 v110, v70, v114, s49
    v_mfma_f32_16x16x32_bf16 v[120:123], a[176:179], v[184:187], v[120:123]
    s_waitcnt lgkmcnt(11)
    v_exp_f32 v71, v71
    v_mfma_f32_16x16x32_bf16 v[128:131], a[176:179], v[188:191], v[128:131]
    s_waitcnt lgkmcnt(10)
    ds_write_addtid_b32 v110 offset:16512
    v_perm_b32 v111, v71, v115, s49
    v_mfma_f32_16x16x32_bf16 v[124:127], a[180:183], v[184:187], v[124:127]
    v_exp_f32 v64, v64
    v_mfma_f32_16x16x32_bf16 v[132:135], a[180:183], v[188:191], v[132:135]
    ds_write_addtid_b32 v111 offset:22688
    ds_read_b128 v[104:107], v0 offset:3072
    v_mfma_f32_16x16x32_bf16 v[68:71], v[88:91], a[112:115], v[252:255]
    v_exp_f32 v65, v65
    v_mfma_f32_16x16x32_bf16 v[68:71], v[92:95], a[116:119], v[68:71]
    ds_read_b128 v[72:75], v5 offset:2048
    ds_read_b128 v[76:79], v6 offset:2048
    v_mfma_f32_16x16x32_bf16 v[68:71], v[96:99], a[120:123], v[68:71]
    v_exp_f32 v66, v66
    v_mfma_f32_16x16x32_bf16 v[68:71], v[100:103], a[124:127], v[68:71]
    s_waitcnt lgkmcnt(14)
    ds_read_b128 v[80:83], v7 offset:2048
    ds_read_b128 v[84:87], v8 offset:2048
    v_mfma_f32_16x16x32_bf16 v[136:139], a[176:179], v[192:195], v[136:139]
    s_waitcnt lgkmcnt(14)
    v_exp_f32 v67, v67
    v_mfma_f32_16x16x32_bf16 v[144:147], a[176:179], v[196:199], v[144:147]
    ds_read_b128 v[172:175], v3 offset:256
    ds_read_b64_tr_b16 a[214:215], v1 offset:15496
    v_mfma_f32_16x16x32_bf16 v[140:143], a[180:183], v[192:195], v[140:143]
    v_exp_f32 v68, v68
    v_mfma_f32_16x16x32_bf16 v[148:151], a[180:183], v[196:199], v[148:151]
    s_waitcnt lgkmcnt(6)
    ds_read_b128 v[176:179], v3 offset:512
    v_perm_b32 v108, v68, v64, s49
    v_mfma_f32_16x16x32_bf16 v[40:43], v[32:35], v[104:107], v[40:43]
    s_waitcnt vmcnt(5) lgkmcnt(5)
    ds_write_addtid_b32 v108 offset:4352
    ds_read_b128 v[180:183], v3 offset:768
    v_mfma_f32_16x16x32_bf16 v[112:115], v[72:75], a[96:99], v[252:255]
    s_xor_b32 s27, s58, 24576
    ds_write_b128 v1, a[240:243] offset:3072
    v_exp_f32 v69, v69
    v_mfma_f32_16x16x32_bf16 v[112:115], v[76:79], a[100:103], v[112:115]
    s_waitcnt vmcnt(4) lgkmcnt(6)
    ds_read_b128 v[184:187], v4 offset:0
    v_perm_b32 v109, v69, v65, s49
    v_mfma_f32_16x16x32_bf16 v[112:115], v[80:83], a[104:107], v[112:115]
    s_xor_b32 s26, s58, 28672
    ds_write_b128 v1, a[244:247] offset:15488
    v_exp_f32 v70, v70
    v_mfma_f32_16x16x32_bf16 v[112:115], v[84:87], a[108:111], v[112:115]
    buffer_load_dwordx4 a[216:219], v31, s[16:19], s27 offen
    ds_write_addtid_b32 v109 offset:10528
    ds_read_b64_tr_b16 a[240:241], v1 offset:3072
    ds_read_b64_tr_b16 a[242:243], v1 offset:15488
    ds_read_b64_tr_b16 a[244:245], v1 offset:3080
    ds_read_b64_tr_b16 a[246:247], v1 offset:15496
    v_perm_b32 v110, v70, v66, s49
    v_mfma_f32_16x16x32_bf16 v[120:123], a[208:211], v[168:171], v[120:123]
    s_waitcnt lgkmcnt(12)
    v_exp_f32 v71, v71
    v_mfma_f32_16x16x32_bf16 v[128:131], a[208:211], v[172:175], v[128:131]
    s_waitcnt lgkmcnt(11)
    ds_write_addtid_b32 v110 offset:16768
    v_perm_b32 v111, v71, v67, s49
    v_mfma_f32_16x16x32_bf16 v[124:127], a[212:215], v[168:171], v[124:127]
    v_exp_f32 v112, v112
    v_mfma_f32_16x16x32_bf16 v[132:135], a[212:215], v[172:175], v[132:135]
    ds_write_addtid_b32 v111 offset:22944
    ds_read_b128 v[104:107], v0 offset:3328
    v_mfma_f32_16x16x32_bf16 v[68:71], v[72:75], a[112:115], v[252:255]
    v_exp_f32 v113, v113
    v_mfma_f32_16x16x32_bf16 v[68:71], v[76:79], a[116:119], v[68:71]
    ds_read_b128 v[88:91], v5 offset:3072
    ds_read_b128 v[92:95], v6 offset:3072
    v_mfma_f32_16x16x32_bf16 v[68:71], v[80:83], a[120:123], v[68:71]
    v_exp_f32 v114, v114
    v_mfma_f32_16x16x32_bf16 v[68:71], v[84:87], a[124:127], v[68:71]
    s_waitcnt lgkmcnt(15)
    ds_read_b128 v[96:99], v7 offset:3072
    ds_read_b128 v[100:103], v8 offset:3072
    v_mfma_f32_16x16x32_bf16 v[136:139], a[208:211], v[176:179], v[136:139]
    s_waitcnt lgkmcnt(15)
    v_exp_f32 v115, v115
    v_mfma_f32_16x16x32_bf16 v[144:147], a[208:211], v[180:183], v[144:147]
    ds_read_b128 v[188:191], v4 offset:256
    v_add_u32 v28, 4096, v12
    v_add_u32 v29, 5632, v12
    v_mfma_f32_16x16x32_bf16 v[140:143], a[212:215], v[176:179], v[140:143]
    v_exp_f32 v68, v68
    v_mfma_f32_16x16x32_bf16 v[148:151], a[212:215], v[180:183], v[148:151]
    s_waitcnt lgkmcnt(5)
    ds_read_b128 v[192:195], v4 offset:512
    v_perm_b32 v108, v68, v112, s49
    v_mfma_f32_16x16x32_bf16 v[40:43], v[36:39], v[104:107], v[40:43]
    s_waitcnt lgkmcnt(5)
    ds_write_addtid_b32 v108 offset:4608
    ds_read_b128 v[196:199], v4 offset:768
    v_mfma_f32_16x16x32_bf16 v[64:67], v[88:91], a[96:99], v[252:255]
    s_waitcnt lgkmcnt(6)
    v_exp_f32 v69, v69
    v_mfma_f32_16x16x32_bf16 v[64:67], v[92:95], a[100:103], v[64:67]
    s_waitcnt lgkmcnt(5)
    ds_read_b128 v[168:171], v0 offset:1024
    v_perm_b32 v109, v69, v113, s49
    v_mfma_f32_16x16x32_bf16 v[64:67], v[96:99], a[104:107], v[64:67]
    s_waitcnt lgkmcnt(5)
    v_exp_f32 v70, v70
    v_mfma_f32_16x16x32_bf16 v[64:67], v[100:103], a[108:111], v[64:67]
    ds_write_addtid_b32 v109 offset:10784
    v_perm_b32 v110, v70, v114, s49
    v_mfma_f32_16x16x32_bf16 v[120:123], a[240:243], v[184:187], v[120:123]
    s_waitcnt lgkmcnt(5)
    v_exp_f32 v71, v71
    v_mfma_f32_16x16x32_bf16 v[128:131], a[240:243], v[188:191], v[128:131]
    ds_write_addtid_b32 v110 offset:17024
    v_perm_b32 v111, v71, v115, s49
    v_mfma_f32_16x16x32_bf16 v[124:127], a[244:247], v[184:187], v[124:127]
    v_exp_f32 v64, v64
    v_mfma_f32_16x16x32_bf16 v[132:135], a[244:247], v[188:191], v[132:135]
    ds_write_addtid_b32 v111 offset:23200
    ds_read_b128 v[104:107], v0 offset:3584
    v_mfma_f32_16x16x32_bf16 v[68:71], v[88:91], a[112:115], v[252:255]
    v_exp_f32 v65, v65
    v_mfma_f32_16x16x32_bf16 v[68:71], v[92:95], a[116:119], v[68:71]
    ds_read_b128 v[72:75], v5 offset:4096
    ds_read_b128 v[76:79], v6 offset:4096
    v_mfma_f32_16x16x32_bf16 v[68:71], v[96:99], a[120:123], v[68:71]
    v_exp_f32 v66, v66
    v_mfma_f32_16x16x32_bf16 v[68:71], v[100:103], a[124:127], v[68:71]
    s_waitcnt lgkmcnt(9)
    ds_read_b128 v[80:83], v7 offset:4096
    ds_read_b128 v[84:87], v8 offset:4096
    v_mfma_f32_16x16x32_bf16 v[136:139], a[240:243], v[192:195], v[136:139]
    s_waitcnt lgkmcnt(9)
    v_exp_f32 v67, v67
    v_mfma_f32_16x16x32_bf16 v[144:147], a[240:243], v[196:199], v[144:147]
    ds_read_b128 v[172:175], v0 offset:1280
    v_cndmask_b32 v28, v12, v28, s[50:51]
    v_cndmask_b32 v29, v12, v29, s[50:51]
    v_mfma_f32_16x16x32_bf16 v[140:143], a[244:247], v[192:195], v[140:143]
    v_exp_f32 v68, v68
    v_mfma_f32_16x16x32_bf16 v[148:151], a[244:247], v[196:199], v[148:151]
    s_waitcnt lgkmcnt(5)
    ds_read_b128 v[176:179], v0 offset:1536
    v_perm_b32 v108, v68, v64, s49
    v_mfma_f32_16x16x32_bf16 v[44:47], v[32:35], v[104:107], v[44:47]
    s_waitcnt lgkmcnt(5)
    ds_write_addtid_b32 v108 offset:4864
    ds_read_b128 v[180:183], v0 offset:1792
    v_mfma_f32_16x16x32_bf16 v[112:115], v[72:75], a[96:99], v[252:255]
    s_waitcnt lgkmcnt(6)
    buffer_load_dwordx4 a[220:223], v31, s[16:19], s26 offen
    v_exp_f32 v69, v69
    v_mfma_f32_16x16x32_bf16 v[112:115], v[76:79], a[100:103], v[112:115]
    s_waitcnt lgkmcnt(5)
    ds_read_b128 v[184:187], v2 offset:1024
    v_perm_b32 v109, v69, v65, s49
    v_mfma_f32_16x16x32_bf16 v[112:115], v[80:83], a[104:107], v[112:115]
    s_waitcnt lgkmcnt(5)
    v_exp_f32 v70, v70
    v_mfma_f32_16x16x32_bf16 v[112:115], v[84:87], a[108:111], v[112:115]
    ds_write_addtid_b32 v109 offset:11040
    v_perm_b32 v110, v70, v66, s49
    v_mfma_f32_16x16x32_bf16 v[152:155], a[144:147], v[168:171], v[152:155]
    s_waitcnt lgkmcnt(5)
    v_exp_f32 v71, v71
    v_mfma_f32_16x16x32_bf16 v[160:163], a[144:147], v[172:175], v[160:163]
    ds_write_addtid_b32 v110 offset:17280
    v_perm_b32 v111, v71, v67, s49
    v_mfma_f32_16x16x32_bf16 v[156:159], a[148:151], v[168:171], v[156:159]
    v_exp_f32 v112, v112
    v_mfma_f32_16x16x32_bf16 v[164:167], a[148:151], v[172:175], v[164:167]
    ds_write_addtid_b32 v111 offset:23456
    ds_read_b128 v[104:107], v0 offset:3840
    v_mfma_f32_16x16x32_bf16 v[68:71], v[72:75], a[112:115], v[252:255]
    v_exp_f32 v113, v113
    v_mfma_f32_16x16x32_bf16 v[68:71], v[76:79], a[116:119], v[68:71]
    ds_read_b128 v[88:91], v5 offset:5120
    ds_read_b128 v[92:95], v6 offset:5120
    v_mfma_f32_16x16x32_bf16 v[68:71], v[80:83], a[120:123], v[68:71]
    s_waitcnt lgkmcnt(7)
    v_exp_f32 v114, v114
    v_mfma_f32_16x16x32_bf16 v[68:71], v[84:87], a[124:127], v[68:71]
    s_xor_b32 s27, s59, 24576
    ds_read_b128 v[96:99], v7 offset:5120
    ds_read_b128 v[100:103], v8 offset:5120
    v_mfma_f32_16x16x32_bf16 v[200:203], a[144:147], v[176:179], v[200:203]
    s_xor_b32 s26, s59, 28672
    v_exp_f32 v115, v115
    v_mfma_f32_16x16x32_bf16 v[208:211], a[144:147], v[180:183], v[208:211]
    ds_read_b128 v[188:191], v2 offset:1280
    ds_write_b32 v28, v40 offset:0
    v_mfma_f32_16x16x32_bf16 v[204:207], a[148:151], v[176:179], v[204:207]
    v_exp_f32 v68, v68
    v_mfma_f32_16x16x32_bf16 v[212:215], a[148:151], v[180:183], v[212:215]
    s_waitcnt lgkmcnt(6)
    ds_read_b128 v[192:195], v2 offset:1536
    v_perm_b32 v108, v68, v112, s49
    v_mfma_f32_16x16x32_bf16 v[44:47], v[36:39], v[104:107], v[44:47]
    s_waitcnt lgkmcnt(6)
    ds_write_addtid_b32 v108 offset:5120
    ds_read_b128 v[196:199], v2 offset:1792
    v_mfma_f32_16x16x32_bf16 v[64:67], v[88:91], a[96:99], v[252:255]
    s_waitcnt lgkmcnt(7)
    v_exp_f32 v69, v69
    v_mfma_f32_16x16x32_bf16 v[64:67], v[92:95], a[100:103], v[64:67]
    s_waitcnt lgkmcnt(6)
    ds_read_b128 v[168:171], v3 offset:1024
    v_perm_b32 v109, v69, v113, s49
    v_mfma_f32_16x16x32_bf16 v[64:67], v[96:99], a[104:107], v[64:67]
    s_waitcnt lgkmcnt(6)
    v_exp_f32 v70, v70
    v_mfma_f32_16x16x32_bf16 v[64:67], v[100:103], a[108:111], v[64:67]
    ds_write_addtid_b32 v109 offset:11296
    v_perm_b32 v110, v70, v114, s49
    v_mfma_f32_16x16x32_bf16 v[152:155], a[176:179], v[184:187], v[152:155]
    s_waitcnt lgkmcnt(6)
    v_exp_f32 v71, v71
    v_mfma_f32_16x16x32_bf16 v[160:163], a[176:179], v[188:191], v[160:163]
    ds_write_addtid_b32 v110 offset:17536
    v_perm_b32 v111, v71, v115, s49
    v_mfma_f32_16x16x32_bf16 v[156:159], a[180:183], v[184:187], v[156:159]
    v_exp_f32 v64, v64
    v_mfma_f32_16x16x32_bf16 v[164:167], a[180:183], v[188:191], v[164:167]
    ds_write_addtid_b32 v111 offset:23712
    ds_read_b128 v[104:107], v0 offset:4096
    v_mfma_f32_16x16x32_bf16 v[68:71], v[88:91], a[112:115], v[252:255]
    v_exp_f32 v65, v65
    v_mfma_f32_16x16x32_bf16 v[68:71], v[92:95], a[116:119], v[68:71]
    ds_read_b128 v[72:75], v5 offset:6144
    ds_read_b128 v[76:79], v6 offset:6144
    v_mfma_f32_16x16x32_bf16 v[68:71], v[96:99], a[120:123], v[68:71]
    v_exp_f32 v66, v66
    v_mfma_f32_16x16x32_bf16 v[68:71], v[100:103], a[124:127], v[68:71]
    s_waitcnt lgkmcnt(9)
    buffer_load_dwordx4 a[248:251], v31, s[16:19], s27 offen
    ds_read_b128 v[80:83], v7 offset:6144
    ds_read_b128 v[84:87], v8 offset:6144
    ds_write_b32 v28, v44 offset:512
    v_mfma_f32_16x16x32_bf16 v[200:203], a[176:179], v[192:195], v[200:203]
    s_waitcnt lgkmcnt(10)
    v_exp_f32 v67, v67
    v_mfma_f32_16x16x32_bf16 v[208:211], a[176:179], v[196:199], v[208:211]
    ds_read_b128 v[172:175], v3 offset:1280
    ds_add_u32 v14, v16
    v_mfma_f32_16x16x32_bf16 v[204:207], a[180:183], v[192:195], v[204:207]
    v_exp_f32 v68, v68
    v_mfma_f32_16x16x32_bf16 v[212:215], a[180:183], v[196:199], v[212:215]
    s_waitcnt lgkmcnt(7)
    ds_read_b128 v[176:179], v3 offset:1536
    v_perm_b32 v108, v68, v64, s49
    v_mfma_f32_16x16x32_bf16 v[48:51], v[32:35], v[104:107], v[48:51]
    s_waitcnt lgkmcnt(6)
    ds_write_addtid_b32 v108 offset:5376
    ds_read_b128 v[180:183], v3 offset:1792
    v_mfma_f32_16x16x32_bf16 v[112:115], v[72:75], a[96:99], v[252:255]
    s_add_u32 s24, s24, 1
    v_exp_f32 v69, v69
    v_mfma_f32_16x16x32_bf16 v[112:115], v[76:79], a[100:103], v[112:115]
    s_waitcnt lgkmcnt(7)
    ds_read_b128 v[184:187], v4 offset:1024
    v_perm_b32 v109, v69, v65, s49
    v_mfma_f32_16x16x32_bf16 v[112:115], v[80:83], a[104:107], v[112:115]
    s_waitcnt lgkmcnt(7)
    v_exp_f32 v70, v70
    v_mfma_f32_16x16x32_bf16 v[112:115], v[84:87], a[108:111], v[112:115]
    ds_write_addtid_b32 v109 offset:11552
    v_perm_b32 v110, v70, v66, s49
    v_mfma_f32_16x16x32_bf16 v[152:155], a[208:211], v[168:171], v[152:155]
    s_waitcnt lgkmcnt(6)
    v_exp_f32 v71, v71
    v_mfma_f32_16x16x32_bf16 v[160:163], a[208:211], v[172:175], v[160:163]
    ds_write_addtid_b32 v110 offset:17792
    v_perm_b32 v111, v71, v67, s49
    v_mfma_f32_16x16x32_bf16 v[156:159], a[212:215], v[168:171], v[156:159]
    v_exp_f32 v112, v112
    v_mfma_f32_16x16x32_bf16 v[164:167], a[212:215], v[172:175], v[164:167]
    ds_write_addtid_b32 v111 offset:23968
    ds_read_b128 v[104:107], v0 offset:4352
    v_mfma_f32_16x16x32_bf16 v[68:71], v[72:75], a[112:115], v[252:255]
    v_exp_f32 v113, v113
    v_mfma_f32_16x16x32_bf16 v[68:71], v[76:79], a[116:119], v[68:71]
    ds_read_b128 v[88:91], v5 offset:7168
    ds_read_b128 v[92:95], v6 offset:7168
    v_mfma_f32_16x16x32_bf16 v[68:71], v[80:83], a[120:123], v[68:71]
    v_exp_f32 v114, v114
    v_mfma_f32_16x16x32_bf16 v[68:71], v[84:87], a[124:127], v[68:71]
    s_waitcnt lgkmcnt(9)
    ds_read_b128 v[96:99], v7 offset:7168
    ds_read_b128 v[100:103], v8 offset:7168
    v_mfma_f32_16x16x32_bf16 v[200:203], a[208:211], v[176:179], v[200:203]
    s_waitcnt lgkmcnt(9)
    v_exp_f32 v115, v115
    v_mfma_f32_16x16x32_bf16 v[208:211], a[208:211], v[180:183], v[208:211]
    buffer_load_dwordx4 a[252:255], v31, s[16:19], s26 offen
    ds_read_b128 v[188:191], v4 offset:1280
    v_mfma_f32_16x16x32_bf16 v[204:207], a[212:215], v[176:179], v[204:207]
    v_exp_f32 v68, v68
    v_mfma_f32_16x16x32_bf16 v[212:215], a[212:215], v[180:183], v[212:215]
    s_waitcnt lgkmcnt(5)
    ds_read_b128 v[192:195], v4 offset:1536
    v_perm_b32 v108, v68, v112, s49
    v_mfma_f32_16x16x32_bf16 v[48:51], v[36:39], v[104:107], v[48:51]
    s_waitcnt lgkmcnt(5)
    ds_write_addtid_b32 v108 offset:5632
    ds_read_b128 v[196:199], v4 offset:1792
    ds_read_b32 v19, v15
    v_mfma_f32_16x16x32_bf16 v[64:67], v[88:91], a[96:99], v[252:255]
    s_waitcnt lgkmcnt(7)
    v_exp_f32 v69, v69
    v_mfma_f32_16x16x32_bf16 v[64:67], v[92:95], a[100:103], v[64:67]
    s_waitcnt lgkmcnt(6)
    ds_read_b128 v[168:171], v0 offset:2048
    v_perm_b32 v109, v69, v113, s49
    v_mfma_f32_16x16x32_bf16 v[64:67], v[96:99], a[104:107], v[64:67]
    s_waitcnt lgkmcnt(6)
    v_exp_f32 v70, v70
    v_mfma_f32_16x16x32_bf16 v[64:67], v[100:103], a[108:111], v[64:67]
    ds_write_addtid_b32 v109 offset:11808
    v_perm_b32 v110, v70, v114, s49
    v_mfma_f32_16x16x32_bf16 v[152:155], a[240:243], v[184:187], v[152:155]
    s_waitcnt lgkmcnt(6)
    v_exp_f32 v71, v71
    v_mfma_f32_16x16x32_bf16 v[160:163], a[240:243], v[188:191], v[160:163]
    ds_write_addtid_b32 v110 offset:18048
    v_perm_b32 v111, v71, v115, s49
    v_mfma_f32_16x16x32_bf16 v[156:159], a[244:247], v[184:187], v[156:159]
    v_exp_f32 v64, v64
    v_mfma_f32_16x16x32_bf16 v[164:167], a[244:247], v[188:191], v[164:167]
    ds_write_addtid_b32 v111 offset:24224
    ds_read_b128 v[104:107], v0 offset:4608
    v_mfma_f32_16x16x32_bf16 v[68:71], v[88:91], a[112:115], v[252:255]
    v_exp_f32 v65, v65
    v_mfma_f32_16x16x32_bf16 v[68:71], v[92:95], a[116:119], v[68:71]
    ds_read_b128 v[72:75], v5 offset:8192
    ds_read_b128 v[76:79], v6 offset:8192
    v_mfma_f32_16x16x32_bf16 v[68:71], v[96:99], a[120:123], v[68:71]
    v_exp_f32 v66, v66
    v_mfma_f32_16x16x32_bf16 v[68:71], v[100:103], a[124:127], v[68:71]
    s_waitcnt lgkmcnt(7)
    ds_read_b128 v[80:83], v7 offset:8192
    ds_read_b128 v[84:87], v8 offset:8192
    v_cmp_gt_u32 vcc, s24, v19
    v_mfma_f32_16x16x32_bf16 v[200:203], a[240:243], v[192:195], v[200:203]
    v_exp_f32 v67, v67
    v_mfma_f32_16x16x32_bf16 v[208:211], a[240:243], v[196:199], v[208:211]
    ds_read_b128 v[172:175], v0 offset:2304
    v_mfma_f32_16x16x32_bf16 v[204:207], a[244:247], v[192:195], v[204:207]
    v_exp_f32 v68, v68
    v_mfma_f32_16x16x32_bf16 v[212:215], a[244:247], v[196:199], v[212:215]
    s_waitcnt lgkmcnt(5)
    ds_read_b128 v[176:179], v0 offset:2560
    v_perm_b32 v108, v68, v64, s49
    v_mfma_f32_16x16x32_bf16 v[52:55], v[32:35], v[104:107], v[52:55]
    s_waitcnt lgkmcnt(5)
    ds_write_addtid_b32 v108 offset:5888
    ds_read_b128 v[180:183], v0 offset:2816
    s_cbranch_vccnz L_retry107
L_back107:
    v_mfma_f32_16x16x32_bf16 v[112:115], v[72:75], a[96:99], v[252:255]
    s_waitcnt lgkmcnt(4)
    v_exp_f32 v69, v69
    v_mfma_f32_16x16x32_bf16 v[112:115], v[76:79], a[100:103], v[112:115]
    s_mov_b32 s21, 57344
    ds_read_b128 v[184:187], v2 offset:2048
    v_perm_b32 v109, v69, v65, s49
    v_mfma_f32_16x16x32_bf16 v[112:115], v[80:83], a[104:107], v[112:115]
    s_add_u32 m0, s23, 2048
    v_exp_f32 v70, v70
    v_mfma_f32_16x16x32_bf16 v[112:115], v[84:87], a[108:111], v[112:115]
    ds_write_addtid_b32 v109 offset:23328
    v_perm_b32 v110, v70, v66, s49
    v_mfma_f32_16x16x32_bf16 v[216:219], a[144:147], v[168:171], v[216:219]
    s_waitcnt lgkmcnt(5)
    v_exp_f32 v71, v71
    v_mfma_f32_16x16x32_bf16 v[224:227], a[144:147], v[172:175], v[224:227]
    ds_write_addtid_b32 v110 offset:29568
    v_perm_b32 v111, v71, v67, s49
    v_mfma_f32_16x16x32_bf16 v[220:223], a[148:151], v[168:171], v[220:223]
    v_exp_f32 v112, v112
    v_mfma_f32_16x16x32_bf16 v[228:231], a[148:151], v[172:175], v[228:231]
    ds_write_addtid_b32 v111 offset:35744
    ds_read_b128 v[104:107], v0 offset:4864
    v_mfma_f32_16x16x32_bf16 v[68:71], v[72:75], a[112:115], v[252:255]
    v_exp_f32 v113, v113
    v_mfma_f32_16x16x32_bf16 v[68:71], v[76:79], a[116:119], v[68:71]
    ds_read_b128 v[88:91], v5 offset:9216
    ds_read_b128 v[92:95], v6 offset:9216
    v_mfma_f32_16x16x32_bf16 v[68:71], v[80:83], a[120:123], v[68:71]
    v_exp_f32 v114, v114
    v_mfma_f32_16x16x32_bf16 v[68:71], v[84:87], a[124:127], v[68:71]
    s_waitcnt lgkmcnt(9)
    ds_read_b128 v[96:99], v7 offset:9216
    ds_read_b128 v[100:103], v8 offset:9216
    v_mfma_f32_16x16x32_bf16 v[232:235], a[144:147], v[176:179], v[232:235]
    s_waitcnt lgkmcnt(9)
    v_exp_f32 v115, v115
    v_mfma_f32_16x16x32_bf16 v[240:243], a[144:147], v[180:183], v[240:243]
    s_waitcnt lgkmcnt(4)
    buffer_load_dwordx4 v9, s[4:7], s21 offen nt lds
    ds_read_b128 v[188:191], v2 offset:2304
    v_mfma_f32_16x16x32_bf16 v[236:239], a[148:151], v[176:179], v[236:239]
    s_mov_b32 s21, 61440
    v_exp_f32 v68, v68
    v_mfma_f32_16x16x32_bf16 v[244:247], a[148:151], v[180:183], v[244:247]
    s_add_u32 m0, s23, 3072
    ds_read_b128 v[192:195], v2 offset:2560
    v_perm_b32 v108, v68, v112, s49
    v_mfma_f32_16x16x32_bf16 v[52:55], v[36:39], v[104:107], v[52:55]
    s_waitcnt lgkmcnt(5)
    ds_write_addtid_b32 v108 offset:16384
    ds_read_b128 v[196:199], v2 offset:2816
    v_mfma_f32_16x16x32_bf16 v[64:67], v[88:91], a[96:99], v[252:255]
    s_waitcnt lgkmcnt(6)
    v_exp_f32 v69, v69
    v_mfma_f32_16x16x32_bf16 v[64:67], v[92:95], a[100:103], v[64:67]
    s_waitcnt lgkmcnt(5)
    ds_read_b128 v[168:171], v3 offset:2048
    v_perm_b32 v109, v69, v113, s49
    v_mfma_f32_16x16x32_bf16 v[64:67], v[96:99], a[104:107], v[64:67]
    s_waitcnt lgkmcnt(5)
    v_exp_f32 v70, v70
    v_mfma_f32_16x16x32_bf16 v[64:67], v[100:103], a[108:111], v[64:67]
    ds_write_addtid_b32 v109 offset:22560
    v_perm_b32 v110, v70, v114, s49
    v_mfma_f32_16x16x32_bf16 v[216:219], a[176:179], v[184:187], v[216:219]
    s_waitcnt lgkmcnt(5)
    v_exp_f32 v71, v71
    v_mfma_f32_16x16x32_bf16 v[224:227], a[176:179], v[188:191], v[224:227]
    ds_write_addtid_b32 v110 offset:28800
    v_perm_b32 v111, v71, v115, s49
    v_mfma_f32_16x16x32_bf16 v[220:223], a[180:183], v[184:187], v[220:223]
    v_exp_f32 v64, v64
    v_mfma_f32_16x16x32_bf16 v[228:231], a[180:183], v[188:191], v[228:231]
    ds_write_addtid_b32 v111 offset:34976
    ds_read_b128 v[104:107], v0 offset:5120
    v_mfma_f32_16x16x32_bf16 v[68:71], v[88:91], a[112:115], v[252:255]
    v_exp_f32 v65, v65
    v_mfma_f32_16x16x32_bf16 v[68:71], v[92:95], a[116:119], v[68:71]
    ds_read_b128 v[72:75], v5 offset:10240
    ds_read_b128 v[76:79], v6 offset:10240
    v_mfma_f32_16x16x32_bf16 v[68:71], v[96:99], a[120:123], v[68:71]
    v_exp_f32 v66, v66
    v_mfma_f32_16x16x32_bf16 v[68:71], v[100:103], a[124:127], v[68:71]
    s_waitcnt lgkmcnt(9)
    ds_read_b128 v[80:83], v7 offset:10240
    ds_read_b128 v[84:87], v8 offset:10240
    v_mfma_f32_16x16x32_bf16 v[232:235], a[176:179], v[192:195], v[232:235]
    s_waitcnt lgkmcnt(9)
    v_exp_f32 v67, v67
    v_mfma_f32_16x16x32_bf16 v[240:243], a[176:179], v[196:199], v[240:243]
    s_waitcnt lgkmcnt(4)
    buffer_load_dwordx4 v9, s[4:7], s21 offen nt lds
    ds_read_b128 v[172:175], v3 offset:2304
    v_mfma_f32_16x16x32_bf16 v[236:239], a[180:183], v[192:195], v[236:239]
    s_mov_b32 s21, 65536
    v_exp_f32 v68, v68
    v_mfma_f32_16x16x32_bf16 v[244:247], a[180:183], v[196:199], v[244:247]
    s_add_u32 m0, s23, 4096
    ds_read_b128 v[176:179], v3 offset:2560
    v_perm_b32 v108, v68, v64, s49
    v_mfma_f32_16x16x32_bf16 v[56:59], v[32:35], v[104:107], v[56:59]
    s_waitcnt lgkmcnt(5)
    ds_write_addtid_b32 v108 offset:15616
    ds_read_b128 v[180:183], v3 offset:2816
    v_mfma_f32_16x16x32_bf16 v[112:115], v[72:75], a[96:99], v[252:255]
    s_waitcnt lgkmcnt(6)
    v_exp_f32 v69, v69
    v_mfma_f32_16x16x32_bf16 v[112:115], v[76:79], a[100:103], v[112:115]
    s_waitcnt lgkmcnt(5)
    ds_read_b128 v[184:187], v4 offset:2048
    v_perm_b32 v109, v69, v65, s49
    v_mfma_f32_16x16x32_bf16 v[112:115], v[80:83], a[104:107], v[112:115]
    s_waitcnt lgkmcnt(5)
    v_exp_f32 v70, v70
    v_mfma_f32_16x16x32_bf16 v[112:115], v[84:87], a[108:111], v[112:115]
    ds_write_addtid_b32 v109 offset:21792
    v_perm_b32 v110, v70, v66, s49
    v_mfma_f32_16x16x32_bf16 v[216:219], a[208:211], v[168:171], v[216:219]
    s_waitcnt lgkmcnt(5)
    v_exp_f32 v71, v71
    v_mfma_f32_16x16x32_bf16 v[224:227], a[208:211], v[172:175], v[224:227]
    ds_write_addtid_b32 v110 offset:28032
    v_perm_b32 v111, v71, v67, s49
    v_mfma_f32_16x16x32_bf16 v[220:223], a[212:215], v[168:171], v[220:223]
    v_exp_f32 v112, v112
    v_mfma_f32_16x16x32_bf16 v[228:231], a[212:215], v[172:175], v[228:231]
    ds_write_addtid_b32 v111 offset:34208
    ds_read_b128 v[104:107], v0 offset:5376
    v_mfma_f32_16x16x32_bf16 v[68:71], v[72:75], a[112:115], v[252:255]
    v_exp_f32 v113, v113
    v_mfma_f32_16x16x32_bf16 v[68:71], v[76:79], a[116:119], v[68:71]
    ds_read_b128 v[88:91], v5 offset:11264
    ds_read_b128 v[92:95], v6 offset:11264
    v_mfma_f32_16x16x32_bf16 v[68:71], v[80:83], a[120:123], v[68:71]
    v_exp_f32 v114, v114
    v_mfma_f32_16x16x32_bf16 v[68:71], v[84:87], a[124:127], v[68:71]
    s_waitcnt lgkmcnt(9)
    ds_read_b128 v[96:99], v7 offset:11264
    ds_read_b128 v[100:103], v8 offset:11264
    v_mfma_f32_16x16x32_bf16 v[232:235], a[208:211], v[176:179], v[232:235]
    s_waitcnt lgkmcnt(9)
    v_exp_f32 v115, v115
    v_mfma_f32_16x16x32_bf16 v[240:243], a[208:211], v[180:183], v[240:243]
    buffer_load_dwordx4 v9, s[4:7], s21 offen nt lds
    ds_read_b128 v[188:191], v4 offset:2304
    v_mfma_f32_16x16x32_bf16 v[236:239], a[212:215], v[176:179], v[236:239]
    v_exp_f32 v68, v68
    v_mfma_f32_16x16x32_bf16 v[244:247], a[212:215], v[180:183], v[244:247]
    s_waitcnt lgkmcnt(5)
    ds_read_b128 v[192:195], v4 offset:2560
    v_perm_b32 v108, v68, v112, s49
    v_mfma_f32_16x16x32_bf16 v[56:59], v[36:39], v[104:107], v[56:59]
    s_waitcnt lgkmcnt(5)
    ds_write_addtid_b32 v108 offset:15872
    ds_read_b128 v[196:199], v4 offset:2816
    v_mfma_f32_16x16x32_bf16 v[64:67], v[88:91], a[96:99], v[252:255]
    s_waitcnt lgkmcnt(6)
    v_exp_f32 v69, v69
    v_mfma_f32_16x16x32_bf16 v[64:67], v[92:95], a[100:103], v[64:67]
    s_waitcnt lgkmcnt(5)
    ds_read_b128 v[168:171], v0 offset:3072
    v_perm_b32 v109, v69, v113, s49
    v_mfma_f32_16x16x32_bf16 v[64:67], v[96:99], a[104:107], v[64:67]
    s_waitcnt lgkmcnt(5)
    v_exp_f32 v70, v70
    v_mfma_f32_16x16x32_bf16 v[64:67], v[100:103], a[108:111], v[64:67]
    ds_write_addtid_b32 v109 offset:22048
    v_perm_b32 v110, v70, v114, s49
    v_mfma_f32_16x16x32_bf16 v[216:219], a[240:243], v[184:187], v[216:219]
    s_waitcnt lgkmcnt(5)
    v_exp_f32 v71, v71
L_pad4:
    s_cbranch_execz L_pad8
    v_mfma_f32_16x16x32_bf16 v[224:227], a[240:243], v[188:191], v[224:227]
    ds_write_addtid_b32 v110 offset:28288
    v_perm_b32 v111, v71, v115, s49
    v_mfma_f32_16x16x32_bf16 v[220:223], a[244:247], v[184:187], v[220:223]
    v_exp_f32 v64, v64
    v_mfma_f32_16x16x32_bf16 v[228:231], a[244:247], v[188:191], v[228:231]
    ds_write_addtid_b32 v111 offset:34464
    ds_read_b128 v[104:107], v0 offset:5632
    v_mfma_f32_16x16x32_bf16 v[68:71], v[88:91], a[112:115], v[252:255]
    v_exp_f32 v65, v65
    v_mfma_f32_16x16x32_bf16 v[68:71], v[92:95], a[116:119], v[68:71]
    ds_read_b128 v[72:75], v5 offset:12288
    ds_read_b128 v[76:79], v6 offset:12288
    v_mfma_f32_16x16x32_bf16 v[68:71], v[96:99], a[120:123], v[68:71]
    v_exp_f32 v66, v66
    v_mfma_f32_16x16x32_bf16 v[68:71], v[100:103], a[124:127], v[68:71]
    s_waitcnt lgkmcnt(9)
    ds_read_b128 v[80:83], v7 offset:12288
    ds_read_b128 v[84:87], v8 offset:12288
    v_mfma_f32_16x16x32_bf16 v[232:235], a[240:243], v[192:195], v[232:235]
    s_waitcnt lgkmcnt(9)
    v_exp_f32 v67, v67
    v_mfma_f32_16x16x32_bf16 v[240:243], a[240:243], v[196:199], v[240:243]
    ds_read_b128 v[172:175], v0 offset:3328
    v_mfma_f32_16x16x32_bf16 v[236:239], a[244:247], v[192:195], v[236:239]
    v_exp_f32 v68, v68
    v_mfma_f32_16x16x32_bf16 v[244:247], a[244:247], v[196:199], v[244:247]
    s_waitcnt lgkmcnt(5)
    ds_read_b128 v[176:179], v0 offset:3584
    v_perm_b32 v108, v68, v64, s49
    v_mfma_f32_16x16x32_bf16 v[60:63], v[32:35], v[104:107], v[60:63]
    ds_write_addtid_b32 v108 offset:16128
    ds_read_b128 v[180:183], v0 offset:3840
    s_waitcnt vmcnt(9) lgkmcnt(7)
    ds_write_b128 v1, a[152:155] offset:0
    ds_write_b128 v1, a[156:159] offset:12416
    ds_read_b64_tr_b16 a[152:153], v1 offset:0
    ds_read_b64_tr_b16 a[154:155], v1 offset:12416
    ds_read_b64_tr_b16 a[156:157], v1 offset:8
    ds_read_b64_tr_b16 a[158:159], v1 offset:12424
    v_mfma_f32_16x16x32_bf16 v[112:115], v[72:75], a[0:3], v[252:255]
    s_waitcnt vmcnt(8) lgkmcnt(12)
    ds_write_b128 v1, a[184:187] offset:0
    v_exp_f32 v69, v69
    v_mfma_f32_16x16x32_bf16 v[112:115], v[76:79], a[4:7], v[112:115]
    s_waitcnt vmcnt(7) lgkmcnt(11)
    ds_read_b128 v[184:187], v2 offset:3072
    v_perm_b32 v109, v69, v65, s49
    v_mfma_f32_16x16x32_bf16 v[112:115], v[80:83], a[8:11], v[112:115]
    s_mov_b32 s21, 69632
    ds_write_b128 v1, a[188:191] offset:12416
    v_exp_f32 v70, v70
    v_mfma_f32_16x16x32_bf16 v[112:115], v[84:87], a[12:15], v[112:115]
    s_waitcnt lgkmcnt(5)
    ds_write_addtid_b32 v109 offset:22304
    ds_read_b64_tr_b16 a[184:185], v1 offset:0
    v_perm_b32 v110, v70, v66, s49
    v_mfma_f32_16x16x32_bf16 v[120:123], a[152:155], v[168:171], v[120:123]
    ds_read_b64_tr_b16 a[186:187], v1 offset:12416
    v_exp_f32 v71, v71
    v_mfma_f32_16x16x32_bf16 v[128:131], a[152:155], v[172:175], v[128:131]
    s_waitcnt lgkmcnt(6)
    ds_write_addtid_b32 v110 offset:28544
    ds_read_b64_tr_b16 a[188:189], v1 offset:8
    v_perm_b32 v111, v71, v67, s49
    v_mfma_f32_16x16x32_bf16 v[124:127], a[156:159], v[168:171], v[124:127]
    ds_read_b64_tr_b16 a[190:191], v1 offset:12424
    v_exp_f32 v112, v112
    v_mfma_f32_16x16x32_bf16 v[132:135], a[156:159], v[172:175], v[132:135]
    ds_write_addtid_b32 v111 offset:34720
    ds_read_b128 v[104:107], v0 offset:5888
    v_mfma_f32_16x16x32_bf16 v[68:71], v[72:75], a[16:19], v[252:255]
    v_exp_f32 v113, v113
    v_mfma_f32_16x16x32_bf16 v[68:71], v[76:79], a[20:23], v[68:71]
    ds_read_b128 v[88:91], v5 offset:13312
    ds_write_b32 v28, v48 offset:1024
    v_mfma_f32_16x16x32_bf16 v[68:71], v[80:83], a[24:27], v[68:71]
    v_exp_f32 v114, v114
    v_mfma_f32_16x16x32_bf16 v[68:71], v[84:87], a[28:31], v[68:71]
    ds_write_b32 v29, v52 offset:0
    v_mfma_f32_16x16x32_bf16 v[136:139], a[152:155], v[176:179], v[136:139]
    v_exp_f32 v115, v115
    v_mfma_f32_16x16x32_bf16 v[144:147], a[152:155], v[180:183], v[144:147]
    ds_read_b128 v[188:191], v2 offset:3328
    ds_write_b32 v29, v56 offset:512
    v_mfma_f32_16x16x32_bf16 v[140:143], a[156:159], v[176:179], v[140:143]
    v_exp_f32 v68, v68
    v_mfma_f32_16x16x32_bf16 v[148:151], a[156:159], v[180:183], v[148:151]
    s_waitcnt lgkmcnt(5)
    ds_read_b128 v[192:195], v2 offset:3584
    v_perm_b32 v108, v68, v112, s49
    v_mfma_f32_16x16x32_bf16 v[60:63], v[36:39], v[104:107], v[60:63]
    s_waitcnt vmcnt(6)
    ds_write_addtid_b32 v108 offset:10240
    ds_read_b128 v[196:199], v2 offset:3840
    v_mfma_f32_16x16x32_bf16 v[64:67], v[72:75], a[32:35], v[252:255]
    s_add_u32 m0, s23, 5120
    ds_write_b128 v1, a[216:219] offset:0
    v_exp_f32 v69, v69
    v_mfma_f32_16x16x32_bf16 v[64:67], v[76:79], a[36:39], v[64:67]
    ds_read_b128 v[168:171], v3 offset:3072
    v_perm_b32 v109, v69, v113, s49
    v_mfma_f32_16x16x32_bf16 v[64:67], v[80:83], a[40:43], v[64:67]
    s_waitcnt vmcnt(5)
    ds_write_b128 v1, a[220:223] offset:12416
    v_exp_f32 v70, v70
    v_mfma_f32_16x16x32_bf16 v[64:67], v[84:87], a[44:47], v[64:67]
    ds_write_addtid_b32 v109 offset:15392
    ds_read_b64_tr_b16 a[216:217], v1 offset:0
    v_perm_b32 v110, v70, v114, s49
    v_mfma_f32_16x16x32_bf16 v[120:123], a[184:187], v[184:187], v[120:123]
    s_waitcnt lgkmcnt(9)
    ds_read_b64_tr_b16 a[218:219], v1 offset:12416
    v_exp_f32 v71, v71
    v_mfma_f32_16x16x32_bf16 v[128:131], a[184:187], v[188:191], v[128:131]
    ds_write_addtid_b32 v110 offset:21632
    ds_read_b64_tr_b16 a[220:221], v1 offset:8
    v_perm_b32 v111, v71, v115, s49
    v_mfma_f32_16x16x32_bf16 v[124:127], a[188:191], v[184:187], v[124:127]
    v_exp_f32 v64, v64
    v_mfma_f32_16x16x32_bf16 v[132:135], a[188:191], v[188:191], v[132:135]
    ds_write_addtid_b32 v111 offset:27808
    ds_read_b128 v[104:107], v0 offset:0
    v_mfma_f32_16x16x32_bf16 v[68:71], v[72:75], a[48:51], v[252:255]
    v_exp_f32 v65, v65
    v_mfma_f32_16x16x32_bf16 v[68:71], v[76:79], a[52:55], v[68:71]
    ds_read_b128 v[92:95], v6 offset:13312
    ds_read_b64_tr_b16 a[222:223], v1 offset:12424
    v_mfma_f32_16x16x32_bf16 v[68:71], v[80:83], a[56:59], v[68:71]
    v_exp_f32 v66, v66
    v_mfma_f32_16x16x32_bf16 v[68:71], v[84:87], a[60:63], v[68:71]
    s_waitcnt lgkmcnt(14)
    ds_write_b32 v29, v60 offset:1024
    v_mfma_f32_16x16x32_bf16 v[136:139], a[184:187], v[192:195], v[136:139]
    s_waitcnt lgkmcnt(13)
    v_exp_f32 v67, v67
    v_mfma_f32_16x16x32_bf16 v[144:147], a[184:187], v[196:199], v[144:147]
    s_waitcnt vmcnt(1)
    ds_read_b128 v[172:175], v3 offset:3328
    ds_add_u32 v14, v16
    v_mfma_f32_16x16x32_bf16 v[140:143], a[188:191], v[192:195], v[140:143]
    v_exp_f32 v68, v68
    v_mfma_f32_16x16x32_bf16 v[148:151], a[188:191], v[196:199], v[148:151]
    s_waitcnt lgkmcnt(5)
    ds_read_b128 v[176:179], v3 offset:3584
    v_perm_b32 v108, v68, v64, s49
    v_mfma_f32_16x16x32_bf16 v[40:43], v[32:35], v[104:107], 0
    ds_write_addtid_b32 v108 offset:9472
    ds_read_b128 v[180:183], v3 offset:3840
    v_mfma_f32_16x16x32_bf16 v[112:115], v[72:75], a[64:67], v[252:255]
    s_add_u32 s24, s24, 1
    ds_write_b128 v1, a[248:251] offset:0
    v_exp_f32 v69, v69
    v_mfma_f32_16x16x32_bf16 v[112:115], v[76:79], a[68:71], v[112:115]
    ds_read_b128 v[184:187], v4 offset:3072
    v_perm_b32 v109, v69, v65, s49
    v_mfma_f32_16x16x32_bf16 v[112:115], v[80:83], a[72:75], v[112:115]
    ds_write_b128 v1, a[252:255] offset:12416
    v_exp_f32 v70, v70
    v_mfma_f32_16x16x32_bf16 v[112:115], v[84:87], a[76:79], v[112:115]
    ds_write_addtid_b32 v109 offset:15648
    ds_read_b64_tr_b16 a[248:249], v1 offset:0
    v_perm_b32 v110, v70, v66, s49
    v_mfma_f32_16x16x32_bf16 v[120:123], a[216:219], v[168:171], v[120:123]
    s_waitcnt lgkmcnt(9)
    v_exp_f32 v71, v71
    v_mfma_f32_16x16x32_bf16 v[128:131], a[216:219], v[172:175], v[128:131]
    ds_write_addtid_b32 v110 offset:21888
    v_perm_b32 v111, v71, v67, s49
    v_mfma_f32_16x16x32_bf16 v[124:127], a[220:223], v[168:171], v[124:127]
    v_exp_f32 v112, v112
    v_mfma_f32_16x16x32_bf16 v[132:135], a[220:223], v[172:175], v[132:135]
    ds_write_addtid_b32 v111 offset:28064
    ds_read_b128 v[104:107], v0 offset:256
    v_mfma_f32_16x16x32_bf16 v[68:71], v[72:75], a[80:83], v[252:255]
    v_exp_f32 v113, v113
    v_mfma_f32_16x16x32_bf16 v[68:71], v[76:79], a[84:87], v[68:71]
    ds_read_b128 v[96:99], v7 offset:13312
    ds_read_b64_tr_b16 a[250:251], v1 offset:12416
    v_mfma_f32_16x16x32_bf16 v[68:71], v[80:83], a[88:91], v[68:71]
    v_exp_f32 v114, v114
    v_mfma_f32_16x16x32_bf16 v[68:71], v[84:87], a[92:95], v[68:71]
    s_waitcnt lgkmcnt(12)
    ds_read_b128 v[100:103], v8 offset:13312
    ds_read_b64_tr_b16 a[252:253], v1 offset:8
    v_mfma_f32_16x16x32_bf16 v[136:139], a[216:219], v[176:179], v[136:139]
    s_waitcnt lgkmcnt(12)
    v_exp_f32 v115, v115
    v_mfma_f32_16x16x32_bf16 v[144:147], a[216:219], v[180:183], v[144:147]
    ds_read_b128 v[188:191], v4 offset:3328
    ds_read_b64_tr_b16 a[254:255], v1 offset:12424
    v_mfma_f32_16x16x32_bf16 v[140:143], a[220:223], v[176:179], v[140:143]
    v_exp_f32 v68, v68
    v_mfma_f32_16x16x32_bf16 v[148:151], a[220:223], v[180:183], v[148:151]
    s_waitcnt lgkmcnt(6)
    ds_read_b128 v[192:195], v4 offset:3584
    v_perm_b32 v108, v68, v112, s49
    v_mfma_f32_16x16x32_bf16 v[40:43], v[32:35], v[104:107], v[40:43]
    ds_write_addtid_b32 v108 offset:9728
    ds_read_b128 v[196:199], v4 offset:3840
    ds_read_b32 v19, v15
    v_mfma_f32_16x16x32_bf16 v[64:67], v[72:75], a[96:99], v[252:255]
    v_exp_f32 v69, v69
    v_mfma_f32_16x16x32_bf16 v[64:67], v[76:79], a[100:103], v[64:67]
    ds_read_b128 v[168:171], v0 offset:4096
    v_perm_b32 v109, v69, v113, s49
    v_mfma_f32_16x16x32_bf16 v[64:67], v[80:83], a[104:107], v[64:67]
    v_exp_f32 v70, v70
    v_mfma_f32_16x16x32_bf16 v[64:67], v[84:87], a[108:111], v[64:67]
    s_waitcnt lgkmcnt(9)
    ds_write_addtid_b32 v109 offset:15904
    v_perm_b32 v110, v70, v114, s49
    v_mfma_f32_16x16x32_bf16 v[120:123], a[248:251], v[184:187], v[120:123]
    s_waitcnt lgkmcnt(7)
    v_exp_f32 v71, v71
    v_mfma_f32_16x16x32_bf16 v[128:131], a[248:251], v[188:191], v[128:131]
    s_waitcnt lgkmcnt(6)
    ds_write_addtid_b32 v110 offset:22144
    v_perm_b32 v111, v71, v115, s49
    v_mfma_f32_16x16x32_bf16 v[124:127], a[252:255], v[184:187], v[124:127]
    v_exp_f32 v64, v64
    v_mfma_f32_16x16x32_bf16 v[132:135], a[252:255], v[188:191], v[132:135]
    ds_write_addtid_b32 v111 offset:28320
    ds_read_b128 v[104:107], v0 offset:512
    v_mfma_f32_16x16x32_bf16 v[68:71], v[72:75], a[112:115], v[252:255]
    v_exp_f32 v65, v65
    v_mfma_f32_16x16x32_bf16 v[68:71], v[76:79], a[116:119], v[68:71]
    buffer_load_dwordx4 v9, s[4:7], s21 offen nt lds
    v_mfma_f32_16x16x32_bf16 v[68:71], v[80:83], a[120:123], v[68:71]
    v_exp_f32 v66, v66
    v_mfma_f32_16x16x32_bf16 v[68:71], v[84:87], a[124:127], v[68:71]
    s_waitcnt lgkmcnt(5)
    v_cmp_gt_u32 vcc, s24, v19
    v_mfma_f32_16x16x32_bf16 v[136:139], a[248:251], v[192:195], v[136:139]
    v_exp_f32 v67, v67
    v_mfma_f32_16x16x32_bf16 v[144:147], a[248:251], v[196:199], v[144:147]
    ds_read_b128 v[172:175], v0 offset:4352
    v_mfma_f32_16x16x32_bf16 v[140:143], a[252:255], v[192:195], v[140:143]
    v_exp_f32 v68, v68
    v_mfma_f32_16x16x32_bf16 v[148:151], a[252:255], v[196:199], v[148:151]
    s_waitcnt lgkmcnt(1)
    ds_read_b128 v[176:179], v0 offset:4608
    v_perm_b32 v108, v68, v64, s49
    v_mfma_f32_16x16x32_bf16 v[40:43], v[32:35], v[104:107], v[40:43]
    ds_write_addtid_b32 v108 offset:9984
    ds_read_b128 v[180:183], v0 offset:4864
    s_cbranch_vccnz L_retry109
L_back109:
    v_mfma_f32_16x16x32_bf16 v[112:115], v[88:91], a[0:3], v[252:255]
    s_waitcnt lgkmcnt(3)
    v_exp_f32 v69, v69
    v_mfma_f32_16x16x32_bf16 v[112:115], v[92:95], a[4:7], v[112:115]
    s_mov_b32 s26, 0
    ds_read_b128 v[184:187], v2 offset:4096
    ds_read_b128 v[24:27], v13 offset:4096
    v_perm_b32 v109, v69, v65, s49
    v_mfma_f32_16x16x32_bf16 v[112:115], v[96:99], a[8:11], v[112:115]
    s_mov_b32 s27, 4096
    v_exp_f32 v70, v70
    v_mfma_f32_16x16x32_bf16 v[112:115], v[100:103], a[12:15], v[112:115]
    s_mov_b32 s21, 73728
    ds_write_addtid_b32 v109 offset:16160
    v_perm_b32 v110, v70, v66, s49
    v_mfma_f32_16x16x32_bf16 v[152:155], a[152:155], v[168:171], v[152:155]
    s_add_u32 m0, s23, 6144
    v_exp_f32 v71, v71
    v_mfma_f32_16x16x32_bf16 v[160:163], a[152:155], v[172:175], v[160:163]
    ds_write_addtid_b32 v110 offset:21376
    v_perm_b32 v111, v71, v67, s49
    v_mfma_f32_16x16x32_bf16 v[156:159], a[156:159], v[168:171], v[156:159]
    v_exp_f32 v112, v112
    v_mfma_f32_16x16x32_bf16 v[164:167], a[156:159], v[172:175], v[164:167]
    ds_write_addtid_b32 v111 offset:27552
    ds_read_b128 v[104:107], v0 offset:768
    v_mfma_f32_16x16x32_bf16 v[68:71], v[88:91], a[16:19], v[252:255]
    v_exp_f32 v113, v113
    v_mfma_f32_16x16x32_bf16 v[68:71], v[92:95], a[20:23], v[68:71]
    s_waitcnt lgkmcnt(4)
    ds_read_b128 v[72:75], v5 offset:2048
    v_add_f32 v24, v24, v25
    v_add_f32 v26, v26, v27
    v_mfma_f32_16x16x32_bf16 v[68:71], v[96:99], a[24:27], v[68:71]
    v_exp_f32 v114, v114
    v_add_f32 v248, v24, v26
    v_mfma_f32_16x16x32_bf16 v[68:71], v[100:103], a[28:31], v[68:71]
    ds_read_b128 v[24:27], v13 offset:4352
    v_rcp_f32 v248, v248
    v_mfma_f32_16x16x32_bf16 v[200:203], a[152:155], v[176:179], v[200:203]
    v_exp_f32 v115, v115
    v_mul_f32 v120, v248, v120
    v_mfma_f32_16x16x32_bf16 v[208:211], a[152:155], v[180:183], v[208:211]
    ds_read_b128 v[188:191], v2 offset:4352
    v_mul_f32 v121, v248, v121
    v_mul_f32 v122, v248, v122
    v_mfma_f32_16x16x32_bf16 v[204:207], a[156:159], v[176:179], v[204:207]
    v_exp_f32 v68, v68
    v_mul_f32 v123, v248, v123
    v_mfma_f32_16x16x32_bf16 v[212:215], a[156:159], v[180:183], v[212:215]
    s_waitcnt lgkmcnt(3)
    ds_read_b128 v[192:195], v2 offset:4608
    v_perm_b32 v108, v68, v112, s49
    v_mul_f32 v124, v248, v124
    v_mfma_f32_16x16x32_bf16 v[40:43], v[32:35], v[104:107], v[40:43]
    ds_write_addtid_b32 v108 offset:9216
    ds_read_b128 v[196:199], v2 offset:4864
    v_mul_f32 v125, v248, v125
    v_mfma_f32_16x16x32_bf16 v[64:67], v[88:91], a[32:35], v[252:255]
    v_exp_f32 v69, v69
    v_mul_f32 v126, v248, v126
    v_mfma_f32_16x16x32_bf16 v[64:67], v[92:95], a[36:39], v[64:67]
    ds_read_b128 v[168:171], v3 offset:4096
    v_perm_b32 v109, v69, v113, s49
    v_mul_f32 v127, v248, v127
    v_mfma_f32_16x16x32_bf16 v[64:67], v[96:99], a[40:43], v[64:67]
    v_exp_f32 v70, v70
    v_bitop3_b32 v17, v17, v248, s29 bitop3:0xe8
    v_mfma_f32_16x16x32_bf16 v[64:67], v[100:103], a[44:47], v[64:67]
    ds_write_addtid_b32 v109 offset:15392
    v_perm_b32 v110, v70, v114, s49
    v_cvt_pk_bf16_f32 v120, v120, v121
    v_mfma_f32_16x16x32_bf16 v[152:155], a[184:187], v[184:187], v[152:155]
    s_waitcnt lgkmcnt(5)
    v_exp_f32 v71, v71
    v_cvt_pk_bf16_f32 v121, v122, v123
    v_mfma_f32_16x16x32_bf16 v[160:163], a[184:187], v[188:191], v[160:163]
    ds_write_addtid_b32 v110 offset:21632
    v_perm_b32 v111, v71, v115, s49
    v_cvt_pk_bf16_f32 v122, v124, v125
    v_mfma_f32_16x16x32_bf16 v[156:159], a[188:191], v[184:187], v[156:159]
    v_exp_f32 v64, v64
    v_cvt_pk_bf16_f32 v123, v126, v127
    v_mfma_f32_16x16x32_bf16 v[164:167], a[188:191], v[188:191], v[164:167]
    buffer_store_dwordx4 v[120:123], v11, s[8:11], s26 offen nt
    buffer_load_dwordx4 v9, s[4:7], s21 offen nt lds
    ds_write_addtid_b32 v111 offset:27808
    ds_read_b128 v[104:107], v0 offset:1024
    v_add_f32 v24, v24, v25
    v_add_f32 v26, v26, v27
    v_add_f32 v249, v24, v26
    v_rcp_f32 v249, v249
    v_mfma_f32_16x16x32_bf16 v[68:71], v[88:91], a[48:51], v[252:255]
    s_mov_b32 s21, 77824
    v_exp_f32 v65, v65
    v_mul_f32 v128, v249, v128
    v_mfma_f32_16x16x32_bf16 v[68:71], v[92:95], a[52:55], v[68:71]
    s_add_u32 m0, s23, 7168
    ds_read_b128 v[76:79], v6 offset:2048
    v_mul_f32 v129, v249, v129
    v_mfma_f32_16x16x32_bf16 v[68:71], v[96:99], a[56:59], v[68:71]
    v_exp_f32 v66, v66
    v_mfma_f32_16x16x32_bf16 v[68:71], v[100:103], a[60:63], v[68:71]
    s_waitcnt lgkmcnt(8)
    v_mul_f32 v130, v249, v130
    v_mul_f32 v131, v249, v131
    v_mfma_f32_16x16x32_bf16 v[200:203], a[184:187], v[192:195], v[200:203]
    s_waitcnt lgkmcnt(6)
    v_exp_f32 v67, v67
    v_mfma_f32_16x16x32_bf16 v[208:211], a[184:187], v[196:199], v[208:211]
    ds_read_b128 v[172:175], v3 offset:4352
    v_mul_f32 v132, v249, v132
    v_mfma_f32_16x16x32_bf16 v[204:207], a[188:191], v[192:195], v[204:207]
    v_exp_f32 v68, v68
    v_mfma_f32_16x16x32_bf16 v[212:215], a[188:191], v[196:199], v[212:215]
    s_waitcnt lgkmcnt(2)
    ds_read_b128 v[176:179], v3 offset:4608
    v_perm_b32 v108, v68, v64, s49
    v_mfma_f32_16x16x32_bf16 v[40:43], v[36:39], v[104:107], v[40:43]
    ds_write_addtid_b32 v108 offset:8448
    ds_read_b128 v[180:183], v3 offset:4864
    v_mfma_f32_16x16x32_bf16 v[112:115], v[88:91], a[64:67], v[252:255]
    v_exp_f32 v69, v69
    v_mfma_f32_16x16x32_bf16 v[112:115], v[92:95], a[68:71], v[112:115]
    ds_read_b128 v[184:187], v4 offset:4096
    v_perm_b32 v109, v69, v65, s49
    v_mfma_f32_16x16x32_bf16 v[112:115], v[96:99], a[72:75], v[112:115]
    v_exp_f32 v70, v70
    v_mfma_f32_16x16x32_bf16 v[112:115], v[100:103], a[76:79], v[112:115]
    ds_write_addtid_b32 v109 offset:14624
    v_perm_b32 v110, v70, v66, s49
    v_mfma_f32_16x16x32_bf16 v[152:155], a[216:219], v[168:171], v[152:155]
    s_waitcnt lgkmcnt(5)
    v_exp_f32 v71, v71
    v_mfma_f32_16x16x32_bf16 v[160:163], a[216:219], v[172:175], v[160:163]
    ds_write_addtid_b32 v110 offset:20864
    v_perm_b32 v111, v71, v67, s49
    v_mfma_f32_16x16x32_bf16 v[156:159], a[220:223], v[168:171], v[156:159]
    v_exp_f32 v112, v112
    v_mfma_f32_16x16x32_bf16 v[164:167], a[220:223], v[172:175], v[164:167]
    ds_write_addtid_b32 v111 offset:27040
    ds_read_b128 v[104:107], v0 offset:1280
    v_mfma_f32_16x16x32_bf16 v[68:71], v[88:91], a[80:83], v[252:255]
    v_exp_f32 v113, v113
    v_mfma_f32_16x16x32_bf16 v[68:71], v[92:95], a[84:87], v[68:71]
    ds_read_b128 v[80:83], v7 offset:2048
    v_mul_f32 v133, v249, v133
    v_mfma_f32_16x16x32_bf16 v[68:71], v[96:99], a[88:91], v[68:71]
    v_exp_f32 v114, v114
    v_mfma_f32_16x16x32_bf16 v[68:71], v[100:103], a[92:95], v[68:71]
    s_waitcnt lgkmcnt(8)
    ds_read_b128 v[84:87], v8 offset:2048
    v_mul_f32 v134, v249, v134
    v_mfma_f32_16x16x32_bf16 v[200:203], a[216:219], v[176:179], v[200:203]
    s_waitcnt lgkmcnt(7)
    v_exp_f32 v115, v115
    v_mfma_f32_16x16x32_bf16 v[208:211], a[216:219], v[180:183], v[208:211]
    ds_read_b128 v[188:191], v4 offset:4352
    v_mul_f32 v135, v249, v135
    v_mfma_f32_16x16x32_bf16 v[204:207], a[220:223], v[176:179], v[204:207]
    v_exp_f32 v68, v68
    v_mfma_f32_16x16x32_bf16 v[212:215], a[220:223], v[180:183], v[212:215]
    s_waitcnt lgkmcnt(3)
    ds_read_b128 v[192:195], v4 offset:4608
    v_perm_b32 v108, v68, v112, s49
    v_mfma_f32_16x16x32_bf16 v[40:43], v[36:39], v[104:107], v[40:43]
    ds_write_addtid_b32 v108 offset:8704
    ds_read_b128 v[196:199], v4 offset:4864
    v_mfma_f32_16x16x32_bf16 v[64:67], v[88:91], a[96:99], v[252:255]
    v_exp_f32 v69, v69
    v_mfma_f32_16x16x32_bf16 v[64:67], v[92:95], a[100:103], v[64:67]
    ds_read_b128 v[168:171], v0 offset:5120
    v_perm_b32 v109, v69, v113, s49
    v_mfma_f32_16x16x32_bf16 v[64:67], v[96:99], a[104:107], v[64:67]
    v_exp_f32 v70, v70
    v_mfma_f32_16x16x32_bf16 v[64:67], v[100:103], a[108:111], v[64:67]
    ds_write_addtid_b32 v109 offset:14880
    v_perm_b32 v110, v70, v114, s49
    v_mfma_f32_16x16x32_bf16 v[152:155], a[248:251], v[184:187], v[152:155]
    s_waitcnt lgkmcnt(5)
    v_exp_f32 v71, v71
    v_mfma_f32_16x16x32_bf16 v[160:163], a[248:251], v[188:191], v[160:163]
    ds_write_addtid_b32 v110 offset:21120
    v_perm_b32 v111, v71, v115, s49
    v_mfma_f32_16x16x32_bf16 v[156:159], a[252:255], v[184:187], v[156:159]
    v_exp_f32 v64, v64
    v_mfma_f32_16x16x32_bf16 v[164:167], a[252:255], v[188:191], v[164:167]
    ds_write_addtid_b32 v111 offset:27296
    ds_read_b128 v[104:107], v0 offset:1536
    v_mfma_f32_16x16x32_bf16 v[68:71], v[88:91], a[112:115], v[252:255]
    v_exp_f32 v65, v65
    v_mfma_f32_16x16x32_bf16 v[68:71], v[92:95], a[116:119], v[68:71]
    v_bitop3_b32 v17, v17, v249, s29 bitop3:0xe8
    v_cvt_pk_bf16_f32 v128, v128, v129
    v_mfma_f32_16x16x32_bf16 v[68:71], v[96:99], a[120:123], v[68:71]
    v_exp_f32 v66, v66
    v_mfma_f32_16x16x32_bf16 v[68:71], v[100:103], a[124:127], v[68:71]
    s_waitcnt lgkmcnt(7)
    v_cvt_pk_bf16_f32 v129, v130, v131
    v_cvt_pk_bf16_f32 v130, v132, v133
    v_mfma_f32_16x16x32_bf16 v[200:203], a[248:251], v[192:195], v[200:203]
    s_waitcnt lgkmcnt(5)
    v_exp_f32 v67, v67
    v_mfma_f32_16x16x32_bf16 v[208:211], a[248:251], v[196:199], v[208:211]
    ds_read_b128 v[172:175], v0 offset:5376
    v_cvt_pk_bf16_f32 v131, v134, v135
    v_mfma_f32_16x16x32_bf16 v[204:207], a[252:255], v[192:195], v[204:207]
    buffer_store_dwordx4 v[128:131], v11, s[8:11], s27 offen nt
    buffer_load_dwordx4 v9, s[4:7], s21 offen nt lds
    v_exp_f32 v68, v68
    v_mfma_f32_16x16x32_bf16 v[212:215], a[252:255], v[196:199], v[212:215]
    s_waitcnt lgkmcnt(1)
    ds_read_b128 v[176:179], v0 offset:5632
    v_perm_b32 v108, v68, v64, s49
    v_mfma_f32_16x16x32_bf16 v[40:43], v[36:39], v[104:107], v[40:43]
    ds_write_addtid_b32 v108 offset:8960
    ds_read_b128 v[180:183], v0 offset:5888
    v_mfma_f32_16x16x32_bf16 v[112:115], v[72:75], a[0:3], v[252:255]
    s_waitcnt lgkmcnt(3)
    v_exp_f32 v69, v69
    v_mfma_f32_16x16x32_bf16 v[112:115], v[76:79], a[4:7], v[112:115]
    s_mov_b32 s26, 8192
    ds_read_b128 v[184:187], v2 offset:5120
    ds_read_b128 v[24:27], v13 offset:4608
    v_perm_b32 v109, v69, v65, s49
    v_mfma_f32_16x16x32_bf16 v[112:115], v[80:83], a[8:11], v[112:115]
    s_mov_b32 s27, 12288
    v_exp_f32 v70, v70
    v_mfma_f32_16x16x32_bf16 v[112:115], v[84:87], a[12:15], v[112:115]
    s_mov_b32 s21, 81920
    ds_write_addtid_b32 v109 offset:15136
    v_perm_b32 v110, v70, v66, s49
    v_mfma_f32_16x16x32_bf16 v[216:219], a[152:155], v[168:171], v[216:219]
    s_add_u32 m0, s23, 8192
    v_exp_f32 v71, v71
    v_mfma_f32_16x16x32_bf16 v[224:227], a[152:155], v[172:175], v[224:227]
    ds_write_addtid_b32 v110 offset:20352
    v_perm_b32 v111, v71, v67, s49
    v_mfma_f32_16x16x32_bf16 v[220:223], a[156:159], v[168:171], v[220:223]
    v_exp_f32 v112, v112
    v_mfma_f32_16x16x32_bf16 v[228:231], a[156:159], v[172:175], v[228:231]
    ds_write_addtid_b32 v111 offset:26528
    ds_read_b128 v[104:107], v0 offset:1792
    v_mfma_f32_16x16x32_bf16 v[68:71], v[72:75], a[16:19], v[252:255]
    v_exp_f32 v113, v113
    v_mfma_f32_16x16x32_bf16 v[68:71], v[76:79], a[20:23], v[68:71]
    s_waitcnt lgkmcnt(4)
    ds_read_b128 v[88:91], v5 offset:3072
    v_add_f32 v24, v24, v25
    v_add_f32 v26, v26, v27
    v_mfma_f32_16x16x32_bf16 v[68:71], v[80:83], a[24:27], v[68:71]
    v_exp_f32 v114, v114
    v_add_f32 v248, v24, v26
    v_mfma_f32_16x16x32_bf16 v[68:71], v[84:87], a[28:31], v[68:71]
    ds_read_b128 v[24:27], v13 offset:4864
    v_rcp_f32 v248, v248
    v_mfma_f32_16x16x32_bf16 v[232:235], a[152:155], v[176:179], v[232:235]
    v_exp_f32 v115, v115
    v_mul_f32 v136, v248, v136
    v_mul_f32 v137, v248, v137
    v_mfma_f32_16x16x32_bf16 v[240:243], a[152:155], v[180:183], v[240:243]
    v_bfe_i32 v1, v14, 2, 1
    v_and_b32 v1, 0xaaaaaaaa, v1
    ds_read_b128 v[188:191], v2 offset:5376
    v_mfma_f32_16x16x32_bf16 v[236:239], a[156:159], v[176:179], v[236:239]
    v_exp_f32 v68, v68
    v_mul_f32 v138, v248, v138
    v_mfma_f32_16x16x32_bf16 v[244:247], a[156:159], v[180:183], v[244:247]
    s_waitcnt lgkmcnt(3)
    ds_read_b128 v[192:195], v2 offset:5632
    v_perm_b32 v108, v68, v112, s49
    v_mul_f32 v139, v248, v139
    v_mfma_f32_16x16x32_bf16 v[40:43], v[36:39], v[104:107], v[40:43]
    ds_write_addtid_b32 v108 offset:8192
    ds_read_b128 v[196:199], v2 offset:5888
    v_mul_f32 v140, v248, v140
    v_mfma_f32_16x16x32_bf16 v[64:67], v[72:75], a[32:35], v[252:255]
    v_exp_f32 v69, v69
    v_mul_f32 v141, v248, v141
    v_mfma_f32_16x16x32_bf16 v[64:67], v[76:79], a[36:39], v[64:67]
    ds_read_b128 v[168:171], v3 offset:5120
    v_perm_b32 v109, v69, v113, s49
    v_mul_f32 v142, v248, v142
    v_mfma_f32_16x16x32_bf16 v[64:67], v[80:83], a[40:43], v[64:67]
    v_exp_f32 v70, v70
    v_mul_f32 v143, v248, v143
    v_mfma_f32_16x16x32_bf16 v[64:67], v[84:87], a[44:47], v[64:67]
    ds_write_addtid_b32 v109 offset:14368
    v_perm_b32 v110, v70, v114, s49
    v_bitop3_b32 v17, v17, v248, s29 bitop3:0xe8
    v_mfma_f32_16x16x32_bf16 v[216:219], a[184:187], v[184:187], v[216:219]
    s_waitcnt lgkmcnt(5)
    v_exp_f32 v71, v71
    v_cvt_pk_bf16_f32 v136, v136, v137
    v_mfma_f32_16x16x32_bf16 v[224:227], a[184:187], v[188:191], v[224:227]
    ds_write_addtid_b32 v110 offset:20608
    v_perm_b32 v111, v71, v115, s49
    v_cvt_pk_bf16_f32 v137, v138, v139
    v_mfma_f32_16x16x32_bf16 v[220:223], a[188:191], v[184:187], v[220:223]
    v_exp_f32 v64, v64
    v_cvt_pk_bf16_f32 v138, v140, v141
    v_mfma_f32_16x16x32_bf16 v[228:231], a[188:191], v[188:191], v[228:231]
    ds_write_addtid_b32 v111 offset:26784
    ds_read_b128 v[104:107], v0 offset:2048
    v_cvt_pk_bf16_f32 v139, v142, v143
    v_mfma_f32_16x16x32_bf16 v[68:71], v[72:75], a[48:51], v[252:255]
    buffer_store_dwordx4 v[136:139], v11, s[8:11], s26 offen nt
    buffer_load_dwordx4 v9, s[4:7], s21 offen nt lds
    v_exp_f32 v65, v65
    v_add_f32 v24, v24, v25
    v_add_f32 v26, v26, v27
    v_add_f32 v249, v24, v26
    v_rcp_f32 v249, v249
    v_mfma_f32_16x16x32_bf16 v[68:71], v[76:79], a[52:55], v[68:71]
    s_mov_b32 s21, 86016
    ds_read_b128 v[92:95], v6 offset:3072
    v_mul_f32 v144, v249, v144
    v_mul_f32 v145, v249, v145
    v_mfma_f32_16x16x32_bf16 v[68:71], v[80:83], a[56:59], v[68:71]
    s_add_u32 m0, s23, 9216
    v_exp_f32 v66, v66
    v_mul_f32 v146, v249, v146
    v_mfma_f32_16x16x32_bf16 v[68:71], v[84:87], a[60:63], v[68:71]
    s_waitcnt lgkmcnt(8)
    ds_write_b32 v12, v40 offset:0
    v_mul_f32 v147, v249, v147
    v_mfma_f32_16x16x32_bf16 v[232:235], a[184:187], v[192:195], v[232:235]
    s_waitcnt lgkmcnt(7)
    v_exp_f32 v67, v67
    v_mul_f32 v148, v249, v148
    v_mfma_f32_16x16x32_bf16 v[240:243], a[184:187], v[196:199], v[240:243]
    s_waitcnt vmcnt(6)
    ds_read_b128 v[172:175], v3 offset:5376
    ds_add_u32 v14, v16
    v_mfma_f32_16x16x32_bf16 v[236:239], a[188:191], v[192:195], v[236:239]
    v_exp_f32 v68, v68
    v_mul_f32 v149, v249, v149
    v_mfma_f32_16x16x32_bf16 v[244:247], a[188:191], v[196:199], v[244:247]
    s_waitcnt lgkmcnt(4)
    ds_read_b128 v[176:179], v3 offset:5632
    v_perm_b32 v108, v68, v64, s49
    v_mul_f32 v150, v249, v150
    v_mfma_f32_16x16x32_bf16 v[44:47], v[32:35], v[104:107], 0
    ds_write_addtid_b32 v108 offset:7424
    ds_read_b128 v[180:183], v3 offset:5888
    v_mul_f32 v151, v249, v151
    v_mfma_f32_16x16x32_bf16 v[112:115], v[72:75], a[64:67], v[252:255]
    s_add_u32 s24, s24, 1
    v_exp_f32 v69, v69
    v_mfma_f32_16x16x32_bf16 v[112:115], v[76:79], a[68:71], v[112:115]
    ds_read_b128 v[184:187], v4 offset:5120
    v_perm_b32 v109, v69, v65, s49
    v_mfma_f32_16x16x32_bf16 v[112:115], v[80:83], a[72:75], v[112:115]
    v_exp_f32 v70, v70
    v_mfma_f32_16x16x32_bf16 v[112:115], v[84:87], a[76:79], v[112:115]
    ds_write_addtid_b32 v109 offset:13600
    v_perm_b32 v110, v70, v66, s49
    v_mfma_f32_16x16x32_bf16 v[216:219], a[216:219], v[168:171], v[216:219]
    s_waitcnt lgkmcnt(6)
L_pad5:
    s_cbranch_execz L_pad9
    v_exp_f32 v71, v71
    v_mfma_f32_16x16x32_bf16 v[224:227], a[216:219], v[172:175], v[224:227]
    ds_write_addtid_b32 v110 offset:19840
    v_perm_b32 v111, v71, v67, s49
    v_mfma_f32_16x16x32_bf16 v[220:223], a[220:223], v[168:171], v[220:223]
    v_exp_f32 v112, v112
    v_mfma_f32_16x16x32_bf16 v[228:231], a[220:223], v[172:175], v[228:231]
    ds_write_addtid_b32 v111 offset:26016
    ds_read_b128 v[104:107], v0 offset:2304
    v_mfma_f32_16x16x32_bf16 v[68:71], v[72:75], a[80:83], v[252:255]
    v_exp_f32 v113, v113
    v_mfma_f32_16x16x32_bf16 v[68:71], v[76:79], a[84:87], v[68:71]
    ds_read_b128 v[96:99], v7 offset:3072
    v_bitop3_b32 v17, v17, v249, s29 bitop3:0xe8
    v_mfma_f32_16x16x32_bf16 v[68:71], v[80:83], a[88:91], v[68:71]
    v_exp_f32 v114, v114
    v_mfma_f32_16x16x32_bf16 v[68:71], v[84:87], a[92:95], v[68:71]
    s_waitcnt lgkmcnt(8)
    ds_read_b128 v[100:103], v8 offset:3072
    v_cvt_pk_bf16_f32 v144, v144, v145
    v_mfma_f32_16x16x32_bf16 v[232:235], a[216:219], v[176:179], v[232:235]
    s_waitcnt lgkmcnt(7)
    v_exp_f32 v115, v115
    v_mfma_f32_16x16x32_bf16 v[240:243], a[216:219], v[180:183], v[240:243]
    v_or_b32 v1, 0x44444444, v1
    ds_read_b128 v[188:191], v4 offset:5376
    v_mfma_f32_16x16x32_bf16 v[236:239], a[220:223], v[176:179], v[236:239]
    v_exp_f32 v68, v68
    v_mfma_f32_16x16x32_bf16 v[244:247], a[220:223], v[180:183], v[244:247]
    s_waitcnt lgkmcnt(3)
    ds_read_b128 v[192:195], v4 offset:5632
    v_perm_b32 v108, v68, v112, s49
    v_mfma_f32_16x16x32_bf16 v[44:47], v[32:35], v[104:107], v[44:47]
    ds_write_addtid_b32 v108 offset:7680
    ds_read_b128 v[196:199], v4 offset:5888
    ds_read_b32 v19, v15
    v_mfma_f32_16x16x32_bf16 v[64:67], v[72:75], a[96:99], v[252:255]
    v_exp_f32 v69, v69
    v_mfma_f32_16x16x32_bf16 v[64:67], v[76:79], a[100:103], v[64:67]
    ds_read_b128 v[168:171], v0 offset:0
    v_perm_b32 v109, v69, v113, s49
    v_mfma_f32_16x16x32_bf16 v[64:67], v[80:83], a[104:107], v[64:67]
    v_exp_f32 v70, v70
    v_mfma_f32_16x16x32_bf16 v[64:67], v[84:87], a[108:111], v[64:67]
    ds_write_addtid_b32 v109 offset:13856
    v_perm_b32 v110, v70, v114, s49
    v_mfma_f32_16x16x32_bf16 v[216:219], a[248:251], v[184:187], v[216:219]
    s_waitcnt lgkmcnt(6)
    v_exp_f32 v71, v71
    v_mfma_f32_16x16x32_bf16 v[224:227], a[248:251], v[188:191], v[224:227]
    ds_write_addtid_b32 v110 offset:20096
    v_perm_b32 v111, v71, v115, s49
    v_mfma_f32_16x16x32_bf16 v[220:223], a[252:255], v[184:187], v[220:223]
    v_exp_f32 v64, v64
    v_mfma_f32_16x16x32_bf16 v[228:231], a[252:255], v[188:191], v[228:231]
    ds_write_addtid_b32 v111 offset:26272
    ds_read_b128 v[104:107], v0 offset:2560
    v_mfma_f32_16x16x32_bf16 v[68:71], v[72:75], a[112:115], v[252:255]
    v_exp_f32 v65, v65
    v_mfma_f32_16x16x32_bf16 v[68:71], v[76:79], a[116:119], v[68:71]
    v_cvt_pk_bf16_f32 v145, v146, v147
    v_cvt_pk_bf16_f32 v146, v148, v149
    v_mfma_f32_16x16x32_bf16 v[68:71], v[80:83], a[120:123], v[68:71]
    v_exp_f32 v66, v66
    v_mfma_f32_16x16x32_bf16 v[68:71], v[84:87], a[124:127], v[68:71]
    s_waitcnt lgkmcnt(5)
    v_cmp_gt_u32 vcc, s24, v19
    v_cvt_pk_bf16_f32 v147, v150, v151
    v_mfma_f32_16x16x32_bf16 v[232:235], a[248:251], v[192:195], v[232:235]
    buffer_store_dwordx4 v[144:147], v11, s[8:11], s27 offen nt
    buffer_load_dwordx4 v9, s[4:7], s21 offen nt lds
    v_exp_f32 v67, v67
    v_mfma_f32_16x16x32_bf16 v[240:243], a[248:251], v[196:199], v[240:243]
    v_mov_b64 v[40:41], 0
    ds_read_b128 v[172:175], v0 offset:256
    v_mfma_f32_16x16x32_bf16 v[236:239], a[252:255], v[192:195], v[236:239]
    v_exp_f32 v68, v68
    v_mfma_f32_16x16x32_bf16 v[244:247], a[252:255], v[196:199], v[244:247]
    s_waitcnt lgkmcnt(1)
    ds_read_b128 v[176:179], v0 offset:512
    v_perm_b32 v108, v68, v64, s49
    v_mfma_f32_16x16x32_bf16 v[44:47], v[32:35], v[104:107], v[44:47]
    ds_write_addtid_b32 v108 offset:7936
    ds_read_b128 v[180:183], v0 offset:768
    s_cbranch_vccnz L_retry111
L_back111:
    v_mfma_f32_16x16x32_bf16 v[112:115], v[88:91], a[0:3], v[252:255]
    s_waitcnt lgkmcnt(3)
    v_exp_f32 v69, v69
    v_mfma_f32_16x16x32_bf16 v[112:115], v[92:95], a[4:7], v[112:115]
    s_mov_b32 s26, 16384
    ds_read_b128 v[184:187], v2 offset:0
    ds_read_b128 v[120:123], v13 offset:5120
    v_perm_b32 v109, v69, v65, s49
    v_mfma_f32_16x16x32_bf16 v[112:115], v[96:99], a[8:11], v[112:115]
    s_mov_b32 s27, 20480
    v_exp_f32 v70, v70
    v_mfma_f32_16x16x32_bf16 v[112:115], v[100:103], a[12:15], v[112:115]
    s_mov_b32 s21, 90112
    ds_write_addtid_b32 v109 offset:14112
    v_perm_b32 v110, v70, v66, s49
    v_mfma_f32_16x16x32_bf16 v[48:51], a[128:131], v[168:171], 0
    s_add_u32 m0, s23, 10240
    v_exp_f32 v71, v71
    v_mfma_f32_16x16x32_bf16 v[48:51], a[136:139], v[172:175], v[48:51]
    ds_write_addtid_b32 v110 offset:19328
    v_perm_b32 v111, v71, v67, s49
    v_mfma_f32_16x16x32_bf16 v[52:55], a[132:135], v[168:171], 0
    v_exp_f32 v112, v112
    v_mfma_f32_16x16x32_bf16 v[52:55], a[140:143], v[172:175], v[52:55]
    ds_write_addtid_b32 v111 offset:25504
    ds_read_b128 v[104:107], v0 offset:2816
    v_mfma_f32_16x16x32_bf16 v[68:71], v[88:91], a[16:19], v[252:255]
    v_exp_f32 v113, v113
    v_mfma_f32_16x16x32_bf16 v[68:71], v[92:95], a[20:23], v[68:71]
    s_waitcnt lgkmcnt(4)
    ds_read_b128 v[72:75], v5 offset:4096
    ds_read_b128 v[24:27], v18 offset:0
    v_add_f32 v120, v120, v121
    v_mfma_f32_16x16x32_bf16 v[68:71], v[96:99], a[24:27], v[68:71]
    v_exp_f32 v114, v114
    v_mfma_f32_16x16x32_bf16 v[68:71], v[100:103], a[28:31], v[68:71]
    v_add_f32 v122, v122, v123
    v_add_f32 v248, v120, v122
    v_mfma_f32_16x16x32_bf16 v[48:51], a[144:147], v[176:179], v[48:51]
    v_exp_f32 v115, v115
    v_mfma_f32_16x16x32_bf16 v[48:51], a[152:155], v[180:183], v[48:51]
    ds_read_b128 v[188:191], v2 offset:256
    ds_read_b128 v[120:123], v13 offset:5376
    v_mfma_f32_16x16x32_bf16 v[52:55], a[148:151], v[176:179], v[52:55]
    v_exp_f32 v68, v68
    v_mfma_f32_16x16x32_bf16 v[52:55], a[156:159], v[180:183], v[52:55]
    s_waitcnt lgkmcnt(4)
    ds_read_b128 v[192:195], v2 offset:512
    v_perm_b32 v108, v68, v112, s49
    v_mfma_f32_16x16x32_bf16 v[44:47], v[32:35], v[104:107], v[44:47]
    ds_write_addtid_b32 v108 offset:7168
    ds_read_b128 v[196:199], v2 offset:768
    v_mfma_f32_16x16x32_bf16 v[64:67], v[88:91], a[32:35], v[252:255]
    s_waitcnt lgkmcnt(5)
    v_exp_f32 v69, v69
    v_add_f32 v24, v24, v25
    v_mfma_f32_16x16x32_bf16 v[64:67], v[92:95], a[36:39], v[64:67]
    ds_read_b128 v[168:171], v3 offset:0
    v_perm_b32 v109, v69, v113, s49
    v_add_f32 v26, v26, v27
    v_mfma_f32_16x16x32_bf16 v[64:67], v[96:99], a[40:43], v[64:67]
    v_exp_f32 v70, v70
    v_add_f32 v24, v24, v26
    v_mfma_f32_16x16x32_bf16 v[64:67], v[100:103], a[44:47], v[64:67]
    ds_write_addtid_b32 v109 offset:13344
    v_perm_b32 v110, v70, v114, s49
    v_rcp_f32 v248, v248
    v_mfma_f32_16x16x32_bf16 v[48:51], a[160:163], v[184:187], v[48:51]
    s_waitcnt lgkmcnt(6)
    v_exp_f32 v71, v71
    v_mul_f32 v152, v248, v152
    v_mfma_f32_16x16x32_bf16 v[48:51], a[168:171], v[188:191], v[48:51]
    ds_write_addtid_b32 v110 offset:19584
    v_perm_b32 v111, v71, v115, s49
    v_mul_f32 v153, v248, v153
    v_mfma_f32_16x16x32_bf16 v[52:55], a[164:167], v[184:187], v[52:55]
    v_exp_f32 v64, v64
    v_mul_f32 v154, v248, v154
    v_mfma_f32_16x16x32_bf16 v[52:55], a[172:175], v[188:191], v[52:55]
    ds_write_addtid_b32 v111 offset:25760
    ds_read_b128 v[104:107], v0 offset:3072
    v_mul_f32 v155, v248, v155
    v_mfma_f32_16x16x32_bf16 v[68:71], v[88:91], a[48:51], v[252:255]
    v_exp_f32 v65, v65
    v_mul_f32 v156, v248, v156
    v_mfma_f32_16x16x32_bf16 v[68:71], v[92:95], a[52:55], v[68:71]
    ds_read_b128 v[76:79], v6 offset:4096
    v_mul_f32 v157, v248, v157
    v_mul_f32 v158, v248, v158
    v_mfma_f32_16x16x32_bf16 v[68:71], v[96:99], a[56:59], v[68:71]
    v_exp_f32 v66, v66
    v_mul_f32 v159, v248, v159
    v_mfma_f32_16x16x32_bf16 v[68:71], v[100:103], a[60:63], v[68:71]
    s_waitcnt lgkmcnt(8)
    v_bitop3_b32 v17, v17, v248, s29 bitop3:0xe8
    v_cvt_pk_bf16_f32 v152, v152, v153
    v_cvt_pk_bf16_f32 v153, v154, v155
    v_mfma_f32_16x16x32_bf16 v[48:51], a[176:179], v[192:195], v[48:51]
    s_waitcnt lgkmcnt(6)
    v_exp_f32 v67, v67
    v_cvt_pk_bf16_f32 v154, v156, v157
    v_mfma_f32_16x16x32_bf16 v[48:51], a[184:187], v[196:199], v[48:51]
    ds_read_b128 v[172:175], v3 offset:256
    v_cvt_pk_bf16_f32 v155, v158, v159
    v_mfma_f32_16x16x32_bf16 v[52:55], a[180:183], v[192:195], v[52:55]
    buffer_store_dwordx4 v[152:155], v11, s[8:11], s26 offen nt
    v_exp_f32 v68, v68
    v_rcp_f32 v20, v24
    v_mfma_f32_16x16x32_bf16 v[52:55], a[188:191], v[196:199], v[52:55]
    s_waitcnt lgkmcnt(2)
    ds_read_b128 v[176:179], v3 offset:512
    v_perm_b32 v108, v68, v64, s49
    v_bitop3_b32 v17, v17, v20, s29 bitop3:0xe8
    v_mfma_f32_16x16x32_bf16 v[44:47], v[36:39], v[104:107], v[44:47]
    ds_write_addtid_b32 v108 offset:7424
    ds_read_b128 v[180:183], v3 offset:768
    v_mov_b32 v21, v20
    v_mfma_f32_16x16x32_bf16 v[112:115], v[88:91], a[64:67], v[252:255]
    v_exp_f32 v69, v69
    v_permlane32_swap_b32 v20, v21
    v_mfma_f32_16x16x32_bf16 v[112:115], v[92:95], a[68:71], v[112:115]
    ds_read_b128 v[184:187], v4 offset:0
    v_perm_b32 v109, v69, v65, s49
    v_add_f32 v120, v120, v121
    v_mfma_f32_16x16x32_bf16 v[112:115], v[96:99], a[72:75], v[112:115]
    v_exp_f32 v70, v70
    v_add_f32 v122, v122, v123
    v_mfma_f32_16x16x32_bf16 v[112:115], v[100:103], a[76:79], v[112:115]
    ds_write_addtid_b32 v109 offset:13600
    v_perm_b32 v110, v70, v66, s49
    v_add_f32 v249, v120, v122
    v_mfma_f32_16x16x32_bf16 v[48:51], a[192:195], v[168:171], v[48:51]
    s_waitcnt lgkmcnt(5)
    v_exp_f32 v71, v71
    v_mfma_f32_16x16x32_bf16 v[48:51], a[200:203], v[172:175], v[48:51]
    ds_write_addtid_b32 v110 offset:19840
    v_perm_b32 v111, v71, v67, s49
    v_mfma_f32_16x16x32_bf16 v[52:55], a[196:199], v[168:171], v[52:55]
    v_exp_f32 v112, v112
    v_mfma_f32_16x16x32_bf16 v[52:55], a[204:207], v[172:175], v[52:55]
    ds_write_addtid_b32 v111 offset:26016
    ds_read_b128 v[104:107], v0 offset:3328
    v_mfma_f32_16x16x32_bf16 v[68:71], v[88:91], a[80:83], v[252:255]
    v_exp_f32 v113, v113
    v_mfma_f32_16x16x32_bf16 v[68:71], v[92:95], a[84:87], v[68:71]
    ds_read_b128 v[80:83], v7 offset:4096
    v_rcp_f32 v249, v249
    v_mfma_f32_16x16x32_bf16 v[68:71], v[96:99], a[88:91], v[68:71]
    v_exp_f32 v114, v114
    v_mul_f32 v160, v249, v160
    v_mfma_f32_16x16x32_bf16 v[68:71], v[100:103], a[92:95], v[68:71]
    s_waitcnt lgkmcnt(8)
    ds_read_b128 v[84:87], v8 offset:4096
    v_mul_f32 v161, v249, v161
    v_mul_f32 v162, v249, v162
    v_mfma_f32_16x16x32_bf16 v[48:51], a[208:211], v[176:179], v[48:51]
    s_waitcnt lgkmcnt(7)
    v_exp_f32 v115, v115
    v_mul_f32 v163, v249, v163
    v_mfma_f32_16x16x32_bf16 v[48:51], a[216:219], v[180:183], v[48:51]
    ds_read_b128 v[188:191], v4 offset:256
    v_mul_f32 v164, v249, v164
    v_mul_f32 v165, v249, v165
    v_mfma_f32_16x16x32_bf16 v[52:55], a[212:215], v[176:179], v[52:55]
    v_exp_f32 v68, v68
    v_mul_f32 v166, v249, v166
    v_mfma_f32_16x16x32_bf16 v[52:55], a[220:223], v[180:183], v[52:55]
    s_waitcnt lgkmcnt(3)
    ds_read_b128 v[192:195], v4 offset:512
    v_perm_b32 v108, v68, v112, s49
    v_mul_f32 v167, v249, v167
    v_mfma_f32_16x16x32_bf16 v[44:47], v[36:39], v[104:107], v[44:47]
    ds_write_addtid_b32 v108 offset:7680
    ds_read_b128 v[196:199], v4 offset:768
    v_mfma_f32_16x16x32_bf16 v[64:67], v[88:91], a[96:99], v[252:255]
    v_exp_f32 v69, v69
    v_mfma_f32_16x16x32_bf16 v[64:67], v[92:95], a[100:103], v[64:67]
    ds_read_b128 v[168:171], v0 offset:1024
    v_perm_b32 v109, v69, v113, s49
    v_mfma_f32_16x16x32_bf16 v[64:67], v[96:99], a[104:107], v[64:67]
    v_exp_f32 v70, v70
    v_mfma_f32_16x16x32_bf16 v[64:67], v[100:103], a[108:111], v[64:67]
    ds_write_addtid_b32 v109 offset:13856
    v_perm_b32 v110, v70, v114, s49
    v_mfma_f32_16x16x32_bf16 v[48:51], a[224:227], v[184:187], v[48:51]
    s_waitcnt lgkmcnt(5)
    v_exp_f32 v71, v71
    v_mfma_f32_16x16x32_bf16 v[48:51], a[232:235], v[188:191], v[48:51]
    ds_write_addtid_b32 v110 offset:20096
    v_perm_b32 v111, v71, v115, s49
    v_mfma_f32_16x16x32_bf16 v[52:55], a[228:231], v[184:187], v[52:55]
    v_exp_f32 v64, v64
    v_mfma_f32_16x16x32_bf16 v[52:55], a[236:239], v[188:191], v[52:55]
    ds_write_addtid_b32 v111 offset:26272
    ds_read_b128 v[104:107], v0 offset:3584
    v_mfma_f32_16x16x32_bf16 v[68:71], v[88:91], a[112:115], v[252:255]
    v_exp_f32 v65, v65
    v_mfma_f32_16x16x32_bf16 v[68:71], v[92:95], a[116:119], v[68:71]
    v_bitop3_b32 v17, v17, v249, s29 bitop3:0xe8
    v_cvt_pk_bf16_f32 v160, v160, v161
    v_mfma_f32_16x16x32_bf16 v[68:71], v[96:99], a[120:123], v[68:71]
    v_exp_f32 v66, v66
    v_mfma_f32_16x16x32_bf16 v[68:71], v[100:103], a[124:127], v[68:71]
    s_waitcnt lgkmcnt(7)
    v_cvt_pk_bf16_f32 v161, v162, v163
    v_cvt_pk_bf16_f32 v162, v164, v165
    v_mfma_f32_16x16x32_bf16 v[48:51], a[240:243], v[192:195], v[48:51]
    s_waitcnt lgkmcnt(5)
    v_exp_f32 v67, v67
    v_mfma_f32_16x16x32_bf16 v[48:51], a[248:251], v[196:199], v[48:51]
    ds_read_b128 v[172:175], v0 offset:1280
    v_cvt_pk_bf16_f32 v163, v166, v167
    v_mfma_f32_16x16x32_bf16 v[52:55], a[244:247], v[192:195], v[52:55]
    buffer_store_dwordx4 v[160:163], v11, s[8:11], s27 offen nt
    buffer_load_dwordx4 v9, s[4:7], s21 offen nt lds
    v_exp_f32 v68, v68
    v_mfma_f32_16x16x32_bf16 v[52:55], a[252:255], v[196:199], v[52:55]
    s_waitcnt lgkmcnt(1)
    ds_read_b128 v[176:179], v0 offset:1536
    v_perm_b32 v108, v68, v64, s49
    v_mfma_f32_16x16x32_bf16 v[44:47], v[36:39], v[104:107], v[44:47]
    ds_write_addtid_b32 v108 offset:7936
    ds_read_b128 v[180:183], v0 offset:1792
    v_mfma_f32_16x16x32_bf16 v[164:167], v[72:75], a[0:3], v[252:255]
    s_waitcnt lgkmcnt(3)
    v_exp_f32 v69, v69
    v_mfma_f32_16x16x32_bf16 v[164:167], v[76:79], a[4:7], v[164:167]
    s_mov_b32 s26, 24576
    ds_read_b128 v[184:187], v2 offset:1024
    ds_read_b128 v[120:123], v13 offset:5632
    v_perm_b32 v109, v69, v65, s49
    v_mfma_f32_16x16x32_bf16 v[164:167], v[80:83], a[8:11], v[164:167]
    s_mov_b32 s27, 28672
    v_exp_f32 v70, v70
    v_mfma_f32_16x16x32_bf16 v[164:167], v[84:87], a[12:15], v[164:167]
    s_mov_b32 s21, 94208
    ds_write_addtid_b32 v109 offset:14112
    v_perm_b32 v110, v70, v66, s49
    v_mul_f32 v48, v20, v48
    v_mfma_f32_16x16x32_bf16 v[56:59], a[128:131], v[168:171], 0
    s_add_u32 m0, s23, 11264
    v_exp_f32 v71, v71
    v_mul_f32 v49, v20, v49
    v_mfma_f32_16x16x32_bf16 v[56:59], a[136:139], v[172:175], v[56:59]
    ds_write_addtid_b32 v110 offset:19328
    v_perm_b32 v111, v71, v67, s49
    v_mul_f32 v50, v20, v50
    v_mfma_f32_16x16x32_bf16 v[60:63], a[132:135], v[168:171], 0
    v_exp_f32 v164, v164
    v_mul_f32 v51, v20, v51
    v_mfma_f32_16x16x32_bf16 v[60:63], a[140:143], v[172:175], v[60:63]
    ds_write_addtid_b32 v111 offset:25504
    ds_read_b128 v[104:107], v0 offset:3840
    v_mul_f32 v52, v20, v52
    v_mfma_f32_16x16x32_bf16 v[68:71], v[72:75], a[16:19], v[252:255]
    v_exp_f32 v165, v165
    v_mul_f32 v53, v20, v53
    v_mfma_f32_16x16x32_bf16 v[68:71], v[76:79], a[20:23], v[68:71]
    ds_read_b128 v[88:91], v5 offset:5120
    v_mul_f32 v54, v20, v54
    v_mul_f32 v55, v20, v55
    v_mfma_f32_16x16x32_bf16 v[68:71], v[80:83], a[24:27], v[68:71]
    v_exp_f32 v166, v166
    v_cvt_pk_bf16_f32 v28, v48, v49
    v_mfma_f32_16x16x32_bf16 v[68:71], v[84:87], a[28:31], v[68:71]
    s_waitcnt lgkmcnt(5)
    v_add_f32 v120, v120, v121
    v_add_f32 v122, v122, v123
    v_add_f32 v248, v120, v122
    v_mfma_f32_16x16x32_bf16 v[56:59], a[144:147], v[176:179], v[56:59]
    ds_read_b128 v[120:123], v13 offset:5888
    v_exp_f32 v167, v167
    v_mfma_f32_16x16x32_bf16 v[56:59], a[152:155], v[180:183], v[56:59]
    ds_read_b128 v[188:191], v2 offset:1280
    v_cvt_pk_bf16_f32 v29, v50, v51
    v_cvt_pk_bf16_f32 v30, v52, v53
    v_mfma_f32_16x16x32_bf16 v[60:63], a[148:151], v[176:179], v[60:63]
    s_waitcnt lgkmcnt(3)
    v_exp_f32 v68, v68
    v_cvt_pk_bf16_f32 v31, v54, v55
    v_mfma_f32_16x16x32_bf16 v[60:63], a[156:159], v[180:183], v[60:63]
    buffer_store_dwordx4 v[28:31], v11, s[8:11], s22 offen nt
    ds_read_b128 v[192:195], v2 offset:1536
    v_perm_b32 v160, v68, v164, s49
    v_rcp_f32 v248, v248
    v_mfma_f32_16x16x32_bf16 v[44:47], v[36:39], v[104:107], v[44:47]
    s_add_u32 s22, s22, 4096
    ds_write_addtid_b32 v160 offset:7168
    ds_read_b128 v[196:199], v2 offset:1792
    v_mul_f32 v200, v248, v200
    v_mfma_f32_16x16x32_bf16 v[64:67], v[72:75], a[32:35], v[252:255]
    v_exp_f32 v69, v69
    v_mul_f32 v201, v248, v201
    v_mfma_f32_16x16x32_bf16 v[64:67], v[76:79], a[36:39], v[64:67]
    ds_read_b128 v[168:171], v3 offset:1024
    v_perm_b32 v161, v69, v165, s49
    v_mul_f32 v202, v248, v202
    v_mfma_f32_16x16x32_bf16 v[64:67], v[80:83], a[40:43], v[64:67]
    v_exp_f32 v70, v70
    v_mul_f32 v203, v248, v203
    v_mfma_f32_16x16x32_bf16 v[64:67], v[84:87], a[44:47], v[64:67]
    ds_write_addtid_b32 v161 offset:13344
    v_perm_b32 v162, v70, v166, s49
    v_mul_f32 v204, v248, v204
    v_mfma_f32_16x16x32_bf16 v[56:59], a[160:163], v[184:187], v[56:59]
    s_waitcnt lgkmcnt(5)
    v_exp_f32 v71, v71
    v_mul_f32 v205, v248, v205
    v_mfma_f32_16x16x32_bf16 v[56:59], a[168:171], v[188:191], v[56:59]
    ds_write_addtid_b32 v162 offset:19584
    v_perm_b32 v163, v71, v167, s49
    v_mul_f32 v206, v248, v206
    v_mfma_f32_16x16x32_bf16 v[60:63], a[164:167], v[184:187], v[60:63]
    v_exp_f32 v64, v64
    v_mul_f32 v207, v248, v207
    v_mfma_f32_16x16x32_bf16 v[60:63], a[172:175], v[188:191], v[60:63]
    ds_write_addtid_b32 v163 offset:25760
    ds_read_b128 v[104:107], v0 offset:4096
    v_bitop3_b32 v17, v17, v248, s29 bitop3:0xe8
    v_mfma_f32_16x16x32_bf16 v[68:71], v[72:75], a[48:51], v[252:255]
    v_exp_f32 v65, v65
    v_cvt_pk_bf16_f32 v200, v200, v201
    v_mfma_f32_16x16x32_bf16 v[68:71], v[76:79], a[52:55], v[68:71]
    ds_read_b128 v[92:95], v6 offset:5120
    v_cvt_pk_bf16_f32 v201, v202, v203
    v_cvt_pk_bf16_f32 v202, v204, v205
    v_mfma_f32_16x16x32_bf16 v[68:71], v[80:83], a[56:59], v[68:71]
    s_waitcnt lgkmcnt(8)
    v_exp_f32 v66, v66
    v_cvt_pk_bf16_f32 v203, v206, v207
    v_mfma_f32_16x16x32_bf16 v[68:71], v[84:87], a[60:63], v[68:71]
    buffer_store_dwordx4 v[200:203], v11, s[8:11], s26 offen nt
    ds_write_b32 v12, v44 offset:512
    v_add_f32 v120, v120, v121
    v_add_f32 v122, v122, v123
    v_add_f32 v249, v120, v122
    v_rcp_f32 v249, v249
    v_mfma_f32_16x16x32_bf16 v[56:59], a[176:179], v[192:195], v[56:59]
    s_waitcnt lgkmcnt(7)
    v_exp_f32 v67, v67
    v_mul_f32 v208, v249, v208
    v_mfma_f32_16x16x32_bf16 v[56:59], a[184:187], v[196:199], v[56:59]
    s_waitcnt vmcnt(9)
    ds_read_b128 v[172:175], v3 offset:1280
    ds_add_u32 v14, v16
    v_mfma_f32_16x16x32_bf16 v[60:63], a[180:183], v[192:195], v[60:63]
    v_exp_f32 v68, v68
    v_mul_f32 v209, v249, v209
    v_mfma_f32_16x16x32_bf16 v[60:63], a[188:191], v[196:199], v[60:63]
    ds_read_b128 v[176:179], v3 offset:1536
    v_perm_b32 v160, v68, v64, s49
    ds_read_b128 v[180:183], v3 offset:1792
    v_mfma_f32_16x16x32_bf16 v[164:167], v[72:75], a[64:67], v[252:255]
    s_add_u32 s24, s24, 1
    ds_write_addtid_b32 v160 offset:7424
    v_exp_f32 v69, v69
    v_mfma_f32_16x16x32_bf16 v[164:167], v[76:79], a[68:71], v[164:167]
    ds_read_b128 v[184:187], v4 offset:1024
    v_perm_b32 v161, v69, v65, s49
    v_mul_f32 v210, v249, v210
    v_mfma_f32_16x16x32_bf16 v[164:167], v[80:83], a[72:75], v[164:167]
    v_exp_f32 v70, v70
    v_mul_f32 v211, v249, v211
    v_mfma_f32_16x16x32_bf16 v[164:167], v[84:87], a[76:79], v[164:167]
    s_waitcnt lgkmcnt(12)
    ds_write_addtid_b32 v161 offset:13600
    v_perm_b32 v162, v70, v66, s49
    v_mul_f32 v212, v249, v212
    v_mfma_f32_16x16x32_bf16 v[56:59], a[192:195], v[168:171], v[56:59]
    s_waitcnt lgkmcnt(6)
    v_exp_f32 v71, v71
    v_mul_f32 v213, v249, v213
    v_mfma_f32_16x16x32_bf16 v[56:59], a[200:203], v[172:175], v[56:59]
    ds_write_addtid_b32 v162 offset:19840
    v_perm_b32 v163, v71, v67, s49
    v_mul_f32 v214, v249, v214
    v_mfma_f32_16x16x32_bf16 v[60:63], a[196:199], v[168:171], v[60:63]
    v_exp_f32 v164, v164
    v_mfma_f32_16x16x32_bf16 v[60:63], a[204:207], v[172:175], v[60:63]
    ds_write_addtid_b32 v163 offset:26016
    ds_read_b128 v[108:111], v0 offset:4352
    v_mfma_f32_16x16x32_bf16 v[68:71], v[72:75], a[80:83], v[252:255]
    v_exp_f32 v165, v165
    v_mfma_f32_16x16x32_bf16 v[68:71], v[76:79], a[84:87], v[68:71]
    ds_read_b128 v[96:99], v7 offset:5120
    v_mul_f32 v215, v249, v215
    v_mfma_f32_16x16x32_bf16 v[68:71], v[80:83], a[88:91], v[68:71]
    v_exp_f32 v166, v166
    v_mfma_f32_16x16x32_bf16 v[68:71], v[84:87], a[92:95], v[68:71]
    s_waitcnt lgkmcnt(8)
    ds_read_b128 v[100:103], v8 offset:5120
    v_bitop3_b32 v17, v17, v249, s29 bitop3:0xe8
    v_mfma_f32_16x16x32_bf16 v[56:59], a[208:211], v[176:179], v[56:59]
    s_waitcnt lgkmcnt(8)
    v_exp_f32 v167, v167
    v_mfma_f32_16x16x32_bf16 v[56:59], a[216:219], v[180:183], v[56:59]
    ds_read_b128 v[188:191], v4 offset:1280
    v_cvt_pk_bf16_f32 v208, v208, v209
    v_mfma_f32_16x16x32_bf16 v[60:63], a[212:215], v[176:179], v[60:63]
    v_exp_f32 v68, v68
    v_mfma_f32_16x16x32_bf16 v[60:63], a[220:223], v[180:183], v[60:63]
    s_waitcnt lgkmcnt(3)
    ds_read_b128 v[192:195], v4 offset:1536
    v_perm_b32 v160, v68, v164, s49
    v_smfmac_f32_16x16x64_bf16 v[40:43], v[32:35], v[104:111], v1
    ds_write_addtid_b32 v160 offset:7680
    ds_read_b128 v[196:199], v4 offset:1792
    ds_read_b32 v19, v15
    v_mfma_f32_16x16x32_bf16 v[64:67], v[72:75], a[96:99], v[252:255]
    v_exp_f32 v69, v69
    v_mfma_f32_16x16x32_bf16 v[64:67], v[76:79], a[100:103], v[64:67]
    ds_read_b128 v[168:171], v0 offset:2048
    v_perm_b32 v161, v69, v165, s49
    v_mfma_f32_16x16x32_bf16 v[64:67], v[80:83], a[104:107], v[64:67]
    v_exp_f32 v70, v70
    v_mfma_f32_16x16x32_bf16 v[64:67], v[84:87], a[108:111], v[64:67]
    ds_write_addtid_b32 v161 offset:13856
    v_perm_b32 v162, v70, v166, s49
    v_mfma_f32_16x16x32_bf16 v[56:59], a[224:227], v[184:187], v[56:59]
    s_waitcnt lgkmcnt(6)
    v_exp_f32 v71, v71
    v_mfma_f32_16x16x32_bf16 v[56:59], a[232:235], v[188:191], v[56:59]
    ds_write_addtid_b32 v162 offset:20096
    v_perm_b32 v163, v71, v167, s49
    v_mfma_f32_16x16x32_bf16 v[60:63], a[228:231], v[184:187], v[60:63]
    v_exp_f32 v64, v64
    v_mfma_f32_16x16x32_bf16 v[60:63], a[236:239], v[188:191], v[60:63]
    ds_write_addtid_b32 v163 offset:26272
    ds_read_b128 v[112:115], v0 offset:4608
    v_mfma_f32_16x16x32_bf16 v[68:71], v[72:75], a[112:115], v[252:255]
    v_exp_f32 v65, v65
    v_mfma_f32_16x16x32_bf16 v[68:71], v[76:79], a[116:119], v[68:71]
    v_cvt_pk_bf16_f32 v209, v210, v211
    v_cvt_pk_bf16_f32 v210, v212, v213
    v_mfma_f32_16x16x32_bf16 v[68:71], v[80:83], a[120:123], v[68:71]
    v_exp_f32 v66, v66
    v_mfma_f32_16x16x32_bf16 v[68:71], v[84:87], a[124:127], v[68:71]
    s_waitcnt lgkmcnt(5)
    v_cmp_gt_u32 vcc, s24, v19
    v_cvt_pk_bf16_f32 v211, v214, v215
    v_mfma_f32_16x16x32_bf16 v[56:59], a[240:243], v[192:195], v[56:59]
    v_exp_f32 v67, v67
    v_mfma_f32_16x16x32_bf16 v[56:59], a[248:251], v[196:199], v[56:59]
    v_mov_b64 v[44:45], 0
    ds_read_b128 v[172:175], v0 offset:2304
    v_mfma_f32_16x16x32_bf16 v[60:63], a[244:247], v[192:195], v[60:63]
    v_exp_f32 v68, v68
    v_mfma_f32_16x16x32_bf16 v[60:63], a[252:255], v[196:199], v[60:63]
    buffer_store_dwordx4 v[208:211], v11, s[8:11], s27 offen nt
    buffer_load_dwordx4 v9, s[4:7], s21 offen nt lds
    ds_read_b128 v[176:179], v0 offset:2560
    v_perm_b32 v160, v68, v64, s49
    ds_read_b128 v[180:183], v0 offset:2816
    s_cbranch_vccnz L_retry113
L_back113:
    v_mfma_f32_16x16x32_bf16 v[164:167], v[88:91], a[0:3], v[252:255]
    s_waitcnt lgkmcnt(2)
    ds_write_addtid_b32 v160 offset:7936
    v_exp_f32 v69, v69
    v_mfma_f32_16x16x32_bf16 v[164:167], v[92:95], a[4:7], v[164:167]
    s_mov_b32 s26, 32768
    ds_read_b128 v[184:187], v2 offset:2048
    ds_read_b128 v[204:207], v13 offset:6144
    v_perm_b32 v161, v69, v65, s49
    v_mfma_f32_16x16x32_bf16 v[164:167], v[96:99], a[8:11], v[164:167]
    s_mov_b32 s27, 36864
    v_exp_f32 v70, v70
    v_mfma_f32_16x16x32_bf16 v[164:167], v[100:103], a[12:15], v[164:167]
    s_mov_b32 s21, 98304
    ds_write_addtid_b32 v161 offset:14112
    v_perm_b32 v162, v70, v66, s49
    v_mul_f32 v56, v21, v56
    v_mfma_f32_16x16x32_bf16 v[48:51], a[128:131], v[168:171], 0
    s_add_u32 m0, s23, 0
    v_exp_f32 v71, v71
    v_mul_f32 v57, v21, v57
    v_mfma_f32_16x16x32_bf16 v[48:51], a[136:139], v[172:175], v[48:51]
    ds_write_addtid_b32 v162 offset:31616
    v_perm_b32 v163, v71, v67, s49
    v_mul_f32 v58, v21, v58
    v_mfma_f32_16x16x32_bf16 v[52:55], a[132:135], v[168:171], 0
    v_exp_f32 v164, v164
    v_mul_f32 v59, v21, v59
    v_mfma_f32_16x16x32_bf16 v[52:55], a[140:143], v[172:175], v[52:55]
    ds_write_addtid_b32 v163 offset:37792
    ds_read_b128 v[116:119], v0 offset:4864
    v_mul_f32 v60, v21, v60
    v_mfma_f32_16x16x32_bf16 v[68:71], v[88:91], a[16:19], v[252:255]
    v_exp_f32 v165, v165
    v_mul_f32 v61, v21, v61
    v_mfma_f32_16x16x32_bf16 v[68:71], v[92:95], a[20:23], v[68:71]
    ds_read_b128 v[72:75], v5 offset:6144
    ds_read_b128 v[24:27], v18 offset:512
    v_mul_f32 v62, v21, v62
    v_mfma_f32_16x16x32_bf16 v[68:71], v[96:99], a[24:27], v[68:71]
    v_exp_f32 v166, v166
    v_mul_f32 v63, v21, v63
    v_mfma_f32_16x16x32_bf16 v[68:71], v[100:103], a[28:31], v[68:71]
    s_waitcnt lgkmcnt(6)
    v_cvt_pk_bf16_f32 v28, v56, v57
    v_add_f32 v204, v204, v205
    v_add_f32 v206, v206, v207
    v_mfma_f32_16x16x32_bf16 v[48:51], a[144:147], v[176:179], v[48:51]
    v_exp_f32 v167, v167
    v_add_f32 v248, v204, v206
    v_mfma_f32_16x16x32_bf16 v[48:51], a[152:155], v[180:183], v[48:51]
    ds_read_b128 v[188:191], v2 offset:2304
    ds_read_b128 v[204:207], v13 offset:6400
    v_cvt_pk_bf16_f32 v29, v58, v59
    v_mfma_f32_16x16x32_bf16 v[52:55], a[148:151], v[176:179], v[52:55]
    v_exp_f32 v68, v68
    v_cvt_pk_bf16_f32 v30, v60, v61
    v_mfma_f32_16x16x32_bf16 v[52:55], a[156:159], v[180:183], v[52:55]
    s_waitcnt lgkmcnt(4)
    ds_read_b128 v[192:195], v2 offset:2560
    v_perm_b32 v160, v68, v164, s49
    v_cvt_pk_bf16_f32 v31, v62, v63
    v_smfmac_f32_16x16x64_bf16 v[40:43], v[32:35], v[112:119], v1
    s_waitcnt lgkmcnt(3)
    ds_write_addtid_b32 v160 offset:19456
    ds_read_b128 v[196:199], v2 offset:2816
    v_mfma_f32_16x16x32_bf16 v[64:67], v[88:91], a[32:35], v[252:255]
    buffer_store_dwordx4 v[28:31], v11, s[8:11], s22 offen nt
    v_exp_f32 v69, v69
    v_add_f32 v24, v24, v25
    v_add_f32 v26, v26, v27
    v_add_f32 v24, v24, v26
    v_rcp_f32 v248, v248
    v_mfma_f32_16x16x32_bf16 v[64:67], v[92:95], a[36:39], v[64:67]
    s_add_u32 s22, s22, 4096
    ds_read_b128 v[168:171], v3 offset:2048
    v_perm_b32 v161, v69, v165, s49
    v_mul_f32 v216, v248, v216
    v_mfma_f32_16x16x32_bf16 v[64:67], v[96:99], a[40:43], v[64:67]
L_pad6:
    s_cbranch_execz L_pad10
    v_exp_f32 v70, v70
    v_mul_f32 v217, v248, v217
    v_mfma_f32_16x16x32_bf16 v[64:67], v[100:103], a[44:47], v[64:67]
    ds_write_addtid_b32 v161 offset:25632
    v_perm_b32 v162, v70, v166, s49
    v_mul_f32 v218, v248, v218
    v_mfma_f32_16x16x32_bf16 v[48:51], a[160:163], v[184:187], v[48:51]
    s_waitcnt lgkmcnt(6)
    v_exp_f32 v71, v71
    v_mul_f32 v219, v248, v219
    v_mfma_f32_16x16x32_bf16 v[48:51], a[168:171], v[188:191], v[48:51]
    ds_write_addtid_b32 v162 offset:31872
    v_perm_b32 v163, v71, v167, s49
    v_mul_f32 v220, v248, v220
    v_mfma_f32_16x16x32_bf16 v[52:55], a[164:167], v[184:187], v[52:55]
    v_exp_f32 v64, v64
    v_mul_f32 v221, v248, v221
    v_mfma_f32_16x16x32_bf16 v[52:55], a[172:175], v[188:191], v[52:55]
    ds_write_addtid_b32 v163 offset:38048
    ds_read_b128 v[120:123], v0 offset:5120
    v_mul_f32 v222, v248, v222
    v_mfma_f32_16x16x32_bf16 v[68:71], v[88:91], a[48:51], v[252:255]
    v_exp_f32 v65, v65
    v_mul_f32 v223, v248, v223
    v_mfma_f32_16x16x32_bf16 v[68:71], v[92:95], a[52:55], v[68:71]
    ds_read_b128 v[76:79], v6 offset:6144
    v_bitop3_b32 v17, v17, v248, s29 bitop3:0xe8
    v_cvt_pk_bf16_f32 v216, v216, v217
    v_mfma_f32_16x16x32_bf16 v[68:71], v[96:99], a[56:59], v[68:71]
    v_exp_f32 v66, v66
    v_cvt_pk_bf16_f32 v217, v218, v219
    v_mfma_f32_16x16x32_bf16 v[68:71], v[100:103], a[60:63], v[68:71]
    s_waitcnt lgkmcnt(6)
    v_cvt_pk_bf16_f32 v218, v220, v221
    v_cvt_pk_bf16_f32 v219, v222, v223
    v_mfma_f32_16x16x32_bf16 v[48:51], a[176:179], v[192:195], v[48:51]
    buffer_store_dwordx4 v[216:219], v11, s[8:11], s26 offen nt
    v_exp_f32 v67, v67
    v_rcp_f32 v22, v24
    v_mfma_f32_16x16x32_bf16 v[48:51], a[184:187], v[196:199], v[48:51]
    ds_read_b128 v[172:175], v3 offset:2304
    v_bitop3_b32 v17, v17, v22, s29 bitop3:0xe8
    v_mov_b32 v23, v22
    v_mfma_f32_16x16x32_bf16 v[52:55], a[180:183], v[192:195], v[52:55]
    v_exp_f32 v68, v68
    v_permlane32_swap_b32 v22, v23
    v_mfma_f32_16x16x32_bf16 v[52:55], a[188:191], v[196:199], v[52:55]
    ds_read_b128 v[176:179], v3 offset:2560
    v_perm_b32 v160, v68, v64, s49
    ds_read_b128 v[180:183], v3 offset:2816
    v_mfma_f32_16x16x32_bf16 v[164:167], v[88:91], a[64:67], v[252:255]
    ds_write_addtid_b32 v160 offset:19712
    v_exp_f32 v69, v69
    v_mfma_f32_16x16x32_bf16 v[164:167], v[92:95], a[68:71], v[164:167]
    ds_read_b128 v[184:187], v4 offset:2048
    v_perm_b32 v161, v69, v65, s49
    v_add_f32 v204, v204, v205
    v_mfma_f32_16x16x32_bf16 v[164:167], v[96:99], a[72:75], v[164:167]
    v_exp_f32 v70, v70
    v_add_f32 v206, v206, v207
    v_mfma_f32_16x16x32_bf16 v[164:167], v[100:103], a[76:79], v[164:167]
    s_waitcnt lgkmcnt(10)
    ds_write_addtid_b32 v161 offset:25888
    v_perm_b32 v162, v70, v66, s49
    v_add_f32 v249, v204, v206
    v_mfma_f32_16x16x32_bf16 v[48:51], a[192:195], v[168:171], v[48:51]
    s_waitcnt lgkmcnt(5)
    v_exp_f32 v71, v71
    v_mfma_f32_16x16x32_bf16 v[48:51], a[200:203], v[172:175], v[48:51]
    ds_write_addtid_b32 v162 offset:32128
    v_perm_b32 v163, v71, v67, s49
    v_mfma_f32_16x16x32_bf16 v[52:55], a[196:199], v[168:171], v[52:55]
    v_exp_f32 v164, v164
    v_mfma_f32_16x16x32_bf16 v[52:55], a[204:207], v[172:175], v[52:55]
    ds_write_addtid_b32 v163 offset:38304
    ds_read_b128 v[124:127], v0 offset:5376
    v_mfma_f32_16x16x32_bf16 v[68:71], v[88:91], a[80:83], v[252:255]
    v_exp_f32 v165, v165
    v_mfma_f32_16x16x32_bf16 v[68:71], v[92:95], a[84:87], v[68:71]
    ds_read_b128 v[80:83], v7 offset:6144
    v_rcp_f32 v249, v249
    v_mfma_f32_16x16x32_bf16 v[68:71], v[96:99], a[88:91], v[68:71]
    v_exp_f32 v166, v166
    v_mul_f32 v224, v249, v224
    v_mfma_f32_16x16x32_bf16 v[68:71], v[100:103], a[92:95], v[68:71]
    s_waitcnt lgkmcnt(8)
    ds_read_b128 v[84:87], v8 offset:6144
    v_mul_f32 v225, v249, v225
    v_mul_f32 v226, v249, v226
    v_mfma_f32_16x16x32_bf16 v[48:51], a[208:211], v[176:179], v[48:51]
    s_waitcnt lgkmcnt(8)
    v_exp_f32 v167, v167
    v_mul_f32 v227, v249, v227
    v_mfma_f32_16x16x32_bf16 v[48:51], a[216:219], v[180:183], v[48:51]
    ds_read_b128 v[188:191], v4 offset:2304
    v_mul_f32 v228, v249, v228
    v_mul_f32 v229, v249, v229
    v_mfma_f32_16x16x32_bf16 v[52:55], a[212:215], v[176:179], v[52:55]
    v_exp_f32 v68, v68
    v_mul_f32 v230, v249, v230
    v_mfma_f32_16x16x32_bf16 v[52:55], a[220:223], v[180:183], v[52:55]
    s_waitcnt lgkmcnt(3)
    ds_read_b128 v[192:195], v4 offset:2560
    v_perm_b32 v160, v68, v164, s49
    v_mul_f32 v231, v249, v231
    v_smfmac_f32_16x16x64_bf16 v[40:43], v[36:39], v[120:127], v1
    ds_write_addtid_b32 v160 offset:19968
    ds_read_b128 v[196:199], v4 offset:2816
    v_mfma_f32_16x16x32_bf16 v[64:67], v[88:91], a[96:99], v[252:255]
    v_exp_f32 v69, v69
    v_mfma_f32_16x16x32_bf16 v[64:67], v[92:95], a[100:103], v[64:67]
    ds_read_b128 v[168:171], v0 offset:3072
    v_perm_b32 v161, v69, v165, s49
    v_mfma_f32_16x16x32_bf16 v[64:67], v[96:99], a[104:107], v[64:67]
    v_exp_f32 v70, v70
    v_mfma_f32_16x16x32_bf16 v[64:67], v[100:103], a[108:111], v[64:67]
    ds_write_addtid_b32 v161 offset:26144
    v_perm_b32 v162, v70, v166, s49
    v_mfma_f32_16x16x32_bf16 v[48:51], a[224:227], v[184:187], v[48:51]
    s_waitcnt lgkmcnt(5)
    v_exp_f32 v71, v71
    v_mfma_f32_16x16x32_bf16 v[48:51], a[232:235], v[188:191], v[48:51]
    ds_write_addtid_b32 v162 offset:32384
    v_perm_b32 v163, v71, v167, s49
    v_mfma_f32_16x16x32_bf16 v[52:55], a[228:231], v[184:187], v[52:55]
    v_exp_f32 v64, v64
    v_mfma_f32_16x16x32_bf16 v[52:55], a[236:239], v[188:191], v[52:55]
    ds_write_addtid_b32 v163 offset:38560
    ds_read_b128 v[128:131], v0 offset:5632
    v_mfma_f32_16x16x32_bf16 v[68:71], v[88:91], a[112:115], v[252:255]
    v_exp_f32 v65, v65
    v_mfma_f32_16x16x32_bf16 v[68:71], v[92:95], a[116:119], v[68:71]
    v_bitop3_b32 v17, v17, v249, s29 bitop3:0xe8
    v_cvt_pk_bf16_f32 v224, v224, v225
    v_mfma_f32_16x16x32_bf16 v[68:71], v[96:99], a[120:123], v[68:71]
    v_exp_f32 v66, v66
    v_mfma_f32_16x16x32_bf16 v[68:71], v[100:103], a[124:127], v[68:71]
    s_waitcnt lgkmcnt(7)
    v_cvt_pk_bf16_f32 v225, v226, v227
    v_cvt_pk_bf16_f32 v226, v228, v229
    v_mfma_f32_16x16x32_bf16 v[48:51], a[240:243], v[192:195], v[48:51]
    s_waitcnt lgkmcnt(5)
    v_exp_f32 v67, v67
    v_mfma_f32_16x16x32_bf16 v[48:51], a[248:251], v[196:199], v[48:51]
    ds_read_b128 v[172:175], v0 offset:3328
    v_cvt_pk_bf16_f32 v227, v230, v231
    v_mfma_f32_16x16x32_bf16 v[52:55], a[244:247], v[192:195], v[52:55]
    v_exp_f32 v68, v68
    v_mfma_f32_16x16x32_bf16 v[52:55], a[252:255], v[196:199], v[52:55]
    buffer_store_dwordx4 v[224:227], v11, s[8:11], s27 offen nt
    buffer_load_dwordx4 v9, s[4:7], s21 offen nt lds
    ds_read_b128 v[176:179], v0 offset:3584
    v_perm_b32 v160, v68, v64, s49
    ds_read_b128 v[180:183], v0 offset:3840
    v_mfma_f32_16x16x32_bf16 v[164:167], v[72:75], a[0:3], v[252:255]
    s_waitcnt lgkmcnt(7)
    ds_write_addtid_b32 v160 offset:20224
    v_exp_f32 v69, v69
    v_mfma_f32_16x16x32_bf16 v[164:167], v[76:79], a[4:7], v[164:167]
    s_mov_b32 s26, 40960
    ds_read_b128 v[184:187], v2 offset:3072
    ds_read_b128 v[204:207], v13 offset:6656
    v_perm_b32 v161, v69, v65, s49
    v_mfma_f32_16x16x32_bf16 v[164:167], v[80:83], a[8:11], v[164:167]
    s_mov_b32 s21, 102400
    v_exp_f32 v70, v70
    v_mfma_f32_16x16x32_bf16 v[164:167], v[84:87], a[12:15], v[164:167]
    s_add_u32 m0, s23, 1024
    s_nop 0
    ds_write_addtid_b32 v161 offset:25376
    v_perm_b32 v162, v70, v66, s49
    v_mul_f32 v48, v22, v48
    v_mfma_f32_16x16x32_bf16 v[56:59], a[128:131], v[168:171], 0
    s_waitcnt lgkmcnt(6)
    v_exp_f32 v71, v71
    v_mul_f32 v49, v22, v49
    v_mfma_f32_16x16x32_bf16 v[56:59], a[136:139], v[172:175], v[56:59]
    ds_write_addtid_b32 v162 offset:31616
    v_perm_b32 v163, v71, v67, s49
    v_mul_f32 v50, v22, v50
    v_mfma_f32_16x16x32_bf16 v[60:63], a[132:135], v[168:171], 0
    v_exp_f32 v164, v164
    v_mul_f32 v51, v22, v51
    v_mfma_f32_16x16x32_bf16 v[60:63], a[140:143], v[172:175], v[60:63]
    ds_write_addtid_b32 v163 offset:37792
    ds_read_b128 v[132:135], v0 offset:5888
    v_mul_f32 v52, v22, v52
    v_mfma_f32_16x16x32_bf16 v[68:71], v[72:75], a[16:19], v[252:255]
    v_exp_f32 v165, v165
    v_mul_f32 v53, v22, v53
    v_mfma_f32_16x16x32_bf16 v[68:71], v[76:79], a[20:23], v[68:71]
    ds_read_b128 v[88:91], v5 offset:7168
    v_mul_f32 v54, v22, v54
    v_mul_f32 v55, v22, v55
    v_mfma_f32_16x16x32_bf16 v[68:71], v[80:83], a[24:27], v[68:71]
    v_exp_f32 v166, v166
    v_cvt_pk_bf16_f32 v28, v48, v49
    v_mfma_f32_16x16x32_bf16 v[68:71], v[84:87], a[28:31], v[68:71]
    s_waitcnt lgkmcnt(5)
    v_cvt_pk_bf16_f32 v29, v50, v51
    v_cvt_pk_bf16_f32 v30, v52, v53
    v_cvt_pk_bf16_f32 v31, v54, v55
    v_mfma_f32_16x16x32_bf16 v[56:59], a[144:147], v[176:179], v[56:59]
    buffer_store_dwordx4 v[28:31], v11, s[8:11], s22 offen nt
    v_exp_f32 v167, v167
    v_add_f32 v204, v204, v205
    v_add_f32 v206, v206, v207
    v_add_f32 v248, v204, v206
    v_rcp_f32 v248, v248
    v_mfma_f32_16x16x32_bf16 v[56:59], a[152:155], v[180:183], v[56:59]
    s_add_u32 s22, s22, 4096
    ds_read_b128 v[188:191], v2 offset:3328
    v_mul_f32 v232, v248, v232
    v_mul_f32 v233, v248, v233
    v_mfma_f32_16x16x32_bf16 v[60:63], a[148:151], v[176:179], v[60:63]
    v_exp_f32 v68, v68
    v_mul_f32 v234, v248, v234
    v_mfma_f32_16x16x32_bf16 v[60:63], a[156:159], v[180:183], v[60:63]
    s_waitcnt lgkmcnt(2)
    ds_read_b128 v[192:195], v2 offset:3584
    v_perm_b32 v160, v68, v164, s49
    v_mul_f32 v235, v248, v235
    v_smfmac_f32_16x16x64_bf16 v[40:43], v[36:39], v[128:135], v1
    ds_write_addtid_b32 v160 offset:13312
    ds_read_b128 v[196:199], v2 offset:3840
    v_mfma_f32_16x16x32_bf16 v[64:67], v[72:75], a[32:35], v[252:255]
    v_exp_f32 v69, v69
    v_mfma_f32_16x16x32_bf16 v[64:67], v[76:79], a[36:39], v[64:67]
    ds_read_b128 v[168:171], v3 offset:3072
    v_perm_b32 v161, v69, v165, s49
    v_mfma_f32_16x16x32_bf16 v[64:67], v[80:83], a[40:43], v[64:67]
    v_exp_f32 v70, v70
    v_mfma_f32_16x16x32_bf16 v[64:67], v[84:87], a[44:47], v[64:67]
    ds_write_addtid_b32 v161 offset:19488
    v_perm_b32 v162, v70, v166, s49
    v_mfma_f32_16x16x32_bf16 v[56:59], a[160:163], v[184:187], v[56:59]
    s_waitcnt lgkmcnt(5)
    v_exp_f32 v71, v71
    v_mfma_f32_16x16x32_bf16 v[56:59], a[168:171], v[188:191], v[56:59]
    ds_write_addtid_b32 v162 offset:25728
    v_perm_b32 v163, v71, v167, s49
    v_add_f32 v40, v40, v41
    v_mfma_f32_16x16x32_bf16 v[60:63], a[164:167], v[184:187], v[60:63]
    v_exp_f32 v64, v64
    v_mfma_f32_16x16x32_bf16 v[60:63], a[172:175], v[188:191], v[60:63]
    ds_write_addtid_b32 v163 offset:31904
    ds_read_b128 v[136:139], v0 offset:0
    v_mfma_f32_16x16x32_bf16 v[68:71], v[72:75], a[48:51], v[252:255]
    v_exp_f32 v65, v65
    v_mfma_f32_16x16x32_bf16 v[68:71], v[76:79], a[52:55], v[68:71]
    ds_read_b128 v[92:95], v6 offset:7168
    v_mul_f32 v236, v248, v236
    v_mfma_f32_16x16x32_bf16 v[68:71], v[80:83], a[56:59], v[68:71]
    v_exp_f32 v66, v66
    v_mfma_f32_16x16x32_bf16 v[68:71], v[84:87], a[60:63], v[68:71]
    s_waitcnt lgkmcnt(8)
    ds_write_b32 v12, v40 offset:1024
    v_mfma_f32_16x16x32_bf16 v[56:59], a[176:179], v[192:195], v[56:59]
    s_waitcnt lgkmcnt(7)
    v_exp_f32 v67, v67
    v_mfma_f32_16x16x32_bf16 v[56:59], a[184:187], v[196:199], v[56:59]
    s_waitcnt vmcnt(12)
    ds_read_b128 v[172:175], v3 offset:3328
    ds_add_u32 v14, v16
    v_mfma_f32_16x16x32_bf16 v[60:63], a[180:183], v[192:195], v[60:63]
    v_exp_f32 v68, v68
    v_mfma_f32_16x16x32_bf16 v[60:63], a[188:191], v[196:199], v[60:63]
    ds_read_b128 v[176:179], v3 offset:3584
    v_perm_b32 v160, v68, v64, s49
    ds_read_b128 v[180:183], v3 offset:3840
    v_mfma_f32_16x16x32_bf16 v[164:167], v[72:75], a[64:67], v[252:255]
    s_add_u32 s24, s24, 1
    ds_write_addtid_b32 v160 offset:13568
    v_exp_f32 v69, v69
    v_mfma_f32_16x16x32_bf16 v[164:167], v[76:79], a[68:71], v[164:167]
    ds_read_b128 v[184:187], v4 offset:3072
    v_perm_b32 v161, v69, v65, s49
    v_mfma_f32_16x16x32_bf16 v[164:167], v[80:83], a[72:75], v[164:167]
    v_exp_f32 v70, v70
    v_mfma_f32_16x16x32_bf16 v[164:167], v[84:87], a[76:79], v[164:167]
    s_waitcnt lgkmcnt(12)
    ds_write_addtid_b32 v161 offset:19744
    v_perm_b32 v162, v70, v66, s49
    v_mfma_f32_16x16x32_bf16 v[56:59], a[192:195], v[168:171], v[56:59]
    s_waitcnt lgkmcnt(6)
    v_exp_f32 v71, v71
    v_mfma_f32_16x16x32_bf16 v[56:59], a[200:203], v[172:175], v[56:59]
    ds_write_addtid_b32 v162 offset:25984
    v_perm_b32 v163, v71, v67, s49
    v_mfma_f32_16x16x32_bf16 v[60:63], a[196:199], v[168:171], v[60:63]
    v_exp_f32 v164, v164
    v_mfma_f32_16x16x32_bf16 v[60:63], a[204:207], v[172:175], v[60:63]
    ds_write_addtid_b32 v163 offset:32160
    ds_read_b128 v[140:143], v0 offset:256
    v_mfma_f32_16x16x32_bf16 v[68:71], v[72:75], a[80:83], v[252:255]
    v_exp_f32 v165, v165
    v_mfma_f32_16x16x32_bf16 v[68:71], v[76:79], a[84:87], v[68:71]
    ds_read_b128 v[96:99], v7 offset:7168
    v_mul_f32 v237, v248, v237
    v_mfma_f32_16x16x32_bf16 v[68:71], v[80:83], a[88:91], v[68:71]
    v_exp_f32 v166, v166
    v_mfma_f32_16x16x32_bf16 v[68:71], v[84:87], a[92:95], v[68:71]
    s_waitcnt lgkmcnt(8)
    ds_read_b128 v[100:103], v8 offset:7168
    v_mul_f32 v238, v248, v238
    v_mfma_f32_16x16x32_bf16 v[56:59], a[208:211], v[176:179], v[56:59]
    s_waitcnt lgkmcnt(8)
    v_exp_f32 v167, v167
    v_mfma_f32_16x16x32_bf16 v[56:59], a[216:219], v[180:183], v[56:59]
    ds_read_b128 v[188:191], v4 offset:3328
    v_mul_f32 v239, v248, v239
    v_mfma_f32_16x16x32_bf16 v[60:63], a[212:215], v[176:179], v[60:63]
    v_exp_f32 v68, v68
    v_mfma_f32_16x16x32_bf16 v[60:63], a[220:223], v[180:183], v[60:63]
    s_waitcnt lgkmcnt(3)
    ds_read_b128 v[192:195], v4 offset:3584
    v_perm_b32 v160, v68, v164, s49
    v_smfmac_f32_16x16x64_bf16 v[44:47], v[32:35], v[136:143], v1
    ds_write_addtid_b32 v160 offset:13824
    ds_read_b128 v[196:199], v4 offset:3840
    ds_read_b32 v19, v15
    v_mfma_f32_16x16x32_bf16 v[64:67], v[72:75], a[96:99], v[252:255]
    v_exp_f32 v69, v69
    v_mfma_f32_16x16x32_bf16 v[64:67], v[76:79], a[100:103], v[64:67]
    v_perm_b32 v161, v69, v165, s49
    v_bitop3_b32 v17, v17, v248, s29 bitop3:0xe8
    v_mfma_f32_16x16x32_bf16 v[64:67], v[80:83], a[104:107], v[64:67]
    v_exp_f32 v70, v70
    v_mfma_f32_16x16x32_bf16 v[64:67], v[84:87], a[108:111], v[64:67]
    ds_write_addtid_b32 v161 offset:20000
    v_perm_b32 v162, v70, v166, s49
    v_mfma_f32_16x16x32_bf16 v[56:59], a[224:227], v[184:187], v[56:59]
    s_waitcnt lgkmcnt(5)
    v_exp_f32 v71, v71
    v_mfma_f32_16x16x32_bf16 v[56:59], a[232:235], v[188:191], v[56:59]
    ds_write_addtid_b32 v162 offset:26240
    v_perm_b32 v163, v71, v167, s49
    v_mfma_f32_16x16x32_bf16 v[60:63], a[228:231], v[184:187], v[60:63]
    v_exp_f32 v64, v64
    v_mfma_f32_16x16x32_bf16 v[60:63], a[236:239], v[188:191], v[60:63]
    ds_write_addtid_b32 v163 offset:32416
    ds_read_b128 v[144:147], v0 offset:512
    v_mfma_f32_16x16x32_bf16 v[68:71], v[72:75], a[112:115], v[252:255]
    v_exp_f32 v65, v65
    v_mfma_f32_16x16x32_bf16 v[68:71], v[76:79], a[116:119], v[68:71]
    v_cvt_pk_bf16_f32 v232, v232, v233
    v_cvt_pk_bf16_f32 v233, v234, v235
    v_mfma_f32_16x16x32_bf16 v[68:71], v[80:83], a[120:123], v[68:71]
    v_exp_f32 v66, v66
    v_mfma_f32_16x16x32_bf16 v[68:71], v[84:87], a[124:127], v[68:71]
    s_waitcnt lgkmcnt(4)
    v_cmp_gt_u32 vcc, s24, v19
    v_cvt_pk_bf16_f32 v234, v236, v237
    v_mfma_f32_16x16x32_bf16 v[56:59], a[240:243], v[192:195], v[56:59]
    v_exp_f32 v67, v67
    v_mfma_f32_16x16x32_bf16 v[56:59], a[248:251], v[196:199], v[56:59]
    v_mov_b64 v[40:41], 0
    v_cvt_pk_bf16_f32 v235, v238, v239
    v_mfma_f32_16x16x32_bf16 v[60:63], a[244:247], v[192:195], v[60:63]
    buffer_store_dwordx4 v[232:235], v11, s[8:11], s26 offen nt
    buffer_load_dwordx4 v9, s[4:7], s21 offen nt lds
    v_exp_f32 v68, v68
    v_mfma_f32_16x16x32_bf16 v[60:63], a[252:255], v[196:199], v[60:63]
    v_perm_b32 v160, v68, v64, s49
    s_cbranch_vccnz L_retry115
L_back115:
    v_mfma_f32_16x16x32_bf16 v[220:223], v[88:91], a[0:3], v[252:255]
    ds_write_addtid_b32 v160 offset:14080
    v_exp_f32 v69, v69
    v_mfma_f32_16x16x32_bf16 v[220:223], v[92:95], a[4:7], v[220:223]
    s_mov_b32 s26, 45056
    ds_read_b128 v[168:171], v2 offset:4096
    ds_read_b128 v[204:207], v13 offset:6912
    v_perm_b32 v161, v69, v65, s49
    v_mfma_f32_16x16x32_bf16 v[220:223], v[96:99], a[8:11], v[220:223]
    s_mov_b32 s21, 106496
    v_exp_f32 v70, v70
    v_mfma_f32_16x16x32_bf16 v[220:223], v[100:103], a[12:15], v[220:223]
    s_add_u32 m0, s23, 2048
    s_nop 0
    ds_write_addtid_b32 v161 offset:19232
    v_perm_b32 v162, v70, v66, s49
    v_mul_f32 v56, v23, v56
    v_mfma_f32_16x16x32_bf16 v[48:51], a[128:131], v[104:107], 0
    v_exp_f32 v71, v71
    v_mul_f32 v57, v23, v57
    v_mfma_f32_16x16x32_bf16 v[48:51], a[136:139], v[108:111], v[48:51]
    ds_write_addtid_b32 v162 offset:25472
    v_perm_b32 v163, v71, v67, s49
    v_mul_f32 v58, v23, v58
    v_mfma_f32_16x16x32_bf16 v[48:51], a[144:147], v[112:115], v[48:51]
    v_exp_f32 v220, v220
    v_mul_f32 v59, v23, v59
    v_mfma_f32_16x16x32_bf16 v[48:51], a[152:155], v[116:119], v[48:51]
    ds_write_addtid_b32 v163 offset:31648
    ds_read_b128 v[148:151], v0 offset:768
    v_mul_f32 v60, v23, v60
    v_mfma_f32_16x16x32_bf16 v[68:71], v[88:91], a[16:19], v[252:255]
    v_exp_f32 v221, v221
    v_mul_f32 v61, v23, v61
    v_mfma_f32_16x16x32_bf16 v[68:71], v[92:95], a[20:23], v[68:71]
    ds_read_b128 v[172:175], v2 offset:4352
    ds_read_b128 v[72:75], v5 offset:8192
    v_mul_f32 v62, v23, v62
    v_mfma_f32_16x16x32_bf16 v[68:71], v[96:99], a[24:27], v[68:71]
    v_exp_f32 v222, v222
    v_mul_f32 v63, v23, v63
    v_mfma_f32_16x16x32_bf16 v[68:71], v[100:103], a[28:31], v[68:71]
    ds_read_b128 v[176:179], v2 offset:4608
    ds_read_b128 v[24:27], v18 offset:1024
    v_cvt_pk_bf16_f32 v28, v56, v57
    v_mfma_f32_16x16x32_bf16 v[52:55], a[132:135], v[104:107], 0
    v_exp_f32 v223, v223
    v_mfma_f32_16x16x32_bf16 v[52:55], a[140:143], v[108:111], v[52:55]
    v_cvt_pk_bf16_f32 v29, v58, v59
    v_cvt_pk_bf16_f32 v30, v60, v61
    v_mfma_f32_16x16x32_bf16 v[52:55], a[148:151], v[112:115], v[52:55]
    v_exp_f32 v68, v68
    v_mfma_f32_16x16x32_bf16 v[52:55], a[156:159], v[116:119], v[52:55]
    s_waitcnt lgkmcnt(4)
    ds_read_b128 v[180:183], v2 offset:4864
    v_perm_b32 v216, v68, v220, s49
    v_smfmac_f32_16x16x64_bf16 v[44:47], v[32:35], v[144:151], v1
    ds_write_addtid_b32 v216 offset:13312
    v_cvt_pk_bf16_f32 v31, v62, v63
    v_mfma_f32_16x16x32_bf16 v[64:67], v[88:91], a[32:35], v[252:255]
    v_exp_f32 v69, v69
    v_mfma_f32_16x16x32_bf16 v[64:67], v[92:95], a[36:39], v[64:67]
    s_waitcnt lgkmcnt(2)
    ds_read_b128 v[184:187], v3 offset:4096
    v_perm_b32 v217, v69, v221, s49
    v_mfma_f32_16x16x32_bf16 v[64:67], v[96:99], a[40:43], v[64:67]
    buffer_store_dwordx4 v[28:31], v11, s[8:11], s22 offen nt
    v_exp_f32 v70, v70
    v_add_f32 v24, v24, v25
    v_add_f32 v26, v26, v27
    v_add_f32 v24, v24, v26
    v_rcp_f32 v20, v24
    v_mfma_f32_16x16x32_bf16 v[64:67], v[100:103], a[44:47], v[64:67]
    s_add_u32 s22, s22, 4096
    ds_write_addtid_b32 v217 offset:19488
    v_perm_b32 v218, v70, v222, s49
    v_bitop3_b32 v17, v17, v20, s29 bitop3:0xe8
    v_mfma_f32_16x16x32_bf16 v[48:51], a[160:163], v[168:171], v[48:51]
    v_exp_f32 v71, v71
    v_mov_b32 v21, v20
    v_mfma_f32_16x16x32_bf16 v[48:51], a[168:171], v[172:175], v[48:51]
    ds_write_addtid_b32 v218 offset:25728
    v_perm_b32 v219, v71, v223, s49
    v_permlane32_swap_b32 v20, v21
    v_mfma_f32_16x16x32_bf16 v[48:51], a[176:179], v[176:179], v[48:51]
    s_waitcnt lgkmcnt(4)
    v_exp_f32 v64, v64
    v_add_f32 v204, v204, v205
    v_mfma_f32_16x16x32_bf16 v[48:51], a[184:187], v[180:183], v[48:51]
    ds_write_addtid_b32 v219 offset:31904
    ds_read_b128 v[152:155], v0 offset:1024
    v_add_f32 v206, v206, v207
    v_mfma_f32_16x16x32_bf16 v[68:71], v[88:91], a[48:51], v[252:255]
    v_exp_f32 v65, v65
    v_add_f32 v248, v204, v206
    v_mfma_f32_16x16x32_bf16 v[68:71], v[92:95], a[52:55], v[68:71]
    ds_read_b128 v[188:191], v3 offset:4352
    ds_read_b128 v[76:79], v6 offset:8192
    v_mfma_f32_16x16x32_bf16 v[68:71], v[96:99], a[56:59], v[68:71]
    v_exp_f32 v66, v66
    v_mfma_f32_16x16x32_bf16 v[68:71], v[100:103], a[60:63], v[68:71]
    ds_read_b128 v[192:195], v3 offset:4608
    v_rcp_f32 v248, v248
    v_mfma_f32_16x16x32_bf16 v[52:55], a[164:167], v[168:171], v[52:55]
    v_exp_f32 v67, v67
    v_mul_f32 v240, v248, v240
    v_mfma_f32_16x16x32_bf16 v[52:55], a[172:175], v[172:175], v[52:55]
    v_mul_f32 v241, v248, v241
    v_mul_f32 v242, v248, v242
    v_mul_f32 v243, v248, v243
    v_mfma_f32_16x16x32_bf16 v[52:55], a[180:183], v[176:179], v[52:55]
    v_exp_f32 v68, v68
    v_mul_f32 v244, v248, v244
    v_mfma_f32_16x16x32_bf16 v[52:55], a[188:191], v[180:183], v[52:55]
    ds_read_b128 v[196:199], v3 offset:4864
    v_perm_b32 v216, v68, v64, s49
    v_mul_f32 v245, v248, v245
    v_mfma_f32_16x16x32_bf16 v[220:223], v[88:91], a[64:67], v[252:255]
    ds_write_addtid_b32 v216 offset:13568
    v_exp_f32 v69, v69
    v_mfma_f32_16x16x32_bf16 v[220:223], v[92:95], a[68:71], v[220:223]
    ds_read_b128 v[224:227], v4 offset:4096
    v_perm_b32 v217, v69, v65, s49
    v_mfma_f32_16x16x32_bf16 v[220:223], v[96:99], a[72:75], v[220:223]
    v_exp_f32 v70, v70
    v_mfma_f32_16x16x32_bf16 v[220:223], v[100:103], a[76:79], v[220:223]
    s_waitcnt lgkmcnt(10)
    ds_write_addtid_b32 v217 offset:19744
    v_perm_b32 v218, v70, v66, s49
    v_mfma_f32_16x16x32_bf16 v[48:51], a[192:195], v[184:187], v[48:51]
    s_waitcnt lgkmcnt(6)
    v_exp_f32 v71, v71
    v_mfma_f32_16x16x32_bf16 v[48:51], a[200:203], v[188:191], v[48:51]
    s_waitcnt lgkmcnt(4)
    ds_write_addtid_b32 v218 offset:25984
    v_perm_b32 v219, v71, v67, s49
    v_mfma_f32_16x16x32_bf16 v[48:51], a[208:211], v[192:195], v[48:51]
    s_waitcnt lgkmcnt(4)
    v_exp_f32 v220, v220
    v_mfma_f32_16x16x32_bf16 v[48:51], a[216:219], v[196:199], v[48:51]
    ds_write_addtid_b32 v219 offset:32160
    ds_read_b128 v[156:159], v0 offset:1280
    v_mfma_f32_16x16x32_bf16 v[68:71], v[88:91], a[80:83], v[252:255]
    v_exp_f32 v221, v221
    v_mfma_f32_16x16x32_bf16 v[68:71], v[92:95], a[84:87], v[68:71]
    ds_read_b128 v[228:231], v4 offset:4352
    ds_read_b128 v[80:83], v7 offset:8192
    v_mfma_f32_16x16x32_bf16 v[68:71], v[96:99], a[88:91], v[68:71]
    v_exp_f32 v222, v222
    v_mfma_f32_16x16x32_bf16 v[68:71], v[100:103], a[92:95], v[68:71]
    ds_read_b128 v[232:235], v4 offset:4608
    ds_read_b128 v[84:87], v8 offset:8192
    v_mfma_f32_16x16x32_bf16 v[52:55], a[196:199], v[184:187], v[52:55]
    v_exp_f32 v223, v223
    v_mfma_f32_16x16x32_bf16 v[52:55], a[204:207], v[188:191], v[52:55]
    v_mul_f32 v246, v248, v246
    v_mul_f32 v247, v248, v247
    v_mfma_f32_16x16x32_bf16 v[52:55], a[212:215], v[192:195], v[52:55]
    v_exp_f32 v68, v68
    v_mfma_f32_16x16x32_bf16 v[52:55], a[220:223], v[196:199], v[52:55]
    s_waitcnt lgkmcnt(4)
    ds_read_b128 v[236:239], v4 offset:4864
    v_perm_b32 v216, v68, v220, s49
    v_smfmac_f32_16x16x64_bf16 v[44:47], v[36:39], v[152:159], v1
    ds_write_addtid_b32 v216 offset:13824
    v_bitop3_b32 v17, v17, v248, s29 bitop3:0xe8
    v_mfma_f32_16x16x32_bf16 v[64:67], v[88:91], a[96:99], v[252:255]
    v_exp_f32 v69, v69
    v_mfma_f32_16x16x32_bf16 v[64:67], v[92:95], a[100:103], v[64:67]
    v_perm_b32 v217, v69, v221, s49
    v_cvt_pk_bf16_f32 v240, v240, v241
    v_mfma_f32_16x16x32_bf16 v[64:67], v[96:99], a[104:107], v[64:67]
    v_exp_f32 v70, v70
    v_mfma_f32_16x16x32_bf16 v[64:67], v[100:103], a[108:111], v[64:67]
    ds_write_addtid_b32 v217 offset:20000
    v_perm_b32 v218, v70, v222, s49
    v_mfma_f32_16x16x32_bf16 v[48:51], a[224:227], v[224:227], v[48:51]
    s_waitcnt lgkmcnt(6)
    v_exp_f32 v71, v71
    v_mfma_f32_16x16x32_bf16 v[48:51], a[232:235], v[228:231], v[48:51]
    s_waitcnt lgkmcnt(4)
    ds_write_addtid_b32 v218 offset:26240
    v_perm_b32 v219, v71, v223, s49
    v_mfma_f32_16x16x32_bf16 v[48:51], a[240:243], v[232:235], v[48:51]
    s_waitcnt lgkmcnt(3)
    v_exp_f32 v64, v64
    v_mfma_f32_16x16x32_bf16 v[48:51], a[248:251], v[236:239], v[48:51]
    ds_write_addtid_b32 v219 offset:32416
    ds_read_b128 v[160:163], v0 offset:1536
    v_mfma_f32_16x16x32_bf16 v[68:71], v[88:91], a[112:115], v[252:255]
    v_exp_f32 v65, v65
    v_mfma_f32_16x16x32_bf16 v[68:71], v[92:95], a[116:119], v[68:71]
    v_cvt_pk_bf16_f32 v241, v242, v243
    v_cvt_pk_bf16_f32 v242, v244, v245
    v_mfma_f32_16x16x32_bf16 v[68:71], v[96:99], a[120:123], v[68:71]
    v_exp_f32 v66, v66
    v_mfma_f32_16x16x32_bf16 v[68:71], v[100:103], a[124:127], v[68:71]
    v_mul_f32 v48, v20, v48
    v_cvt_pk_bf16_f32 v243, v246, v247
    v_mfma_f32_16x16x32_bf16 v[52:55], a[228:231], v[224:227], v[52:55]
    v_exp_f32 v67, v67
    v_mfma_f32_16x16x32_bf16 v[52:55], a[236:239], v[228:231], v[52:55]
    v_mul_f32 v49, v20, v49
    v_mul_f32 v50, v20, v50
    v_mfma_f32_16x16x32_bf16 v[52:55], a[244:247], v[232:235], v[52:55]
    v_exp_f32 v68, v68
    v_mfma_f32_16x16x32_bf16 v[52:55], a[252:255], v[236:239], v[52:55]
    buffer_store_dwordx4 v[240:243], v11, s[8:11], s26 offen nt
    buffer_load_dwordx4 v9, s[4:7], s21 offen nt lds
    v_mul_f32 v51, v20, v51
    v_perm_b32 v216, v68, v64, s49
    v_cvt_pk_bf16_f32 v28, v48, v49
.p2align 6
L_loop:
    v_mfma_f32_16x16x32_bf16 v[220:223], v[72:75], a[0:3], v[252:255]
    ds_write_addtid_b32 v216 offset:14080
    v_exp_f32 v69, v69
    v_mfma_f32_16x16x32_bf16 v[220:223], v[76:79], a[4:7], v[220:223]
    ds_read_b128 v[168:171], v2 offset:5120
    v_perm_b32 v217, v69, v65, s49
    v_mfma_f32_16x16x32_bf16 v[220:223], v[80:83], a[8:11], v[220:223]
    s_waitcnt lgkmcnt(2)
    v_exp_f32 v70, v70
    v_mfma_f32_16x16x32_bf16 v[220:223], v[84:87], a[12:15], v[220:223]
    ds_write_addtid_b32 v217 offset:20256
    v_perm_b32 v218, v70, v66, s49
    v_mfma_f32_16x16x32_bf16 v[56:59], a[128:131], v[120:123], 0
    v_exp_f32 v71, v71
    v_mfma_f32_16x16x32_bf16 v[56:59], a[136:139], v[124:127], v[56:59]
    ds_write_addtid_b32 v218 offset:26496
    v_perm_b32 v219, v71, v67, s49
    v_mfma_f32_16x16x32_bf16 v[56:59], a[144:147], v[128:131], v[56:59]
    v_exp_f32 v220, v220
    v_mfma_f32_16x16x32_bf16 v[56:59], a[152:155], v[132:135], v[56:59]
    ds_write_addtid_b32 v219 offset:32672
    ds_read_b128 v[164:167], v0 offset:1792
    v_mfma_f32_16x16x32_bf16 v[68:71], v[72:75], a[16:19], v[252:255]
    v_exp_f32 v221, v221
    v_mfma_f32_16x16x32_bf16 v[68:71], v[76:79], a[20:23], v[68:71]
    ds_read_b128 v[172:175], v2 offset:5376
    v_mul_f32 v52, v20, v52
    v_mfma_f32_16x16x32_bf16 v[68:71], v[80:83], a[24:27], v[68:71]
    v_exp_f32 v222, v222
    v_mfma_f32_16x16x32_bf16 v[68:71], v[84:87], a[28:31], v[68:71]
    ds_read_b128 v[176:179], v2 offset:5632
    v_mul_f32 v53, v20, v53
    v_mfma_f32_16x16x32_bf16 v[60:63], a[132:135], v[120:123], 0
    v_exp_f32 v223, v223
    v_mfma_f32_16x16x32_bf16 v[60:63], a[140:143], v[124:127], v[60:63]
    ds_read_b128 v[184:187], v3 offset:5120
    v_mul_f32 v54, v20, v54
    v_mfma_f32_16x16x32_bf16 v[60:63], a[148:151], v[128:131], v[60:63]
L_pad7:
    s_cbranch_execz L_pad11
    s_waitcnt lgkmcnt(3)
    v_exp_f32 v68, v68
    v_mfma_f32_16x16x32_bf16 v[60:63], a[156:159], v[132:135], v[60:63]
    ds_read_b128 v[180:183], v2 offset:5888
    v_perm_b32 v216, v68, v220, s49
    v_smfmac_f32_16x16x64_bf16 v[44:47], v[36:39], v[160:167], v1
    ds_write_addtid_b32 v216 offset:14336
    v_mul_f32 v55, v20, v55
    v_mfma_f32_16x16x32_bf16 v[64:67], v[72:75], a[32:35], v[252:255]
    v_exp_f32 v69, v69
    v_mfma_f32_16x16x32_bf16 v[64:67], v[76:79], a[36:39], v[64:67]
    ds_read_b128 v[188:191], v3 offset:5376
    v_perm_b32 v217, v69, v221, s49
    v_mfma_f32_16x16x32_bf16 v[64:67], v[80:83], a[40:43], v[64:67]
    v_exp_f32 v70, v70
    v_mfma_f32_16x16x32_bf16 v[64:67], v[84:87], a[44:47], v[64:67]
    ds_write_addtid_b32 v217 offset:20512
    v_perm_b32 v218, v70, v222, s49
    v_mfma_f32_16x16x32_bf16 v[56:59], a[160:163], v[168:171], v[56:59]
    s_waitcnt lgkmcnt(5)
    v_exp_f32 v71, v71
    v_mfma_f32_16x16x32_bf16 v[56:59], a[168:171], v[172:175], v[56:59]
    ds_write_addtid_b32 v218 offset:26752
    v_perm_b32 v219, v71, v223, s49
    v_add_f32 v44, v44, v45
    v_mfma_f32_16x16x32_bf16 v[56:59], a[176:179], v[176:179], v[56:59]
    s_waitcnt lgkmcnt(4)
    v_exp_f32 v64, v64
    v_mfma_f32_16x16x32_bf16 v[56:59], a[184:187], v[180:183], v[56:59]
    ds_write_addtid_b32 v219 offset:32928
    ds_read_b128 v[104:107], v0 offset:2048
    v_mfma_f32_16x16x32_bf16 v[68:71], v[72:75], a[48:51], v[252:255]
    v_exp_f32 v65, v65
    v_mfma_f32_16x16x32_bf16 v[68:71], v[76:79], a[52:55], v[68:71]
    ds_write_b32 v12, v44 offset:0
    v_mfma_f32_16x16x32_bf16 v[68:71], v[80:83], a[56:59], v[68:71]
    s_waitcnt vmcnt(6)
    v_exp_f32 v66, v66
    v_mfma_f32_16x16x32_bf16 v[68:71], v[84:87], a[60:63], v[68:71]
    ds_add_u32 v14, v16
    v_mfma_f32_16x16x32_bf16 v[60:63], a[164:167], v[168:171], v[60:63]
    s_add_u32 s24, s24, 1
    v_exp_f32 v67, v67
    v_mfma_f32_16x16x32_bf16 v[60:63], a[172:175], v[172:175], v[60:63]
    ds_read_b128 v[192:195], v3 offset:5632
    v_cvt_pk_bf16_f32 v29, v50, v51
    v_mfma_f32_16x16x32_bf16 v[60:63], a[180:183], v[176:179], v[60:63]
    v_exp_f32 v68, v68
    v_mfma_f32_16x16x32_bf16 v[60:63], a[188:191], v[180:183], v[60:63]
    ds_read_b128 v[196:199], v3 offset:5888
    v_perm_b32 v216, v68, v64, s49
    v_cvt_pk_bf16_f32 v30, v52, v53
    v_mfma_f32_16x16x32_bf16 v[220:223], v[72:75], a[64:67], v[252:255]
    ds_write_addtid_b32 v216 offset:14592
    v_exp_f32 v69, v69
    v_mfma_f32_16x16x32_bf16 v[220:223], v[76:79], a[68:71], v[220:223]
    ds_read_b128 v[224:227], v4 offset:5120
    v_perm_b32 v217, v69, v65, s49
    v_mfma_f32_16x16x32_bf16 v[220:223], v[80:83], a[72:75], v[220:223]
    v_exp_f32 v70, v70
    v_mfma_f32_16x16x32_bf16 v[220:223], v[84:87], a[76:79], v[220:223]
    ds_write_addtid_b32 v217 offset:20768
    v_perm_b32 v218, v70, v66, s49
    v_mfma_f32_16x16x32_bf16 v[56:59], a[192:195], v[184:187], v[56:59]
    s_waitcnt lgkmcnt(4)
    v_exp_f32 v71, v71
    v_mfma_f32_16x16x32_bf16 v[56:59], a[200:203], v[188:191], v[56:59]
    ds_write_addtid_b32 v218 offset:27008
    v_perm_b32 v219, v71, v67, s49
    v_mfma_f32_16x16x32_bf16 v[56:59], a[208:211], v[192:195], v[56:59]
    s_waitcnt lgkmcnt(4)
    v_exp_f32 v220, v220
    v_mfma_f32_16x16x32_bf16 v[56:59], a[216:219], v[196:199], v[56:59]
    ds_write_addtid_b32 v219 offset:33184
    ds_read_b128 v[108:111], v0 offset:2304
    v_mfma_f32_16x16x32_bf16 v[68:71], v[72:75], a[80:83], v[252:255]
    v_exp_f32 v221, v221
    v_mfma_f32_16x16x32_bf16 v[68:71], v[76:79], a[84:87], v[68:71]
    ds_read_b128 v[228:231], v4 offset:5376
    v_cvt_pk_bf16_f32 v31, v54, v55
    v_mfma_f32_16x16x32_bf16 v[68:71], v[80:83], a[88:91], v[68:71]
    v_exp_f32 v222, v222
    v_mfma_f32_16x16x32_bf16 v[68:71], v[84:87], a[92:95], v[68:71]
    ds_read_b128 v[232:235], v4 offset:5632
    ds_read_b128 v[88:91], v5 offset:9216
    v_mfma_f32_16x16x32_bf16 v[60:63], a[196:199], v[184:187], v[60:63]
    v_exp_f32 v223, v223
    v_mfma_f32_16x16x32_bf16 v[60:63], a[204:207], v[188:191], v[60:63]
    ds_read_b128 v[92:95], v6 offset:9216
    ds_read_b128 v[96:99], v7 offset:9216
    v_mfma_f32_16x16x32_bf16 v[60:63], a[212:215], v[192:195], v[60:63]
    s_waitcnt lgkmcnt(5)
    v_exp_f32 v68, v68
    v_mfma_f32_16x16x32_bf16 v[60:63], a[220:223], v[196:199], v[60:63]
    ds_read_b128 v[236:239], v4 offset:5888
    v_perm_b32 v216, v68, v220, s49
    v_smfmac_f32_16x16x64_bf16 v[40:43], v[32:35], v[104:111], v1
    ds_write_addtid_b32 v216 offset:14848
    ds_read_b128 v[100:103], v8 offset:9216
    v_mfma_f32_16x16x32_bf16 v[64:67], v[72:75], a[96:99], v[252:255]
    v_exp_f32 v69, v69
    v_mfma_f32_16x16x32_bf16 v[64:67], v[76:79], a[100:103], v[64:67]
    ds_read_b32 v19, v15
    v_perm_b32 v217, v69, v221, s49
    v_mfma_f32_16x16x32_bf16 v[64:67], v[80:83], a[104:107], v[64:67]
    v_exp_f32 v70, v70
    v_mfma_f32_16x16x32_bf16 v[64:67], v[84:87], a[108:111], v[64:67]
    ds_write_addtid_b32 v217 offset:21024
    v_perm_b32 v218, v70, v222, s49
    v_mfma_f32_16x16x32_bf16 v[56:59], a[224:227], v[224:227], v[56:59]
    s_waitcnt lgkmcnt(8)
    v_exp_f32 v71, v71
    v_mfma_f32_16x16x32_bf16 v[56:59], a[232:235], v[228:231], v[56:59]
    ds_write_addtid_b32 v218 offset:27264
    v_perm_b32 v219, v71, v223, s49
    v_mfma_f32_16x16x32_bf16 v[56:59], a[240:243], v[232:235], v[56:59]
    s_waitcnt lgkmcnt(5)
    v_exp_f32 v64, v64
    v_mfma_f32_16x16x32_bf16 v[56:59], a[248:251], v[236:239], v[56:59]
    ds_write_addtid_b32 v219 offset:33440
    ds_read_b128 v[112:115], v0 offset:2560
    v_mfma_f32_16x16x32_bf16 v[68:71], v[72:75], a[112:115], v[252:255]
    v_exp_f32 v65, v65
    v_mfma_f32_16x16x32_bf16 v[68:71], v[76:79], a[116:119], v[68:71]
    v_mul_f32 v56, v21, v56
    v_mul_f32 v57, v21, v57
    v_mfma_f32_16x16x32_bf16 v[68:71], v[80:83], a[120:123], v[68:71]
    v_exp_f32 v66, v66
    v_mfma_f32_16x16x32_bf16 v[68:71], v[84:87], a[124:127], v[68:71]
    s_waitcnt lgkmcnt(4)
    v_cmp_gt_u32 vcc, s24, v19
    v_mul_f32 v58, v21, v58
    v_mfma_f32_16x16x32_bf16 v[60:63], a[228:231], v[224:227], v[60:63]
    s_add_u32 m0, s23, 3072
    v_exp_f32 v67, v67
    v_mfma_f32_16x16x32_bf16 v[60:63], a[236:239], v[228:231], v[60:63]
    buffer_store_dwordx4 v[28:31], v11, s[8:11], s22 offen nt
    buffer_load_dwordx4 v10, s[4:7], s22 offen nt lds
    v_mul_f32 v59, v21, v59
    v_mov_b64 v[44:45], 0
    s_cbranch_vccnz L_retry5
L_back5:
    v_mfma_f32_16x16x32_bf16 v[60:63], a[244:247], v[232:235], v[60:63]
    v_exp_f32 v68, v68
    v_mfma_f32_16x16x32_bf16 v[60:63], a[252:255], v[236:239], v[60:63]
    v_cvt_pk_bf16_f32 v28, v56, v57
    v_perm_b32 v216, v68, v64, s49
    v_cvt_pk_bf16_f32 v29, v58, v59
    v_mfma_f32_16x16x32_bf16 v[220:223], v[88:91], a[0:3], v[252:255]
    ds_write_addtid_b32 v216 offset:14080
    v_exp_f32 v69, v69
    v_mfma_f32_16x16x32_bf16 v[220:223], v[92:95], a[4:7], v[220:223]
    ds_read_b128 v[168:171], v2 offset:0
    v_perm_b32 v217, v69, v65, s49
    v_mfma_f32_16x16x32_bf16 v[220:223], v[96:99], a[8:11], v[220:223]
    v_exp_f32 v70, v70
    v_mfma_f32_16x16x32_bf16 v[220:223], v[100:103], a[12:15], v[220:223]
    ds_write_addtid_b32 v217 offset:20256
    v_perm_b32 v218, v70, v66, s49
    v_mfma_f32_16x16x32_bf16 v[48:51], a[128:131], v[136:139], 0
    v_exp_f32 v71, v71
    v_mfma_f32_16x16x32_bf16 v[48:51], a[136:139], v[140:143], v[48:51]
    ds_write_addtid_b32 v218 offset:26496
    v_perm_b32 v219, v71, v67, s49
    v_mfma_f32_16x16x32_bf16 v[48:51], a[144:147], v[144:147], v[48:51]
    v_exp_f32 v220, v220
    v_mfma_f32_16x16x32_bf16 v[48:51], a[152:155], v[148:151], v[48:51]
    ds_write_addtid_b32 v219 offset:32672
    ds_read_b128 v[116:119], v0 offset:2816
    v_mfma_f32_16x16x32_bf16 v[68:71], v[88:91], a[16:19], v[252:255]
    s_add_u32 s22, s22, 4096
    v_exp_f32 v221, v221
    v_mfma_f32_16x16x32_bf16 v[68:71], v[92:95], a[20:23], v[68:71]
    ds_read_b128 v[172:175], v2 offset:256
    v_mul_f32 v60, v21, v60
    v_mfma_f32_16x16x32_bf16 v[68:71], v[96:99], a[24:27], v[68:71]
    v_exp_f32 v222, v222
    v_mfma_f32_16x16x32_bf16 v[68:71], v[100:103], a[28:31], v[68:71]
    ds_read_b128 v[176:179], v2 offset:512
    v_mul_f32 v61, v21, v61
    v_mfma_f32_16x16x32_bf16 v[52:55], a[132:135], v[136:139], 0
    v_exp_f32 v223, v223
    v_mfma_f32_16x16x32_bf16 v[52:55], a[140:143], v[140:143], v[52:55]
    ds_read_b128 v[24:27], v18 offset:0
    v_mul_f32 v62, v21, v62
    v_mfma_f32_16x16x32_bf16 v[52:55], a[148:151], v[144:147], v[52:55]
    s_waitcnt lgkmcnt(3)
    v_exp_f32 v68, v68
    v_mfma_f32_16x16x32_bf16 v[52:55], a[156:159], v[148:151], v[52:55]
    ds_read_b128 v[180:183], v2 offset:768
    v_perm_b32 v216, v68, v220, s49
    v_smfmac_f32_16x16x64_bf16 v[40:43], v[32:35], v[112:119], v1
    ds_write_addtid_b32 v216 offset:14336
    v_mul_f32 v63, v21, v63
    v_mfma_f32_16x16x32_bf16 v[64:67], v[88:91], a[32:35], v[252:255]
    v_exp_f32 v69, v69
    v_mfma_f32_16x16x32_bf16 v[64:67], v[92:95], a[36:39], v[64:67]
    ds_read_b128 v[184:187], v3 offset:0
    v_perm_b32 v217, v69, v221, s49
    v_mfma_f32_16x16x32_bf16 v[64:67], v[96:99], a[40:43], v[64:67]
    v_exp_f32 v70, v70
    v_mfma_f32_16x16x32_bf16 v[64:67], v[100:103], a[44:47], v[64:67]
    ds_write_addtid_b32 v217 offset:20512
    v_perm_b32 v218, v70, v222, s49
    v_mfma_f32_16x16x32_bf16 v[48:51], a[160:163], v[168:171], v[48:51]
    s_waitcnt lgkmcnt(5)
    v_exp_f32 v71, v71
    v_mfma_f32_16x16x32_bf16 v[48:51], a[168:171], v[172:175], v[48:51]
    ds_write_addtid_b32 v218 offset:26752
    v_perm_b32 v219, v71, v223, s49
    v_mfma_f32_16x16x32_bf16 v[48:51], a[176:179], v[176:179], v[48:51]
    s_waitcnt lgkmcnt(4)
    v_exp_f32 v64, v64
    v_mfma_f32_16x16x32_bf16 v[48:51], a[184:187], v[180:183], v[48:51]
    ds_write_addtid_b32 v219 offset:32928
    ds_read_b128 v[120:123], v0 offset:3072
    v_mfma_f32_16x16x32_bf16 v[68:71], v[88:91], a[48:51], v[252:255]
    v_exp_f32 v65, v65
    v_mfma_f32_16x16x32_bf16 v[68:71], v[92:95], a[52:55], v[68:71]
    ds_read_b128 v[188:191], v3 offset:256
    v_cvt_pk_bf16_f32 v30, v60, v61
    v_mfma_f32_16x16x32_bf16 v[68:71], v[96:99], a[56:59], v[68:71]
    v_exp_f32 v66, v66
    v_mfma_f32_16x16x32_bf16 v[68:71], v[100:103], a[60:63], v[68:71]
    ds_read_b128 v[192:195], v3 offset:512
    v_cvt_pk_bf16_f32 v31, v62, v63
    v_mfma_f32_16x16x32_bf16 v[52:55], a[164:167], v[168:171], v[52:55]
    s_add_u32 m0, s23, 4096
    v_exp_f32 v67, v67
    v_mfma_f32_16x16x32_bf16 v[52:55], a[172:175], v[172:175], v[52:55]
    buffer_store_dwordx4 v[28:31], v11, s[8:11], s22 offen nt
    buffer_load_dwordx4 v10, s[4:7], s22 offen nt lds
    v_add_f32 v24, v24, v25
    v_add_f32 v26, v26, v27
    v_add_f32 v24, v24, v26
    v_mfma_f32_16x16x32_bf16 v[52:55], a[180:183], v[176:179], v[52:55]
    v_exp_f32 v68, v68
    v_mfma_f32_16x16x32_bf16 v[52:55], a[188:191], v[180:183], v[52:55]
    ds_read_b128 v[196:199], v3 offset:768
    v_perm_b32 v216, v68, v64, s49
    ds_read_b128 v[72:75], v5 offset:10240
    v_mfma_f32_16x16x32_bf16 v[220:223], v[88:91], a[64:67], v[252:255]
    ds_write_addtid_b32 v216 offset:13568
    v_exp_f32 v69, v69
    v_mfma_f32_16x16x32_bf16 v[220:223], v[92:95], a[68:71], v[220:223]
    ds_read_b128 v[224:227], v4 offset:0
    v_perm_b32 v217, v69, v65, s49
    v_mfma_f32_16x16x32_bf16 v[220:223], v[96:99], a[72:75], v[220:223]
    s_waitcnt lgkmcnt(10)
    v_exp_f32 v70, v70
    v_mfma_f32_16x16x32_bf16 v[220:223], v[100:103], a[76:79], v[220:223]
    ds_write_addtid_b32 v217 offset:19744
    v_perm_b32 v218, v70, v66, s49
    v_mfma_f32_16x16x32_bf16 v[48:51], a[192:195], v[184:187], v[48:51]
    s_waitcnt lgkmcnt(5)
    v_exp_f32 v71, v71
    v_mfma_f32_16x16x32_bf16 v[48:51], a[200:203], v[188:191], v[48:51]
    ds_write_addtid_b32 v218 offset:25984
    v_perm_b32 v219, v71, v67, s49
    v_mfma_f32_16x16x32_bf16 v[48:51], a[208:211], v[192:195], v[48:51]
    s_waitcnt lgkmcnt(5)
    v_exp_f32 v220, v220
    v_mfma_f32_16x16x32_bf16 v[48:51], a[216:219], v[196:199], v[48:51]
    ds_write_addtid_b32 v219 offset:32160
    ds_read_b128 v[124:127], v0 offset:3328
    v_mfma_f32_16x16x32_bf16 v[68:71], v[88:91], a[80:83], v[252:255]
    s_add_u32 s22, s22, 4096
    v_exp_f32 v221, v221
    v_mfma_f32_16x16x32_bf16 v[68:71], v[92:95], a[84:87], v[68:71]
    v_rcp_f32 v22, v24
    v_mfma_f32_16x16x32_bf16 v[68:71], v[96:99], a[88:91], v[68:71]
    v_exp_f32 v222, v222
    v_mfma_f32_16x16x32_bf16 v[68:71], v[100:103], a[92:95], v[68:71]
    ds_read_b128 v[228:231], v4 offset:256
    v_bitop3_b32 v17, v17, v22, s29 bitop3:0xe8
    v_mfma_f32_16x16x32_bf16 v[52:55], a[196:199], v[184:187], v[52:55]
    v_exp_f32 v223, v223
    v_mfma_f32_16x16x32_bf16 v[52:55], a[204:207], v[188:191], v[52:55]
    ds_read_b128 v[232:235], v4 offset:512
    v_mov_b32 v23, v22
    v_mfma_f32_16x16x32_bf16 v[52:55], a[212:215], v[192:195], v[52:55]
    s_waitcnt lgkmcnt(2)
    v_exp_f32 v68, v68
    v_mfma_f32_16x16x32_bf16 v[52:55], a[220:223], v[196:199], v[52:55]
    ds_read_b128 v[236:239], v4 offset:768
    v_perm_b32 v216, v68, v220, s49
    v_smfmac_f32_16x16x64_bf16 v[40:43], v[36:39], v[120:127], v1
    ds_write_addtid_b32 v216 offset:13824
    ds_read_b128 v[76:79], v6 offset:10240
    v_mfma_f32_16x16x32_bf16 v[64:67], v[88:91], a[96:99], v[252:255]
    v_exp_f32 v69, v69
    v_mfma_f32_16x16x32_bf16 v[64:67], v[92:95], a[100:103], v[64:67]
    ds_read_b128 v[80:83], v7 offset:10240
    v_perm_b32 v217, v69, v221, s49
    v_mfma_f32_16x16x32_bf16 v[64:67], v[96:99], a[104:107], v[64:67]
    v_exp_f32 v70, v70
    v_mfma_f32_16x16x32_bf16 v[64:67], v[100:103], a[108:111], v[64:67]
    ds_write_addtid_b32 v217 offset:20000
    v_perm_b32 v218, v70, v222, s49
    v_mfma_f32_16x16x32_bf16 v[48:51], a[224:227], v[224:227], v[48:51]
    s_waitcnt lgkmcnt(5)
    v_exp_f32 v71, v71
    v_mfma_f32_16x16x32_bf16 v[48:51], a[232:235], v[228:231], v[48:51]
    ds_write_addtid_b32 v218 offset:26240
    v_perm_b32 v219, v71, v223, s49
    v_mfma_f32_16x16x32_bf16 v[48:51], a[240:243], v[232:235], v[48:51]
    s_waitcnt lgkmcnt(5)
    v_exp_f32 v64, v64
    v_mfma_f32_16x16x32_bf16 v[48:51], a[248:251], v[236:239], v[48:51]
    ds_write_addtid_b32 v219 offset:32416
    ds_read_b128 v[128:131], v0 offset:3584
    v_mfma_f32_16x16x32_bf16 v[68:71], v[88:91], a[112:115], v[252:255]
    v_exp_f32 v65, v65
    v_mfma_f32_16x16x32_bf16 v[68:71], v[92:95], a[116:119], v[68:71]
    v_permlane32_swap_b32 v22, v23
    v_mfma_f32_16x16x32_bf16 v[68:71], v[96:99], a[120:123], v[68:71]
    v_exp_f32 v66, v66
    v_mfma_f32_16x16x32_bf16 v[68:71], v[100:103], a[124:127], v[68:71]
    ds_read_b128 v[84:87], v8 offset:10240
    v_mul_f32 v48, v22, v48
    v_mfma_f32_16x16x32_bf16 v[52:55], a[228:231], v[224:227], v[52:55]
    v_exp_f32 v67, v67
    v_mfma_f32_16x16x32_bf16 v[52:55], a[236:239], v[228:231], v[52:55]
    v_mul_f32 v49, v22, v49
    v_mul_f32 v50, v22, v50
    v_mfma_f32_16x16x32_bf16 v[52:55], a[244:247], v[232:235], v[52:55]
    v_exp_f32 v68, v68
    v_mfma_f32_16x16x32_bf16 v[52:55], a[252:255], v[236:239], v[52:55]
    s_waitcnt lgkmcnt(5)
    v_mul_f32 v51, v22, v51
    v_perm_b32 v216, v68, v64, s49
    v_cvt_pk_bf16_f32 v28, v48, v49
    v_mfma_f32_16x16x32_bf16 v[220:223], v[72:75], a[0:3], v[252:255]
    ds_write_addtid_b32 v216 offset:14080
    v_exp_f32 v69, v69
    v_mfma_f32_16x16x32_bf16 v[220:223], v[76:79], a[4:7], v[220:223]
    ds_read_b128 v[168:171], v2 offset:1024
    v_perm_b32 v217, v69, v65, s49
    v_mfma_f32_16x16x32_bf16 v[220:223], v[80:83], a[8:11], v[220:223]
    s_waitcnt lgkmcnt(2)
    v_exp_f32 v70, v70
    v_mfma_f32_16x16x32_bf16 v[220:223], v[84:87], a[12:15], v[220:223]
    ds_write_addtid_b32 v217 offset:20256
    v_perm_b32 v218, v70, v66, s49
    v_mfma_f32_16x16x32_bf16 v[56:59], a[128:131], v[152:155], 0
    v_exp_f32 v71, v71
    v_mfma_f32_16x16x32_bf16 v[56:59], a[136:139], v[156:159], v[56:59]
    ds_write_addtid_b32 v218 offset:26496
    v_perm_b32 v219, v71, v67, s49
    v_mfma_f32_16x16x32_bf16 v[56:59], a[144:147], v[160:163], v[56:59]
    v_exp_f32 v220, v220
    v_mfma_f32_16x16x32_bf16 v[56:59], a[152:155], v[164:167], v[56:59]
    ds_write_addtid_b32 v219 offset:32672
    ds_read_b128 v[132:135], v0 offset:3840
    v_mfma_f32_16x16x32_bf16 v[68:71], v[72:75], a[16:19], v[252:255]
    v_exp_f32 v221, v221
    v_mfma_f32_16x16x32_bf16 v[68:71], v[76:79], a[20:23], v[68:71]
    ds_read_b128 v[172:175], v2 offset:1280
    v_mul_f32 v52, v22, v52
    v_mfma_f32_16x16x32_bf16 v[68:71], v[80:83], a[24:27], v[68:71]
    v_exp_f32 v222, v222
    v_mfma_f32_16x16x32_bf16 v[68:71], v[84:87], a[28:31], v[68:71]
    ds_read_b128 v[176:179], v2 offset:1536
    v_mul_f32 v53, v22, v53
    v_mfma_f32_16x16x32_bf16 v[60:63], a[132:135], v[152:155], 0
    v_exp_f32 v223, v223
    v_mfma_f32_16x16x32_bf16 v[60:63], a[140:143], v[156:159], v[60:63]
    ds_read_b128 v[184:187], v3 offset:1024
    v_mul_f32 v54, v22, v54
    v_mfma_f32_16x16x32_bf16 v[60:63], a[148:151], v[160:163], v[60:63]
    s_waitcnt lgkmcnt(3)
    v_exp_f32 v68, v68
    v_mfma_f32_16x16x32_bf16 v[60:63], a[156:159], v[164:167], v[60:63]
    ds_read_b128 v[180:183], v2 offset:1792
    v_perm_b32 v216, v68, v220, s49
    v_smfmac_f32_16x16x64_bf16 v[40:43], v[36:39], v[128:135], v1
    ds_write_addtid_b32 v216 offset:14336
    v_mul_f32 v55, v22, v55
    v_mfma_f32_16x16x32_bf16 v[64:67], v[72:75], a[32:35], v[252:255]
    v_exp_f32 v69, v69
    v_mfma_f32_16x16x32_bf16 v[64:67], v[76:79], a[36:39], v[64:67]
    ds_read_b128 v[188:191], v3 offset:1280
    v_perm_b32 v217, v69, v221, s49
    v_mfma_f32_16x16x32_bf16 v[64:67], v[80:83], a[40:43], v[64:67]
    v_exp_f32 v70, v70
    v_mfma_f32_16x16x32_bf16 v[64:67], v[84:87], a[44:47], v[64:67]
    ds_write_addtid_b32 v217 offset:20512
    v_perm_b32 v218, v70, v222, s49
    v_mfma_f32_16x16x32_bf16 v[56:59], a[160:163], v[168:171], v[56:59]
    s_waitcnt lgkmcnt(5)
    v_exp_f32 v71, v71
    v_mfma_f32_16x16x32_bf16 v[56:59], a[168:171], v[172:175], v[56:59]
    ds_write_addtid_b32 v218 offset:26752
    v_perm_b32 v219, v71, v223, s49
    v_add_f32 v40, v40, v41
    v_mfma_f32_16x16x32_bf16 v[56:59], a[176:179], v[176:179], v[56:59]
    s_waitcnt lgkmcnt(4)
    v_exp_f32 v64, v64
    v_mfma_f32_16x16x32_bf16 v[56:59], a[184:187], v[180:183], v[56:59]
    ds_write_addtid_b32 v219 offset:32928
    ds_read_b128 v[136:139], v0 offset:4096
    v_mfma_f32_16x16x32_bf16 v[68:71], v[72:75], a[48:51], v[252:255]
    v_exp_f32 v65, v65
    v_mfma_f32_16x16x32_bf16 v[68:71], v[76:79], a[52:55], v[68:71]
    ds_write_b32 v12, v40 offset:512
    v_mfma_f32_16x16x32_bf16 v[68:71], v[80:83], a[56:59], v[68:71]
    s_waitcnt vmcnt(6)
    v_exp_f32 v66, v66
    v_mfma_f32_16x16x32_bf16 v[68:71], v[84:87], a[60:63], v[68:71]
    ds_add_u32 v14, v16
    v_mfma_f32_16x16x32_bf16 v[60:63], a[164:167], v[168:171], v[60:63]
    s_add_u32 s24, s24, 1
    v_exp_f32 v67, v67
    v_mfma_f32_16x16x32_bf16 v[60:63], a[172:175], v[172:175], v[60:63]
    ds_read_b128 v[192:195], v3 offset:1536
    v_cvt_pk_bf16_f32 v29, v50, v51
    v_mfma_f32_16x16x32_bf16 v[60:63], a[180:183], v[176:179], v[60:63]
    v_exp_f32 v68, v68
    v_mfma_f32_16x16x32_bf16 v[60:63], a[188:191], v[180:183], v[60:63]
    ds_read_b128 v[196:199], v3 offset:1792
    v_perm_b32 v216, v68, v64, s49
    v_cvt_pk_bf16_f32 v30, v52, v53
    v_mfma_f32_16x16x32_bf16 v[220:223], v[72:75], a[64:67], v[252:255]
    ds_write_addtid_b32 v216 offset:14592
    v_exp_f32 v69, v69
    v_mfma_f32_16x16x32_bf16 v[220:223], v[76:79], a[68:71], v[220:223]
    ds_read_b128 v[224:227], v4 offset:1024
    v_perm_b32 v217, v69, v65, s49
    v_mfma_f32_16x16x32_bf16 v[220:223], v[80:83], a[72:75], v[220:223]
    v_exp_f32 v70, v70
    v_mfma_f32_16x16x32_bf16 v[220:223], v[84:87], a[76:79], v[220:223]
    ds_write_addtid_b32 v217 offset:20768
    v_perm_b32 v218, v70, v66, s49
    v_mfma_f32_16x16x32_bf16 v[56:59], a[192:195], v[184:187], v[56:59]
    s_waitcnt lgkmcnt(4)
    v_exp_f32 v71, v71
    v_mfma_f32_16x16x32_bf16 v[56:59], a[200:203], v[188:191], v[56:59]
    ds_write_addtid_b32 v218 offset:27008
    v_perm_b32 v219, v71, v67, s49
    v_mfma_f32_16x16x32_bf16 v[56:59], a[208:211], v[192:195], v[56:59]
    s_waitcnt lgkmcnt(4)
    v_exp_f32 v220, v220
    v_mfma_f32_16x16x32_bf16 v[56:59], a[216:219], v[196:199], v[56:59]
    ds_write_addtid_b32 v219 offset:33184
    ds_read_b128 v[140:143], v0 offset:4352
    v_mfma_f32_16x16x32_bf16 v[68:71], v[72:75], a[80:83], v[252:255]
    v_exp_f32 v221, v221
    v_mfma_f32_16x16x32_bf16 v[68:71], v[76:79], a[84:87], v[68:71]
    ds_read_b128 v[228:231], v4 offset:1280
    v_cvt_pk_bf16_f32 v31, v54, v55
    v_mfma_f32_16x16x32_bf16 v[68:71], v[80:83], a[88:91], v[68:71]
    v_exp_f32 v222, v222
    v_mfma_f32_16x16x32_bf16 v[68:71], v[84:87], a[92:95], v[68:71]
    ds_read_b128 v[232:235], v4 offset:1536
    ds_read_b128 v[88:91], v5 offset:11264
    v_mfma_f32_16x16x32_bf16 v[60:63], a[196:199], v[184:187], v[60:63]
    v_exp_f32 v223, v223
    v_mfma_f32_16x16x32_bf16 v[60:63], a[204:207], v[188:191], v[60:63]
    ds_read_b128 v[92:95], v6 offset:11264
    ds_read_b128 v[96:99], v7 offset:11264
    v_mfma_f32_16x16x32_bf16 v[60:63], a[212:215], v[192:195], v[60:63]
    s_waitcnt lgkmcnt(5)
    v_exp_f32 v68, v68
    v_mfma_f32_16x16x32_bf16 v[60:63], a[220:223], v[196:199], v[60:63]
    ds_read_b128 v[236:239], v4 offset:1792
    v_perm_b32 v216, v68, v220, s49
    v_smfmac_f32_16x16x64_bf16 v[44:47], v[32:35], v[136:143], v1
    ds_write_addtid_b32 v216 offset:14848
    ds_read_b128 v[100:103], v8 offset:11264
    v_mfma_f32_16x16x32_bf16 v[64:67], v[72:75], a[96:99], v[252:255]
    v_exp_f32 v69, v69
    v_mfma_f32_16x16x32_bf16 v[64:67], v[76:79], a[100:103], v[64:67]
    ds_read_b32 v19, v15
    v_perm_b32 v217, v69, v221, s49
    v_mfma_f32_16x16x32_bf16 v[64:67], v[80:83], a[104:107], v[64:67]
    v_exp_f32 v70, v70
    v_mfma_f32_16x16x32_bf16 v[64:67], v[84:87], a[108:111], v[64:67]
    ds_write_addtid_b32 v217 offset:21024
    v_perm_b32 v218, v70, v222, s49
    v_mfma_f32_16x16x32_bf16 v[56:59], a[224:227], v[224:227], v[56:59]
    s_waitcnt lgkmcnt(8)
    v_exp_f32 v71, v71
    v_mfma_f32_16x16x32_bf16 v[56:59], a[232:235], v[228:231], v[56:59]
    ds_write_addtid_b32 v218 offset:27264
    v_perm_b32 v219, v71, v223, s49
    v_mfma_f32_16x16x32_bf16 v[56:59], a[240:243], v[232:235], v[56:59]
    s_waitcnt lgkmcnt(5)
    v_exp_f32 v64, v64
    v_mfma_f32_16x16x32_bf16 v[56:59], a[248:251], v[236:239], v[56:59]
    ds_write_addtid_b32 v219 offset:33440
    ds_read_b128 v[144:147], v0 offset:4608
    v_mfma_f32_16x16x32_bf16 v[68:71], v[72:75], a[112:115], v[252:255]
    v_exp_f32 v65, v65
    v_mfma_f32_16x16x32_bf16 v[68:71], v[76:79], a[116:119], v[68:71]
    v_mul_f32 v56, v23, v56
    v_mul_f32 v57, v23, v57
    v_mfma_f32_16x16x32_bf16 v[68:71], v[80:83], a[120:123], v[68:71]
    v_exp_f32 v66, v66
    v_mfma_f32_16x16x32_bf16 v[68:71], v[84:87], a[124:127], v[68:71]
    s_waitcnt lgkmcnt(4)
    v_cmp_gt_u32 vcc, s24, v19
    v_mul_f32 v58, v23, v58
    v_mfma_f32_16x16x32_bf16 v[60:63], a[228:231], v[224:227], v[60:63]
    s_add_u32 m0, s23, 5120
    v_exp_f32 v67, v67
    v_mfma_f32_16x16x32_bf16 v[60:63], a[236:239], v[228:231], v[60:63]
    buffer_store_dwordx4 v[28:31], v11, s[8:11], s22 offen nt
    buffer_load_dwordx4 v10, s[4:7], s22 offen nt lds
    v_mul_f32 v59, v23, v59
    v_mov_b64 v[40:41], 0
    s_cbranch_vccnz L_retry7
L_back7:
    v_mfma_f32_16x16x32_bf16 v[60:63], a[244:247], v[232:235], v[60:63]
    v_exp_f32 v68, v68
    v_mfma_f32_16x16x32_bf16 v[60:63], a[252:255], v[236:239], v[60:63]
    v_cvt_pk_bf16_f32 v28, v56, v57
    v_perm_b32 v216, v68, v64, s49
    v_cvt_pk_bf16_f32 v29, v58, v59
    v_mfma_f32_16x16x32_bf16 v[220:223], v[88:91], a[0:3], v[252:255]
    ds_write_addtid_b32 v216 offset:14080
    v_exp_f32 v69, v69
    v_mfma_f32_16x16x32_bf16 v[220:223], v[92:95], a[4:7], v[220:223]
    ds_read_b128 v[168:171], v2 offset:2048
    v_perm_b32 v217, v69, v65, s49
    v_mfma_f32_16x16x32_bf16 v[220:223], v[96:99], a[8:11], v[220:223]
    v_exp_f32 v70, v70
    v_mfma_f32_16x16x32_bf16 v[220:223], v[100:103], a[12:15], v[220:223]
    ds_write_addtid_b32 v217 offset:20256
    v_perm_b32 v218, v70, v66, s49
    v_mfma_f32_16x16x32_bf16 v[48:51], a[128:131], v[104:107], 0
    v_exp_f32 v71, v71
    v_mfma_f32_16x16x32_bf16 v[48:51], a[136:139], v[108:111], v[48:51]
    ds_write_addtid_b32 v218 offset:26496
    v_perm_b32 v219, v71, v67, s49
    v_mfma_f32_16x16x32_bf16 v[48:51], a[144:147], v[112:115], v[48:51]
    v_exp_f32 v220, v220
    v_mfma_f32_16x16x32_bf16 v[48:51], a[152:155], v[116:119], v[48:51]
    ds_write_addtid_b32 v219 offset:32672
    ds_read_b128 v[148:151], v0 offset:4864
    v_mfma_f32_16x16x32_bf16 v[68:71], v[88:91], a[16:19], v[252:255]
    s_add_u32 s22, s22, 4096
    v_exp_f32 v221, v221
    v_mfma_f32_16x16x32_bf16 v[68:71], v[92:95], a[20:23], v[68:71]
    ds_read_b128 v[172:175], v2 offset:2304
    v_mul_f32 v60, v23, v60
    v_mfma_f32_16x16x32_bf16 v[68:71], v[96:99], a[24:27], v[68:71]
    v_exp_f32 v222, v222
    v_mfma_f32_16x16x32_bf16 v[68:71], v[100:103], a[28:31], v[68:71]
    ds_read_b128 v[176:179], v2 offset:2560
    v_mul_f32 v61, v23, v61
    v_mfma_f32_16x16x32_bf16 v[52:55], a[132:135], v[104:107], 0
    v_exp_f32 v223, v223
    v_mfma_f32_16x16x32_bf16 v[52:55], a[140:143], v[108:111], v[52:55]
    ds_read_b128 v[24:27], v18 offset:512
    v_mul_f32 v62, v23, v62
    v_mfma_f32_16x16x32_bf16 v[52:55], a[148:151], v[112:115], v[52:55]
    s_waitcnt lgkmcnt(3)
    v_exp_f32 v68, v68
    v_mfma_f32_16x16x32_bf16 v[52:55], a[156:159], v[116:119], v[52:55]
    ds_read_b128 v[180:183], v2 offset:2816
    v_perm_b32 v216, v68, v220, s49
    v_smfmac_f32_16x16x64_bf16 v[44:47], v[32:35], v[144:151], v1
    ds_write_addtid_b32 v216 offset:14336
    v_mul_f32 v63, v23, v63
    v_mfma_f32_16x16x32_bf16 v[64:67], v[88:91], a[32:35], v[252:255]
    v_exp_f32 v69, v69
    v_mfma_f32_16x16x32_bf16 v[64:67], v[92:95], a[36:39], v[64:67]
    ds_read_b128 v[184:187], v3 offset:2048
    v_perm_b32 v217, v69, v221, s49
    v_mfma_f32_16x16x32_bf16 v[64:67], v[96:99], a[40:43], v[64:67]
    v_exp_f32 v70, v70
    v_mfma_f32_16x16x32_bf16 v[64:67], v[100:103], a[44:47], v[64:67]
    ds_write_addtid_b32 v217 offset:20512
    v_perm_b32 v218, v70, v222, s49
    v_mfma_f32_16x16x32_bf16 v[48:51], a[160:163], v[168:171], v[48:51]
    s_waitcnt lgkmcnt(5)
    v_exp_f32 v71, v71
    v_mfma_f32_16x16x32_bf16 v[48:51], a[168:171], v[172:175], v[48:51]
    ds_write_addtid_b32 v218 offset:26752
    v_perm_b32 v219, v71, v223, s49
    v_mfma_f32_16x16x32_bf16 v[48:51], a[176:179], v[176:179], v[48:51]
    s_waitcnt lgkmcnt(4)
    v_exp_f32 v64, v64
    v_mfma_f32_16x16x32_bf16 v[48:51], a[184:187], v[180:183], v[48:51]
    ds_write_addtid_b32 v219 offset:32928
    ds_read_b128 v[152:155], v0 offset:5120
    v_mfma_f32_16x16x32_bf16 v[68:71], v[88:91], a[48:51], v[252:255]
    v_exp_f32 v65, v65
    v_mfma_f32_16x16x32_bf16 v[68:71], v[92:95], a[52:55], v[68:71]
    ds_read_b128 v[188:191], v3 offset:2304
    v_cvt_pk_bf16_f32 v30, v60, v61
    v_mfma_f32_16x16x32_bf16 v[68:71], v[96:99], a[56:59], v[68:71]
    v_exp_f32 v66, v66
    v_mfma_f32_16x16x32_bf16 v[68:71], v[100:103], a[60:63], v[68:71]
    ds_read_b128 v[192:195], v3 offset:2560
    v_cvt_pk_bf16_f32 v31, v62, v63
    v_mfma_f32_16x16x32_bf16 v[52:55], a[164:167], v[168:171], v[52:55]
    s_add_u32 m0, s23, 6144
    v_exp_f32 v67, v67
    v_mfma_f32_16x16x32_bf16 v[52:55], a[172:175], v[172:175], v[52:55]
    buffer_store_dwordx4 v[28:31], v11, s[8:11], s22 offen nt
    buffer_load_dwordx4 v10, s[4:7], s22 offen nt lds
    v_add_f32 v24, v24, v25
L_pad8:
    s_cbranch_execz L_hret
    v_add_f32 v26, v26, v27
    v_add_f32 v24, v24, v26
    v_mfma_f32_16x16x32_bf16 v[52:55], a[180:183], v[176:179], v[52:55]
    v_exp_f32 v68, v68
    v_mfma_f32_16x16x32_bf16 v[52:55], a[188:191], v[180:183], v[52:55]
    ds_read_b128 v[196:199], v3 offset:2816
    v_perm_b32 v216, v68, v64, s49
    ds_read_b128 v[72:75], v5 offset:0
    v_mfma_f32_16x16x32_bf16 v[220:223], v[88:91], a[64:67], v[252:255]
    ds_write_addtid_b32 v216 offset:13568
    v_exp_f32 v69, v69
    v_mfma_f32_16x16x32_bf16 v[220:223], v[92:95], a[68:71], v[220:223]
    ds_read_b128 v[224:227], v4 offset:2048
    v_perm_b32 v217, v69, v65, s49
    v_mfma_f32_16x16x32_bf16 v[220:223], v[96:99], a[72:75], v[220:223]
    s_waitcnt lgkmcnt(10)
    v_exp_f32 v70, v70
    v_mfma_f32_16x16x32_bf16 v[220:223], v[100:103], a[76:79], v[220:223]
    ds_write_addtid_b32 v217 offset:19744
    v_perm_b32 v218, v70, v66, s49
    v_mfma_f32_16x16x32_bf16 v[48:51], a[192:195], v[184:187], v[48:51]
    s_waitcnt lgkmcnt(5)
    v_exp_f32 v71, v71
    v_mfma_f32_16x16x32_bf16 v[48:51], a[200:203], v[188:191], v[48:51]
    ds_write_addtid_b32 v218 offset:25984
    v_perm_b32 v219, v71, v67, s49
    v_mfma_f32_16x16x32_bf16 v[48:51], a[208:211], v[192:195], v[48:51]
    s_waitcnt lgkmcnt(5)
    v_exp_f32 v220, v220
    v_mfma_f32_16x16x32_bf16 v[48:51], a[216:219], v[196:199], v[48:51]
    ds_write_addtid_b32 v219 offset:32160
    ds_read_b128 v[156:159], v0 offset:5376
    v_mfma_f32_16x16x32_bf16 v[68:71], v[88:91], a[80:83], v[252:255]
    s_add_u32 s22, s22, 4096
    v_exp_f32 v221, v221
    v_mfma_f32_16x16x32_bf16 v[68:71], v[92:95], a[84:87], v[68:71]
    v_rcp_f32 v20, v24
    v_mfma_f32_16x16x32_bf16 v[68:71], v[96:99], a[88:91], v[68:71]
    v_exp_f32 v222, v222
    v_mfma_f32_16x16x32_bf16 v[68:71], v[100:103], a[92:95], v[68:71]
    ds_read_b128 v[228:231], v4 offset:2304
    v_bitop3_b32 v17, v17, v20, s29 bitop3:0xe8
    v_mfma_f32_16x16x32_bf16 v[52:55], a[196:199], v[184:187], v[52:55]
    v_exp_f32 v223, v223
    v_mfma_f32_16x16x32_bf16 v[52:55], a[204:207], v[188:191], v[52:55]
    ds_read_b128 v[232:235], v4 offset:2560
    v_mov_b32 v21, v20
    v_mfma_f32_16x16x32_bf16 v[52:55], a[212:215], v[192:195], v[52:55]
    s_waitcnt lgkmcnt(2)
    v_exp_f32 v68, v68
    v_mfma_f32_16x16x32_bf16 v[52:55], a[220:223], v[196:199], v[52:55]
    ds_read_b128 v[236:239], v4 offset:2816
    v_perm_b32 v216, v68, v220, s49
    v_smfmac_f32_16x16x64_bf16 v[44:47], v[36:39], v[152:159], v1
    ds_write_addtid_b32 v216 offset:13824
    ds_read_b128 v[76:79], v6 offset:0
    v_mfma_f32_16x16x32_bf16 v[64:67], v[88:91], a[96:99], v[252:255]
    v_exp_f32 v69, v69
    v_mfma_f32_16x16x32_bf16 v[64:67], v[92:95], a[100:103], v[64:67]
    ds_read_b128 v[80:83], v7 offset:0
    v_perm_b32 v217, v69, v221, s49
    v_mfma_f32_16x16x32_bf16 v[64:67], v[96:99], a[104:107], v[64:67]
    v_exp_f32 v70, v70
    v_mfma_f32_16x16x32_bf16 v[64:67], v[100:103], a[108:111], v[64:67]
    ds_write_addtid_b32 v217 offset:20000
    v_perm_b32 v218, v70, v222, s49
    v_mfma_f32_16x16x32_bf16 v[48:51], a[224:227], v[224:227], v[48:51]
    s_waitcnt lgkmcnt(5)
    v_exp_f32 v71, v71
    v_mfma_f32_16x16x32_bf16 v[48:51], a[232:235], v[228:231], v[48:51]
    ds_write_addtid_b32 v218 offset:26240
    v_perm_b32 v219, v71, v223, s49
    v_mfma_f32_16x16x32_bf16 v[48:51], a[240:243], v[232:235], v[48:51]
    s_waitcnt lgkmcnt(5)
    v_exp_f32 v64, v64
    v_mfma_f32_16x16x32_bf16 v[48:51], a[248:251], v[236:239], v[48:51]
    ds_write_addtid_b32 v219 offset:32416
    ds_read_b128 v[160:163], v0 offset:5632
    v_mfma_f32_16x16x32_bf16 v[68:71], v[88:91], a[112:115], v[252:255]
    v_exp_f32 v65, v65
    v_mfma_f32_16x16x32_bf16 v[68:71], v[92:95], a[116:119], v[68:71]
    v_permlane32_swap_b32 v20, v21
    v_mfma_f32_16x16x32_bf16 v[68:71], v[96:99], a[120:123], v[68:71]
    v_exp_f32 v66, v66
    v_mfma_f32_16x16x32_bf16 v[68:71], v[100:103], a[124:127], v[68:71]
    ds_read_b128 v[84:87], v8 offset:0
    v_mul_f32 v48, v20, v48
    v_mfma_f32_16x16x32_bf16 v[52:55], a[228:231], v[224:227], v[52:55]
    v_exp_f32 v67, v67
    v_mfma_f32_16x16x32_bf16 v[52:55], a[236:239], v[228:231], v[52:55]
    v_mul_f32 v49, v20, v49
    v_mul_f32 v50, v20, v50
    v_mfma_f32_16x16x32_bf16 v[52:55], a[244:247], v[232:235], v[52:55]
    v_exp_f32 v68, v68
    v_mfma_f32_16x16x32_bf16 v[52:55], a[252:255], v[236:239], v[52:55]
    s_waitcnt lgkmcnt(5)
    v_mul_f32 v51, v20, v51
    v_perm_b32 v216, v68, v64, s49
    v_cvt_pk_bf16_f32 v28, v48, v49
    v_mfma_f32_16x16x32_bf16 v[220:223], v[72:75], a[0:3], v[252:255]
    ds_write_addtid_b32 v216 offset:14080
    v_exp_f32 v69, v69
    v_mfma_f32_16x16x32_bf16 v[220:223], v[76:79], a[4:7], v[220:223]
    ds_read_b128 v[168:171], v2 offset:3072
    v_perm_b32 v217, v69, v65, s49
    v_mfma_f32_16x16x32_bf16 v[220:223], v[80:83], a[8:11], v[220:223]
    s_waitcnt lgkmcnt(2)
    v_exp_f32 v70, v70
    v_mfma_f32_16x16x32_bf16 v[220:223], v[84:87], a[12:15], v[220:223]
    ds_write_addtid_b32 v217 offset:20256
    v_perm_b32 v218, v70, v66, s49
    v_mfma_f32_16x16x32_bf16 v[56:59], a[128:131], v[120:123], 0
    v_exp_f32 v71, v71
    v_mfma_f32_16x16x32_bf16 v[56:59], a[136:139], v[124:127], v[56:59]
    ds_write_addtid_b32 v218 offset:26496
    v_perm_b32 v219, v71, v67, s49
    v_mfma_f32_16x16x32_bf16 v[56:59], a[144:147], v[128:131], v[56:59]
    v_exp_f32 v220, v220
    v_mfma_f32_16x16x32_bf16 v[56:59], a[152:155], v[132:135], v[56:59]
    ds_write_addtid_b32 v219 offset:32672
    ds_read_b128 v[164:167], v0 offset:5888
    v_mfma_f32_16x16x32_bf16 v[68:71], v[72:75], a[16:19], v[252:255]
    v_exp_f32 v221, v221
    v_mfma_f32_16x16x32_bf16 v[68:71], v[76:79], a[20:23], v[68:71]
    ds_read_b128 v[172:175], v2 offset:3328
    v_mul_f32 v52, v20, v52
    v_mfma_f32_16x16x32_bf16 v[68:71], v[80:83], a[24:27], v[68:71]
    v_exp_f32 v222, v222
    v_mfma_f32_16x16x32_bf16 v[68:71], v[84:87], a[28:31], v[68:71]
    ds_read_b128 v[176:179], v2 offset:3584
    v_mul_f32 v53, v20, v53
    v_mfma_f32_16x16x32_bf16 v[60:63], a[132:135], v[120:123], 0
    v_exp_f32 v223, v223
    v_mfma_f32_16x16x32_bf16 v[60:63], a[140:143], v[124:127], v[60:63]
    ds_read_b128 v[184:187], v3 offset:3072
    v_mul_f32 v54, v20, v54
    v_mfma_f32_16x16x32_bf16 v[60:63], a[148:151], v[128:131], v[60:63]
    s_waitcnt lgkmcnt(3)
    v_exp_f32 v68, v68
    v_mfma_f32_16x16x32_bf16 v[60:63], a[156:159], v[132:135], v[60:63]
    ds_read_b128 v[180:183], v2 offset:3840
    v_perm_b32 v216, v68, v220, s49
    v_smfmac_f32_16x16x64_bf16 v[44:47], v[36:39], v[160:167], v1
    ds_write_addtid_b32 v216 offset:8192
    v_mul_f32 v55, v20, v55
    v_mfma_f32_16x16x32_bf16 v[64:67], v[72:75], a[32:35], v[252:255]
    v_exp_f32 v69, v69
    v_mfma_f32_16x16x32_bf16 v[64:67], v[76:79], a[36:39], v[64:67]
    ds_read_b128 v[188:191], v3 offset:3328
    v_perm_b32 v217, v69, v221, s49
    v_mfma_f32_16x16x32_bf16 v[64:67], v[80:83], a[40:43], v[64:67]
    v_exp_f32 v70, v70
    v_mfma_f32_16x16x32_bf16 v[64:67], v[84:87], a[44:47], v[64:67]
    ds_write_addtid_b32 v217 offset:14368
    v_perm_b32 v218, v70, v222, s49
    v_mfma_f32_16x16x32_bf16 v[56:59], a[160:163], v[168:171], v[56:59]
    s_waitcnt lgkmcnt(5)
    v_exp_f32 v71, v71
    v_mfma_f32_16x16x32_bf16 v[56:59], a[168:171], v[172:175], v[56:59]
    ds_write_addtid_b32 v218 offset:20608
    v_perm_b32 v219, v71, v223, s49
    v_add_f32 v44, v44, v45
    v_mfma_f32_16x16x32_bf16 v[56:59], a[176:179], v[176:179], v[56:59]
    s_waitcnt lgkmcnt(4)
    v_exp_f32 v64, v64
    v_mfma_f32_16x16x32_bf16 v[56:59], a[184:187], v[180:183], v[56:59]
    ds_write_addtid_b32 v219 offset:26784
    ds_read_b128 v[104:107], v0 offset:0
    v_mfma_f32_16x16x32_bf16 v[68:71], v[72:75], a[48:51], v[252:255]
    v_exp_f32 v65, v65
    v_mfma_f32_16x16x32_bf16 v[68:71], v[76:79], a[52:55], v[68:71]
    ds_write_b32 v12, v44 offset:1024
    v_mfma_f32_16x16x32_bf16 v[68:71], v[80:83], a[56:59], v[68:71]
    s_waitcnt vmcnt(6)
    v_exp_f32 v66, v66
    v_mfma_f32_16x16x32_bf16 v[68:71], v[84:87], a[60:63], v[68:71]
    ds_add_u32 v14, v16
    v_mfma_f32_16x16x32_bf16 v[60:63], a[164:167], v[168:171], v[60:63]
    s_add_u32 s24, s24, 1
    v_exp_f32 v67, v67
    v_mfma_f32_16x16x32_bf16 v[60:63], a[172:175], v[172:175], v[60:63]
    ds_read_b128 v[192:195], v3 offset:3584
    v_cvt_pk_bf16_f32 v29, v50, v51
    v_mfma_f32_16x16x32_bf16 v[60:63], a[180:183], v[176:179], v[60:63]
    v_exp_f32 v68, v68
    v_mfma_f32_16x16x32_bf16 v[60:63], a[188:191], v[180:183], v[60:63]
    ds_read_b128 v[196:199], v3 offset:3840
    v_perm_b32 v216, v68, v64, s49
    v_cvt_pk_bf16_f32 v30, v52, v53
    v_mfma_f32_16x16x32_bf16 v[220:223], v[72:75], a[64:67], v[252:255]
    ds_write_addtid_b32 v216 offset:8448
    v_exp_f32 v69, v69
    v_mfma_f32_16x16x32_bf16 v[220:223], v[76:79], a[68:71], v[220:223]
    ds_read_b128 v[224:227], v4 offset:3072
    v_perm_b32 v217, v69, v65, s49
    v_mfma_f32_16x16x32_bf16 v[220:223], v[80:83], a[72:75], v[220:223]
    v_exp_f32 v70, v70
    v_mfma_f32_16x16x32_bf16 v[220:223], v[84:87], a[76:79], v[220:223]
    ds_write_addtid_b32 v217 offset:14624
    v_perm_b32 v218, v70, v66, s49
    v_mfma_f32_16x16x32_bf16 v[56:59], a[192:195], v[184:187], v[56:59]
    s_waitcnt lgkmcnt(4)
    v_exp_f32 v71, v71
    v_mfma_f32_16x16x32_bf16 v[56:59], a[200:203], v[188:191], v[56:59]
    ds_write_addtid_b32 v218 offset:20864
    v_perm_b32 v219, v71, v67, s49
    v_mfma_f32_16x16x32_bf16 v[56:59], a[208:211], v[192:195], v[56:59]
    s_waitcnt lgkmcnt(4)
    v_exp_f32 v220, v220
    v_mfma_f32_16x16x32_bf16 v[56:59], a[216:219], v[196:199], v[56:59]
    ds_write_addtid_b32 v219 offset:27040
    ds_read_b128 v[108:111], v0 offset:256
    v_mfma_f32_16x16x32_bf16 v[68:71], v[72:75], a[80:83], v[252:255]
    v_exp_f32 v221, v221
    v_mfma_f32_16x16x32_bf16 v[68:71], v[76:79], a[84:87], v[68:71]
    ds_read_b128 v[228:231], v4 offset:3328
    v_cvt_pk_bf16_f32 v31, v54, v55
    v_mfma_f32_16x16x32_bf16 v[68:71], v[80:83], a[88:91], v[68:71]
    v_exp_f32 v222, v222
    v_mfma_f32_16x16x32_bf16 v[68:71], v[84:87], a[92:95], v[68:71]
    ds_read_b128 v[232:235], v4 offset:3584
    ds_read_b128 v[88:91], v5 offset:1024
    v_mfma_f32_16x16x32_bf16 v[60:63], a[196:199], v[184:187], v[60:63]
    v_exp_f32 v223, v223
    v_mfma_f32_16x16x32_bf16 v[60:63], a[204:207], v[188:191], v[60:63]
    ds_read_b128 v[92:95], v6 offset:1024
    ds_read_b128 v[96:99], v7 offset:1024
    v_mfma_f32_16x16x32_bf16 v[60:63], a[212:215], v[192:195], v[60:63]
    s_waitcnt lgkmcnt(5)
    v_exp_f32 v68, v68
    v_mfma_f32_16x16x32_bf16 v[60:63], a[220:223], v[196:199], v[60:63]
    ds_read_b128 v[236:239], v4 offset:3840
    v_perm_b32 v216, v68, v220, s49
    v_smfmac_f32_16x16x64_bf16 v[40:43], v[32:35], v[104:111], v1
    ds_write_addtid_b32 v216 offset:8704
    ds_read_b128 v[100:103], v8 offset:1024
    v_mfma_f32_16x16x32_bf16 v[64:67], v[72:75], a[96:99], v[252:255]
    v_exp_f32 v69, v69
    v_mfma_f32_16x16x32_bf16 v[64:67], v[76:79], a[100:103], v[64:67]
    ds_read_b32 v19, v15
    v_perm_b32 v217, v69, v221, s49
    v_mfma_f32_16x16x32_bf16 v[64:67], v[80:83], a[104:107], v[64:67]
    v_exp_f32 v70, v70
    v_mfma_f32_16x16x32_bf16 v[64:67], v[84:87], a[108:111], v[64:67]
    ds_write_addtid_b32 v217 offset:14880
    v_perm_b32 v218, v70, v222, s49
    v_mfma_f32_16x16x32_bf16 v[56:59], a[224:227], v[224:227], v[56:59]
    s_waitcnt lgkmcnt(8)
    v_exp_f32 v71, v71
    v_mfma_f32_16x16x32_bf16 v[56:59], a[232:235], v[228:231], v[56:59]
    ds_write_addtid_b32 v218 offset:21120
    v_perm_b32 v219, v71, v223, s49
    v_mfma_f32_16x16x32_bf16 v[56:59], a[240:243], v[232:235], v[56:59]
    s_waitcnt lgkmcnt(5)
    v_exp_f32 v64, v64
    v_mfma_f32_16x16x32_bf16 v[56:59], a[248:251], v[236:239], v[56:59]
    ds_write_addtid_b32 v219 offset:27296
    ds_read_b128 v[112:115], v0 offset:512
    v_mfma_f32_16x16x32_bf16 v[68:71], v[72:75], a[112:115], v[252:255]
    v_exp_f32 v65, v65
    v_mfma_f32_16x16x32_bf16 v[68:71], v[76:79], a[116:119], v[68:71]
    v_mul_f32 v56, v21, v56
    v_mul_f32 v57, v21, v57
    v_mfma_f32_16x16x32_bf16 v[68:71], v[80:83], a[120:123], v[68:71]
    v_exp_f32 v66, v66
    v_mfma_f32_16x16x32_bf16 v[68:71], v[84:87], a[124:127], v[68:71]
    s_waitcnt lgkmcnt(4)
    v_cmp_gt_u32 vcc, s24, v19
    v_mul_f32 v58, v21, v58
    v_mfma_f32_16x16x32_bf16 v[60:63], a[228:231], v[224:227], v[60:63]
    s_add_u32 m0, s23, 7168
    v_exp_f32 v67, v67
    v_mfma_f32_16x16x32_bf16 v[60:63], a[236:239], v[228:231], v[60:63]
    buffer_store_dwordx4 v[28:31], v11, s[8:11], s22 offen nt
    buffer_load_dwordx4 v10, s[4:7], s22 offen nt lds
    v_mul_f32 v59, v21, v59
    v_mov_b64 v[44:45], 0
    s_cbranch_vccnz L_retry9
L_back9:
    v_mfma_f32_16x16x32_bf16 v[60:63], a[244:247], v[232:235], v[60:63]
    v_exp_f32 v68, v68
    v_mfma_f32_16x16x32_bf16 v[60:63], a[252:255], v[236:239], v[60:63]
    v_cvt_pk_bf16_f32 v28, v56, v57
    v_perm_b32 v216, v68, v64, s49
    v_cvt_pk_bf16_f32 v29, v58, v59
    v_mfma_f32_16x16x32_bf16 v[220:223], v[88:91], a[0:3], v[252:255]
    ds_write_addtid_b32 v216 offset:7936
    v_exp_f32 v69, v69
    v_mfma_f32_16x16x32_bf16 v[220:223], v[92:95], a[4:7], v[220:223]
    ds_read_b128 v[168:171], v2 offset:4096
    v_perm_b32 v217, v69, v65, s49
    v_mfma_f32_16x16x32_bf16 v[220:223], v[96:99], a[8:11], v[220:223]
    v_exp_f32 v70, v70
    v_mfma_f32_16x16x32_bf16 v[220:223], v[100:103], a[12:15], v[220:223]
    ds_write_addtid_b32 v217 offset:14112
    v_perm_b32 v218, v70, v66, s49
    v_mfma_f32_16x16x32_bf16 v[48:51], a[128:131], v[136:139], 0
    v_exp_f32 v71, v71
    v_mfma_f32_16x16x32_bf16 v[48:51], a[136:139], v[140:143], v[48:51]
    ds_write_addtid_b32 v218 offset:20352
    v_perm_b32 v219, v71, v67, s49
    v_mfma_f32_16x16x32_bf16 v[48:51], a[144:147], v[144:147], v[48:51]
    v_exp_f32 v220, v220
    v_mfma_f32_16x16x32_bf16 v[48:51], a[152:155], v[148:151], v[48:51]
    ds_write_addtid_b32 v219 offset:26528
    ds_read_b128 v[116:119], v0 offset:768
    v_mfma_f32_16x16x32_bf16 v[68:71], v[88:91], a[16:19], v[252:255]
    s_add_u32 s22, s22, 4096
    v_exp_f32 v221, v221
    v_mfma_f32_16x16x32_bf16 v[68:71], v[92:95], a[20:23], v[68:71]
    ds_read_b128 v[172:175], v2 offset:4352
    v_mul_f32 v60, v21, v60
    v_mfma_f32_16x16x32_bf16 v[68:71], v[96:99], a[24:27], v[68:71]
    v_exp_f32 v222, v222
    v_mfma_f32_16x16x32_bf16 v[68:71], v[100:103], a[28:31], v[68:71]
    ds_read_b128 v[176:179], v2 offset:4608
    v_mul_f32 v61, v21, v61
    v_mfma_f32_16x16x32_bf16 v[52:55], a[132:135], v[136:139], 0
    v_exp_f32 v223, v223
    v_mfma_f32_16x16x32_bf16 v[52:55], a[140:143], v[140:143], v[52:55]
    ds_read_b128 v[24:27], v18 offset:1024
    v_mul_f32 v62, v21, v62
    v_mfma_f32_16x16x32_bf16 v[52:55], a[148:151], v[144:147], v[52:55]
    s_waitcnt lgkmcnt(3)
    v_exp_f32 v68, v68
    v_mfma_f32_16x16x32_bf16 v[52:55], a[156:159], v[148:151], v[52:55]
    ds_read_b128 v[180:183], v2 offset:4864
    v_perm_b32 v216, v68, v220, s49
    v_smfmac_f32_16x16x64_bf16 v[40:43], v[32:35], v[112:119], v1
    ds_write_addtid_b32 v216 offset:8192
    v_mul_f32 v63, v21, v63
    v_mfma_f32_16x16x32_bf16 v[64:67], v[88:91], a[32:35], v[252:255]
    v_exp_f32 v69, v69
    v_mfma_f32_16x16x32_bf16 v[64:67], v[92:95], a[36:39], v[64:67]
    ds_read_b128 v[184:187], v3 offset:4096
    v_perm_b32 v217, v69, v221, s49
    v_mfma_f32_16x16x32_bf16 v[64:67], v[96:99], a[40:43], v[64:67]
    v_exp_f32 v70, v70
    v_mfma_f32_16x16x32_bf16 v[64:67], v[100:103], a[44:47], v[64:67]
    ds_write_addtid_b32 v217 offset:14368
    v_perm_b32 v218, v70, v222, s49
    v_mfma_f32_16x16x32_bf16 v[48:51], a[160:163], v[168:171], v[48:51]
    s_waitcnt lgkmcnt(5)
    v_exp_f32 v71, v71
    v_mfma_f32_16x16x32_bf16 v[48:51], a[168:171], v[172:175], v[48:51]
    ds_write_addtid_b32 v218 offset:20608
    v_perm_b32 v219, v71, v223, s49
    v_mfma_f32_16x16x32_bf16 v[48:51], a[176:179], v[176:179], v[48:51]
    s_waitcnt lgkmcnt(4)
    v_exp_f32 v64, v64
    v_mfma_f32_16x16x32_bf16 v[48:51], a[184:187], v[180:183], v[48:51]
    ds_write_addtid_b32 v219 offset:26784
    ds_read_b128 v[120:123], v0 offset:1024
    v_mfma_f32_16x16x32_bf16 v[68:71], v[88:91], a[48:51], v[252:255]
    v_exp_f32 v65, v65
    v_mfma_f32_16x16x32_bf16 v[68:71], v[92:95], a[52:55], v[68:71]
    ds_read_b128 v[188:191], v3 offset:4352
    v_cvt_pk_bf16_f32 v30, v60, v61
    v_mfma_f32_16x16x32_bf16 v[68:71], v[96:99], a[56:59], v[68:71]
    v_exp_f32 v66, v66
    v_mfma_f32_16x16x32_bf16 v[68:71], v[100:103], a[60:63], v[68:71]
    ds_read_b128 v[192:195], v3 offset:4608
    v_cvt_pk_bf16_f32 v31, v62, v63
    v_mfma_f32_16x16x32_bf16 v[52:55], a[164:167], v[168:171], v[52:55]
    s_add_u32 m0, s23, 8192
    v_exp_f32 v67, v67
    v_mfma_f32_16x16x32_bf16 v[52:55], a[172:175], v[172:175], v[52:55]
    buffer_store_dwordx4 v[28:31], v11, s[8:11], s22 offen nt
    buffer_load_dwordx4 v10, s[4:7], s22 offen nt lds
    v_add_f32 v24, v24, v25
    v_add_f32 v26, v26, v27
    v_add_f32 v24, v24, v26
    v_mfma_f32_16x16x32_bf16 v[52:55], a[180:183], v[176:179], v[52:55]
    v_exp_f32 v68, v68
    v_mfma_f32_16x16x32_bf16 v[52:55], a[188:191], v[180:183], v[52:55]
    ds_read_b128 v[196:199], v3 offset:4864
    v_perm_b32 v216, v68, v64, s49
    ds_read_b128 v[72:75], v5 offset:2048
    v_mfma_f32_16x16x32_bf16 v[220:223], v[88:91], a[64:67], v[252:255]
    ds_write_addtid_b32 v216 offset:7424
    v_exp_f32 v69, v69
    v_mfma_f32_16x16x32_bf16 v[220:223], v[92:95], a[68:71], v[220:223]
    ds_read_b128 v[224:227], v4 offset:4096
    v_perm_b32 v217, v69, v65, s49
    v_mfma_f32_16x16x32_bf16 v[220:223], v[96:99], a[72:75], v[220:223]
    s_waitcnt lgkmcnt(10)
    v_exp_f32 v70, v70
    v_mfma_f32_16x16x32_bf16 v[220:223], v[100:103], a[76:79], v[220:223]
    ds_write_addtid_b32 v217 offset:13600
    v_perm_b32 v218, v70, v66, s49
    v_mfma_f32_16x16x32_bf16 v[48:51], a[192:195], v[184:187], v[48:51]
    s_waitcnt lgkmcnt(5)
    v_exp_f32 v71, v71
    v_mfma_f32_16x16x32_bf16 v[48:51], a[200:203], v[188:191], v[48:51]
    ds_write_addtid_b32 v218 offset:19840
    v_perm_b32 v219, v71, v67, s49
    v_mfma_f32_16x16x32_bf16 v[48:51], a[208:211], v[192:195], v[48:51]
    s_waitcnt lgkmcnt(5)
    v_exp_f32 v220, v220
    v_mfma_f32_16x16x32_bf16 v[48:51], a[216:219], v[196:199], v[48:51]
    ds_write_addtid_b32 v219 offset:26016
    ds_read_b128 v[124:127], v0 offset:1280
    v_mfma_f32_16x16x32_bf16 v[68:71], v[88:91], a[80:83], v[252:255]
    s_add_u32 s22, s22, 4096
    v_exp_f32 v221, v221
    v_mfma_f32_16x16x32_bf16 v[68:71], v[92:95], a[84:87], v[68:71]
    v_rcp_f32 v22, v24
    v_mfma_f32_16x16x32_bf16 v[68:71], v[96:99], a[88:91], v[68:71]
    v_exp_f32 v222, v222
    v_mfma_f32_16x16x32_bf16 v[68:71], v[100:103], a[92:95], v[68:71]
    ds_read_b128 v[228:231], v4 offset:4352
    v_bitop3_b32 v17, v17, v22, s29 bitop3:0xe8
    v_mfma_f32_16x16x32_bf16 v[52:55], a[196:199], v[184:187], v[52:55]
    v_exp_f32 v223, v223
    v_mfma_f32_16x16x32_bf16 v[52:55], a[204:207], v[188:191], v[52:55]
    ds_read_b128 v[232:235], v4 offset:4608
    v_mov_b32 v23, v22
    v_mfma_f32_16x16x32_bf16 v[52:55], a[212:215], v[192:195], v[52:55]
    s_waitcnt lgkmcnt(2)
    v_exp_f32 v68, v68
    v_mfma_f32_16x16x32_bf16 v[52:55], a[220:223], v[196:199], v[52:55]
    ds_read_b128 v[236:239], v4 offset:4864
    v_perm_b32 v216, v68, v220, s49
    v_smfmac_f32_16x16x64_bf16 v[40:43], v[36:39], v[120:127], v1
    ds_write_addtid_b32 v216 offset:7680
    ds_read_b128 v[76:79], v6 offset:2048
    v_mfma_f32_16x16x32_bf16 v[64:67], v[88:91], a[96:99], v[252:255]
    v_exp_f32 v69, v69
    v_mfma_f32_16x16x32_bf16 v[64:67], v[92:95], a[100:103], v[64:67]
    ds_read_b128 v[80:83], v7 offset:2048
    v_perm_b32 v217, v69, v221, s49
    v_mfma_f32_16x16x32_bf16 v[64:67], v[96:99], a[104:107], v[64:67]
    v_exp_f32 v70, v70
    v_mfma_f32_16x16x32_bf16 v[64:67], v[100:103], a[108:111], v[64:67]
    ds_write_addtid_b32 v217 offset:13856
    v_perm_b32 v218, v70, v222, s49
    v_mfma_f32_16x16x32_bf16 v[48:51], a[224:227], v[224:227], v[48:51]
    s_waitcnt lgkmcnt(5)
    v_exp_f32 v71, v71
    v_mfma_f32_16x16x32_bf16 v[48:51], a[232:235], v[228:231], v[48:51]
    ds_write_addtid_b32 v218 offset:20096
    v_perm_b32 v219, v71, v223, s49
    v_mfma_f32_16x16x32_bf16 v[48:51], a[240:243], v[232:235], v[48:51]
    s_waitcnt lgkmcnt(5)
    v_exp_f32 v64, v64
    v_mfma_f32_16x16x32_bf16 v[48:51], a[248:251], v[236:239], v[48:51]
    ds_write_addtid_b32 v219 offset:26272
    ds_read_b128 v[128:131], v0 offset:1536
    v_mfma_f32_16x16x32_bf16 v[68:71], v[88:91], a[112:115], v[252:255]
    v_exp_f32 v65, v65
    v_mfma_f32_16x16x32_bf16 v[68:71], v[92:95], a[116:119], v[68:71]
    v_permlane32_swap_b32 v22, v23
    v_mfma_f32_16x16x32_bf16 v[68:71], v[96:99], a[120:123], v[68:71]
    v_exp_f32 v66, v66
    v_mfma_f32_16x16x32_bf16 v[68:71], v[100:103], a[124:127], v[68:71]
    ds_read_b128 v[84:87], v8 offset:2048
    v_mul_f32 v48, v22, v48
    v_mfma_f32_16x16x32_bf16 v[52:55], a[228:231], v[224:227], v[52:55]
    v_exp_f32 v67, v67
    v_mfma_f32_16x16x32_bf16 v[52:55], a[236:239], v[228:231], v[52:55]
    v_mul_f32 v49, v22, v49
    v_mul_f32 v50, v22, v50
    v_mfma_f32_16x16x32_bf16 v[52:55], a[244:247], v[232:235], v[52:55]
    v_exp_f32 v68, v68
    v_mfma_f32_16x16x32_bf16 v[52:55], a[252:255], v[236:239], v[52:55]
    s_waitcnt lgkmcnt(5)
    v_mul_f32 v51, v22, v51
    v_perm_b32 v216, v68, v64, s49
    v_cvt_pk_bf16_f32 v28, v48, v49
    v_mfma_f32_16x16x32_bf16 v[220:223], v[72:75], a[0:3], v[252:255]
    ds_write_addtid_b32 v216 offset:7936
    v_exp_f32 v69, v69
    v_mfma_f32_16x16x32_bf16 v[220:223], v[76:79], a[4:7], v[220:223]
    ds_read_b128 v[168:171], v2 offset:5120
    v_perm_b32 v217, v69, v65, s49
    v_mfma_f32_16x16x32_bf16 v[220:223], v[80:83], a[8:11], v[220:223]
    s_waitcnt lgkmcnt(2)
    v_exp_f32 v70, v70
    v_mfma_f32_16x16x32_bf16 v[220:223], v[84:87], a[12:15], v[220:223]
    ds_write_addtid_b32 v217 offset:14112
    v_perm_b32 v218, v70, v66, s49
    v_mfma_f32_16x16x32_bf16 v[56:59], a[128:131], v[152:155], 0
    v_exp_f32 v71, v71
    v_mfma_f32_16x16x32_bf16 v[56:59], a[136:139], v[156:159], v[56:59]
    ds_write_addtid_b32 v218 offset:20352
    v_perm_b32 v219, v71, v67, s49
    v_mfma_f32_16x16x32_bf16 v[56:59], a[144:147], v[160:163], v[56:59]
    v_exp_f32 v220, v220
    v_mfma_f32_16x16x32_bf16 v[56:59], a[152:155], v[164:167], v[56:59]
    ds_write_addtid_b32 v219 offset:26528
    ds_read_b128 v[132:135], v0 offset:1792
    v_mfma_f32_16x16x32_bf16 v[68:71], v[72:75], a[16:19], v[252:255]
    v_exp_f32 v221, v221
    v_mfma_f32_16x16x32_bf16 v[68:71], v[76:79], a[20:23], v[68:71]
    ds_read_b128 v[172:175], v2 offset:5376
    v_mul_f32 v52, v22, v52
    v_mfma_f32_16x16x32_bf16 v[68:71], v[80:83], a[24:27], v[68:71]
    v_exp_f32 v222, v222
    v_mfma_f32_16x16x32_bf16 v[68:71], v[84:87], a[28:31], v[68:71]
    ds_read_b128 v[176:179], v2 offset:5632
    v_mul_f32 v53, v22, v53
    v_mfma_f32_16x16x32_bf16 v[60:63], a[132:135], v[152:155], 0
    v_exp_f32 v223, v223
    v_mfma_f32_16x16x32_bf16 v[60:63], a[140:143], v[156:159], v[60:63]
    ds_read_b128 v[184:187], v3 offset:5120
    v_mul_f32 v54, v22, v54
    v_mfma_f32_16x16x32_bf16 v[60:63], a[148:151], v[160:163], v[60:63]
    s_waitcnt lgkmcnt(3)
    v_exp_f32 v68, v68
    v_mfma_f32_16x16x32_bf16 v[60:63], a[156:159], v[164:167], v[60:63]
    ds_read_b128 v[180:183], v2 offset:5888
    v_perm_b32 v216, v68, v220, s49
    v_smfmac_f32_16x16x64_bf16 v[40:43], v[36:39], v[128:135], v1
    ds_write_addtid_b32 v216 offset:8192
    v_mul_f32 v55, v22, v55
    v_mfma_f32_16x16x32_bf16 v[64:67], v[72:75], a[32:35], v[252:255]
    v_exp_f32 v69, v69
    v_mfma_f32_16x16x32_bf16 v[64:67], v[76:79], a[36:39], v[64:67]
    ds_read_b128 v[188:191], v3 offset:5376
    v_perm_b32 v217, v69, v221, s49
    v_mfma_f32_16x16x32_bf16 v[64:67], v[80:83], a[40:43], v[64:67]
    v_exp_f32 v70, v70
    v_mfma_f32_16x16x32_bf16 v[64:67], v[84:87], a[44:47], v[64:67]
    ds_write_addtid_b32 v217 offset:14368
    v_perm_b32 v218, v70, v222, s49
    v_mfma_f32_16x16x32_bf16 v[56:59], a[160:163], v[168:171], v[56:59]
    s_waitcnt lgkmcnt(5)
    v_exp_f32 v71, v71
    v_mfma_f32_16x16x32_bf16 v[56:59], a[168:171], v[172:175], v[56:59]
    ds_write_addtid_b32 v218 offset:20608
    v_perm_b32 v219, v71, v223, s49
    v_add_f32 v40, v40, v41
    v_mfma_f32_16x16x32_bf16 v[56:59], a[176:179], v[176:179], v[56:59]
    s_waitcnt lgkmcnt(4)
    v_exp_f32 v64, v64
    v_mfma_f32_16x16x32_bf16 v[56:59], a[184:187], v[180:183], v[56:59]
    ds_write_addtid_b32 v219 offset:26784
    ds_read_b128 v[136:139], v0 offset:2048
    v_mfma_f32_16x16x32_bf16 v[68:71], v[72:75], a[48:51], v[252:255]
    v_exp_f32 v65, v65
    v_mfma_f32_16x16x32_bf16 v[68:71], v[76:79], a[52:55], v[68:71]
    ds_write_b32 v12, v40 offset:0
    v_mfma_f32_16x16x32_bf16 v[68:71], v[80:83], a[56:59], v[68:71]
    s_waitcnt vmcnt(6)
    v_exp_f32 v66, v66
    v_mfma_f32_16x16x32_bf16 v[68:71], v[84:87], a[60:63], v[68:71]
    ds_add_u32 v14, v16
    v_mfma_f32_16x16x32_bf16 v[60:63], a[164:167], v[168:171], v[60:63]
    s_add_u32 s24, s24, 1
    v_exp_f32 v67, v67
    v_mfma_f32_16x16x32_bf16 v[60:63], a[172:175], v[172:175], v[60:63]
    ds_read_b128 v[192:195], v3 offset:5632
    v_cvt_pk_bf16_f32 v29, v50, v51
    v_mfma_f32_16x16x32_bf16 v[60:63], a[180:183], v[176:179], v[60:63]
    v_exp_f32 v68, v68
    v_mfma_f32_16x16x32_bf16 v[60:63], a[188:191], v[180:183], v[60:63]
    ds_read_b128 v[196:199], v3 offset:5888
    v_perm_b32 v216, v68, v64, s49
    v_cvt_pk_bf16_f32 v30, v52, v53
    v_mfma_f32_16x16x32_bf16 v[220:223], v[72:75], a[64:67], v[252:255]
    ds_write_addtid_b32 v216 offset:8448
    v_exp_f32 v69, v69
    v_mfma_f32_16x16x32_bf16 v[220:223], v[76:79], a[68:71], v[220:223]
    ds_read_b128 v[224:227], v4 offset:5120
    v_perm_b32 v217, v69, v65, s49
    v_mfma_f32_16x16x32_bf16 v[220:223], v[80:83], a[72:75], v[220:223]
    v_exp_f32 v70, v70
    v_mfma_f32_16x16x32_bf16 v[220:223], v[84:87], a[76:79], v[220:223]
    ds_write_addtid_b32 v217 offset:14624
    v_perm_b32 v218, v70, v66, s49
    v_mfma_f32_16x16x32_bf16 v[56:59], a[192:195], v[184:187], v[56:59]
    s_waitcnt lgkmcnt(4)
    v_exp_f32 v71, v71
    v_mfma_f32_16x16x32_bf16 v[56:59], a[200:203], v[188:191], v[56:59]
    ds_write_addtid_b32 v218 offset:20864
    v_perm_b32 v219, v71, v67, s49
    v_mfma_f32_16x16x32_bf16 v[56:59], a[208:211], v[192:195], v[56:59]
    s_waitcnt lgkmcnt(4)
    v_exp_f32 v220, v220
    v_mfma_f32_16x16x32_bf16 v[56:59], a[216:219], v[196:199], v[56:59]
    ds_write_addtid_b32 v219 offset:27040
    ds_read_b128 v[140:143], v0 offset:2304
    v_mfma_f32_16x16x32_bf16 v[68:71], v[72:75], a[80:83], v[252:255]
    v_exp_f32 v221, v221
    v_mfma_f32_16x16x32_bf16 v[68:71], v[76:79], a[84:87], v[68:71]
    ds_read_b128 v[228:231], v4 offset:5376
    v_cvt_pk_bf16_f32 v31, v54, v55
    v_mfma_f32_16x16x32_bf16 v[68:71], v[80:83], a[88:91], v[68:71]
    v_exp_f32 v222, v222
    v_mfma_f32_16x16x32_bf16 v[68:71], v[84:87], a[92:95], v[68:71]
    ds_read_b128 v[232:235], v4 offset:5632
    ds_read_b128 v[88:91], v5 offset:3072
    v_mfma_f32_16x16x32_bf16 v[60:63], a[196:199], v[184:187], v[60:63]
    v_exp_f32 v223, v223
    v_mfma_f32_16x16x32_bf16 v[60:63], a[204:207], v[188:191], v[60:63]
    ds_read_b128 v[92:95], v6 offset:3072
    ds_read_b128 v[96:99], v7 offset:3072
    v_mfma_f32_16x16x32_bf16 v[60:63], a[212:215], v[192:195], v[60:63]
    s_waitcnt lgkmcnt(5)
    v_exp_f32 v68, v68
    v_mfma_f32_16x16x32_bf16 v[60:63], a[220:223], v[196:199], v[60:63]
    ds_read_b128 v[236:239], v4 offset:5888
    v_perm_b32 v216, v68, v220, s49
    v_smfmac_f32_16x16x64_bf16 v[44:47], v[32:35], v[136:143], v1
L_pad9:
    s_cbranch_execz L_hret
    ds_write_addtid_b32 v216 offset:8704
    ds_read_b128 v[100:103], v8 offset:3072
    v_mfma_f32_16x16x32_bf16 v[64:67], v[72:75], a[96:99], v[252:255]
    v_exp_f32 v69, v69
    v_mfma_f32_16x16x32_bf16 v[64:67], v[76:79], a[100:103], v[64:67]
    ds_read_b32 v19, v15
    v_perm_b32 v217, v69, v221, s49
    v_mfma_f32_16x16x32_bf16 v[64:67], v[80:83], a[104:107], v[64:67]
    v_exp_f32 v70, v70
    v_mfma_f32_16x16x32_bf16 v[64:67], v[84:87], a[108:111], v[64:67]
    ds_write_addtid_b32 v217 offset:14880
    v_perm_b32 v218, v70, v222, s49
    v_mfma_f32_16x16x32_bf16 v[56:59], a[224:227], v[224:227], v[56:59]
    s_waitcnt lgkmcnt(8)
    v_exp_f32 v71, v71
    v_mfma_f32_16x16x32_bf16 v[56:59], a[232:235], v[228:231], v[56:59]
    ds_write_addtid_b32 v218 offset:21120
    v_perm_b32 v219, v71, v223, s49
    v_mfma_f32_16x16x32_bf16 v[56:59], a[240:243], v[232:235], v[56:59]
    s_waitcnt lgkmcnt(5)
    v_exp_f32 v64, v64
    v_mfma_f32_16x16x32_bf16 v[56:59], a[248:251], v[236:239], v[56:59]
    ds_write_addtid_b32 v219 offset:27296
    ds_read_b128 v[144:147], v0 offset:2560
    v_mfma_f32_16x16x32_bf16 v[68:71], v[72:75], a[112:115], v[252:255]
    v_exp_f32 v65, v65
    v_mfma_f32_16x16x32_bf16 v[68:71], v[76:79], a[116:119], v[68:71]
    v_mul_f32 v56, v23, v56
    v_mul_f32 v57, v23, v57
    v_mfma_f32_16x16x32_bf16 v[68:71], v[80:83], a[120:123], v[68:71]
    v_exp_f32 v66, v66
    v_mfma_f32_16x16x32_bf16 v[68:71], v[84:87], a[124:127], v[68:71]
    s_waitcnt lgkmcnt(4)
    v_cmp_gt_u32 vcc, s24, v19
    v_mul_f32 v58, v23, v58
    v_mfma_f32_16x16x32_bf16 v[60:63], a[228:231], v[224:227], v[60:63]
    s_add_u32 m0, s23, 9216
    v_exp_f32 v67, v67
    v_mfma_f32_16x16x32_bf16 v[60:63], a[236:239], v[228:231], v[60:63]
    buffer_store_dwordx4 v[28:31], v11, s[8:11], s22 offen nt
    buffer_load_dwordx4 v10, s[4:7], s22 offen nt lds
    v_mul_f32 v59, v23, v59
    v_mov_b64 v[40:41], 0
    s_cbranch_vccnz L_retry11
L_back11:
    v_mfma_f32_16x16x32_bf16 v[60:63], a[244:247], v[232:235], v[60:63]
    v_exp_f32 v68, v68
    v_mfma_f32_16x16x32_bf16 v[60:63], a[252:255], v[236:239], v[60:63]
    v_cvt_pk_bf16_f32 v28, v56, v57
    v_perm_b32 v216, v68, v64, s49
    v_cvt_pk_bf16_f32 v29, v58, v59
    v_mfma_f32_16x16x32_bf16 v[220:223], v[88:91], a[0:3], v[252:255]
    ds_write_addtid_b32 v216 offset:7936
    v_exp_f32 v69, v69
    v_mfma_f32_16x16x32_bf16 v[220:223], v[92:95], a[4:7], v[220:223]
    ds_read_b128 v[168:171], v2 offset:0
    v_perm_b32 v217, v69, v65, s49
    v_mfma_f32_16x16x32_bf16 v[220:223], v[96:99], a[8:11], v[220:223]
    v_exp_f32 v70, v70
    v_mfma_f32_16x16x32_bf16 v[220:223], v[100:103], a[12:15], v[220:223]
    ds_write_addtid_b32 v217 offset:14112
    v_perm_b32 v218, v70, v66, s49
    v_mfma_f32_16x16x32_bf16 v[48:51], a[128:131], v[104:107], 0
    v_exp_f32 v71, v71
    v_mfma_f32_16x16x32_bf16 v[48:51], a[136:139], v[108:111], v[48:51]
    ds_write_addtid_b32 v218 offset:20352
    v_perm_b32 v219, v71, v67, s49
    v_mfma_f32_16x16x32_bf16 v[48:51], a[144:147], v[112:115], v[48:51]
    v_exp_f32 v220, v220
    v_mfma_f32_16x16x32_bf16 v[48:51], a[152:155], v[116:119], v[48:51]
    ds_write_addtid_b32 v219 offset:26528
    ds_read_b128 v[148:151], v0 offset:2816
    v_mfma_f32_16x16x32_bf16 v[68:71], v[88:91], a[16:19], v[252:255]
    s_add_u32 s22, s22, 4096
    v_exp_f32 v221, v221
    v_mfma_f32_16x16x32_bf16 v[68:71], v[92:95], a[20:23], v[68:71]
    ds_read_b128 v[172:175], v2 offset:256
    v_mul_f32 v60, v23, v60
    v_mfma_f32_16x16x32_bf16 v[68:71], v[96:99], a[24:27], v[68:71]
    v_exp_f32 v222, v222
    v_mfma_f32_16x16x32_bf16 v[68:71], v[100:103], a[28:31], v[68:71]
    ds_read_b128 v[176:179], v2 offset:512
    v_mul_f32 v61, v23, v61
    v_mfma_f32_16x16x32_bf16 v[52:55], a[132:135], v[104:107], 0
    v_exp_f32 v223, v223
    v_mfma_f32_16x16x32_bf16 v[52:55], a[140:143], v[108:111], v[52:55]
    ds_read_b128 v[24:27], v18 offset:0
    v_mul_f32 v62, v23, v62
    v_mfma_f32_16x16x32_bf16 v[52:55], a[148:151], v[112:115], v[52:55]
    s_waitcnt lgkmcnt(3)
    v_exp_f32 v68, v68
    v_mfma_f32_16x16x32_bf16 v[52:55], a[156:159], v[116:119], v[52:55]
    ds_read_b128 v[180:183], v2 offset:768
    v_perm_b32 v216, v68, v220, s49
    v_smfmac_f32_16x16x64_bf16 v[44:47], v[32:35], v[144:151], v1
    ds_write_addtid_b32 v216 offset:8192
    v_mul_f32 v63, v23, v63
    v_mfma_f32_16x16x32_bf16 v[64:67], v[88:91], a[32:35], v[252:255]
    v_exp_f32 v69, v69
    v_mfma_f32_16x16x32_bf16 v[64:67], v[92:95], a[36:39], v[64:67]
    ds_read_b128 v[184:187], v3 offset:0
    v_perm_b32 v217, v69, v221, s49
    v_mfma_f32_16x16x32_bf16 v[64:67], v[96:99], a[40:43], v[64:67]
    v_exp_f32 v70, v70
    v_mfma_f32_16x16x32_bf16 v[64:67], v[100:103], a[44:47], v[64:67]
    ds_write_addtid_b32 v217 offset:14368
    v_perm_b32 v218, v70, v222, s49
    v_mfma_f32_16x16x32_bf16 v[48:51], a[160:163], v[168:171], v[48:51]
    s_waitcnt lgkmcnt(5)
    v_exp_f32 v71, v71
    v_mfma_f32_16x16x32_bf16 v[48:51], a[168:171], v[172:175], v[48:51]
    ds_write_addtid_b32 v218 offset:20608
    v_perm_b32 v219, v71, v223, s49
    v_mfma_f32_16x16x32_bf16 v[48:51], a[176:179], v[176:179], v[48:51]
    s_waitcnt lgkmcnt(4)
    v_exp_f32 v64, v64
    v_mfma_f32_16x16x32_bf16 v[48:51], a[184:187], v[180:183], v[48:51]
    ds_write_addtid_b32 v219 offset:26784
    ds_read_b128 v[152:155], v0 offset:3072
    v_mfma_f32_16x16x32_bf16 v[68:71], v[88:91], a[48:51], v[252:255]
    v_exp_f32 v65, v65
    v_mfma_f32_16x16x32_bf16 v[68:71], v[92:95], a[52:55], v[68:71]
    ds_read_b128 v[188:191], v3 offset:256
    v_cvt_pk_bf16_f32 v30, v60, v61
    v_mfma_f32_16x16x32_bf16 v[68:71], v[96:99], a[56:59], v[68:71]
    v_exp_f32 v66, v66
    v_mfma_f32_16x16x32_bf16 v[68:71], v[100:103], a[60:63], v[68:71]
    ds_read_b128 v[192:195], v3 offset:512
    v_cvt_pk_bf16_f32 v31, v62, v63
    v_mfma_f32_16x16x32_bf16 v[52:55], a[164:167], v[168:171], v[52:55]
    s_add_u32 m0, s23, 10240
    v_exp_f32 v67, v67
    v_mfma_f32_16x16x32_bf16 v[52:55], a[172:175], v[172:175], v[52:55]
    buffer_store_dwordx4 v[28:31], v11, s[8:11], s22 offen nt
    buffer_load_dwordx4 v10, s[4:7], s22 offen nt lds
    v_add_f32 v24, v24, v25
    v_add_f32 v26, v26, v27
    v_add_f32 v24, v24, v26
    v_mfma_f32_16x16x32_bf16 v[52:55], a[180:183], v[176:179], v[52:55]
    v_exp_f32 v68, v68
    v_mfma_f32_16x16x32_bf16 v[52:55], a[188:191], v[180:183], v[52:55]
    ds_read_b128 v[196:199], v3 offset:768
    v_perm_b32 v216, v68, v64, s49
    ds_read_b128 v[72:75], v5 offset:4096
    v_mfma_f32_16x16x32_bf16 v[220:223], v[88:91], a[64:67], v[252:255]
    ds_write_addtid_b32 v216 offset:7424
    v_exp_f32 v69, v69
    v_mfma_f32_16x16x32_bf16 v[220:223], v[92:95], a[68:71], v[220:223]
    ds_read_b128 v[224:227], v4 offset:0
    v_perm_b32 v217, v69, v65, s49
    v_mfma_f32_16x16x32_bf16 v[220:223], v[96:99], a[72:75], v[220:223]
    s_waitcnt lgkmcnt(10)
    v_exp_f32 v70, v70
    v_mfma_f32_16x16x32_bf16 v[220:223], v[100:103], a[76:79], v[220:223]
    ds_write_addtid_b32 v217 offset:13600
    v_perm_b32 v218, v70, v66, s49
    v_mfma_f32_16x16x32_bf16 v[48:51], a[192:195], v[184:187], v[48:51]
    s_waitcnt lgkmcnt(5)
    v_exp_f32 v71, v71
    v_mfma_f32_16x16x32_bf16 v[48:51], a[200:203], v[188:191], v[48:51]
    ds_write_addtid_b32 v218 offset:19840
    v_perm_b32 v219, v71, v67, s49
    v_mfma_f32_16x16x32_bf16 v[48:51], a[208:211], v[192:195], v[48:51]
    s_waitcnt lgkmcnt(5)
    v_exp_f32 v220, v220
    v_mfma_f32_16x16x32_bf16 v[48:51], a[216:219], v[196:199], v[48:51]
    ds_write_addtid_b32 v219 offset:26016
    ds_read_b128 v[156:159], v0 offset:3328
    v_mfma_f32_16x16x32_bf16 v[68:71], v[88:91], a[80:83], v[252:255]
    s_add_u32 s22, s22, 4096
    v_exp_f32 v221, v221
    v_mfma_f32_16x16x32_bf16 v[68:71], v[92:95], a[84:87], v[68:71]
    v_rcp_f32 v20, v24
    v_mfma_f32_16x16x32_bf16 v[68:71], v[96:99], a[88:91], v[68:71]
    v_exp_f32 v222, v222
    v_mfma_f32_16x16x32_bf16 v[68:71], v[100:103], a[92:95], v[68:71]
    ds_read_b128 v[228:231], v4 offset:256
    v_bitop3_b32 v17, v17, v20, s29 bitop3:0xe8
    v_mfma_f32_16x16x32_bf16 v[52:55], a[196:199], v[184:187], v[52:55]
    v_exp_f32 v223, v223
    v_mfma_f32_16x16x32_bf16 v[52:55], a[204:207], v[188:191], v[52:55]
    ds_read_b128 v[232:235], v4 offset:512
    v_mov_b32 v21, v20
    v_mfma_f32_16x16x32_bf16 v[52:55], a[212:215], v[192:195], v[52:55]
    s_waitcnt lgkmcnt(2)
    v_exp_f32 v68, v68
    v_mfma_f32_16x16x32_bf16 v[52:55], a[220:223], v[196:199], v[52:55]
    ds_read_b128 v[236:239], v4 offset:768
    v_perm_b32 v216, v68, v220, s49
    v_smfmac_f32_16x16x64_bf16 v[44:47], v[36:39], v[152:159], v1
    ds_write_addtid_b32 v216 offset:7680
    ds_read_b128 v[76:79], v6 offset:4096
    v_mfma_f32_16x16x32_bf16 v[64:67], v[88:91], a[96:99], v[252:255]
    v_exp_f32 v69, v69
    v_mfma_f32_16x16x32_bf16 v[64:67], v[92:95], a[100:103], v[64:67]
    ds_read_b128 v[80:83], v7 offset:4096
    v_perm_b32 v217, v69, v221, s49
    v_mfma_f32_16x16x32_bf16 v[64:67], v[96:99], a[104:107], v[64:67]
    v_exp_f32 v70, v70
    v_mfma_f32_16x16x32_bf16 v[64:67], v[100:103], a[108:111], v[64:67]
    ds_write_addtid_b32 v217 offset:13856
    v_perm_b32 v218, v70, v222, s49
    v_mfma_f32_16x16x32_bf16 v[48:51], a[224:227], v[224:227], v[48:51]
    s_waitcnt lgkmcnt(5)
    v_exp_f32 v71, v71
    v_mfma_f32_16x16x32_bf16 v[48:51], a[232:235], v[228:231], v[48:51]
    ds_write_addtid_b32 v218 offset:20096
    v_perm_b32 v219, v71, v223, s49
    v_mfma_f32_16x16x32_bf16 v[48:51], a[240:243], v[232:235], v[48:51]
    s_waitcnt lgkmcnt(5)
    v_exp_f32 v64, v64
    v_mfma_f32_16x16x32_bf16 v[48:51], a[248:251], v[236:239], v[48:51]
    ds_write_addtid_b32 v219 offset:26272
    ds_read_b128 v[160:163], v0 offset:3584
    v_mfma_f32_16x16x32_bf16 v[68:71], v[88:91], a[112:115], v[252:255]
    v_exp_f32 v65, v65
    v_mfma_f32_16x16x32_bf16 v[68:71], v[92:95], a[116:119], v[68:71]
    v_permlane32_swap_b32 v20, v21
    v_mfma_f32_16x16x32_bf16 v[68:71], v[96:99], a[120:123], v[68:71]
    v_exp_f32 v66, v66
    v_mfma_f32_16x16x32_bf16 v[68:71], v[100:103], a[124:127], v[68:71]
    ds_read_b128 v[84:87], v8 offset:4096
    v_mul_f32 v48, v20, v48
    v_mfma_f32_16x16x32_bf16 v[52:55], a[228:231], v[224:227], v[52:55]
    v_exp_f32 v67, v67
    v_mfma_f32_16x16x32_bf16 v[52:55], a[236:239], v[228:231], v[52:55]
    v_mul_f32 v49, v20, v49
    v_mul_f32 v50, v20, v50
    v_mfma_f32_16x16x32_bf16 v[52:55], a[244:247], v[232:235], v[52:55]
    v_exp_f32 v68, v68
    v_mfma_f32_16x16x32_bf16 v[52:55], a[252:255], v[236:239], v[52:55]
    s_waitcnt lgkmcnt(5)
    v_mul_f32 v51, v20, v51
    v_perm_b32 v216, v68, v64, s49
    v_cvt_pk_bf16_f32 v28, v48, v49
    v_mfma_f32_16x16x32_bf16 v[220:223], v[72:75], a[0:3], v[252:255]
    ds_write_addtid_b32 v216 offset:7936
    v_exp_f32 v69, v69
    v_mfma_f32_16x16x32_bf16 v[220:223], v[76:79], a[4:7], v[220:223]
    ds_read_b128 v[168:171], v2 offset:1024
    v_perm_b32 v217, v69, v65, s49
    v_mfma_f32_16x16x32_bf16 v[220:223], v[80:83], a[8:11], v[220:223]
    s_waitcnt lgkmcnt(2)
    v_exp_f32 v70, v70
    v_mfma_f32_16x16x32_bf16 v[220:223], v[84:87], a[12:15], v[220:223]
    ds_write_addtid_b32 v217 offset:14112
    v_perm_b32 v218, v70, v66, s49
    v_mfma_f32_16x16x32_bf16 v[56:59], a[128:131], v[120:123], 0
    v_exp_f32 v71, v71
    v_mfma_f32_16x16x32_bf16 v[56:59], a[136:139], v[124:127], v[56:59]
    ds_write_addtid_b32 v218 offset:20352
    v_perm_b32 v219, v71, v67, s49
    v_mfma_f32_16x16x32_bf16 v[56:59], a[144:147], v[128:131], v[56:59]
    v_exp_f32 v220, v220
    v_mfma_f32_16x16x32_bf16 v[56:59], a[152:155], v[132:135], v[56:59]
    ds_write_addtid_b32 v219 offset:26528
    ds_read_b128 v[164:167], v0 offset:3840
    v_mfma_f32_16x16x32_bf16 v[68:71], v[72:75], a[16:19], v[252:255]
    v_exp_f32 v221, v221
    v_mfma_f32_16x16x32_bf16 v[68:71], v[76:79], a[20:23], v[68:71]
    ds_read_b128 v[172:175], v2 offset:1280
    v_mul_f32 v52, v20, v52
    v_mfma_f32_16x16x32_bf16 v[68:71], v[80:83], a[24:27], v[68:71]
    v_exp_f32 v222, v222
    v_mfma_f32_16x16x32_bf16 v[68:71], v[84:87], a[28:31], v[68:71]
    ds_read_b128 v[176:179], v2 offset:1536
    v_mul_f32 v53, v20, v53
    v_mfma_f32_16x16x32_bf16 v[60:63], a[132:135], v[120:123], 0
    v_exp_f32 v223, v223
    v_mfma_f32_16x16x32_bf16 v[60:63], a[140:143], v[124:127], v[60:63]
    ds_read_b128 v[184:187], v3 offset:1024
    v_mul_f32 v54, v20, v54
    v_mfma_f32_16x16x32_bf16 v[60:63], a[148:151], v[128:131], v[60:63]
    s_waitcnt lgkmcnt(3)
    v_exp_f32 v68, v68
    v_mfma_f32_16x16x32_bf16 v[60:63], a[156:159], v[132:135], v[60:63]
    ds_read_b128 v[180:183], v2 offset:1792
    v_perm_b32 v216, v68, v220, s49
    v_smfmac_f32_16x16x64_bf16 v[44:47], v[36:39], v[160:167], v1
    ds_write_addtid_b32 v216 offset:8192
    v_mul_f32 v55, v20, v55
    v_mfma_f32_16x16x32_bf16 v[64:67], v[72:75], a[32:35], v[252:255]
    v_exp_f32 v69, v69
    v_mfma_f32_16x16x32_bf16 v[64:67], v[76:79], a[36:39], v[64:67]
    ds_read_b128 v[188:191], v3 offset:1280
    v_perm_b32 v217, v69, v221, s49
    v_mfma_f32_16x16x32_bf16 v[64:67], v[80:83], a[40:43], v[64:67]
    v_exp_f32 v70, v70
    v_mfma_f32_16x16x32_bf16 v[64:67], v[84:87], a[44:47], v[64:67]
    ds_write_addtid_b32 v217 offset:14368
    v_perm_b32 v218, v70, v222, s49
    v_mfma_f32_16x16x32_bf16 v[56:59], a[160:163], v[168:171], v[56:59]
    s_waitcnt lgkmcnt(5)
    v_exp_f32 v71, v71
    v_mfma_f32_16x16x32_bf16 v[56:59], a[168:171], v[172:175], v[56:59]
    ds_write_addtid_b32 v218 offset:20608
    v_perm_b32 v219, v71, v223, s49
    v_add_f32 v44, v44, v45
    v_mfma_f32_16x16x32_bf16 v[56:59], a[176:179], v[176:179], v[56:59]
    s_waitcnt lgkmcnt(4)
    v_exp_f32 v64, v64
    v_mfma_f32_16x16x32_bf16 v[56:59], a[184:187], v[180:183], v[56:59]
    ds_write_addtid_b32 v219 offset:26784
    ds_read_b128 v[104:107], v0 offset:4096
    v_mfma_f32_16x16x32_bf16 v[68:71], v[72:75], a[48:51], v[252:255]
    v_exp_f32 v65, v65
    v_mfma_f32_16x16x32_bf16 v[68:71], v[76:79], a[52:55], v[68:71]
    ds_write_b32 v12, v44 offset:512
    v_mfma_f32_16x16x32_bf16 v[68:71], v[80:83], a[56:59], v[68:71]
    s_waitcnt vmcnt(6)
    v_exp_f32 v66, v66
    v_mfma_f32_16x16x32_bf16 v[68:71], v[84:87], a[60:63], v[68:71]
    ds_add_u32 v14, v16
    v_mfma_f32_16x16x32_bf16 v[60:63], a[164:167], v[168:171], v[60:63]
    s_add_u32 s24, s24, 1
    v_exp_f32 v67, v67
    v_mfma_f32_16x16x32_bf16 v[60:63], a[172:175], v[172:175], v[60:63]
    ds_read_b128 v[192:195], v3 offset:1536
    v_cvt_pk_bf16_f32 v29, v50, v51
    v_mfma_f32_16x16x32_bf16 v[60:63], a[180:183], v[176:179], v[60:63]
    v_exp_f32 v68, v68
    v_mfma_f32_16x16x32_bf16 v[60:63], a[188:191], v[180:183], v[60:63]
    ds_read_b128 v[196:199], v3 offset:1792
    v_perm_b32 v216, v68, v64, s49
    v_cvt_pk_bf16_f32 v30, v52, v53
    v_mfma_f32_16x16x32_bf16 v[220:223], v[72:75], a[64:67], v[252:255]
    ds_write_addtid_b32 v216 offset:8448
    v_exp_f32 v69, v69
    v_mfma_f32_16x16x32_bf16 v[220:223], v[76:79], a[68:71], v[220:223]
    ds_read_b128 v[224:227], v4 offset:1024
    v_perm_b32 v217, v69, v65, s49
    v_mfma_f32_16x16x32_bf16 v[220:223], v[80:83], a[72:75], v[220:223]
    v_exp_f32 v70, v70
    v_mfma_f32_16x16x32_bf16 v[220:223], v[84:87], a[76:79], v[220:223]
    ds_write_addtid_b32 v217 offset:14624
    v_perm_b32 v218, v70, v66, s49
    v_mfma_f32_16x16x32_bf16 v[56:59], a[192:195], v[184:187], v[56:59]
    s_waitcnt lgkmcnt(4)
    v_exp_f32 v71, v71
    v_mfma_f32_16x16x32_bf16 v[56:59], a[200:203], v[188:191], v[56:59]
    ds_write_addtid_b32 v218 offset:20864
    v_perm_b32 v219, v71, v67, s49
    v_mfma_f32_16x16x32_bf16 v[56:59], a[208:211], v[192:195], v[56:59]
    s_waitcnt lgkmcnt(4)
    v_exp_f32 v220, v220
    v_mfma_f32_16x16x32_bf16 v[56:59], a[216:219], v[196:199], v[56:59]
    ds_write_addtid_b32 v219 offset:27040
    ds_read_b128 v[108:111], v0 offset:4352
    v_mfma_f32_16x16x32_bf16 v[68:71], v[72:75], a[80:83], v[252:255]
    v_exp_f32 v221, v221
    v_mfma_f32_16x16x32_bf16 v[68:71], v[76:79], a[84:87], v[68:71]
    ds_read_b128 v[228:231], v4 offset:1280
    v_cvt_pk_bf16_f32 v31, v54, v55
    v_mfma_f32_16x16x32_bf16 v[68:71], v[80:83], a[88:91], v[68:71]
    v_exp_f32 v222, v222
    v_mfma_f32_16x16x32_bf16 v[68:71], v[84:87], a[92:95], v[68:71]
    ds_read_b128 v[232:235], v4 offset:1536
    ds_read_b128 v[88:91], v5 offset:5120
    v_mfma_f32_16x16x32_bf16 v[60:63], a[196:199], v[184:187], v[60:63]
    v_exp_f32 v223, v223
    v_mfma_f32_16x16x32_bf16 v[60:63], a[204:207], v[188:191], v[60:63]
    ds_read_b128 v[92:95], v6 offset:5120
    ds_read_b128 v[96:99], v7 offset:5120
    v_mfma_f32_16x16x32_bf16 v[60:63], a[212:215], v[192:195], v[60:63]
    s_waitcnt lgkmcnt(5)
    v_exp_f32 v68, v68
    v_mfma_f32_16x16x32_bf16 v[60:63], a[220:223], v[196:199], v[60:63]
    ds_read_b128 v[236:239], v4 offset:1792
    v_perm_b32 v216, v68, v220, s49
    v_smfmac_f32_16x16x64_bf16 v[40:43], v[32:35], v[104:111], v1
    ds_write_addtid_b32 v216 offset:8704
    ds_read_b128 v[100:103], v8 offset:5120
    v_mfma_f32_16x16x32_bf16 v[64:67], v[72:75], a[96:99], v[252:255]
    v_exp_f32 v69, v69
    v_mfma_f32_16x16x32_bf16 v[64:67], v[76:79], a[100:103], v[64:67]
    ds_read_b32 v19, v15
    v_perm_b32 v217, v69, v221, s49
    v_mfma_f32_16x16x32_bf16 v[64:67], v[80:83], a[104:107], v[64:67]
    v_exp_f32 v70, v70
    v_mfma_f32_16x16x32_bf16 v[64:67], v[84:87], a[108:111], v[64:67]
    ds_write_addtid_b32 v217 offset:14880
    v_perm_b32 v218, v70, v222, s49
    v_mfma_f32_16x16x32_bf16 v[56:59], a[224:227], v[224:227], v[56:59]
    s_waitcnt lgkmcnt(8)
    v_exp_f32 v71, v71
    v_mfma_f32_16x16x32_bf16 v[56:59], a[232:235], v[228:231], v[56:59]
    ds_write_addtid_b32 v218 offset:21120
    v_perm_b32 v219, v71, v223, s49
    v_mfma_f32_16x16x32_bf16 v[56:59], a[240:243], v[232:235], v[56:59]
    s_waitcnt lgkmcnt(5)
    v_exp_f32 v64, v64
    v_mfma_f32_16x16x32_bf16 v[56:59], a[248:251], v[236:239], v[56:59]
    ds_write_addtid_b32 v219 offset:27296
    ds_read_b128 v[112:115], v0 offset:4608
    v_mfma_f32_16x16x32_bf16 v[68:71], v[72:75], a[112:115], v[252:255]
    v_exp_f32 v65, v65
    v_mfma_f32_16x16x32_bf16 v[68:71], v[76:79], a[116:119], v[68:71]
    v_mul_f32 v56, v21, v56
    v_mul_f32 v57, v21, v57
    v_mfma_f32_16x16x32_bf16 v[68:71], v[80:83], a[120:123], v[68:71]
    v_exp_f32 v66, v66
    v_mfma_f32_16x16x32_bf16 v[68:71], v[84:87], a[124:127], v[68:71]
    s_waitcnt lgkmcnt(4)
    v_cmp_gt_u32 vcc, s24, v19
    v_mul_f32 v58, v21, v58
    v_mfma_f32_16x16x32_bf16 v[60:63], a[228:231], v[224:227], v[60:63]
    s_add_u32 m0, s23, 11264
    v_exp_f32 v67, v67
    v_mfma_f32_16x16x32_bf16 v[60:63], a[236:239], v[228:231], v[60:63]
    buffer_store_dwordx4 v[28:31], v11, s[8:11], s22 offen nt
    buffer_load_dwordx4 v10, s[4:7], s22 offen nt lds
    v_mul_f32 v59, v21, v59
    v_mov_b64 v[44:45], 0
    s_cbranch_vccnz L_retry1
L_back1:
    v_mfma_f32_16x16x32_bf16 v[60:63], a[244:247], v[232:235], v[60:63]
    v_exp_f32 v68, v68
    v_mfma_f32_16x16x32_bf16 v[60:63], a[252:255], v[236:239], v[60:63]
    v_cvt_pk_bf16_f32 v28, v56, v57
    v_perm_b32 v216, v68, v64, s49
    v_cvt_pk_bf16_f32 v29, v58, v59
    v_mfma_f32_16x16x32_bf16 v[220:223], v[88:91], a[0:3], v[252:255]
    ds_write_addtid_b32 v216 offset:7936
    v_exp_f32 v69, v69
    v_mfma_f32_16x16x32_bf16 v[220:223], v[92:95], a[4:7], v[220:223]
    ds_read_b128 v[168:171], v2 offset:2048
    v_perm_b32 v217, v69, v65, s49
    v_mfma_f32_16x16x32_bf16 v[220:223], v[96:99], a[8:11], v[220:223]
    v_exp_f32 v70, v70
    v_mfma_f32_16x16x32_bf16 v[220:223], v[100:103], a[12:15], v[220:223]
    ds_write_addtid_b32 v217 offset:14112
    v_perm_b32 v218, v70, v66, s49
    v_mfma_f32_16x16x32_bf16 v[48:51], a[128:131], v[136:139], 0
    v_exp_f32 v71, v71
    v_mfma_f32_16x16x32_bf16 v[48:51], a[136:139], v[140:143], v[48:51]
    ds_write_addtid_b32 v218 offset:20352
    v_perm_b32 v219, v71, v67, s49
    v_mfma_f32_16x16x32_bf16 v[48:51], a[144:147], v[144:147], v[48:51]
    v_exp_f32 v220, v220
    v_mfma_f32_16x16x32_bf16 v[48:51], a[152:155], v[148:151], v[48:51]
    ds_write_addtid_b32 v219 offset:26528
    ds_read_b128 v[116:119], v0 offset:4864
    v_mfma_f32_16x16x32_bf16 v[68:71], v[88:91], a[16:19], v[252:255]
    s_add_u32 s22, s22, 4096
    v_exp_f32 v221, v221
    v_mfma_f32_16x16x32_bf16 v[68:71], v[92:95], a[20:23], v[68:71]
    ds_read_b128 v[172:175], v2 offset:2304
    v_mul_f32 v60, v21, v60
    v_mfma_f32_16x16x32_bf16 v[68:71], v[96:99], a[24:27], v[68:71]
    v_exp_f32 v222, v222
    v_mfma_f32_16x16x32_bf16 v[68:71], v[100:103], a[28:31], v[68:71]
    ds_read_b128 v[176:179], v2 offset:2560
    v_mul_f32 v61, v21, v61
    v_mfma_f32_16x16x32_bf16 v[52:55], a[132:135], v[136:139], 0
    v_exp_f32 v223, v223
    v_mfma_f32_16x16x32_bf16 v[52:55], a[140:143], v[140:143], v[52:55]
    ds_read_b128 v[24:27], v18 offset:512
    v_mul_f32 v62, v21, v62
    v_mfma_f32_16x16x32_bf16 v[52:55], a[148:151], v[144:147], v[52:55]
    s_waitcnt lgkmcnt(3)
    v_exp_f32 v68, v68
    v_mfma_f32_16x16x32_bf16 v[52:55], a[156:159], v[148:151], v[52:55]
    ds_read_b128 v[180:183], v2 offset:2816
    v_perm_b32 v216, v68, v220, s49
    v_smfmac_f32_16x16x64_bf16 v[40:43], v[32:35], v[112:119], v1
    ds_write_addtid_b32 v216 offset:8192
    v_mul_f32 v63, v21, v63
    v_mfma_f32_16x16x32_bf16 v[64:67], v[88:91], a[32:35], v[252:255]
    v_exp_f32 v69, v69
    v_mfma_f32_16x16x32_bf16 v[64:67], v[92:95], a[36:39], v[64:67]
    ds_read_b128 v[184:187], v3 offset:2048
    v_perm_b32 v217, v69, v221, s49
    v_mfma_f32_16x16x32_bf16 v[64:67], v[96:99], a[40:43], v[64:67]
    v_exp_f32 v70, v70
    v_mfma_f32_16x16x32_bf16 v[64:67], v[100:103], a[44:47], v[64:67]
    ds_write_addtid_b32 v217 offset:14368
    v_perm_b32 v218, v70, v222, s49
    v_mfma_f32_16x16x32_bf16 v[48:51], a[160:163], v[168:171], v[48:51]
    s_waitcnt lgkmcnt(5)
    v_exp_f32 v71, v71
    v_mfma_f32_16x16x32_bf16 v[48:51], a[168:171], v[172:175], v[48:51]
    ds_write_addtid_b32 v218 offset:20608
    v_perm_b32 v219, v71, v223, s49
    v_mfma_f32_16x16x32_bf16 v[48:51], a[176:179], v[176:179], v[48:51]
    s_waitcnt lgkmcnt(4)
    v_exp_f32 v64, v64
    v_mfma_f32_16x16x32_bf16 v[48:51], a[184:187], v[180:183], v[48:51]
    ds_write_addtid_b32 v219 offset:26784
    ds_read_b128 v[120:123], v0 offset:5120
    v_mfma_f32_16x16x32_bf16 v[68:71], v[88:91], a[48:51], v[252:255]
    v_exp_f32 v65, v65
    v_mfma_f32_16x16x32_bf16 v[68:71], v[92:95], a[52:55], v[68:71]
    ds_read_b128 v[188:191], v3 offset:2304
    v_cvt_pk_bf16_f32 v30, v60, v61
    v_mfma_f32_16x16x32_bf16 v[68:71], v[96:99], a[56:59], v[68:71]
    v_exp_f32 v66, v66
    v_mfma_f32_16x16x32_bf16 v[68:71], v[100:103], a[60:63], v[68:71]
    ds_read_b128 v[192:195], v3 offset:2560
    v_cvt_pk_bf16_f32 v31, v62, v63
    v_mfma_f32_16x16x32_bf16 v[52:55], a[164:167], v[168:171], v[52:55]
    s_add_u32 m0, s23, 0
    v_exp_f32 v67, v67
    v_mfma_f32_16x16x32_bf16 v[52:55], a[172:175], v[172:175], v[52:55]
    buffer_store_dwordx4 v[28:31], v11, s[8:11], s22 offen nt
    buffer_load_dwordx4 v10, s[4:7], s22 offen nt lds
    v_add_f32 v24, v24, v25
    v_add_f32 v26, v26, v27
    v_add_f32 v24, v24, v26
    v_mfma_f32_16x16x32_bf16 v[52:55], a[180:183], v[176:179], v[52:55]
    v_exp_f32 v68, v68
    v_mfma_f32_16x16x32_bf16 v[52:55], a[188:191], v[180:183], v[52:55]
    ds_read_b128 v[196:199], v3 offset:2816
    v_perm_b32 v216, v68, v64, s49
    ds_read_b128 v[72:75], v5 offset:6144
    v_mfma_f32_16x16x32_bf16 v[220:223], v[88:91], a[64:67], v[252:255]
    ds_write_addtid_b32 v216 offset:19712
    v_exp_f32 v69, v69
    v_mfma_f32_16x16x32_bf16 v[220:223], v[92:95], a[68:71], v[220:223]
    ds_read_b128 v[224:227], v4 offset:2048
    v_perm_b32 v217, v69, v65, s49
    v_mfma_f32_16x16x32_bf16 v[220:223], v[96:99], a[72:75], v[220:223]
    s_waitcnt lgkmcnt(10)
    v_exp_f32 v70, v70
    v_mfma_f32_16x16x32_bf16 v[220:223], v[100:103], a[76:79], v[220:223]
    ds_write_addtid_b32 v217 offset:25888
    v_perm_b32 v218, v70, v66, s49
    v_mfma_f32_16x16x32_bf16 v[48:51], a[192:195], v[184:187], v[48:51]
    s_waitcnt lgkmcnt(5)
    v_exp_f32 v71, v71
    v_mfma_f32_16x16x32_bf16 v[48:51], a[200:203], v[188:191], v[48:51]
    ds_write_addtid_b32 v218 offset:32128
    v_perm_b32 v219, v71, v67, s49
    v_mfma_f32_16x16x32_bf16 v[48:51], a[208:211], v[192:195], v[48:51]
    s_waitcnt lgkmcnt(5)
    v_exp_f32 v220, v220
    v_mfma_f32_16x16x32_bf16 v[48:51], a[216:219], v[196:199], v[48:51]
    ds_write_addtid_b32 v219 offset:38304
    ds_read_b128 v[124:127], v0 offset:5376
    v_mfma_f32_16x16x32_bf16 v[68:71], v[88:91], a[80:83], v[252:255]
    s_add_u32 s22, s22, 4096
    v_exp_f32 v221, v221
    v_mfma_f32_16x16x32_bf16 v[68:71], v[92:95], a[84:87], v[68:71]
    v_rcp_f32 v22, v24
    v_mfma_f32_16x16x32_bf16 v[68:71], v[96:99], a[88:91], v[68:71]
    v_exp_f32 v222, v222
    v_mfma_f32_16x16x32_bf16 v[68:71], v[100:103], a[92:95], v[68:71]
    ds_read_b128 v[228:231], v4 offset:2304
    v_bitop3_b32 v17, v17, v22, s29 bitop3:0xe8
    v_mfma_f32_16x16x32_bf16 v[52:55], a[196:199], v[184:187], v[52:55]
    v_exp_f32 v223, v223
    v_mfma_f32_16x16x32_bf16 v[52:55], a[204:207], v[188:191], v[52:55]
    ds_read_b128 v[232:235], v4 offset:2560
    v_mov_b32 v23, v22
    v_mfma_f32_16x16x32_bf16 v[52:55], a[212:215], v[192:195], v[52:55]
    s_waitcnt lgkmcnt(2)
    v_exp_f32 v68, v68
    v_mfma_f32_16x16x32_bf16 v[52:55], a[220:223], v[196:199], v[52:55]
    ds_read_b128 v[236:239], v4 offset:2816
    v_perm_b32 v216, v68, v220, s49
    v_smfmac_f32_16x16x64_bf16 v[40:43], v[36:39], v[120:127], v1
    ds_write_addtid_b32 v216 offset:19968
    ds_read_b128 v[76:79], v6 offset:6144
    v_mfma_f32_16x16x32_bf16 v[64:67], v[88:91], a[96:99], v[252:255]
    v_exp_f32 v69, v69
    v_mfma_f32_16x16x32_bf16 v[64:67], v[92:95], a[100:103], v[64:67]
    ds_read_b128 v[80:83], v7 offset:6144
    v_perm_b32 v217, v69, v221, s49
    v_mfma_f32_16x16x32_bf16 v[64:67], v[96:99], a[104:107], v[64:67]
    v_exp_f32 v70, v70
    v_mfma_f32_16x16x32_bf16 v[64:67], v[100:103], a[108:111], v[64:67]
    ds_write_addtid_b32 v217 offset:26144
    v_perm_b32 v218, v70, v222, s49
    v_mfma_f32_16x16x32_bf16 v[48:51], a[224:227], v[224:227], v[48:51]
    s_waitcnt lgkmcnt(5)
    v_exp_f32 v71, v71
    v_mfma_f32_16x16x32_bf16 v[48:51], a[232:235], v[228:231], v[48:51]
    ds_write_addtid_b32 v218 offset:32384
    v_perm_b32 v219, v71, v223, s49
    v_mfma_f32_16x16x32_bf16 v[48:51], a[240:243], v[232:235], v[48:51]
    s_waitcnt lgkmcnt(5)
    v_exp_f32 v64, v64
    v_mfma_f32_16x16x32_bf16 v[48:51], a[248:251], v[236:239], v[48:51]
    ds_write_addtid_b32 v219 offset:38560
    ds_read_b128 v[128:131], v0 offset:5632
    v_mfma_f32_16x16x32_bf16 v[68:71], v[88:91], a[112:115], v[252:255]
    v_exp_f32 v65, v65
    v_mfma_f32_16x16x32_bf16 v[68:71], v[92:95], a[116:119], v[68:71]
    v_permlane32_swap_b32 v22, v23
    v_mfma_f32_16x16x32_bf16 v[68:71], v[96:99], a[120:123], v[68:71]
    v_exp_f32 v66, v66
    v_mfma_f32_16x16x32_bf16 v[68:71], v[100:103], a[124:127], v[68:71]
    ds_read_b128 v[84:87], v8 offset:6144
    v_mul_f32 v48, v22, v48
    v_mfma_f32_16x16x32_bf16 v[52:55], a[228:231], v[224:227], v[52:55]
    v_exp_f32 v67, v67
    v_mfma_f32_16x16x32_bf16 v[52:55], a[236:239], v[228:231], v[52:55]
    v_mul_f32 v49, v22, v49
    v_mul_f32 v50, v22, v50
    v_mfma_f32_16x16x32_bf16 v[52:55], a[244:247], v[232:235], v[52:55]
    v_exp_f32 v68, v68
    v_mfma_f32_16x16x32_bf16 v[52:55], a[252:255], v[236:239], v[52:55]
    s_waitcnt lgkmcnt(5)
    v_mul_f32 v51, v22, v51
    v_perm_b32 v216, v68, v64, s49
    v_cvt_pk_bf16_f32 v28, v48, v49
    v_mfma_f32_16x16x32_bf16 v[220:223], v[72:75], a[0:3], v[252:255]
    ds_write_addtid_b32 v216 offset:20224
L_pad10:
    s_cbranch_execz L_hret
    v_exp_f32 v69, v69
    v_mfma_f32_16x16x32_bf16 v[220:223], v[76:79], a[4:7], v[220:223]
    ds_read_b128 v[168:171], v2 offset:3072
    v_perm_b32 v217, v69, v65, s49
    v_mfma_f32_16x16x32_bf16 v[220:223], v[80:83], a[8:11], v[220:223]
    s_waitcnt lgkmcnt(2)
    v_exp_f32 v70, v70
    v_mfma_f32_16x16x32_bf16 v[220:223], v[84:87], a[12:15], v[220:223]
    ds_write_addtid_b32 v217 offset:26400
    v_perm_b32 v218, v70, v66, s49
    v_mfma_f32_16x16x32_bf16 v[56:59], a[128:131], v[152:155], 0
    v_exp_f32 v71, v71
    v_mfma_f32_16x16x32_bf16 v[56:59], a[136:139], v[156:159], v[56:59]
    ds_write_addtid_b32 v218 offset:32640
    v_perm_b32 v219, v71, v67, s49
    v_mfma_f32_16x16x32_bf16 v[56:59], a[144:147], v[160:163], v[56:59]
    v_exp_f32 v220, v220
    v_mfma_f32_16x16x32_bf16 v[56:59], a[152:155], v[164:167], v[56:59]
    ds_write_addtid_b32 v219 offset:38816
    ds_read_b128 v[132:135], v0 offset:5888
    v_mfma_f32_16x16x32_bf16 v[68:71], v[72:75], a[16:19], v[252:255]
    v_exp_f32 v221, v221
    v_mfma_f32_16x16x32_bf16 v[68:71], v[76:79], a[20:23], v[68:71]
    ds_read_b128 v[172:175], v2 offset:3328
    v_mul_f32 v52, v22, v52
    v_mfma_f32_16x16x32_bf16 v[68:71], v[80:83], a[24:27], v[68:71]
    v_exp_f32 v222, v222
    v_mfma_f32_16x16x32_bf16 v[68:71], v[84:87], a[28:31], v[68:71]
    ds_read_b128 v[176:179], v2 offset:3584
    v_mul_f32 v53, v22, v53
    v_mfma_f32_16x16x32_bf16 v[60:63], a[132:135], v[152:155], 0
    v_exp_f32 v223, v223
    v_mfma_f32_16x16x32_bf16 v[60:63], a[140:143], v[156:159], v[60:63]
    ds_read_b128 v[184:187], v3 offset:3072
    v_mul_f32 v54, v22, v54
    v_mfma_f32_16x16x32_bf16 v[60:63], a[148:151], v[160:163], v[60:63]
    s_waitcnt lgkmcnt(3)
    v_exp_f32 v68, v68
    v_mfma_f32_16x16x32_bf16 v[60:63], a[156:159], v[164:167], v[60:63]
    ds_read_b128 v[180:183], v2 offset:3840
    v_perm_b32 v216, v68, v220, s49
    v_smfmac_f32_16x16x64_bf16 v[40:43], v[36:39], v[128:135], v1
    ds_write_addtid_b32 v216 offset:14336
    v_mul_f32 v55, v22, v55
    v_mfma_f32_16x16x32_bf16 v[64:67], v[72:75], a[32:35], v[252:255]
    v_exp_f32 v69, v69
    v_mfma_f32_16x16x32_bf16 v[64:67], v[76:79], a[36:39], v[64:67]
    ds_read_b128 v[188:191], v3 offset:3328
    v_perm_b32 v217, v69, v221, s49
    v_mfma_f32_16x16x32_bf16 v[64:67], v[80:83], a[40:43], v[64:67]
    v_exp_f32 v70, v70
    v_mfma_f32_16x16x32_bf16 v[64:67], v[84:87], a[44:47], v[64:67]
    ds_write_addtid_b32 v217 offset:20512
    v_perm_b32 v218, v70, v222, s49
    v_mfma_f32_16x16x32_bf16 v[56:59], a[160:163], v[168:171], v[56:59]
    s_waitcnt lgkmcnt(5)
    v_exp_f32 v71, v71
    v_mfma_f32_16x16x32_bf16 v[56:59], a[168:171], v[172:175], v[56:59]
    ds_write_addtid_b32 v218 offset:26752
    v_perm_b32 v219, v71, v223, s49
    v_add_f32 v40, v40, v41
    v_mfma_f32_16x16x32_bf16 v[56:59], a[176:179], v[176:179], v[56:59]
    s_waitcnt lgkmcnt(4)
    v_exp_f32 v64, v64
    v_mfma_f32_16x16x32_bf16 v[56:59], a[184:187], v[180:183], v[56:59]
    ds_write_addtid_b32 v219 offset:32928
    ds_read_b128 v[136:139], v0 offset:0
    v_mfma_f32_16x16x32_bf16 v[68:71], v[72:75], a[48:51], v[252:255]
    v_exp_f32 v65, v65
    v_mfma_f32_16x16x32_bf16 v[68:71], v[76:79], a[52:55], v[68:71]
    ds_write_b32 v12, v40 offset:1024
    v_mfma_f32_16x16x32_bf16 v[68:71], v[80:83], a[56:59], v[68:71]
    s_waitcnt vmcnt(6)
    v_exp_f32 v66, v66
    v_mfma_f32_16x16x32_bf16 v[68:71], v[84:87], a[60:63], v[68:71]
    ds_add_u32 v14, v16
    v_mfma_f32_16x16x32_bf16 v[60:63], a[164:167], v[168:171], v[60:63]
    s_add_u32 s24, s24, 1
    v_exp_f32 v67, v67
    v_mfma_f32_16x16x32_bf16 v[60:63], a[172:175], v[172:175], v[60:63]
    ds_read_b128 v[192:195], v3 offset:3584
    v_cvt_pk_bf16_f32 v29, v50, v51
    v_mfma_f32_16x16x32_bf16 v[60:63], a[180:183], v[176:179], v[60:63]
    v_exp_f32 v68, v68
    v_mfma_f32_16x16x32_bf16 v[60:63], a[188:191], v[180:183], v[60:63]
    ds_read_b128 v[196:199], v3 offset:3840
    v_perm_b32 v216, v68, v64, s49
    v_cvt_pk_bf16_f32 v30, v52, v53
    v_mfma_f32_16x16x32_bf16 v[220:223], v[72:75], a[64:67], v[252:255]
    ds_write_addtid_b32 v216 offset:14592
    v_exp_f32 v69, v69
    v_mfma_f32_16x16x32_bf16 v[220:223], v[76:79], a[68:71], v[220:223]
    ds_read_b128 v[224:227], v4 offset:3072
    v_perm_b32 v217, v69, v65, s49
    v_mfma_f32_16x16x32_bf16 v[220:223], v[80:83], a[72:75], v[220:223]
    v_exp_f32 v70, v70
    v_mfma_f32_16x16x32_bf16 v[220:223], v[84:87], a[76:79], v[220:223]
    ds_write_addtid_b32 v217 offset:20768
    v_perm_b32 v218, v70, v66, s49
    v_mfma_f32_16x16x32_bf16 v[56:59], a[192:195], v[184:187], v[56:59]
    s_waitcnt lgkmcnt(4)
    v_exp_f32 v71, v71
    v_mfma_f32_16x16x32_bf16 v[56:59], a[200:203], v[188:191], v[56:59]
    ds_write_addtid_b32 v218 offset:27008
    v_perm_b32 v219, v71, v67, s49
    v_mfma_f32_16x16x32_bf16 v[56:59], a[208:211], v[192:195], v[56:59]
    s_waitcnt lgkmcnt(4)
    v_exp_f32 v220, v220
    v_mfma_f32_16x16x32_bf16 v[56:59], a[216:219], v[196:199], v[56:59]
    ds_write_addtid_b32 v219 offset:33184
    ds_read_b128 v[140:143], v0 offset:256
    v_mfma_f32_16x16x32_bf16 v[68:71], v[72:75], a[80:83], v[252:255]
    v_exp_f32 v221, v221
    v_mfma_f32_16x16x32_bf16 v[68:71], v[76:79], a[84:87], v[68:71]
    ds_read_b128 v[228:231], v4 offset:3328
    v_cvt_pk_bf16_f32 v31, v54, v55
    v_mfma_f32_16x16x32_bf16 v[68:71], v[80:83], a[88:91], v[68:71]
    v_exp_f32 v222, v222
    v_mfma_f32_16x16x32_bf16 v[68:71], v[84:87], a[92:95], v[68:71]
    ds_read_b128 v[232:235], v4 offset:3584
    ds_read_b128 v[88:91], v5 offset:7168
    v_mfma_f32_16x16x32_bf16 v[60:63], a[196:199], v[184:187], v[60:63]
    v_exp_f32 v223, v223
    v_mfma_f32_16x16x32_bf16 v[60:63], a[204:207], v[188:191], v[60:63]
    ds_read_b128 v[92:95], v6 offset:7168
    ds_read_b128 v[96:99], v7 offset:7168
    v_mfma_f32_16x16x32_bf16 v[60:63], a[212:215], v[192:195], v[60:63]
    s_waitcnt lgkmcnt(5)
    v_exp_f32 v68, v68
    v_mfma_f32_16x16x32_bf16 v[60:63], a[220:223], v[196:199], v[60:63]
    ds_read_b128 v[236:239], v4 offset:3840
    v_perm_b32 v216, v68, v220, s49
    v_smfmac_f32_16x16x64_bf16 v[44:47], v[32:35], v[136:143], v1
    ds_write_addtid_b32 v216 offset:14848
    ds_read_b128 v[100:103], v8 offset:7168
    v_mfma_f32_16x16x32_bf16 v[64:67], v[72:75], a[96:99], v[252:255]
    v_exp_f32 v69, v69
    v_mfma_f32_16x16x32_bf16 v[64:67], v[76:79], a[100:103], v[64:67]
    ds_read_b32 v19, v15
    v_perm_b32 v217, v69, v221, s49
    v_mfma_f32_16x16x32_bf16 v[64:67], v[80:83], a[104:107], v[64:67]
    v_exp_f32 v70, v70
    v_mfma_f32_16x16x32_bf16 v[64:67], v[84:87], a[108:111], v[64:67]
    ds_write_addtid_b32 v217 offset:21024
    v_perm_b32 v218, v70, v222, s49
    v_mfma_f32_16x16x32_bf16 v[56:59], a[224:227], v[224:227], v[56:59]
    s_waitcnt lgkmcnt(8)
    v_exp_f32 v71, v71
    v_mfma_f32_16x16x32_bf16 v[56:59], a[232:235], v[228:231], v[56:59]
    ds_write_addtid_b32 v218 offset:27264
    v_perm_b32 v219, v71, v223, s49
    v_mfma_f32_16x16x32_bf16 v[56:59], a[240:243], v[232:235], v[56:59]
    s_waitcnt lgkmcnt(5)
    v_exp_f32 v64, v64
    v_mfma_f32_16x16x32_bf16 v[56:59], a[248:251], v[236:239], v[56:59]
    ds_write_addtid_b32 v219 offset:33440
    ds_read_b128 v[144:147], v0 offset:512
    v_mfma_f32_16x16x32_bf16 v[68:71], v[72:75], a[112:115], v[252:255]
    v_exp_f32 v65, v65
    v_mfma_f32_16x16x32_bf16 v[68:71], v[76:79], a[116:119], v[68:71]
    v_mul_f32 v56, v23, v56
    v_mul_f32 v57, v23, v57
    v_mfma_f32_16x16x32_bf16 v[68:71], v[80:83], a[120:123], v[68:71]
    v_exp_f32 v66, v66
    v_mfma_f32_16x16x32_bf16 v[68:71], v[84:87], a[124:127], v[68:71]
    s_waitcnt lgkmcnt(4)
    v_cmp_gt_u32 vcc, s24, v19
    v_mul_f32 v58, v23, v58
    v_mfma_f32_16x16x32_bf16 v[60:63], a[228:231], v[224:227], v[60:63]
    s_add_u32 m0, s23, 1024
    v_exp_f32 v67, v67
    v_mfma_f32_16x16x32_bf16 v[60:63], a[236:239], v[228:231], v[60:63]
    buffer_store_dwordx4 v[28:31], v11, s[8:11], s22 offen nt
    buffer_load_dwordx4 v10, s[4:7], s22 offen nt lds
    v_mul_f32 v59, v23, v59
    v_mov_b64 v[40:41], 0
    s_cbranch_vccnz L_retry3
L_back3:
    v_mfma_f32_16x16x32_bf16 v[60:63], a[244:247], v[232:235], v[60:63]
    v_exp_f32 v68, v68
    v_mfma_f32_16x16x32_bf16 v[60:63], a[252:255], v[236:239], v[60:63]
    v_cvt_pk_bf16_f32 v28, v56, v57
    v_perm_b32 v216, v68, v64, s49
    v_cvt_pk_bf16_f32 v29, v58, v59
    v_mfma_f32_16x16x32_bf16 v[220:223], v[88:91], a[0:3], v[252:255]
    ds_write_addtid_b32 v216 offset:14080
    v_exp_f32 v69, v69
    v_mfma_f32_16x16x32_bf16 v[220:223], v[92:95], a[4:7], v[220:223]
    ds_read_b128 v[168:171], v2 offset:4096
    v_perm_b32 v217, v69, v65, s49
    v_mfma_f32_16x16x32_bf16 v[220:223], v[96:99], a[8:11], v[220:223]
    v_exp_f32 v70, v70
    v_mfma_f32_16x16x32_bf16 v[220:223], v[100:103], a[12:15], v[220:223]
    ds_write_addtid_b32 v217 offset:20256
    v_perm_b32 v218, v70, v66, s49
    v_mfma_f32_16x16x32_bf16 v[48:51], a[128:131], v[104:107], 0
    v_exp_f32 v71, v71
    v_mfma_f32_16x16x32_bf16 v[48:51], a[136:139], v[108:111], v[48:51]
    ds_write_addtid_b32 v218 offset:26496
    v_perm_b32 v219, v71, v67, s49
    v_mfma_f32_16x16x32_bf16 v[48:51], a[144:147], v[112:115], v[48:51]
    v_exp_f32 v220, v220
    v_mfma_f32_16x16x32_bf16 v[48:51], a[152:155], v[116:119], v[48:51]
    ds_write_addtid_b32 v219 offset:32672
    ds_read_b128 v[148:151], v0 offset:768
    v_mfma_f32_16x16x32_bf16 v[68:71], v[88:91], a[16:19], v[252:255]
    s_add_u32 s22, s22, 4096
    v_exp_f32 v221, v221
    v_mfma_f32_16x16x32_bf16 v[68:71], v[92:95], a[20:23], v[68:71]
    ds_read_b128 v[172:175], v2 offset:4352
    v_mul_f32 v60, v23, v60
    v_mfma_f32_16x16x32_bf16 v[68:71], v[96:99], a[24:27], v[68:71]
    v_exp_f32 v222, v222
    v_mfma_f32_16x16x32_bf16 v[68:71], v[100:103], a[28:31], v[68:71]
    ds_read_b128 v[176:179], v2 offset:4608
    v_mul_f32 v61, v23, v61
    v_mfma_f32_16x16x32_bf16 v[52:55], a[132:135], v[104:107], 0
    v_exp_f32 v223, v223
    v_mfma_f32_16x16x32_bf16 v[52:55], a[140:143], v[108:111], v[52:55]
    ds_read_b128 v[24:27], v18 offset:1024
    v_mul_f32 v62, v23, v62
    v_mfma_f32_16x16x32_bf16 v[52:55], a[148:151], v[112:115], v[52:55]
    s_waitcnt lgkmcnt(3)
    v_exp_f32 v68, v68
    v_mfma_f32_16x16x32_bf16 v[52:55], a[156:159], v[116:119], v[52:55]
    ds_read_b128 v[180:183], v2 offset:4864
    v_perm_b32 v216, v68, v220, s49
    v_smfmac_f32_16x16x64_bf16 v[44:47], v[32:35], v[144:151], v1
    ds_write_addtid_b32 v216 offset:14336
    v_mul_f32 v63, v23, v63
    v_mfma_f32_16x16x32_bf16 v[64:67], v[88:91], a[32:35], v[252:255]
    v_exp_f32 v69, v69
    v_mfma_f32_16x16x32_bf16 v[64:67], v[92:95], a[36:39], v[64:67]
    ds_read_b128 v[184:187], v3 offset:4096
    v_perm_b32 v217, v69, v221, s49
    v_mfma_f32_16x16x32_bf16 v[64:67], v[96:99], a[40:43], v[64:67]
    v_exp_f32 v70, v70
    v_mfma_f32_16x16x32_bf16 v[64:67], v[100:103], a[44:47], v[64:67]
    ds_write_addtid_b32 v217 offset:20512
    v_perm_b32 v218, v70, v222, s49
    v_mfma_f32_16x16x32_bf16 v[48:51], a[160:163], v[168:171], v[48:51]
    s_waitcnt lgkmcnt(5)
    v_exp_f32 v71, v71
    v_mfma_f32_16x16x32_bf16 v[48:51], a[168:171], v[172:175], v[48:51]
    ds_write_addtid_b32 v218 offset:26752
    v_perm_b32 v219, v71, v223, s49
    v_mfma_f32_16x16x32_bf16 v[48:51], a[176:179], v[176:179], v[48:51]
    s_waitcnt lgkmcnt(4)
    v_exp_f32 v64, v64
    v_mfma_f32_16x16x32_bf16 v[48:51], a[184:187], v[180:183], v[48:51]
    ds_write_addtid_b32 v219 offset:32928
    ds_read_b128 v[152:155], v0 offset:1024
    v_mfma_f32_16x16x32_bf16 v[68:71], v[88:91], a[48:51], v[252:255]
    v_exp_f32 v65, v65
    v_mfma_f32_16x16x32_bf16 v[68:71], v[92:95], a[52:55], v[68:71]
    ds_read_b128 v[188:191], v3 offset:4352
    v_cvt_pk_bf16_f32 v30, v60, v61
    v_mfma_f32_16x16x32_bf16 v[68:71], v[96:99], a[56:59], v[68:71]
    v_exp_f32 v66, v66
    v_mfma_f32_16x16x32_bf16 v[68:71], v[100:103], a[60:63], v[68:71]
    ds_read_b128 v[192:195], v3 offset:4608
    v_cvt_pk_bf16_f32 v31, v62, v63
    v_mfma_f32_16x16x32_bf16 v[52:55], a[164:167], v[168:171], v[52:55]
    s_add_u32 m0, s23, 2048
    v_exp_f32 v67, v67
    v_mfma_f32_16x16x32_bf16 v[52:55], a[172:175], v[172:175], v[52:55]
    buffer_store_dwordx4 v[28:31], v11, s[8:11], s22 offen nt
    buffer_load_dwordx4 v10, s[4:7], s22 offen nt lds
    v_add_f32 v24, v24, v25
    v_add_f32 v26, v26, v27
    v_add_f32 v24, v24, v26
    v_mfma_f32_16x16x32_bf16 v[52:55], a[180:183], v[176:179], v[52:55]
    v_exp_f32 v68, v68
    v_mfma_f32_16x16x32_bf16 v[52:55], a[188:191], v[180:183], v[52:55]
    ds_read_b128 v[196:199], v3 offset:4864
    v_perm_b32 v216, v68, v64, s49
    ds_read_b128 v[72:75], v5 offset:8192
    v_mfma_f32_16x16x32_bf16 v[220:223], v[88:91], a[64:67], v[252:255]
    ds_write_addtid_b32 v216 offset:13568
    v_exp_f32 v69, v69
    v_mfma_f32_16x16x32_bf16 v[220:223], v[92:95], a[68:71], v[220:223]
    ds_read_b128 v[224:227], v4 offset:4096
    v_perm_b32 v217, v69, v65, s49
    v_mfma_f32_16x16x32_bf16 v[220:223], v[96:99], a[72:75], v[220:223]
    s_waitcnt lgkmcnt(10)
    v_exp_f32 v70, v70
    v_mfma_f32_16x16x32_bf16 v[220:223], v[100:103], a[76:79], v[220:223]
    ds_write_addtid_b32 v217 offset:19744
    v_perm_b32 v218, v70, v66, s49
    v_mfma_f32_16x16x32_bf16 v[48:51], a[192:195], v[184:187], v[48:51]
    s_waitcnt lgkmcnt(5)
    v_exp_f32 v71, v71
    v_mfma_f32_16x16x32_bf16 v[48:51], a[200:203], v[188:191], v[48:51]
    ds_write_addtid_b32 v218 offset:25984
    v_perm_b32 v219, v71, v67, s49
    v_mfma_f32_16x16x32_bf16 v[48:51], a[208:211], v[192:195], v[48:51]
    s_waitcnt lgkmcnt(5)
    v_exp_f32 v220, v220
    v_mfma_f32_16x16x32_bf16 v[48:51], a[216:219], v[196:199], v[48:51]
    ds_write_addtid_b32 v219 offset:32160
    ds_read_b128 v[156:159], v0 offset:1280
    v_mfma_f32_16x16x32_bf16 v[68:71], v[88:91], a[80:83], v[252:255]
    s_add_u32 s22, s22, 4096
    v_exp_f32 v221, v221
    v_mfma_f32_16x16x32_bf16 v[68:71], v[92:95], a[84:87], v[68:71]
    v_rcp_f32 v20, v24
    v_mfma_f32_16x16x32_bf16 v[68:71], v[96:99], a[88:91], v[68:71]
    v_exp_f32 v222, v222
    v_mfma_f32_16x16x32_bf16 v[68:71], v[100:103], a[92:95], v[68:71]
    ds_read_b128 v[228:231], v4 offset:4352
    v_bitop3_b32 v17, v17, v20, s29 bitop3:0xe8
    v_mfma_f32_16x16x32_bf16 v[52:55], a[196:199], v[184:187], v[52:55]
    v_exp_f32 v223, v223
    v_mfma_f32_16x16x32_bf16 v[52:55], a[204:207], v[188:191], v[52:55]
    ds_read_b128 v[232:235], v4 offset:4608
    v_mov_b32 v21, v20
    v_mfma_f32_16x16x32_bf16 v[52:55], a[212:215], v[192:195], v[52:55]
    s_waitcnt lgkmcnt(2)
    v_exp_f32 v68, v68
    v_mfma_f32_16x16x32_bf16 v[52:55], a[220:223], v[196:199], v[52:55]
    ds_read_b128 v[236:239], v4 offset:4864
    v_perm_b32 v216, v68, v220, s49
    v_smfmac_f32_16x16x64_bf16 v[44:47], v[36:39], v[152:159], v1
    ds_write_addtid_b32 v216 offset:13824
    ds_read_b128 v[76:79], v6 offset:8192
    v_mfma_f32_16x16x32_bf16 v[64:67], v[88:91], a[96:99], v[252:255]
    v_exp_f32 v69, v69
    v_mfma_f32_16x16x32_bf16 v[64:67], v[92:95], a[100:103], v[64:67]
    ds_read_b128 v[80:83], v7 offset:8192
    v_perm_b32 v217, v69, v221, s49
    v_mfma_f32_16x16x32_bf16 v[64:67], v[96:99], a[104:107], v[64:67]
    v_exp_f32 v70, v70
    v_mfma_f32_16x16x32_bf16 v[64:67], v[100:103], a[108:111], v[64:67]
    ds_write_addtid_b32 v217 offset:20000
    v_perm_b32 v218, v70, v222, s49
    v_mfma_f32_16x16x32_bf16 v[48:51], a[224:227], v[224:227], v[48:51]
    s_waitcnt lgkmcnt(5)
    v_exp_f32 v71, v71
    v_mfma_f32_16x16x32_bf16 v[48:51], a[232:235], v[228:231], v[48:51]
    ds_write_addtid_b32 v218 offset:26240
    v_perm_b32 v219, v71, v223, s49
    v_mfma_f32_16x16x32_bf16 v[48:51], a[240:243], v[232:235], v[48:51]
    s_waitcnt lgkmcnt(5)
    v_exp_f32 v64, v64
    v_mfma_f32_16x16x32_bf16 v[48:51], a[248:251], v[236:239], v[48:51]
    ds_write_addtid_b32 v219 offset:32416
    ds_read_b128 v[160:163], v0 offset:1536
    v_mfma_f32_16x16x32_bf16 v[68:71], v[88:91], a[112:115], v[252:255]
    v_exp_f32 v65, v65
    v_mfma_f32_16x16x32_bf16 v[68:71], v[92:95], a[116:119], v[68:71]
    v_permlane32_swap_b32 v20, v21
    v_mfma_f32_16x16x32_bf16 v[68:71], v[96:99], a[120:123], v[68:71]
    v_exp_f32 v66, v66
    v_mfma_f32_16x16x32_bf16 v[68:71], v[100:103], a[124:127], v[68:71]
    ds_read_b128 v[84:87], v8 offset:8192
    v_mul_f32 v48, v20, v48
    v_mfma_f32_16x16x32_bf16 v[52:55], a[228:231], v[224:227], v[52:55]
    v_exp_f32 v67, v67
    v_mfma_f32_16x16x32_bf16 v[52:55], a[236:239], v[228:231], v[52:55]
    s_waitcnt lgkmcnt(5)
    v_mul_f32 v49, v20, v49
    v_mul_f32 v50, v20, v50
    v_mfma_f32_16x16x32_bf16 v[52:55], a[244:247], v[232:235], v[52:55]
    s_add_u32 s25, s25, 1
    v_exp_f32 v68, v68
    v_mfma_f32_16x16x32_bf16 v[52:55], a[252:255], v[236:239], v[52:55]
    v_mul_f32 v51, v20, v51
    v_perm_b32 v216, v68, v64, s49
    v_cvt_pk_bf16_f32 v28, v48, v49
    s_cbranch_scc0 L_loop
    ds_add_u32 v14, v16
    ds_write_addtid_b32 v216 offset:14080
    ds_read_b128 v[168:171], v2 offset:5120
    ds_read_b128 v[172:175], v2 offset:5376
    v_exp_f32 v69, v69
    v_mfma_f32_16x16x32_bf16 v[56:59], a[128:131], v[120:123], 0
    ds_read_b128 v[176:179], v2 offset:5632
    v_perm_b32 v217, v69, v65, s49
    v_exp_f32 v70, v70
    v_mfma_f32_16x16x32_bf16 v[56:59], a[136:139], v[124:127], v[56:59]
    ds_write_addtid_b32 v217 offset:20256
    v_perm_b32 v218, v70, v66, s49
    v_exp_f32 v71, v71
    v_mfma_f32_16x16x32_bf16 v[56:59], a[144:147], v[128:131], v[56:59]
    ds_write_addtid_b32 v218 offset:26496
    v_perm_b32 v219, v71, v67, s49
    v_mfma_f32_16x16x32_bf16 v[56:59], a[152:155], v[132:135], v[56:59]
    ds_write_addtid_b32 v219 offset:32672
    ds_read_b128 v[164:167], v0 offset:1792
    v_mfma_f32_16x16x32_bf16 v[60:63], a[132:135], v[120:123], 0
    s_add_u32 s24, s24, 1
    ds_read_b128 v[180:183], v2 offset:5888
    v_mul_f32 v52, v20, v52
    v_mfma_f32_16x16x32_bf16 v[60:63], a[140:143], v[124:127], v[60:63]
    ds_read_b128 v[184:187], v3 offset:5120
    v_mul_f32 v53, v20, v53
    v_mfma_f32_16x16x32_bf16 v[60:63], a[148:151], v[128:131], v[60:63]
    ds_read_b128 v[188:191], v3 offset:5376
    v_mul_f32 v54, v20, v54
    v_mfma_f32_16x16x32_bf16 v[60:63], a[156:159], v[132:135], v[60:63]
    s_waitcnt lgkmcnt(9)
    ds_read_b128 v[192:195], v3 offset:5632
    v_mul_f32 v55, v20, v55
    v_mfma_f32_16x16x32_bf16 v[56:59], a[160:163], v[168:171], v[56:59]
    s_waitcnt lgkmcnt(9)
    ds_read_b128 v[196:199], v3 offset:5888
    v_cvt_pk_bf16_f32 v29, v50, v51
    v_mfma_f32_16x16x32_bf16 v[56:59], a[168:171], v[172:175], v[56:59]
    s_waitcnt lgkmcnt(9)
    ds_read_b128 v[72:75], v4 offset:5120
    v_cvt_pk_bf16_f32 v30, v52, v53
    v_mfma_f32_16x16x32_bf16 v[56:59], a[176:179], v[176:179], v[56:59]
    s_waitcnt lgkmcnt(5)
    ds_read_b128 v[76:79], v4 offset:5376
    v_cvt_pk_bf16_f32 v31, v54, v55
    v_smfmac_f32_16x16x64_bf16 v[44:47], v[36:39], v[160:167], v1
    v_mfma_f32_16x16x32_bf16 v[56:59], a[184:187], v[180:183], v[56:59]
    ds_read_b128 v[80:83], v4 offset:5632
    v_mfma_f32_16x16x32_bf16 v[60:63], a[164:167], v[168:171], v[60:63]
    ds_read_b128 v[84:87], v4 offset:5888
    v_mfma_f32_16x16x32_bf16 v[60:63], a[172:175], v[172:175], v[60:63]
    v_add_f32 v44, v44, v45
    v_mfma_f32_16x16x32_bf16 v[60:63], a[180:183], v[176:179], v[60:63]
    ds_write_b32 v12, v44 offset:0
    ds_add_u32 v14, v16
    v_mfma_f32_16x16x32_bf16 v[60:63], a[188:191], v[180:183], v[60:63]
    s_waitcnt lgkmcnt(9)
    ds_read_b32 v19, v15
    buffer_store_dwordx4 v[28:31], v11, s[8:11], s22 offen nt
    s_add_u32 s22, s22, 4096
    v_mfma_f32_16x16x32_bf16 v[56:59], a[192:195], v[184:187], v[56:59]
    s_waitcnt lgkmcnt(9)
    v_mfma_f32_16x16x32_bf16 v[56:59], a[200:203], v[188:191], v[56:59]
    s_waitcnt lgkmcnt(8)
    v_mfma_f32_16x16x32_bf16 v[56:59], a[208:211], v[192:195], v[56:59]
    s_waitcnt lgkmcnt(7)
    v_mfma_f32_16x16x32_bf16 v[56:59], a[216:219], v[196:199], v[56:59]
    v_mfma_f32_16x16x32_bf16 v[60:63], a[196:199], v[184:187], v[60:63]
    s_waitcnt lgkmcnt(0)
    v_cmp_gt_u32 vcc, s24, v19
    v_mfma_f32_16x16x32_bf16 v[60:63], a[204:207], v[188:191], v[60:63]
    s_cbranch_vccnz L_retry189
L_back189:
    v_mfma_f32_16x16x32_bf16 v[60:63], a[212:215], v[192:195], v[60:63]
    ds_read_b128 v[88:91], v2 offset:0
    v_mfma_f32_16x16x32_bf16 v[60:63], a[220:223], v[196:199], v[60:63]
    ds_read_b128 v[92:95], v2 offset:256
    v_mfma_f32_16x16x32_bf16 v[56:59], a[224:227], v[72:75], v[56:59]
    ds_read_b128 v[96:99], v2 offset:512
    v_mfma_f32_16x16x32_bf16 v[56:59], a[232:235], v[76:79], v[56:59]
    ds_read_b128 v[100:103], v2 offset:768
    v_mfma_f32_16x16x32_bf16 v[56:59], a[240:243], v[80:83], v[56:59]
    ds_read_b128 v[168:171], v3 offset:0
    v_mfma_f32_16x16x32_bf16 v[56:59], a[248:251], v[84:87], v[56:59]
    ds_read_b128 v[172:175], v3 offset:256
    v_mfma_f32_16x16x32_bf16 v[60:63], a[228:231], v[72:75], v[60:63]
    ds_read_b128 v[176:179], v3 offset:512
    v_mfma_f32_16x16x32_bf16 v[60:63], a[236:239], v[76:79], v[60:63]
    ds_read_b128 v[180:183], v3 offset:768
    v_mfma_f32_16x16x32_bf16 v[60:63], a[244:247], v[80:83], v[60:63]
    ds_read_b128 v[184:187], v4 offset:0
    v_mfma_f32_16x16x32_bf16 v[60:63], a[252:255], v[84:87], v[60:63]
    ds_read_b128 v[188:191], v4 offset:256
    v_mfma_f32_16x16x32_bf16 v[48:51], a[128:131], v[136:139], 0
    ds_read_b128 v[192:195], v4 offset:512
    v_mfma_f32_16x16x32_bf16 v[48:51], a[136:139], v[140:143], v[48:51]
    ds_read_b128 v[196:199], v4 offset:768
    v_mfma_f32_16x16x32_bf16 v[48:51], a[144:147], v[144:147], v[48:51]
    v_mul_f32 v56, v21, v56
    v_mfma_f32_16x16x32_bf16 v[48:51], a[152:155], v[148:151], v[48:51]
    v_mul_f32 v57, v21, v57
    v_mfma_f32_16x16x32_bf16 v[52:55], a[132:135], v[136:139], 0
    v_mul_f32 v58, v21, v58
    v_mfma_f32_16x16x32_bf16 v[52:55], a[140:143], v[140:143], v[52:55]
    v_mul_f32 v59, v21, v59
    v_mfma_f32_16x16x32_bf16 v[52:55], a[148:151], v[144:147], v[52:55]
    s_add_u32 s24, s24, 1
    ds_read_b32 v19, v15
    v_mul_f32 v60, v21, v60
    v_mfma_f32_16x16x32_bf16 v[52:55], a[156:159], v[148:151], v[52:55]
    s_waitcnt lgkmcnt(12)
    v_mul_f32 v61, v21, v61
    v_mfma_f32_16x16x32_bf16 v[48:51], a[160:163], v[88:91], v[48:51]
    s_waitcnt lgkmcnt(11)
    v_mul_f32 v62, v21, v62
    v_mfma_f32_16x16x32_bf16 v[48:51], a[168:171], v[92:95], v[48:51]
    s_waitcnt lgkmcnt(10)
    v_mul_f32 v63, v21, v63
    v_mfma_f32_16x16x32_bf16 v[48:51], a[176:179], v[96:99], v[48:51]
    s_waitcnt lgkmcnt(9)
    v_cvt_pk_bf16_f32 v28, v56, v57
    v_mfma_f32_16x16x32_bf16 v[48:51], a[184:187], v[100:103], v[48:51]
    s_waitcnt lgkmcnt(0)
    v_cmp_gt_u32 vcc, s24, v19
    v_cvt_pk_bf16_f32 v29, v58, v59
    v_mfma_f32_16x16x32_bf16 v[52:55], a[164:167], v[88:91], v[52:55]
    s_cbranch_vccnz L_retry191
L_back191:
    v_cvt_pk_bf16_f32 v30, v60, v61
    v_mfma_f32_16x16x32_bf16 v[52:55], a[172:175], v[92:95], v[52:55]
    ds_read_b128 v[24:27], v18 offset:0
    v_cvt_pk_bf16_f32 v31, v62, v63
    v_mfma_f32_16x16x32_bf16 v[52:55], a[180:183], v[96:99], v[52:55]
    ds_read_b128 v[72:75], v2 offset:1024
    v_mfma_f32_16x16x32_bf16 v[52:55], a[188:191], v[100:103], v[52:55]
    ds_read_b128 v[76:79], v2 offset:1280
    buffer_store_dwordx4 v[28:31], v11, s[8:11], s22 offen nt
    s_add_u32 s22, s22, 4096
    v_mfma_f32_16x16x32_bf16 v[48:51], a[192:195], v[168:171], v[48:51]
    ds_read_b128 v[80:83], v2 offset:1536
    v_mfma_f32_16x16x32_bf16 v[48:51], a[200:203], v[172:175], v[48:51]
    ds_read_b128 v[84:87], v2 offset:1792
    v_mfma_f32_16x16x32_bf16 v[48:51], a[208:211], v[176:179], v[48:51]
    ds_read_b128 v[88:91], v3 offset:1024
    v_mfma_f32_16x16x32_bf16 v[48:51], a[216:219], v[180:183], v[48:51]
    ds_read_b128 v[92:95], v3 offset:1280
    v_mfma_f32_16x16x32_bf16 v[52:55], a[196:199], v[168:171], v[52:55]
    ds_read_b128 v[96:99], v3 offset:1536
    v_mfma_f32_16x16x32_bf16 v[52:55], a[204:207], v[172:175], v[52:55]
    s_waitcnt lgkmcnt(7)
    ds_read_b128 v[100:103], v3 offset:1792
    v_add_f32 v24, v24, v25
    v_add_f32 v26, v26, v27
    v_mfma_f32_16x16x32_bf16 v[52:55], a[212:215], v[176:179], v[52:55]
    v_add_f32 v24, v24, v26
    v_mfma_f32_16x16x32_bf16 v[52:55], a[220:223], v[180:183], v[52:55]
    v_mfma_f32_16x16x32_bf16 v[48:51], a[224:227], v[184:187], v[48:51]
    ds_read_b128 v[168:171], v4 offset:1024
    v_rcp_f32 v22, v24
    v_mfma_f32_16x16x32_bf16 v[48:51], a[232:235], v[188:191], v[48:51]
    ds_read_b128 v[172:175], v4 offset:1280
    v_mfma_f32_16x16x32_bf16 v[48:51], a[240:243], v[192:195], v[48:51]
    ds_read_b128 v[176:179], v4 offset:1536
    v_bitop3_b32 v17, v17, v22, s29 bitop3:0xe8
    v_mov_b32 v23, v22
    v_mfma_f32_16x16x32_bf16 v[48:51], a[248:251], v[196:199], v[48:51]
    ds_read_b128 v[180:183], v4 offset:1792
    v_mfma_f32_16x16x32_bf16 v[52:55], a[228:231], v[184:187], v[52:55]
    v_mfma_f32_16x16x32_bf16 v[52:55], a[236:239], v[188:191], v[52:55]
    v_mfma_f32_16x16x32_bf16 v[52:55], a[244:247], v[192:195], v[52:55]
    v_permlane32_swap_b32 v22, v23
    v_mfma_f32_16x16x32_bf16 v[52:55], a[252:255], v[196:199], v[52:55]
    v_mfma_f32_16x16x32_bf16 v[56:59], a[128:131], v[152:155], 0
    v_mfma_f32_16x16x32_bf16 v[56:59], a[136:139], v[156:159], v[56:59]
    v_mfma_f32_16x16x32_bf16 v[56:59], a[144:147], v[160:163], v[56:59]
    v_mul_f32 v48, v22, v48
    v_mfma_f32_16x16x32_bf16 v[56:59], a[152:155], v[164:167], v[56:59]
    v_mul_f32 v49, v22, v49
    v_mfma_f32_16x16x32_bf16 v[60:63], a[132:135], v[152:155], 0
    v_mul_f32 v50, v22, v50
    v_mfma_f32_16x16x32_bf16 v[60:63], a[140:143], v[156:159], v[60:63]
    v_mul_f32 v51, v22, v51
    v_mfma_f32_16x16x32_bf16 v[60:63], a[148:151], v[160:163], v[60:63]
    v_mul_f32 v52, v22, v52
    v_mfma_f32_16x16x32_bf16 v[60:63], a[156:159], v[164:167], v[60:63]
    s_waitcnt lgkmcnt(11)
    v_mul_f32 v53, v22, v53
    v_mfma_f32_16x16x32_bf16 v[56:59], a[160:163], v[72:75], v[56:59]
    s_waitcnt lgkmcnt(10)
    v_mul_f32 v54, v22, v54
    v_mfma_f32_16x16x32_bf16 v[56:59], a[168:171], v[76:79], v[56:59]
    s_waitcnt lgkmcnt(9)
    v_mul_f32 v55, v22, v55
    v_mfma_f32_16x16x32_bf16 v[56:59], a[176:179], v[80:83], v[56:59]
    s_waitcnt lgkmcnt(8)
    v_cvt_pk_bf16_f32 v28, v48, v49
    v_mfma_f32_16x16x32_bf16 v[56:59], a[184:187], v[84:87], v[56:59]
    v_cvt_pk_bf16_f32 v29, v50, v51
    v_mfma_f32_16x16x32_bf16 v[60:63], a[164:167], v[72:75], v[60:63]
    v_cvt_pk_bf16_f32 v30, v52, v53
    v_mfma_f32_16x16x32_bf16 v[60:63], a[172:175], v[76:79], v[60:63]
    v_cvt_pk_bf16_f32 v31, v54, v55
    v_mfma_f32_16x16x32_bf16 v[60:63], a[180:183], v[80:83], v[60:63]
    v_mfma_f32_16x16x32_bf16 v[60:63], a[188:191], v[84:87], v[60:63]
    s_waitcnt lgkmcnt(7)
    buffer_store_dwordx4 v[28:31], v11, s[8:11], s22 offen nt
    s_add_u32 s22, s22, 4096
    v_mfma_f32_16x16x32_bf16 v[56:59], a[192:195], v[88:91], v[56:59]
    s_waitcnt lgkmcnt(6)
    v_mfma_f32_16x16x32_bf16 v[56:59], a[200:203], v[92:95], v[56:59]
    s_waitcnt lgkmcnt(5)
    v_mfma_f32_16x16x32_bf16 v[56:59], a[208:211], v[96:99], v[56:59]
    s_waitcnt lgkmcnt(4)
    v_mfma_f32_16x16x32_bf16 v[56:59], a[216:219], v[100:103], v[56:59]
    v_mfma_f32_16x16x32_bf16 v[60:63], a[196:199], v[88:91], v[60:63]
    v_mfma_f32_16x16x32_bf16 v[60:63], a[204:207], v[92:95], v[60:63]
    v_mfma_f32_16x16x32_bf16 v[60:63], a[212:215], v[96:99], v[60:63]
    v_mfma_f32_16x16x32_bf16 v[60:63], a[220:223], v[100:103], v[60:63]
    s_waitcnt lgkmcnt(3)
    v_mfma_f32_16x16x32_bf16 v[56:59], a[224:227], v[168:171], v[56:59]
    s_waitcnt lgkmcnt(2)
    v_mfma_f32_16x16x32_bf16 v[56:59], a[232:235], v[172:175], v[56:59]
    s_waitcnt lgkmcnt(1)
    v_mfma_f32_16x16x32_bf16 v[56:59], a[240:243], v[176:179], v[56:59]
    s_waitcnt lgkmcnt(0)
    v_mfma_f32_16x16x32_bf16 v[56:59], a[248:251], v[180:183], v[56:59]
    v_mfma_f32_16x16x32_bf16 v[60:63], a[228:231], v[168:171], v[60:63]
    v_mfma_f32_16x16x32_bf16 v[60:63], a[236:239], v[172:175], v[60:63]
    v_mul_f32 v56, v23, v56
    v_mul_f32 v57, v23, v57
    v_mfma_f32_16x16x32_bf16 v[60:63], a[244:247], v[176:179], v[60:63]
    v_mul_f32 v58, v23, v58
    v_mul_f32 v59, v23, v59
    v_mfma_f32_16x16x32_bf16 v[60:63], a[252:255], v[180:183], v[60:63]
    v_cvt_pk_bf16_f32 v28, v56, v57
L_pad11:
    s_cbranch_execz L_hret
    v_cvt_pk_bf16_f32 v29, v58, v59
    s_nop 5
    v_mul_f32 v60, v23, v60
    v_mul_f32 v61, v23, v61
    v_mul_f32 v62, v23, v62
    v_mul_f32 v63, v23, v63
    v_cvt_pk_bf16_f32 v30, v60, v61
    v_cvt_pk_bf16_f32 v31, v62, v63
    buffer_store_dwordx4 v[28:31], v11, s[8:11], s22 offen nt
    s_add_u32 s22, s22, 4096
    v_and_b32 v17, 0x60000000, v17
    v_cmp_ne_u32 vcc, 0x40000000, v17
    s_nop 1
    s_cbranch_vccnz L_slow
L_end:
    s_endpgm
L_retry1:
    ds_read_b32 v19, v15
    s_waitcnt lgkmcnt(0)
    v_cmp_gt_u32 vcc, s24, v19
    s_cbranch_vccnz L_retry1
    s_branch L_back1
L_retry101:
    ds_read_b32 v19, v15
    s_waitcnt lgkmcnt(0)
    v_cmp_gt_u32 vcc, s24, v19
    s_cbranch_vccnz L_retry101
    s_branch L_back101
L_retry103:
    ds_read_b32 v19, v15
    s_waitcnt lgkmcnt(0)
    v_cmp_gt_u32 vcc, s24, v19
    s_cbranch_vccnz L_retry103
    s_branch L_back103
L_retry105:
    ds_read_b32 v19, v15
    s_waitcnt lgkmcnt(0)
    v_cmp_gt_u32 vcc, s24, v19
    s_cbranch_vccnz L_retry105
    s_branch L_back105
L_retry107:
    ds_read_b32 v19, v15
    s_waitcnt lgkmcnt(0)
    v_cmp_gt_u32 vcc, s24, v19
    s_cbranch_vccnz L_retry107
    s_branch L_back107
L_retry109:
    ds_read_b32 v19, v15
    s_waitcnt lgkmcnt(0)
    v_cmp_gt_u32 vcc, s24, v19
    s_cbranch_vccnz L_retry109
    s_branch L_back109
L_retry11:
    ds_read_b32 v19, v15
    s_waitcnt lgkmcnt(0)
    v_cmp_gt_u32 vcc, s24, v19
    s_cbranch_vccnz L_retry11
    s_branch L_back11
L_retry111:
    ds_read_b32 v19, v15
    s_waitcnt lgkmcnt(0)
    v_cmp_gt_u32 vcc, s24, v19
    s_cbranch_vccnz L_retry111
    s_branch L_back111
L_retry113:
    ds_read_b32 v19, v15
    s_waitcnt lgkmcnt(0)
    v_cmp_gt_u32 vcc, s24, v19
    s_cbranch_vccnz L_retry113
    s_branch L_back113
L_retry115:
    ds_read_b32 v19, v15
    s_waitcnt lgkmcnt(0)
    v_cmp_gt_u32 vcc, s24, v19
    s_cbranch_vccnz L_retry115
    s_branch L_back115
L_retry189:
    ds_read_b32 v19, v15
    s_waitcnt lgkmcnt(0)
    v_cmp_gt_u32 vcc, s24, v19
    s_cbranch_vccnz L_retry189
    s_branch L_back189
L_retry191:
    ds_read_b32 v19, v15
    s_waitcnt lgkmcnt(0)
    v_cmp_gt_u32 vcc, s24, v19
    s_cbranch_vccnz L_retry191
    s_branch L_back191
L_retry3:
    ds_read_b32 v19, v15
    s_waitcnt lgkmcnt(0)
    v_cmp_gt_u32 vcc, s24, v19
    s_cbranch_vccnz L_retry3
    s_branch L_back3
L_retry5:
    ds_read_b32 v19, v15
    s_waitcnt lgkmcnt(0)
    v_cmp_gt_u32 vcc, s24, v19
    s_cbranch_vccnz L_retry5
    s_branch L_back5
L_retry7:
    ds_read_b32 v19, v15
    s_waitcnt lgkmcnt(0)
    v_cmp_gt_u32 vcc, s24, v19
    s_cbranch_vccnz L_retry7
    s_branch L_back7
L_retry9:
    ds_read_b32 v19, v15
    s_waitcnt lgkmcnt(0)
    v_cmp_gt_u32 vcc, s24, v19
    s_cbranch_vccnz L_retry9
    s_branch L_back9
L_retry97:
    ds_read_b32 v19, v15
    s_waitcnt lgkmcnt(0)
    v_cmp_gt_u32 vcc, s24, v19
    s_cbranch_vccnz L_retry97
    s_branch L_back97
L_retry99:
    ds_read_b32 v19, v15
    s_waitcnt lgkmcnt(0)
    v_cmp_gt_u32 vcc, s24, v19
    s_cbranch_vccnz L_retry99
    s_branch L_back99
L_last:
L_slow:
    s_waitcnt vmcnt(0) lgkmcnt(0)
    s_barrier
    v_mbcnt_lo_u32_b32 v21, -1, 0
    v_mbcnt_hi_u32_b32 v21, -1, v21
    v_lshrrev_b32 v22, 4, v21
    v_and_b32 v23, 15, v21
    v_lshlrev_b32 v240, 8, v23
    v_lshl_add_u32 v240, v22, 4, v240
    v_lshlrev_b32 v242, 6, v23
    s_lshl_b32 s26, s20, 4
    v_lshl_add_u32 v241, v22, 2, v242
    v_add_u32 v241, s26, v241
    s_mov_b32 s21, 0
    s_mov_b32 s22, 0
    s_mov_b32 s38, 0xffff0000
    s_xor_b32 s26, s20, 0
    s_lshl_b32 s26, s26, 13
    s_add_u32 s26, s26, 57344
    v_lshl_add_u32 v1, v21, 4, s26
    s_xor_b32 s26, s20, 1
    s_lshl_b32 s26, s26, 13
    s_add_u32 s26, s26, 57344
    v_lshl_add_u32 v2, v21, 4, s26
    s_and_b32 s26, s20, 2
    s_xor_b32 s26, s26, 2
    s_lshl_b32 s26, s26, 13
    s_add_u32 s26, s26, 57344
    v_lshl_add_u32 v3, v21, 4, s26
    s_and_b32 s26, s20, 2
    s_xor_b32 s26, s26, 3
    s_lshl_b32 s26, s26, 13
    s_add_u32 s26, s26, 57344
    v_lshl_add_u32 v4, v21, 4, s26
    s_xor_b32 s27, s56, 0
    buffer_load_dwordx4 a[0:3], v240, s[12:15], s27 offen offset:0
    s_xor_b32 s27, s56, 0
    buffer_load_dwordx4 a[4:7], v240, s[12:15], s27 offen offset:64
    s_xor_b32 s27, s56, 0
    buffer_load_dwordx4 a[8:11], v240, s[12:15], s27 offen offset:128
    s_xor_b32 s27, s56, 0
    buffer_load_dwordx4 a[12:15], v240, s[12:15], s27 offen offset:192
    s_xor_b32 s27, s56, 4096
    buffer_load_dwordx4 a[16:19], v240, s[12:15], s27 offen offset:0
    s_xor_b32 s27, s56, 4096
    buffer_load_dwordx4 a[20:23], v240, s[12:15], s27 offen offset:64
    s_xor_b32 s27, s56, 4096
    buffer_load_dwordx4 a[24:27], v240, s[12:15], s27 offen offset:128
    s_xor_b32 s27, s56, 4096
    buffer_load_dwordx4 a[28:31], v240, s[12:15], s27 offen offset:192
    s_xor_b32 s27, s56, 8192
    buffer_load_dwordx4 a[32:35], v240, s[12:15], s27 offen offset:0
    s_xor_b32 s27, s56, 8192
    buffer_load_dwordx4 a[36:39], v240, s[12:15], s27 offen offset:64
    s_xor_b32 s27, s56, 8192
    buffer_load_dwordx4 a[40:43], v240, s[12:15], s27 offen offset:128
    s_xor_b32 s27, s56, 8192
    buffer_load_dwordx4 a[44:47], v240, s[12:15], s27 offen offset:192
    s_xor_b32 s27, s56, 12288
    buffer_load_dwordx4 a[48:51], v240, s[12:15], s27 offen offset:0
    s_xor_b32 s27, s56, 12288
    buffer_load_dwordx4 a[52:55], v240, s[12:15], s27 offen offset:64
    s_xor_b32 s27, s56, 12288
    buffer_load_dwordx4 a[56:59], v240, s[12:15], s27 offen offset:128
    s_xor_b32 s27, s56, 12288
    buffer_load_dwordx4 a[60:63], v240, s[12:15], s27 offen offset:192
    s_xor_b32 s27, s56, 16384
    buffer_load_dwordx4 a[64:67], v240, s[12:15], s27 offen offset:0
    s_xor_b32 s27, s56, 16384
    buffer_load_dwordx4 a[68:71], v240, s[12:15], s27 offen offset:64
    s_xor_b32 s27, s56, 16384
    buffer_load_dwordx4 a[72:75], v240, s[12:15], s27 offen offset:128
    s_xor_b32 s27, s56, 16384
    buffer_load_dwordx4 a[76:79], v240, s[12:15], s27 offen offset:192
    s_xor_b32 s27, s56, 20480
    buffer_load_dwordx4 a[80:83], v240, s[12:15], s27 offen offset:0
    s_xor_b32 s27, s56, 20480
    buffer_load_dwordx4 a[84:87], v240, s[12:15], s27 offen offset:64
    s_xor_b32 s27, s56, 20480
    buffer_load_dwordx4 a[88:91], v240, s[12:15], s27 offen offset:128
    s_xor_b32 s27, s56, 20480
    buffer_load_dwordx4 a[92:95], v240, s[12:15], s27 offen offset:192
    s_xor_b32 s27, s56, 24576
    buffer_load_dwordx4 a[96:99], v240, s[12:15], s27 offen offset:0
    s_xor_b32 s27, s56, 24576
    buffer_load_dwordx4 a[100:103], v240, s[12:15], s27 offen offset:64
    s_xor_b32 s27, s56, 24576
    buffer_load_dwordx4 a[104:107], v240, s[12:15], s27 offen offset:128
    s_xor_b32 s27, s56, 24576
    buffer_load_dwordx4 a[108:111], v240, s[12:15], s27 offen offset:192
    s_xor_b32 s27, s56, 28672
    buffer_load_dwordx4 a[112:115], v240, s[12:15], s27 offen offset:0
    s_xor_b32 s27, s56, 28672
    buffer_load_dwordx4 a[116:119], v240, s[12:15], s27 offen offset:64
    s_xor_b32 s27, s56, 28672
    buffer_load_dwordx4 a[120:123], v240, s[12:15], s27 offen offset:128
    s_xor_b32 s27, s56, 28672
    buffer_load_dwordx4 a[124:127], v240, s[12:15], s27 offen offset:192
    s_waitcnt vmcnt(31)
    v_accvgpr_read_b32 v26, a0
    v_accvgpr_read_b32 v27, a1
    v_lshlrev_b32 v24, 16, v26
    v_lshlrev_b32 v28, 16, v27
    v_and_b32 v25, s38, v26
    v_and_b32 v29, s38, v27
    v_pk_mul_f32 v[24:25], v[24:25], s[36:37]
    v_pk_mul_f32 v[28:29], v[28:29], s[36:37]
    v_cvt_pk_bf16_f32 v24, v24, v25
    v_cvt_pk_bf16_f32 v28, v28, v29
    v_accvgpr_write_b32 a0, v24
    v_accvgpr_write_b32 a1, v28
    v_accvgpr_read_b32 v26, a2
    v_accvgpr_read_b32 v27, a3
    v_lshlrev_b32 v24, 16, v26
    v_lshlrev_b32 v28, 16, v27
    v_and_b32 v25, s38, v26
    v_and_b32 v29, s38, v27
    v_pk_mul_f32 v[24:25], v[24:25], s[36:37]
    v_pk_mul_f32 v[28:29], v[28:29], s[36:37]
    v_cvt_pk_bf16_f32 v24, v24, v25
    v_cvt_pk_bf16_f32 v28, v28, v29
    v_accvgpr_write_b32 a2, v24
    v_accvgpr_write_b32 a3, v28
    s_waitcnt vmcnt(30)
    v_accvgpr_read_b32 v26, a4
    v_accvgpr_read_b32 v27, a5
    v_lshlrev_b32 v24, 16, v26
    v_lshlrev_b32 v28, 16, v27
    v_and_b32 v25, s38, v26
    v_and_b32 v29, s38, v27
    v_pk_mul_f32 v[24:25], v[24:25], s[36:37]
    v_pk_mul_f32 v[28:29], v[28:29], s[36:37]
    v_cvt_pk_bf16_f32 v24, v24, v25
    v_cvt_pk_bf16_f32 v28, v28, v29
    v_accvgpr_write_b32 a4, v24
    v_accvgpr_write_b32 a5, v28
    v_accvgpr_read_b32 v26, a6
    v_accvgpr_read_b32 v27, a7
    v_lshlrev_b32 v24, 16, v26
    v_lshlrev_b32 v28, 16, v27
    v_and_b32 v25, s38, v26
    v_and_b32 v29, s38, v27
    v_pk_mul_f32 v[24:25], v[24:25], s[36:37]
    v_pk_mul_f32 v[28:29], v[28:29], s[36:37]
    v_cvt_pk_bf16_f32 v24, v24, v25
    v_cvt_pk_bf16_f32 v28, v28, v29
    v_accvgpr_write_b32 a6, v24
    v_accvgpr_write_b32 a7, v28
    s_waitcnt vmcnt(29)
    v_accvgpr_read_b32 v26, a8
    v_accvgpr_read_b32 v27, a9
    v_lshlrev_b32 v24, 16, v26
    v_lshlrev_b32 v28, 16, v27
    v_and_b32 v25, s38, v26
    v_and_b32 v29, s38, v27
    v_pk_mul_f32 v[24:25], v[24:25], s[36:37]
    v_pk_mul_f32 v[28:29], v[28:29], s[36:37]
    v_cvt_pk_bf16_f32 v24, v24, v25
    v_cvt_pk_bf16_f32 v28, v28, v29
    v_accvgpr_write_b32 a8, v24
    v_accvgpr_write_b32 a9, v28
    v_accvgpr_read_b32 v26, a10
    v_accvgpr_read_b32 v27, a11
    v_lshlrev_b32 v24, 16, v26
    v_lshlrev_b32 v28, 16, v27
    v_and_b32 v25, s38, v26
    v_and_b32 v29, s38, v27
    v_pk_mul_f32 v[24:25], v[24:25], s[36:37]
    v_pk_mul_f32 v[28:29], v[28:29], s[36:37]
    v_cvt_pk_bf16_f32 v24, v24, v25
    v_cvt_pk_bf16_f32 v28, v28, v29
    v_accvgpr_write_b32 a10, v24
    v_accvgpr_write_b32 a11, v28
    s_waitcnt vmcnt(28)
    v_accvgpr_read_b32 v26, a12
    v_accvgpr_read_b32 v27, a13
    v_lshlrev_b32 v24, 16, v26
    v_lshlrev_b32 v28, 16, v27
    v_and_b32 v25, s38, v26
    v_and_b32 v29, s38, v27
    v_pk_mul_f32 v[24:25], v[24:25], s[36:37]
    v_pk_mul_f32 v[28:29], v[28:29], s[36:37]
    v_cvt_pk_bf16_f32 v24, v24, v25
    v_cvt_pk_bf16_f32 v28, v28, v29
    v_accvgpr_write_b32 a12, v24
    v_accvgpr_write_b32 a13, v28
    v_accvgpr_read_b32 v26, a14
    v_accvgpr_read_b32 v27, a15
    v_lshlrev_b32 v24, 16, v26
    v_lshlrev_b32 v28, 16, v27
    v_and_b32 v25, s38, v26
    v_and_b32 v29, s38, v27
    v_pk_mul_f32 v[24:25], v[24:25], s[36:37]
    v_pk_mul_f32 v[28:29], v[28:29], s[36:37]
    v_cvt_pk_bf16_f32 v24, v24, v25
    v_cvt_pk_bf16_f32 v28, v28, v29
    v_accvgpr_write_b32 a14, v24
    v_accvgpr_write_b32 a15, v28
    s_waitcnt vmcnt(27)
    v_accvgpr_read_b32 v26, a16
    v_accvgpr_read_b32 v27, a17
    v_lshlrev_b32 v24, 16, v26
    v_lshlrev_b32 v28, 16, v27
    v_and_b32 v25, s38, v26
    v_and_b32 v29, s38, v27
    v_pk_mul_f32 v[24:25], v[24:25], s[36:37]
    v_pk_mul_f32 v[28:29], v[28:29], s[36:37]
    v_cvt_pk_bf16_f32 v24, v24, v25
    v_cvt_pk_bf16_f32 v28, v28, v29
    v_accvgpr_write_b32 a16, v24
    v_accvgpr_write_b32 a17, v28
    v_accvgpr_read_b32 v26, a18
    v_accvgpr_read_b32 v27, a19
    v_lshlrev_b32 v24, 16, v26
    v_lshlrev_b32 v28, 16, v27
    v_and_b32 v25, s38, v26
    v_and_b32 v29, s38, v27
    v_pk_mul_f32 v[24:25], v[24:25], s[36:37]
    v_pk_mul_f32 v[28:29], v[28:29], s[36:37]
    v_cvt_pk_bf16_f32 v24, v24, v25
    v_cvt_pk_bf16_f32 v28, v28, v29
    v_accvgpr_write_b32 a18, v24
    v_accvgpr_write_b32 a19, v28
    s_waitcnt vmcnt(26)
    v_accvgpr_read_b32 v26, a20
    v_accvgpr_read_b32 v27, a21
    v_lshlrev_b32 v24, 16, v26
    v_lshlrev_b32 v28, 16, v27
    v_and_b32 v25, s38, v26
    v_and_b32 v29, s38, v27
    v_pk_mul_f32 v[24:25], v[24:25], s[36:37]
    v_pk_mul_f32 v[28:29], v[28:29], s[36:37]
    v_cvt_pk_bf16_f32 v24, v24, v25
    v_cvt_pk_bf16_f32 v28, v28, v29
    v_accvgpr_write_b32 a20, v24
    v_accvgpr_write_b32 a21, v28
    v_accvgpr_read_b32 v26, a22
    v_accvgpr_read_b32 v27, a23
    v_lshlrev_b32 v24, 16, v26
    v_lshlrev_b32 v28, 16, v27
    v_and_b32 v25, s38, v26
    v_and_b32 v29, s38, v27
    v_pk_mul_f32 v[24:25], v[24:25], s[36:37]
    v_pk_mul_f32 v[28:29], v[28:29], s[36:37]
    v_cvt_pk_bf16_f32 v24, v24, v25
    v_cvt_pk_bf16_f32 v28, v28, v29
    v_accvgpr_write_b32 a22, v24
    v_accvgpr_write_b32 a23, v28
    s_waitcnt vmcnt(25)
    v_accvgpr_read_b32 v26, a24
    v_accvgpr_read_b32 v27, a25
    v_lshlrev_b32 v24, 16, v26
    v_lshlrev_b32 v28, 16, v27
    v_and_b32 v25, s38, v26
    v_and_b32 v29, s38, v27
    v_pk_mul_f32 v[24:25], v[24:25], s[36:37]
    v_pk_mul_f32 v[28:29], v[28:29], s[36:37]
    v_cvt_pk_bf16_f32 v24, v24, v25
    v_cvt_pk_bf16_f32 v28, v28, v29
    v_accvgpr_write_b32 a24, v24
    v_accvgpr_write_b32 a25, v28
    v_accvgpr_read_b32 v26, a26
    v_accvgpr_read_b32 v27, a27
    v_lshlrev_b32 v24, 16, v26
    v_lshlrev_b32 v28, 16, v27
    v_and_b32 v25, s38, v26
    v_and_b32 v29, s38, v27
    v_pk_mul_f32 v[24:25], v[24:25], s[36:37]
    v_pk_mul_f32 v[28:29], v[28:29], s[36:37]
    v_cvt_pk_bf16_f32 v24, v24, v25
    v_cvt_pk_bf16_f32 v28, v28, v29
    v_accvgpr_write_b32 a26, v24
    v_accvgpr_write_b32 a27, v28
    s_waitcnt vmcnt(24)
    v_accvgpr_read_b32 v26, a28
    v_accvgpr_read_b32 v27, a29
    v_lshlrev_b32 v24, 16, v26
    v_lshlrev_b32 v28, 16, v27
    v_and_b32 v25, s38, v26
    v_and_b32 v29, s38, v27
    v_pk_mul_f32 v[24:25], v[24:25], s[36:37]
    v_pk_mul_f32 v[28:29], v[28:29], s[36:37]
    v_cvt_pk_bf16_f32 v24, v24, v25
    v_cvt_pk_bf16_f32 v28, v28, v29
    v_accvgpr_write_b32 a28, v24
    v_accvgpr_write_b32 a29, v28
    v_accvgpr_read_b32 v26, a30
    v_accvgpr_read_b32 v27, a31
    v_lshlrev_b32 v24, 16, v26
    v_lshlrev_b32 v28, 16, v27
    v_and_b32 v25, s38, v26
    v_and_b32 v29, s38, v27
    v_pk_mul_f32 v[24:25], v[24:25], s[36:37]
    v_pk_mul_f32 v[28:29], v[28:29], s[36:37]
    v_cvt_pk_bf16_f32 v24, v24, v25
    v_cvt_pk_bf16_f32 v28, v28, v29
    v_accvgpr_write_b32 a30, v24
    v_accvgpr_write_b32 a31, v28
    s_waitcnt vmcnt(23)
    v_accvgpr_read_b32 v26, a32
    v_accvgpr_read_b32 v27, a33
    v_lshlrev_b32 v24, 16, v26
    v_lshlrev_b32 v28, 16, v27
    v_and_b32 v25, s38, v26
    v_and_b32 v29, s38, v27
    v_pk_mul_f32 v[24:25], v[24:25], s[36:37]
    v_pk_mul_f32 v[28:29], v[28:29], s[36:37]
    v_cvt_pk_bf16_f32 v24, v24, v25
    v_cvt_pk_bf16_f32 v28, v28, v29
    v_accvgpr_write_b32 a32, v24
    v_accvgpr_write_b32 a33, v28
    v_accvgpr_read_b32 v26, a34
    v_accvgpr_read_b32 v27, a35
    v_lshlrev_b32 v24, 16, v26
    v_lshlrev_b32 v28, 16, v27
    v_and_b32 v25, s38, v26
    v_and_b32 v29, s38, v27
    v_pk_mul_f32 v[24:25], v[24:25], s[36:37]
    v_pk_mul_f32 v[28:29], v[28:29], s[36:37]
    v_cvt_pk_bf16_f32 v24, v24, v25
    v_cvt_pk_bf16_f32 v28, v28, v29
    v_accvgpr_write_b32 a34, v24
    v_accvgpr_write_b32 a35, v28
    s_waitcnt vmcnt(22)
    v_accvgpr_read_b32 v26, a36
    v_accvgpr_read_b32 v27, a37
    v_lshlrev_b32 v24, 16, v26
    v_lshlrev_b32 v28, 16, v27
    v_and_b32 v25, s38, v26
    v_and_b32 v29, s38, v27
    v_pk_mul_f32 v[24:25], v[24:25], s[36:37]
    v_pk_mul_f32 v[28:29], v[28:29], s[36:37]
    v_cvt_pk_bf16_f32 v24, v24, v25
    v_cvt_pk_bf16_f32 v28, v28, v29
    v_accvgpr_write_b32 a36, v24
    v_accvgpr_write_b32 a37, v28
    v_accvgpr_read_b32 v26, a38
    v_accvgpr_read_b32 v27, a39
    v_lshlrev_b32 v24, 16, v26
    v_lshlrev_b32 v28, 16, v27
    v_and_b32 v25, s38, v26
    v_and_b32 v29, s38, v27
    v_pk_mul_f32 v[24:25], v[24:25], s[36:37]
    v_pk_mul_f32 v[28:29], v[28:29], s[36:37]
    v_cvt_pk_bf16_f32 v24, v24, v25
    v_cvt_pk_bf16_f32 v28, v28, v29
    v_accvgpr_write_b32 a38, v24
    v_accvgpr_write_b32 a39, v28
    s_waitcnt vmcnt(21)
    v_accvgpr_read_b32 v26, a40
    v_accvgpr_read_b32 v27, a41
    v_lshlrev_b32 v24, 16, v26
    v_lshlrev_b32 v28, 16, v27
    v_and_b32 v25, s38, v26
    v_and_b32 v29, s38, v27
    v_pk_mul_f32 v[24:25], v[24:25], s[36:37]
    v_pk_mul_f32 v[28:29], v[28:29], s[36:37]
    v_cvt_pk_bf16_f32 v24, v24, v25
    v_cvt_pk_bf16_f32 v28, v28, v29
    v_accvgpr_write_b32 a40, v24
    v_accvgpr_write_b32 a41, v28
    v_accvgpr_read_b32 v26, a42
    v_accvgpr_read_b32 v27, a43
    v_lshlrev_b32 v24, 16, v26
    v_lshlrev_b32 v28, 16, v27
    v_and_b32 v25, s38, v26
    v_and_b32 v29, s38, v27
    v_pk_mul_f32 v[24:25], v[24:25], s[36:37]
    v_pk_mul_f32 v[28:29], v[28:29], s[36:37]
    v_cvt_pk_bf16_f32 v24, v24, v25
    v_cvt_pk_bf16_f32 v28, v28, v29
    v_accvgpr_write_b32 a42, v24
    v_accvgpr_write_b32 a43, v28
    s_waitcnt vmcnt(20)
    v_accvgpr_read_b32 v26, a44
    v_accvgpr_read_b32 v27, a45
    v_lshlrev_b32 v24, 16, v26
    v_lshlrev_b32 v28, 16, v27
    v_and_b32 v25, s38, v26
    v_and_b32 v29, s38, v27
    v_pk_mul_f32 v[24:25], v[24:25], s[36:37]
    v_pk_mul_f32 v[28:29], v[28:29], s[36:37]
    v_cvt_pk_bf16_f32 v24, v24, v25
    v_cvt_pk_bf16_f32 v28, v28, v29
    v_accvgpr_write_b32 a44, v24
    v_accvgpr_write_b32 a45, v28
    v_accvgpr_read_b32 v26, a46
    v_accvgpr_read_b32 v27, a47
    v_lshlrev_b32 v24, 16, v26
    v_lshlrev_b32 v28, 16, v27
    v_and_b32 v25, s38, v26
    v_and_b32 v29, s38, v27
    v_pk_mul_f32 v[24:25], v[24:25], s[36:37]
    v_pk_mul_f32 v[28:29], v[28:29], s[36:37]
    v_cvt_pk_bf16_f32 v24, v24, v25
    v_cvt_pk_bf16_f32 v28, v28, v29
    v_accvgpr_write_b32 a46, v24
    v_accvgpr_write_b32 a47, v28
    s_waitcnt vmcnt(19)
    v_accvgpr_read_b32 v26, a48
    v_accvgpr_read_b32 v27, a49
    v_lshlrev_b32 v24, 16, v26
    v_lshlrev_b32 v28, 16, v27
    v_and_b32 v25, s38, v26
    v_and_b32 v29, s38, v27
    v_pk_mul_f32 v[24:25], v[24:25], s[36:37]
    v_pk_mul_f32 v[28:29], v[28:29], s[36:37]
    v_cvt_pk_bf16_f32 v24, v24, v25
    v_cvt_pk_bf16_f32 v28, v28, v29
    v_accvgpr_write_b32 a48, v24
    v_accvgpr_write_b32 a49, v28
    v_accvgpr_read_b32 v26, a50
    v_accvgpr_read_b32 v27, a51
    v_lshlrev_b32 v24, 16, v26
    v_lshlrev_b32 v28, 16, v27
    v_and_b32 v25, s38, v26
    v_and_b32 v29, s38, v27
    v_pk_mul_f32 v[24:25], v[24:25], s[36:37]
    v_pk_mul_f32 v[28:29], v[28:29], s[36:37]
    v_cvt_pk_bf16_f32 v24, v24, v25
    v_cvt_pk_bf16_f32 v28, v28, v29
    v_accvgpr_write_b32 a50, v24
    v_accvgpr_write_b32 a51, v28
    s_waitcnt vmcnt(18)
    v_accvgpr_read_b32 v26, a52
    v_accvgpr_read_b32 v27, a53
    v_lshlrev_b32 v24, 16, v26
    v_lshlrev_b32 v28, 16, v27
    v_and_b32 v25, s38, v26
    v_and_b32 v29, s38, v27
    v_pk_mul_f32 v[24:25], v[24:25], s[36:37]
    v_pk_mul_f32 v[28:29], v[28:29], s[36:37]
    v_cvt_pk_bf16_f32 v24, v24, v25
    v_cvt_pk_bf16_f32 v28, v28, v29
    v_accvgpr_write_b32 a52, v24
    v_accvgpr_write_b32 a53, v28
    v_accvgpr_read_b32 v26, a54
    v_accvgpr_read_b32 v27, a55
    v_lshlrev_b32 v24, 16, v26
    v_lshlrev_b32 v28, 16, v27
    v_and_b32 v25, s38, v26
    v_and_b32 v29, s38, v27
    v_pk_mul_f32 v[24:25], v[24:25], s[36:37]
    v_pk_mul_f32 v[28:29], v[28:29], s[36:37]
    v_cvt_pk_bf16_f32 v24, v24, v25
    v_cvt_pk_bf16_f32 v28, v28, v29
    v_accvgpr_write_b32 a54, v24
    v_accvgpr_write_b32 a55, v28
    s_waitcnt vmcnt(17)
    v_accvgpr_read_b32 v26, a56
    v_accvgpr_read_b32 v27, a57
    v_lshlrev_b32 v24, 16, v26
    v_lshlrev_b32 v28, 16, v27
    v_and_b32 v25, s38, v26
    v_and_b32 v29, s38, v27
    v_pk_mul_f32 v[24:25], v[24:25], s[36:37]
    v_pk_mul_f32 v[28:29], v[28:29], s[36:37]
    v_cvt_pk_bf16_f32 v24, v24, v25
    v_cvt_pk_bf16_f32 v28, v28, v29
    v_accvgpr_write_b32 a56, v24
    v_accvgpr_write_b32 a57, v28
    v_accvgpr_read_b32 v26, a58
    v_accvgpr_read_b32 v27, a59
    v_lshlrev_b32 v24, 16, v26
    v_lshlrev_b32 v28, 16, v27
    v_and_b32 v25, s38, v26
    v_and_b32 v29, s38, v27
    v_pk_mul_f32 v[24:25], v[24:25], s[36:37]
    v_pk_mul_f32 v[28:29], v[28:29], s[36:37]
    v_cvt_pk_bf16_f32 v24, v24, v25
    v_cvt_pk_bf16_f32 v28, v28, v29
    v_accvgpr_write_b32 a58, v24
    v_accvgpr_write_b32 a59, v28
    s_waitcnt vmcnt(16)
    v_accvgpr_read_b32 v26, a60
    v_accvgpr_read_b32 v27, a61
    v_lshlrev_b32 v24, 16, v26
    v_lshlrev_b32 v28, 16, v27
    v_and_b32 v25, s38, v26
    v_and_b32 v29, s38, v27
    v_pk_mul_f32 v[24:25], v[24:25], s[36:37]
    v_pk_mul_f32 v[28:29], v[28:29], s[36:37]
    v_cvt_pk_bf16_f32 v24, v24, v25
    v_cvt_pk_bf16_f32 v28, v28, v29
    v_accvgpr_write_b32 a60, v24
    v_accvgpr_write_b32 a61, v28
    v_accvgpr_read_b32 v26, a62
    v_accvgpr_read_b32 v27, a63
    v_lshlrev_b32 v24, 16, v26
    v_lshlrev_b32 v28, 16, v27
    v_and_b32 v25, s38, v26
    v_and_b32 v29, s38, v27
    v_pk_mul_f32 v[24:25], v[24:25], s[36:37]
    v_pk_mul_f32 v[28:29], v[28:29], s[36:37]
    v_cvt_pk_bf16_f32 v24, v24, v25
    v_cvt_pk_bf16_f32 v28, v28, v29
    v_accvgpr_write_b32 a62, v24
    v_accvgpr_write_b32 a63, v28
    s_waitcnt vmcnt(15)
    v_accvgpr_read_b32 v26, a64
    v_accvgpr_read_b32 v27, a65
    v_lshlrev_b32 v24, 16, v26
    v_lshlrev_b32 v28, 16, v27
    v_and_b32 v25, s38, v26
    v_and_b32 v29, s38, v27
    v_pk_mul_f32 v[24:25], v[24:25], s[36:37]
    v_pk_mul_f32 v[28:29], v[28:29], s[36:37]
    v_cvt_pk_bf16_f32 v24, v24, v25
    v_cvt_pk_bf16_f32 v28, v28, v29
    v_accvgpr_write_b32 a64, v24
    v_accvgpr_write_b32 a65, v28
    v_accvgpr_read_b32 v26, a66
    v_accvgpr_read_b32 v27, a67
    v_lshlrev_b32 v24, 16, v26
    v_lshlrev_b32 v28, 16, v27
    v_and_b32 v25, s38, v26
    v_and_b32 v29, s38, v27
    v_pk_mul_f32 v[24:25], v[24:25], s[36:37]
    v_pk_mul_f32 v[28:29], v[28:29], s[36:37]
    v_cvt_pk_bf16_f32 v24, v24, v25
    v_cvt_pk_bf16_f32 v28, v28, v29
    v_accvgpr_write_b32 a66, v24
    v_accvgpr_write_b32 a67, v28
    s_waitcnt vmcnt(14)
    v_accvgpr_read_b32 v26, a68
    v_accvgpr_read_b32 v27, a69
    v_lshlrev_b32 v24, 16, v26
    v_lshlrev_b32 v28, 16, v27
    v_and_b32 v25, s38, v26
    v_and_b32 v29, s38, v27
    v_pk_mul_f32 v[24:25], v[24:25], s[36:37]
    v_pk_mul_f32 v[28:29], v[28:29], s[36:37]
    v_cvt_pk_bf16_f32 v24, v24, v25
    v_cvt_pk_bf16_f32 v28, v28, v29
    v_accvgpr_write_b32 a68, v24
    v_accvgpr_write_b32 a69, v28
    v_accvgpr_read_b32 v26, a70
    v_accvgpr_read_b32 v27, a71
    v_lshlrev_b32 v24, 16, v26
    v_lshlrev_b32 v28, 16, v27
    v_and_b32 v25, s38, v26
    v_and_b32 v29, s38, v27
    v_pk_mul_f32 v[24:25], v[24:25], s[36:37]
    v_pk_mul_f32 v[28:29], v[28:29], s[36:37]
    v_cvt_pk_bf16_f32 v24, v24, v25
    v_cvt_pk_bf16_f32 v28, v28, v29
    v_accvgpr_write_b32 a70, v24
    v_accvgpr_write_b32 a71, v28
    s_waitcnt vmcnt(13)
    v_accvgpr_read_b32 v26, a72
    v_accvgpr_read_b32 v27, a73
    v_lshlrev_b32 v24, 16, v26
    v_lshlrev_b32 v28, 16, v27
    v_and_b32 v25, s38, v26
    v_and_b32 v29, s38, v27
    v_pk_mul_f32 v[24:25], v[24:25], s[36:37]
    v_pk_mul_f32 v[28:29], v[28:29], s[36:37]
    v_cvt_pk_bf16_f32 v24, v24, v25
    v_cvt_pk_bf16_f32 v28, v28, v29
    v_accvgpr_write_b32 a72, v24
    v_accvgpr_write_b32 a73, v28
    v_accvgpr_read_b32 v26, a74
    v_accvgpr_read_b32 v27, a75
    v_lshlrev_b32 v24, 16, v26
    v_lshlrev_b32 v28, 16, v27
    v_and_b32 v25, s38, v26
    v_and_b32 v29, s38, v27
    v_pk_mul_f32 v[24:25], v[24:25], s[36:37]
    v_pk_mul_f32 v[28:29], v[28:29], s[36:37]
    v_cvt_pk_bf16_f32 v24, v24, v25
    v_cvt_pk_bf16_f32 v28, v28, v29
    v_accvgpr_write_b32 a74, v24
    v_accvgpr_write_b32 a75, v28
    s_waitcnt vmcnt(12)
    v_accvgpr_read_b32 v26, a76
    v_accvgpr_read_b32 v27, a77
    v_lshlrev_b32 v24, 16, v26
    v_lshlrev_b32 v28, 16, v27
    v_and_b32 v25, s38, v26
    v_and_b32 v29, s38, v27
    v_pk_mul_f32 v[24:25], v[24:25], s[36:37]
    v_pk_mul_f32 v[28:29], v[28:29], s[36:37]
    v_cvt_pk_bf16_f32 v24, v24, v25
    v_cvt_pk_bf16_f32 v28, v28, v29
    v_accvgpr_write_b32 a76, v24
    v_accvgpr_write_b32 a77, v28
    v_accvgpr_read_b32 v26, a78
    v_accvgpr_read_b32 v27, a79
    v_lshlrev_b32 v24, 16, v26
    v_lshlrev_b32 v28, 16, v27
    v_and_b32 v25, s38, v26
    v_and_b32 v29, s38, v27
    v_pk_mul_f32 v[24:25], v[24:25], s[36:37]
    v_pk_mul_f32 v[28:29], v[28:29], s[36:37]
    v_cvt_pk_bf16_f32 v24, v24, v25
    v_cvt_pk_bf16_f32 v28, v28, v29
    v_accvgpr_write_b32 a78, v24
    v_accvgpr_write_b32 a79, v28
    s_waitcnt vmcnt(11)
    v_accvgpr_read_b32 v26, a80
    v_accvgpr_read_b32 v27, a81
    v_lshlrev_b32 v24, 16, v26
    v_lshlrev_b32 v28, 16, v27
    v_and_b32 v25, s38, v26
    v_and_b32 v29, s38, v27
    v_pk_mul_f32 v[24:25], v[24:25], s[36:37]
    v_pk_mul_f32 v[28:29], v[28:29], s[36:37]
    v_cvt_pk_bf16_f32 v24, v24, v25
    v_cvt_pk_bf16_f32 v28, v28, v29
    v_accvgpr_write_b32 a80, v24
    v_accvgpr_write_b32 a81, v28
    v_accvgpr_read_b32 v26, a82
    v_accvgpr_read_b32 v27, a83
    v_lshlrev_b32 v24, 16, v26
    v_lshlrev_b32 v28, 16, v27
    v_and_b32 v25, s38, v26
    v_and_b32 v29, s38, v27
    v_pk_mul_f32 v[24:25], v[24:25], s[36:37]
    v_pk_mul_f32 v[28:29], v[28:29], s[36:37]
    v_cvt_pk_bf16_f32 v24, v24, v25
    v_cvt_pk_bf16_f32 v28, v28, v29
    v_accvgpr_write_b32 a82, v24
    v_accvgpr_write_b32 a83, v28
    s_waitcnt vmcnt(10)
    v_accvgpr_read_b32 v26, a84
    v_accvgpr_read_b32 v27, a85
    v_lshlrev_b32 v24, 16, v26
    v_lshlrev_b32 v28, 16, v27
    v_and_b32 v25, s38, v26
    v_and_b32 v29, s38, v27
    v_pk_mul_f32 v[24:25], v[24:25], s[36:37]
    v_pk_mul_f32 v[28:29], v[28:29], s[36:37]
    v_cvt_pk_bf16_f32 v24, v24, v25
    v_cvt_pk_bf16_f32 v28, v28, v29
    v_accvgpr_write_b32 a84, v24
    v_accvgpr_write_b32 a85, v28
    v_accvgpr_read_b32 v26, a86
    v_accvgpr_read_b32 v27, a87
    v_lshlrev_b32 v24, 16, v26
    v_lshlrev_b32 v28, 16, v27
    v_and_b32 v25, s38, v26
    v_and_b32 v29, s38, v27
    v_pk_mul_f32 v[24:25], v[24:25], s[36:37]
    v_pk_mul_f32 v[28:29], v[28:29], s[36:37]
    v_cvt_pk_bf16_f32 v24, v24, v25
    v_cvt_pk_bf16_f32 v28, v28, v29
    v_accvgpr_write_b32 a86, v24
    v_accvgpr_write_b32 a87, v28
    s_waitcnt vmcnt(9)
    v_accvgpr_read_b32 v26, a88
    v_accvgpr_read_b32 v27, a89
    v_lshlrev_b32 v24, 16, v26
    v_lshlrev_b32 v28, 16, v27
    v_and_b32 v25, s38, v26
    v_and_b32 v29, s38, v27
    v_pk_mul_f32 v[24:25], v[24:25], s[36:37]
    v_pk_mul_f32 v[28:29], v[28:29], s[36:37]
    v_cvt_pk_bf16_f32 v24, v24, v25
    v_cvt_pk_bf16_f32 v28, v28, v29
    v_accvgpr_write_b32 a88, v24
    v_accvgpr_write_b32 a89, v28
    v_accvgpr_read_b32 v26, a90
    v_accvgpr_read_b32 v27, a91
    v_lshlrev_b32 v24, 16, v26
    v_lshlrev_b32 v28, 16, v27
    v_and_b32 v25, s38, v26
    v_and_b32 v29, s38, v27
    v_pk_mul_f32 v[24:25], v[24:25], s[36:37]
    v_pk_mul_f32 v[28:29], v[28:29], s[36:37]
    v_cvt_pk_bf16_f32 v24, v24, v25
    v_cvt_pk_bf16_f32 v28, v28, v29
    v_accvgpr_write_b32 a90, v24
    v_accvgpr_write_b32 a91, v28
    s_waitcnt vmcnt(8)
    v_accvgpr_read_b32 v26, a92
    v_accvgpr_read_b32 v27, a93
    v_lshlrev_b32 v24, 16, v26
    v_lshlrev_b32 v28, 16, v27
    v_and_b32 v25, s38, v26
    v_and_b32 v29, s38, v27
    v_pk_mul_f32 v[24:25], v[24:25], s[36:37]
    v_pk_mul_f32 v[28:29], v[28:29], s[36:37]
    v_cvt_pk_bf16_f32 v24, v24, v25
    v_cvt_pk_bf16_f32 v28, v28, v29
    v_accvgpr_write_b32 a92, v24
    v_accvgpr_write_b32 a93, v28
    v_accvgpr_read_b32 v26, a94
    v_accvgpr_read_b32 v27, a95
    v_lshlrev_b32 v24, 16, v26
    v_lshlrev_b32 v28, 16, v27
    v_and_b32 v25, s38, v26
    v_and_b32 v29, s38, v27
    v_pk_mul_f32 v[24:25], v[24:25], s[36:37]
    v_pk_mul_f32 v[28:29], v[28:29], s[36:37]
    v_cvt_pk_bf16_f32 v24, v24, v25
    v_cvt_pk_bf16_f32 v28, v28, v29
    v_accvgpr_write_b32 a94, v24
    v_accvgpr_write_b32 a95, v28
    s_waitcnt vmcnt(7)
    v_accvgpr_read_b32 v26, a96
    v_accvgpr_read_b32 v27, a97
    v_lshlrev_b32 v24, 16, v26
    v_lshlrev_b32 v28, 16, v27
    v_and_b32 v25, s38, v26
    v_and_b32 v29, s38, v27
    v_pk_mul_f32 v[24:25], v[24:25], s[36:37]
    v_pk_mul_f32 v[28:29], v[28:29], s[36:37]
    v_cvt_pk_bf16_f32 v24, v24, v25
    v_cvt_pk_bf16_f32 v28, v28, v29
    v_accvgpr_write_b32 a96, v24
    v_accvgpr_write_b32 a97, v28
    v_accvgpr_read_b32 v26, a98
    v_accvgpr_read_b32 v27, a99
    v_lshlrev_b32 v24, 16, v26
    v_lshlrev_b32 v28, 16, v27
    v_and_b32 v25, s38, v26
    v_and_b32 v29, s38, v27
    v_pk_mul_f32 v[24:25], v[24:25], s[36:37]
    v_pk_mul_f32 v[28:29], v[28:29], s[36:37]
    v_cvt_pk_bf16_f32 v24, v24, v25
    v_cvt_pk_bf16_f32 v28, v28, v29
    v_accvgpr_write_b32 a98, v24
    v_accvgpr_write_b32 a99, v28
    s_waitcnt vmcnt(6)
    v_accvgpr_read_b32 v26, a100
    v_accvgpr_read_b32 v27, a101
    v_lshlrev_b32 v24, 16, v26
    v_lshlrev_b32 v28, 16, v27
    v_and_b32 v25, s38, v26
    v_and_b32 v29, s38, v27
    v_pk_mul_f32 v[24:25], v[24:25], s[36:37]
    v_pk_mul_f32 v[28:29], v[28:29], s[36:37]
    v_cvt_pk_bf16_f32 v24, v24, v25
    v_cvt_pk_bf16_f32 v28, v28, v29
    v_accvgpr_write_b32 a100, v24
    v_accvgpr_write_b32 a101, v28
    v_accvgpr_read_b32 v26, a102
    v_accvgpr_read_b32 v27, a103
    v_lshlrev_b32 v24, 16, v26
    v_lshlrev_b32 v28, 16, v27
    v_and_b32 v25, s38, v26
    v_and_b32 v29, s38, v27
    v_pk_mul_f32 v[24:25], v[24:25], s[36:37]
    v_pk_mul_f32 v[28:29], v[28:29], s[36:37]
    v_cvt_pk_bf16_f32 v24, v24, v25
    v_cvt_pk_bf16_f32 v28, v28, v29
    v_accvgpr_write_b32 a102, v24
    v_accvgpr_write_b32 a103, v28
    s_waitcnt vmcnt(5)
    v_accvgpr_read_b32 v26, a104
    v_accvgpr_read_b32 v27, a105
    v_lshlrev_b32 v24, 16, v26
    v_lshlrev_b32 v28, 16, v27
    v_and_b32 v25, s38, v26
    v_and_b32 v29, s38, v27
    v_pk_mul_f32 v[24:25], v[24:25], s[36:37]
    v_pk_mul_f32 v[28:29], v[28:29], s[36:37]
    v_cvt_pk_bf16_f32 v24, v24, v25
    v_cvt_pk_bf16_f32 v28, v28, v29
    v_accvgpr_write_b32 a104, v24
    v_accvgpr_write_b32 a105, v28
    v_accvgpr_read_b32 v26, a106
    v_accvgpr_read_b32 v27, a107
    v_lshlrev_b32 v24, 16, v26
    v_lshlrev_b32 v28, 16, v27
    v_and_b32 v25, s38, v26
    v_and_b32 v29, s38, v27
    v_pk_mul_f32 v[24:25], v[24:25], s[36:37]
    v_pk_mul_f32 v[28:29], v[28:29], s[36:37]
    v_cvt_pk_bf16_f32 v24, v24, v25
    v_cvt_pk_bf16_f32 v28, v28, v29
    v_accvgpr_write_b32 a106, v24
    v_accvgpr_write_b32 a107, v28
    s_waitcnt vmcnt(4)
    v_accvgpr_read_b32 v26, a108
    v_accvgpr_read_b32 v27, a109
    v_lshlrev_b32 v24, 16, v26
    v_lshlrev_b32 v28, 16, v27
    v_and_b32 v25, s38, v26
    v_and_b32 v29, s38, v27
    v_pk_mul_f32 v[24:25], v[24:25], s[36:37]
    v_pk_mul_f32 v[28:29], v[28:29], s[36:37]
    v_cvt_pk_bf16_f32 v24, v24, v25
    v_cvt_pk_bf16_f32 v28, v28, v29
    v_accvgpr_write_b32 a108, v24
    v_accvgpr_write_b32 a109, v28
    v_accvgpr_read_b32 v26, a110
    v_accvgpr_read_b32 v27, a111
    v_lshlrev_b32 v24, 16, v26
    v_lshlrev_b32 v28, 16, v27
    v_and_b32 v25, s38, v26
    v_and_b32 v29, s38, v27
    v_pk_mul_f32 v[24:25], v[24:25], s[36:37]
    v_pk_mul_f32 v[28:29], v[28:29], s[36:37]
    v_cvt_pk_bf16_f32 v24, v24, v25
    v_cvt_pk_bf16_f32 v28, v28, v29
    v_accvgpr_write_b32 a110, v24
    v_accvgpr_write_b32 a111, v28
    s_waitcnt vmcnt(3)
    v_accvgpr_read_b32 v26, a112
    v_accvgpr_read_b32 v27, a113
    v_lshlrev_b32 v24, 16, v26
    v_lshlrev_b32 v28, 16, v27
    v_and_b32 v25, s38, v26
    v_and_b32 v29, s38, v27
    v_pk_mul_f32 v[24:25], v[24:25], s[36:37]
    v_pk_mul_f32 v[28:29], v[28:29], s[36:37]
    v_cvt_pk_bf16_f32 v24, v24, v25
    v_cvt_pk_bf16_f32 v28, v28, v29
    v_accvgpr_write_b32 a112, v24
    v_accvgpr_write_b32 a113, v28
    v_accvgpr_read_b32 v26, a114
    v_accvgpr_read_b32 v27, a115
    v_lshlrev_b32 v24, 16, v26
    v_lshlrev_b32 v28, 16, v27
    v_and_b32 v25, s38, v26
    v_and_b32 v29, s38, v27
    v_pk_mul_f32 v[24:25], v[24:25], s[36:37]
    v_pk_mul_f32 v[28:29], v[28:29], s[36:37]
    v_cvt_pk_bf16_f32 v24, v24, v25
    v_cvt_pk_bf16_f32 v28, v28, v29
    v_accvgpr_write_b32 a114, v24
    v_accvgpr_write_b32 a115, v28
    s_waitcnt vmcnt(2)
    v_accvgpr_read_b32 v26, a116
    v_accvgpr_read_b32 v27, a117
    v_lshlrev_b32 v24, 16, v26
    v_lshlrev_b32 v28, 16, v27
    v_and_b32 v25, s38, v26
    v_and_b32 v29, s38, v27
    v_pk_mul_f32 v[24:25], v[24:25], s[36:37]
    v_pk_mul_f32 v[28:29], v[28:29], s[36:37]
    v_cvt_pk_bf16_f32 v24, v24, v25
    v_cvt_pk_bf16_f32 v28, v28, v29
    v_accvgpr_write_b32 a116, v24
    v_accvgpr_write_b32 a117, v28
    v_accvgpr_read_b32 v26, a118
    v_accvgpr_read_b32 v27, a119
    v_lshlrev_b32 v24, 16, v26
    v_lshlrev_b32 v28, 16, v27
    v_and_b32 v25, s38, v26
    v_and_b32 v29, s38, v27
    v_pk_mul_f32 v[24:25], v[24:25], s[36:37]
    v_pk_mul_f32 v[28:29], v[28:29], s[36:37]
    v_cvt_pk_bf16_f32 v24, v24, v25
    v_cvt_pk_bf16_f32 v28, v28, v29
    v_accvgpr_write_b32 a118, v24
    v_accvgpr_write_b32 a119, v28
    s_waitcnt vmcnt(1)
    v_accvgpr_read_b32 v26, a120
    v_accvgpr_read_b32 v27, a121
    v_lshlrev_b32 v24, 16, v26
    v_lshlrev_b32 v28, 16, v27
    v_and_b32 v25, s38, v26
    v_and_b32 v29, s38, v27
    v_pk_mul_f32 v[24:25], v[24:25], s[36:37]
    v_pk_mul_f32 v[28:29], v[28:29], s[36:37]
    v_cvt_pk_bf16_f32 v24, v24, v25
    v_cvt_pk_bf16_f32 v28, v28, v29
    v_accvgpr_write_b32 a120, v24
    v_accvgpr_write_b32 a121, v28
    v_accvgpr_read_b32 v26, a122
    v_accvgpr_read_b32 v27, a123
    v_lshlrev_b32 v24, 16, v26
    v_lshlrev_b32 v28, 16, v27
    v_and_b32 v25, s38, v26
    v_and_b32 v29, s38, v27
    v_pk_mul_f32 v[24:25], v[24:25], s[36:37]
    v_pk_mul_f32 v[28:29], v[28:29], s[36:37]
    v_cvt_pk_bf16_f32 v24, v24, v25
    v_cvt_pk_bf16_f32 v28, v28, v29
    v_accvgpr_write_b32 a122, v24
    v_accvgpr_write_b32 a123, v28
    s_waitcnt vmcnt(0)
    v_accvgpr_read_b32 v26, a124
    v_accvgpr_read_b32 v27, a125
    v_lshlrev_b32 v24, 16, v26
    v_lshlrev_b32 v28, 16, v27
    v_and_b32 v25, s38, v26
    v_and_b32 v29, s38, v27
    v_pk_mul_f32 v[24:25], v[24:25], s[36:37]
    v_pk_mul_f32 v[28:29], v[28:29], s[36:37]
    v_cvt_pk_bf16_f32 v24, v24, v25
    v_cvt_pk_bf16_f32 v28, v28, v29
    v_accvgpr_write_b32 a124, v24
    v_accvgpr_write_b32 a125, v28
    v_accvgpr_read_b32 v26, a126
    v_accvgpr_read_b32 v27, a127
    v_lshlrev_b32 v24, 16, v26
    v_lshlrev_b32 v28, 16, v27
    v_and_b32 v25, s38, v26
    v_and_b32 v29, s38, v27
    v_pk_mul_f32 v[24:25], v[24:25], s[36:37]
    v_pk_mul_f32 v[28:29], v[28:29], s[36:37]
    v_cvt_pk_bf16_f32 v24, v24, v25
    v_cvt_pk_bf16_f32 v28, v28, v29
    v_accvgpr_write_b32 a126, v24
    v_accvgpr_write_b32 a127, v28
L_slow_loop:
    s_add_u32 s26, s21, 4096
    buffer_load_dwordx4 v[72:75], v240, s[4:7], s21 offen offset:0
    buffer_load_dwordx4 v[76:79], v240, s[4:7], s21 offen offset:64
    buffer_load_dwordx4 v[80:83], v240, s[4:7], s21 offen offset:128
    buffer_load_dwordx4 v[84:87], v240, s[4:7], s21 offen offset:192
    buffer_load_dwordx4 v[88:91], v240, s[4:7], s26 offen offset:0
    buffer_load_dwordx4 v[92:95], v240, s[4:7], s26 offen offset:64
    buffer_load_dwordx4 v[96:99], v240, s[4:7], s26 offen offset:128
    buffer_load_dwordx4 v[100:103], v240, s[4:7], s26 offen offset:192
    s_waitcnt vmcnt(7)
    v_mfma_f32_16x16x32_bf16 v[176:179], a[0:3], v[72:75], 0
    s_waitcnt vmcnt(6)
    v_mfma_f32_16x16x32_bf16 v[176:179], a[4:7], v[76:79], v[176:179]
    s_waitcnt vmcnt(5)
    v_mfma_f32_16x16x32_bf16 v[176:179], a[8:11], v[80:83], v[176:179]
    s_waitcnt vmcnt(4)
    v_mfma_f32_16x16x32_bf16 v[176:179], a[12:15], v[84:87], v[176:179]
    v_mfma_f32_16x16x32_bf16 v[180:183], a[16:19], v[72:75], 0
    v_mfma_f32_16x16x32_bf16 v[180:183], a[20:23], v[76:79], v[180:183]
    v_mfma_f32_16x16x32_bf16 v[180:183], a[24:27], v[80:83], v[180:183]
    v_mfma_f32_16x16x32_bf16 v[180:183], a[28:31], v[84:87], v[180:183]
    v_mfma_f32_16x16x32_bf16 v[184:187], a[32:35], v[72:75], 0
    v_mfma_f32_16x16x32_bf16 v[184:187], a[36:39], v[76:79], v[184:187]
    v_mfma_f32_16x16x32_bf16 v[184:187], a[40:43], v[80:83], v[184:187]
    v_mfma_f32_16x16x32_bf16 v[184:187], a[44:47], v[84:87], v[184:187]
    v_mfma_f32_16x16x32_bf16 v[188:191], a[48:51], v[72:75], 0
    v_mfma_f32_16x16x32_bf16 v[188:191], a[52:55], v[76:79], v[188:191]
    v_mfma_f32_16x16x32_bf16 v[188:191], a[56:59], v[80:83], v[188:191]
    v_mfma_f32_16x16x32_bf16 v[188:191], a[60:63], v[84:87], v[188:191]
    v_mfma_f32_16x16x32_bf16 v[192:195], a[64:67], v[72:75], 0
    v_mfma_f32_16x16x32_bf16 v[192:195], a[68:71], v[76:79], v[192:195]
    v_mfma_f32_16x16x32_bf16 v[192:195], a[72:75], v[80:83], v[192:195]
    v_mfma_f32_16x16x32_bf16 v[192:195], a[76:79], v[84:87], v[192:195]
    v_mfma_f32_16x16x32_bf16 v[196:199], a[80:83], v[72:75], 0
    v_mfma_f32_16x16x32_bf16 v[196:199], a[84:87], v[76:79], v[196:199]
    v_mfma_f32_16x16x32_bf16 v[196:199], a[88:91], v[80:83], v[196:199]
    v_mfma_f32_16x16x32_bf16 v[196:199], a[92:95], v[84:87], v[196:199]
    v_mfma_f32_16x16x32_bf16 v[200:203], a[96:99], v[72:75], 0
    v_mfma_f32_16x16x32_bf16 v[200:203], a[100:103], v[76:79], v[200:203]
    v_mfma_f32_16x16x32_bf16 v[200:203], a[104:107], v[80:83], v[200:203]
    v_mfma_f32_16x16x32_bf16 v[200:203], a[108:111], v[84:87], v[200:203]
    v_mfma_f32_16x16x32_bf16 v[204:207], a[112:115], v[72:75], 0
    v_mfma_f32_16x16x32_bf16 v[204:207], a[116:119], v[76:79], v[204:207]
    v_mfma_f32_16x16x32_bf16 v[204:207], a[120:123], v[80:83], v[204:207]
    v_mfma_f32_16x16x32_bf16 v[204:207], a[124:127], v[84:87], v[204:207]
    s_waitcnt vmcnt(3)
    v_mfma_f32_16x16x32_bf16 v[208:211], a[0:3], v[88:91], 0
    s_waitcnt vmcnt(2)
    v_mfma_f32_16x16x32_bf16 v[208:211], a[4:7], v[92:95], v[208:211]
    s_waitcnt vmcnt(1)
    v_mfma_f32_16x16x32_bf16 v[208:211], a[8:11], v[96:99], v[208:211]
    s_waitcnt vmcnt(0)
    v_mfma_f32_16x16x32_bf16 v[208:211], a[12:15], v[100:103], v[208:211]
    v_mfma_f32_16x16x32_bf16 v[212:215], a[16:19], v[88:91], 0
    v_mfma_f32_16x16x32_bf16 v[212:215], a[20:23], v[92:95], v[212:215]
    v_mfma_f32_16x16x32_bf16 v[212:215], a[24:27], v[96:99], v[212:215]
    v_mfma_f32_16x16x32_bf16 v[212:215], a[28:31], v[100:103], v[212:215]
    v_mfma_f32_16x16x32_bf16 v[216:219], a[32:35], v[88:91], 0
    v_mfma_f32_16x16x32_bf16 v[216:219], a[36:39], v[92:95], v[216:219]
    v_mfma_f32_16x16x32_bf16 v[216:219], a[40:43], v[96:99], v[216:219]
    v_mfma_f32_16x16x32_bf16 v[216:219], a[44:47], v[100:103], v[216:219]
    v_mfma_f32_16x16x32_bf16 v[220:223], a[48:51], v[88:91], 0
    v_mfma_f32_16x16x32_bf16 v[220:223], a[52:55], v[92:95], v[220:223]
    v_mfma_f32_16x16x32_bf16 v[220:223], a[56:59], v[96:99], v[220:223]
    v_mfma_f32_16x16x32_bf16 v[220:223], a[60:63], v[100:103], v[220:223]
    v_mfma_f32_16x16x32_bf16 v[224:227], a[64:67], v[88:91], 0
    v_mfma_f32_16x16x32_bf16 v[224:227], a[68:71], v[92:95], v[224:227]
    v_mfma_f32_16x16x32_bf16 v[224:227], a[72:75], v[96:99], v[224:227]
    v_mfma_f32_16x16x32_bf16 v[224:227], a[76:79], v[100:103], v[224:227]
    v_mfma_f32_16x16x32_bf16 v[228:231], a[80:83], v[88:91], 0
    v_mfma_f32_16x16x32_bf16 v[228:231], a[84:87], v[92:95], v[228:231]
    v_mfma_f32_16x16x32_bf16 v[228:231], a[88:91], v[96:99], v[228:231]
    v_mfma_f32_16x16x32_bf16 v[228:231], a[92:95], v[100:103], v[228:231]
    v_mfma_f32_16x16x32_bf16 v[232:235], a[96:99], v[88:91], 0
    v_mfma_f32_16x16x32_bf16 v[232:235], a[100:103], v[92:95], v[232:235]
    v_mfma_f32_16x16x32_bf16 v[232:235], a[104:107], v[96:99], v[232:235]
    v_mfma_f32_16x16x32_bf16 v[232:235], a[108:111], v[100:103], v[232:235]
    v_mfma_f32_16x16x32_bf16 v[236:239], a[112:115], v[88:91], 0
    v_mfma_f32_16x16x32_bf16 v[236:239], a[116:119], v[92:95], v[236:239]
    v_mfma_f32_16x16x32_bf16 v[236:239], a[120:123], v[96:99], v[236:239]
    v_mfma_f32_16x16x32_bf16 v[236:239], a[124:127], v[100:103], v[236:239]
    v_max_f32 v244, v176, v177
    v_max3_f32 v244, v244, v178, v179
    v_max3_f32 v244, v244, v180, v181
    v_max3_f32 v244, v244, v182, v183
    v_max3_f32 v244, v244, v184, v185
    v_max3_f32 v244, v244, v186, v187
    v_max3_f32 v244, v244, v188, v189
    v_max3_f32 v244, v244, v190, v191
    v_max3_f32 v244, v244, v192, v193
    v_max3_f32 v244, v244, v194, v195
    v_max3_f32 v244, v244, v196, v197
    v_max3_f32 v244, v244, v198, v199
    v_max3_f32 v244, v244, v200, v201
    v_max3_f32 v244, v244, v202, v203
    v_max3_f32 v244, v244, v204, v205
    v_max3_f32 v244, v244, v206, v207
    ds_write_b32 v241, v244 offset:0
    v_max_f32 v245, v208, v209
    v_max3_f32 v245, v245, v210, v211
    v_max3_f32 v245, v245, v212, v213
    v_max3_f32 v245, v245, v214, v215
    v_max3_f32 v245, v245, v216, v217
    v_max3_f32 v245, v245, v218, v219
    v_max3_f32 v245, v245, v220, v221
    v_max3_f32 v245, v245, v222, v223
    v_max3_f32 v245, v245, v224, v225
    v_max3_f32 v245, v245, v226, v227
    v_max3_f32 v245, v245, v228, v229
    v_max3_f32 v245, v245, v230, v231
    v_max3_f32 v245, v245, v232, v233
    v_max3_f32 v245, v245, v234, v235
    v_max3_f32 v245, v245, v236, v237
    v_max3_f32 v245, v245, v238, v239
    ds_write_b32 v241, v245 offset:1024
    s_waitcnt lgkmcnt(0)
    s_barrier
    ds_read_b128 v[136:139], v242 offset:0
    ds_read_b128 v[140:143], v242 offset:16
    ds_read_b128 v[144:147], v242 offset:32
    ds_read_b128 v[148:151], v242 offset:48
    s_waitcnt lgkmcnt(3)
    v_max_f32 v244, v136, v137
    v_max3_f32 v244, v244, v138, v139
    s_waitcnt lgkmcnt(2)
    v_max3_f32 v244, v244, v140, v141
    v_max3_f32 v244, v244, v142, v143
    s_waitcnt lgkmcnt(1)
    v_max3_f32 v244, v244, v144, v145
    v_max3_f32 v244, v244, v146, v147
    s_waitcnt lgkmcnt(0)
    v_max3_f32 v244, v244, v148, v149
    v_max3_f32 v244, v244, v150, v151
    ds_read_b128 v[136:139], v242 offset:1024
    ds_read_b128 v[140:143], v242 offset:1040
    ds_read_b128 v[144:147], v242 offset:1056
    ds_read_b128 v[148:151], v242 offset:1072
    s_waitcnt lgkmcnt(3)
    v_max_f32 v245, v136, v137
    v_max3_f32 v245, v245, v138, v139
    s_waitcnt lgkmcnt(2)
    v_max3_f32 v245, v245, v140, v141
    v_max3_f32 v245, v245, v142, v143
    s_waitcnt lgkmcnt(1)
    v_max3_f32 v245, v245, v144, v145
    v_max3_f32 v245, v245, v146, v147
    s_waitcnt lgkmcnt(0)
    v_max3_f32 v245, v245, v148, v149
    v_max3_f32 v245, v245, v150, v151
    v_sub_f32 v176, v176, v244
    v_sub_f32 v177, v177, v244
    v_sub_f32 v178, v178, v244
    v_sub_f32 v179, v179, v244
    v_sub_f32 v180, v180, v244
    v_sub_f32 v181, v181, v244
    v_sub_f32 v182, v182, v244
    v_sub_f32 v183, v183, v244
    v_sub_f32 v184, v184, v244
    v_sub_f32 v185, v185, v244
    v_sub_f32 v186, v186, v244
    v_sub_f32 v187, v187, v244
    v_sub_f32 v188, v188, v244
    v_sub_f32 v189, v189, v244
    v_sub_f32 v190, v190, v244
    v_sub_f32 v191, v191, v244
    v_sub_f32 v192, v192, v244
    v_sub_f32 v193, v193, v244
    v_sub_f32 v194, v194, v244
    v_sub_f32 v195, v195, v244
    v_sub_f32 v196, v196, v244
    v_sub_f32 v197, v197, v244
    v_sub_f32 v198, v198, v244
    v_sub_f32 v199, v199, v244
    v_sub_f32 v200, v200, v244
    v_sub_f32 v201, v201, v244
    v_sub_f32 v202, v202, v244
    v_sub_f32 v203, v203, v244
    v_sub_f32 v204, v204, v244
    v_sub_f32 v205, v205, v244
    v_sub_f32 v206, v206, v244
    v_sub_f32 v207, v207, v244
    v_exp_f32 v176, v176
    v_exp_f32 v177, v177
    v_exp_f32 v178, v178
    v_exp_f32 v179, v179
    v_exp_f32 v180, v180
    v_exp_f32 v181, v181
    v_exp_f32 v182, v182
    v_exp_f32 v183, v183
    v_exp_f32 v184, v184
    v_exp_f32 v185, v185
    v_exp_f32 v186, v186
    v_exp_f32 v187, v187
    v_exp_f32 v188, v188
    v_exp_f32 v189, v189
    v_exp_f32 v190, v190
    v_exp_f32 v191, v191
    v_exp_f32 v192, v192
    v_exp_f32 v193, v193
    v_exp_f32 v194, v194
    v_exp_f32 v195, v195
    v_exp_f32 v196, v196
    v_exp_f32 v197, v197
    v_exp_f32 v198, v198
    v_exp_f32 v199, v199
    v_exp_f32 v200, v200
    v_exp_f32 v201, v201
    v_exp_f32 v202, v202
    v_exp_f32 v203, v203
    v_exp_f32 v204, v204
    v_exp_f32 v205, v205
    v_exp_f32 v206, v206
    v_exp_f32 v207, v207
    v_cvt_pk_bf16_f32 v104, v176, v177
    v_cvt_pk_bf16_f32 v105, v178, v179
    v_cvt_pk_bf16_f32 v106, v180, v181
    v_cvt_pk_bf16_f32 v107, v182, v183
    v_cvt_pk_bf16_f32 v108, v184, v185
    v_cvt_pk_bf16_f32 v109, v186, v187
    v_cvt_pk_bf16_f32 v110, v188, v189
    v_cvt_pk_bf16_f32 v111, v190, v191
    v_cvt_pk_bf16_f32 v112, v192, v193
    v_cvt_pk_bf16_f32 v113, v194, v195
    v_cvt_pk_bf16_f32 v114, v196, v197
    v_cvt_pk_bf16_f32 v115, v198, v199
    v_cvt_pk_bf16_f32 v116, v200, v201
    v_cvt_pk_bf16_f32 v117, v202, v203
    v_cvt_pk_bf16_f32 v118, v204, v205
    v_cvt_pk_bf16_f32 v119, v206, v207
    ds_write_b128 v1, v[104:107] offset:0
    v_mfma_f32_16x16x32_bf16 v[40:43], v[32:35], v[104:107], 0
    ds_write_b128 v1, v[108:111] offset:1024
    v_mfma_f32_16x16x32_bf16 v[40:43], v[32:35], v[108:111], v[40:43]
    ds_write_b128 v1, v[112:115] offset:2048
    v_mfma_f32_16x16x32_bf16 v[40:43], v[32:35], v[112:115], v[40:43]
    ds_write_b128 v1, v[116:119] offset:3072
    v_mfma_f32_16x16x32_bf16 v[40:43], v[32:35], v[116:119], v[40:43]
    v_sub_f32 v208, v208, v245
    v_sub_f32 v209, v209, v245
    v_sub_f32 v210, v210, v245
    v_sub_f32 v211, v211, v245
    v_sub_f32 v212, v212, v245
    v_sub_f32 v213, v213, v245
    v_sub_f32 v214, v214, v245
    v_sub_f32 v215, v215, v245
    v_sub_f32 v216, v216, v245
    v_sub_f32 v217, v217, v245
    v_sub_f32 v218, v218, v245
    v_sub_f32 v219, v219, v245
    v_sub_f32 v220, v220, v245
    v_sub_f32 v221, v221, v245
    v_sub_f32 v222, v222, v245
    v_sub_f32 v223, v223, v245
    v_sub_f32 v224, v224, v245
    v_sub_f32 v225, v225, v245
    v_sub_f32 v226, v226, v245
    v_sub_f32 v227, v227, v245
    v_sub_f32 v228, v228, v245
    v_sub_f32 v229, v229, v245
    v_sub_f32 v230, v230, v245
    v_sub_f32 v231, v231, v245
    v_sub_f32 v232, v232, v245
    v_sub_f32 v233, v233, v245
    v_sub_f32 v234, v234, v245
    v_sub_f32 v235, v235, v245
    v_sub_f32 v236, v236, v245
    v_sub_f32 v237, v237, v245
    v_sub_f32 v238, v238, v245
    v_sub_f32 v239, v239, v245
    v_exp_f32 v208, v208
    v_exp_f32 v209, v209
    v_exp_f32 v210, v210
    v_exp_f32 v211, v211
    v_exp_f32 v212, v212
    v_exp_f32 v213, v213
    v_exp_f32 v214, v214
    v_exp_f32 v215, v215
    v_exp_f32 v216, v216
    v_exp_f32 v217, v217
    v_exp_f32 v218, v218
    v_exp_f32 v219, v219
    v_exp_f32 v220, v220
    v_exp_f32 v221, v221
    v_exp_f32 v222, v222
    v_exp_f32 v223, v223
    v_exp_f32 v224, v224
    v_exp_f32 v225, v225
    v_exp_f32 v226, v226
    v_exp_f32 v227, v227
    v_exp_f32 v228, v228
    v_exp_f32 v229, v229
    v_exp_f32 v230, v230
    v_exp_f32 v231, v231
    v_exp_f32 v232, v232
    v_exp_f32 v233, v233
    v_exp_f32 v234, v234
    v_exp_f32 v235, v235
    v_exp_f32 v236, v236
    v_exp_f32 v237, v237
    v_exp_f32 v238, v238
    v_exp_f32 v239, v239
    v_cvt_pk_bf16_f32 v120, v208, v209
    v_cvt_pk_bf16_f32 v121, v210, v211
    v_cvt_pk_bf16_f32 v122, v212, v213
    v_cvt_pk_bf16_f32 v123, v214, v215
    v_cvt_pk_bf16_f32 v124, v216, v217
    v_cvt_pk_bf16_f32 v125, v218, v219
    v_cvt_pk_bf16_f32 v126, v220, v221
    v_cvt_pk_bf16_f32 v127, v222, v223
    v_cvt_pk_bf16_f32 v128, v224, v225
    v_cvt_pk_bf16_f32 v129, v226, v227
    v_cvt_pk_bf16_f32 v130, v228, v229
    v_cvt_pk_bf16_f32 v131, v230, v231
    v_cvt_pk_bf16_f32 v132, v232, v233
    v_cvt_pk_bf16_f32 v133, v234, v235
    v_cvt_pk_bf16_f32 v134, v236, v237
    v_cvt_pk_bf16_f32 v135, v238, v239
    ds_write_b128 v1, v[120:123] offset:4096
    v_mfma_f32_16x16x32_bf16 v[40:43], v[36:39], v[120:123], v[40:43]
    ds_write_b128 v1, v[124:127] offset:5120
    v_mfma_f32_16x16x32_bf16 v[40:43], v[36:39], v[124:127], v[40:43]
    ds_write_b128 v1, v[128:131] offset:6144
    v_mfma_f32_16x16x32_bf16 v[40:43], v[36:39], v[128:131], v[40:43]
    ds_write_b128 v1, v[132:135] offset:7168
    v_mfma_f32_16x16x32_bf16 v[40:43], v[36:39], v[132:135], v[40:43]
    s_nop 7
    ds_write_b32 v12, v40
    s_waitcnt lgkmcnt(0)
    s_barrier
    ds_read_b128 v[176:179], v2 offset:0
    ds_read_b128 v[180:183], v2 offset:1024
    ds_read_b128 v[184:187], v2 offset:2048
    ds_read_b128 v[188:191], v2 offset:3072
    ds_read_b128 v[192:195], v3 offset:0
    ds_read_b128 v[196:199], v3 offset:1024
    ds_read_b128 v[200:203], v3 offset:2048
    ds_read_b128 v[204:207], v3 offset:3072
    ds_read_b128 v[208:211], v4 offset:0
    ds_read_b128 v[212:215], v4 offset:1024
    ds_read_b128 v[216:219], v4 offset:2048
    ds_read_b128 v[220:223], v4 offset:3072
    ds_read_b128 v[24:27], v13 offset:0
    v_mfma_f32_16x16x32_bf16 v[48:51], a[128:131], v[104:107], 0
    v_mfma_f32_16x16x32_bf16 v[52:55], a[132:135], v[104:107], 0
    v_mfma_f32_16x16x32_bf16 v[48:51], a[136:139], v[108:111], v[48:51]
    v_mfma_f32_16x16x32_bf16 v[52:55], a[140:143], v[108:111], v[52:55]
    v_mfma_f32_16x16x32_bf16 v[48:51], a[144:147], v[112:115], v[48:51]
    v_mfma_f32_16x16x32_bf16 v[52:55], a[148:151], v[112:115], v[52:55]
    v_mfma_f32_16x16x32_bf16 v[48:51], a[152:155], v[116:119], v[48:51]
    v_mfma_f32_16x16x32_bf16 v[52:55], a[156:159], v[116:119], v[52:55]
    s_waitcnt lgkmcnt(12)
    v_mfma_f32_16x16x32_bf16 v[48:51], a[160:163], v[176:179], v[48:51]
    v_mfma_f32_16x16x32_bf16 v[52:55], a[164:167], v[176:179], v[52:55]
    s_waitcnt lgkmcnt(11)
    v_mfma_f32_16x16x32_bf16 v[48:51], a[168:171], v[180:183], v[48:51]
    v_mfma_f32_16x16x32_bf16 v[52:55], a[172:175], v[180:183], v[52:55]
    s_waitcnt lgkmcnt(10)
    v_mfma_f32_16x16x32_bf16 v[48:51], a[176:179], v[184:187], v[48:51]
    v_mfma_f32_16x16x32_bf16 v[52:55], a[180:183], v[184:187], v[52:55]
    s_waitcnt lgkmcnt(9)
    v_mfma_f32_16x16x32_bf16 v[48:51], a[184:187], v[188:191], v[48:51]
    v_mfma_f32_16x16x32_bf16 v[52:55], a[188:191], v[188:191], v[52:55]
    s_waitcnt lgkmcnt(8)
    v_mfma_f32_16x16x32_bf16 v[48:51], a[192:195], v[192:195], v[48:51]
    v_mfma_f32_16x16x32_bf16 v[52:55], a[196:199], v[192:195], v[52:55]
    s_waitcnt lgkmcnt(7)
    v_mfma_f32_16x16x32_bf16 v[48:51], a[200:203], v[196:199], v[48:51]
    v_mfma_f32_16x16x32_bf16 v[52:55], a[204:207], v[196:199], v[52:55]
    s_waitcnt lgkmcnt(6)
    v_mfma_f32_16x16x32_bf16 v[48:51], a[208:211], v[200:203], v[48:51]
    v_mfma_f32_16x16x32_bf16 v[52:55], a[212:215], v[200:203], v[52:55]
    s_waitcnt lgkmcnt(5)
    v_mfma_f32_16x16x32_bf16 v[48:51], a[216:219], v[204:207], v[48:51]
    v_mfma_f32_16x16x32_bf16 v[52:55], a[220:223], v[204:207], v[52:55]
    s_waitcnt lgkmcnt(4)
    v_mfma_f32_16x16x32_bf16 v[48:51], a[224:227], v[208:211], v[48:51]
    v_mfma_f32_16x16x32_bf16 v[52:55], a[228:231], v[208:211], v[52:55]
    s_waitcnt lgkmcnt(3)
    v_mfma_f32_16x16x32_bf16 v[48:51], a[232:235], v[212:215], v[48:51]
    v_mfma_f32_16x16x32_bf16 v[52:55], a[236:239], v[212:215], v[52:55]
    s_waitcnt lgkmcnt(2)
    v_mfma_f32_16x16x32_bf16 v[48:51], a[240:243], v[216:219], v[48:51]
    v_mfma_f32_16x16x32_bf16 v[52:55], a[244:247], v[216:219], v[52:55]
    s_waitcnt lgkmcnt(1)
    v_mfma_f32_16x16x32_bf16 v[48:51], a[248:251], v[220:223], v[48:51]
    v_mfma_f32_16x16x32_bf16 v[52:55], a[252:255], v[220:223], v[52:55]
    s_waitcnt lgkmcnt(0)
    v_add_f32 v24, v24, v25
    v_add_f32 v26, v26, v27
    v_add_f32 v24, v24, v26
    v_rcp_f32 v20, v24
    s_nop 1
    v_mul_f32 v48, v20, v48
    v_mul_f32 v49, v20, v49
    v_mul_f32 v50, v20, v50
    v_mul_f32 v51, v20, v51
    v_mul_f32 v52, v20, v52
    v_mul_f32 v53, v20, v53
    v_mul_f32 v54, v20, v54
    v_mul_f32 v55, v20, v55
    v_cvt_pk_bf16_f32 v28, v48, v49
    v_cvt_pk_bf16_f32 v29, v50, v51
    v_cvt_pk_bf16_f32 v30, v52, v53
    v_cvt_pk_bf16_f32 v31, v54, v55
    buffer_store_dwordx4 v[28:31], v11, s[8:11], s22 offen
    s_add_u32 s22, s22, 4096
    s_waitcnt vmcnt(0)
    ds_read_b128 v[176:179], v2 offset:4096
    ds_read_b128 v[180:183], v2 offset:5120
    ds_read_b128 v[184:187], v2 offset:6144
    ds_read_b128 v[188:191], v2 offset:7168
    ds_read_b128 v[192:195], v3 offset:4096
    ds_read_b128 v[196:199], v3 offset:5120
    ds_read_b128 v[200:203], v3 offset:6144
    ds_read_b128 v[204:207], v3 offset:7168
    ds_read_b128 v[208:211], v4 offset:4096
    ds_read_b128 v[212:215], v4 offset:5120
    ds_read_b128 v[216:219], v4 offset:6144
    ds_read_b128 v[220:223], v4 offset:7168
    ds_read_b128 v[24:27], v13 offset:256
    v_mfma_f32_16x16x32_bf16 v[48:51], a[128:131], v[120:123], 0
    v_mfma_f32_16x16x32_bf16 v[52:55], a[132:135], v[120:123], 0
    v_mfma_f32_16x16x32_bf16 v[48:51], a[136:139], v[124:127], v[48:51]
    v_mfma_f32_16x16x32_bf16 v[52:55], a[140:143], v[124:127], v[52:55]
    v_mfma_f32_16x16x32_bf16 v[48:51], a[144:147], v[128:131], v[48:51]
    v_mfma_f32_16x16x32_bf16 v[52:55], a[148:151], v[128:131], v[52:55]
    v_mfma_f32_16x16x32_bf16 v[48:51], a[152:155], v[132:135], v[48:51]
    v_mfma_f32_16x16x32_bf16 v[52:55], a[156:159], v[132:135], v[52:55]
    s_waitcnt lgkmcnt(12)
    v_mfma_f32_16x16x32_bf16 v[48:51], a[160:163], v[176:179], v[48:51]
    v_mfma_f32_16x16x32_bf16 v[52:55], a[164:167], v[176:179], v[52:55]
    s_waitcnt lgkmcnt(11)
    v_mfma_f32_16x16x32_bf16 v[48:51], a[168:171], v[180:183], v[48:51]
    v_mfma_f32_16x16x32_bf16 v[52:55], a[172:175], v[180:183], v[52:55]
    s_waitcnt lgkmcnt(10)
    v_mfma_f32_16x16x32_bf16 v[48:51], a[176:179], v[184:187], v[48:51]
    v_mfma_f32_16x16x32_bf16 v[52:55], a[180:183], v[184:187], v[52:55]
    s_waitcnt lgkmcnt(9)
    v_mfma_f32_16x16x32_bf16 v[48:51], a[184:187], v[188:191], v[48:51]
    v_mfma_f32_16x16x32_bf16 v[52:55], a[188:191], v[188:191], v[52:55]
    s_waitcnt lgkmcnt(8)
    v_mfma_f32_16x16x32_bf16 v[48:51], a[192:195], v[192:195], v[48:51]
    v_mfma_f32_16x16x32_bf16 v[52:55], a[196:199], v[192:195], v[52:55]
    s_waitcnt lgkmcnt(7)
    v_mfma_f32_16x16x32_bf16 v[48:51], a[200:203], v[196:199], v[48:51]
    v_mfma_f32_16x16x32_bf16 v[52:55], a[204:207], v[196:199], v[52:55]
    s_waitcnt lgkmcnt(6)
    v_mfma_f32_16x16x32_bf16 v[48:51], a[208:211], v[200:203], v[48:51]
    v_mfma_f32_16x16x32_bf16 v[52:55], a[212:215], v[200:203], v[52:55]
    s_waitcnt lgkmcnt(5)
    v_mfma_f32_16x16x32_bf16 v[48:51], a[216:219], v[204:207], v[48:51]
    v_mfma_f32_16x16x32_bf16 v[52:55], a[220:223], v[204:207], v[52:55]
    s_waitcnt lgkmcnt(4)
    v_mfma_f32_16x16x32_bf16 v[48:51], a[224:227], v[208:211], v[48:51]
    v_mfma_f32_16x16x32_bf16 v[52:55], a[228:231], v[208:211], v[52:55]
    s_waitcnt lgkmcnt(3)
    v_mfma_f32_16x16x32_bf16 v[48:51], a[232:235], v[212:215], v[48:51]
    v_mfma_f32_16x16x32_bf16 v[52:55], a[236:239], v[212:215], v[52:55]
    s_waitcnt lgkmcnt(2)
    v_mfma_f32_16x16x32_bf16 v[48:51], a[240:243], v[216:219], v[48:51]
    v_mfma_f32_16x16x32_bf16 v[52:55], a[244:247], v[216:219], v[52:55]
    s_waitcnt lgkmcnt(1)
    v_mfma_f32_16x16x32_bf16 v[48:51], a[248:251], v[220:223], v[48:51]
    v_mfma_f32_16x16x32_bf16 v[52:55], a[252:255], v[220:223], v[52:55]
    s_waitcnt lgkmcnt(0)
    v_add_f32 v24, v24, v25
    v_add_f32 v26, v26, v27
    v_add_f32 v24, v24, v26
    v_rcp_f32 v20, v24
    s_nop 1
    v_mul_f32 v48, v20, v48
    v_mul_f32 v49, v20, v49
    v_mul_f32 v50, v20, v50
    v_mul_f32 v51, v20, v51
    v_mul_f32 v52, v20, v52
    v_mul_f32 v53, v20, v53
    v_mul_f32 v54, v20, v54
    v_mul_f32 v55, v20, v55
    v_cvt_pk_bf16_f32 v28, v48, v49
    v_cvt_pk_bf16_f32 v29, v50, v51
    v_cvt_pk_bf16_f32 v30, v52, v53
    v_cvt_pk_bf16_f32 v31, v54, v55
    buffer_store_dwordx4 v[28:31], v11, s[8:11], s22 offen
    s_add_u32 s22, s22, 4096
    s_waitcnt vmcnt(0)
    s_add_u32 s21, s21, 8192
    s_cmp_lt_u32 s21, 376832
    s_nop 7
    s_cbranch_scc1 L_slow_loop
    s_branch L_end
.p2align 12
L_entry_b:
    s_getpc_b64 s[62:63]
L_pc_b:
    s_lshr_b32 s40, s2, 3
    s_lshl_b32 s40, s40, 8
    v_add_u32 v249, s40, v0
    v_lshlrev_b32 v249, 6, v249
    v_and_b32 v249, 0xffff, v249
    v_min_u32 v249, L_last_b-L_pc_b-4, v249
    global_load_dword v248, v249, s[62:63]
    s_load_dwordx4 s[28:31], s[0:1], 0
    s_load_dwordx4 s[32:35], s[0:1], 16
    v_lshrrev_b32 v20, 6, v0
    v_and_b32 v21, 63, v0
    v_readfirstlane_b32 s20, v20
    v_lshrrev_b32 v22, 4, v21
    v_and_b32 v23, 15, v21
    v_lshlrev_b32 v24, 4, v21
    s_mul_i32 s26, s2, 376832
    s_lshl_b32 s27, s2, 17
    s_mul_i32 s23, s20, 39168
    s_lshl_b32 s40, s20, 2
    v_add_u32 v25, s40, v22
    v_xor_b32 v26, v25, v23
    v_lshlrev_b32 v26, 4, v26
    v_lshl_add_u32 v9, v25, 8, v26
    v_add_u32 v10, 45056, v9
    v_lshlrev_b32 v30, 8, v23
    v_lshl_add_u32 v30, v22, 4, v30
    v_lshrrev_b32 v31, 2, v21
    v_lshlrev_b32 v31, 8, v31
    v_and_b32 v25, 3, v21
    v_lshl_add_u32 v31, v25, 4, v31
    s_lshl_b32 s40, s20, 6
    v_add_u32 v31, s40, v31
    v_add_u32 v11, s40, v30
    v_and_b32 v25, 1, v23
    v_and_b32 v26, 2, v23
    v_and_b32 v30, 12, v23
    v_lshl_add_u32 v30, v25, 1, v30
    v_lshl_add_u32 v30, v26, 3, v30
    v_lshlrev_b32 v30, 8, v30
    v_lshl_add_u32 v30, v22, 4, v30
    s_xor_b32 s56, s20, 0
    s_lshl_b32 s56, s56, 15
    s_xor_b32 s57, s20, 1
    s_lshl_b32 s57, s57, 15
    s_and_b32 s58, s20, 2
    s_xor_b32 s58, s58, 2
    s_lshl_b32 s58, s58, 15
    s_and_b32 s59, s20, 2
    s_xor_b32 s59, s59, 3
    s_lshl_b32 s59, s59, 15
    s_mov_b32 s6, 376832
    s_mov_b32 s7, 0x00020000
    s_mov_b32 s10, 376832
    s_mov_b32 s11, 0x00020000
    s_mov_b32 s14, 131072
    s_mov_b32 s15, 0x00020000
    s_mov_b32 s18, 131072
    s_mov_b32 s19, 0x00020000
    s_waitcnt lgkmcnt(0)
    s_add_u32 s4, s28, s26
    s_addc_u32 s5, s29, 0
    s_add_u32 s12, s30, s27
    s_addc_u32 s13, s31, 0
    s_add_u32 s16, s32, s27
    s_addc_u32 s17, s33, 0
    s_add_u32 s8, s34, s26
    s_addc_u32 s9, s35, 0
    s_xor_b32 s27, s56, 0
    buffer_load_dwordx4 a[0:3], v30, s[12:15], s27 offen offset:0 nt
    s_xor_b32 s27, s56, 0
    buffer_load_dwordx4 a[4:7], v30, s[12:15], s27 offen offset:64 nt
    s_xor_b32 s27, s56, 0
    buffer_load_dwordx4 a[8:11], v30, s[12:15], s27 offen offset:128 nt
    s_xor_b32 s27, s56, 0
    buffer_load_dwordx4 a[12:15], v30, s[12:15], s27 offen offset:192 nt
    s_branch L_al_b
.p2align 12
L_al_b:
    s_mov_b32 s22, 49152
    s_mov_b32 s24, 0
    s_mov_b32 s29, 0x20000000
    v_lshrrev_b32 v25, 5, v21
    v_mul_u32_u24 v25, 6176, v25
    v_and_b32 v26, 31, v21
    v_lshl_add_u32 v25, v26, 4, v25
    s_add_u32 s26, s23, 14848
    v_add_u32 v1, s26, v25
    v_and_b32 v25, 1, v23
    v_mul_u32_u24 v24, 6176, v25
    v_bfe_u32 v25, v23, 1, 1
    v_mul_u32_u24 v25, 12416, v25
    v_add_u32 v24, v24, v25
    v_lshrrev_b32 v25, 2, v23
    v_lshl_add_u32 v24, v25, 6, v24
    v_lshl_add_u32 v24, v22, 4, v24
    s_add_u32 s26, s23, 14336
    v_add_u32 v0, s26, v24
    s_xor_b32 s26, s20, 1
    s_mul_i32 s26, s26, 39168
    s_add_u32 s26, s26, 14336
    v_add_u32 v2, s26, v24
    s_and_b32 s26, s20, 2
    s_xor_b32 s26, s26, 2
    s_mul_i32 s26, s26, 39168
    s_add_u32 s26, s26, 14336
    v_add_u32 v3, s26, v24
    s_and_b32 s26, s20, 2
    s_xor_b32 s26, s26, 3
    s_mul_i32 s26, s26, 39168
    s_add_u32 s26, s26, 14336
    v_add_u32 v4, s26, v24
    v_lshrrev_b32 v26, 2, v23
    v_mul_u32_u24 v26, 39168, v26
    v_and_b32 v25, 3, v23
    v_lshl_add_u32 v26, v25, 8, v26
    v_add_u32 v25, 0, v22
    v_xor_b32 v25, v25, v23
    v_lshl_add_u32 v5, v25, 4, v26
    v_add_u32 v25, 4, v22
    v_xor_b32 v25, v25, v23
    v_lshl_add_u32 v6, v25, 4, v26
    v_add_u32 v25, 8, v22
    v_xor_b32 v25, v25, v23
    v_lshl_add_u32 v7, v25, 4, v26
    v_add_u32 v25, 12, v22
    v_xor_b32 v25, v25, v23
    v_lshl_add_u32 v8, v25, 4, v26
    v_lshrrev_b32 v25, 1, v22
    v_lshl_add_u32 v25, v25, 4, v23
    v_lshlrev_b32 v25, 4, v25
    v_add_u32 v18, 156672, v25
    s_lshl_b32 s26, s20, 2
    s_add_u32 s26, s26, 156672
    v_add_u32 v12, s26, v25
    v_and_b32 v25, 1, v22
    v_mul_u32_u24 v26, 1536, v25
    v_lshlrev_b32 v25, 2, v25
    v_xor_b32 v12, v12, v25
    v_add_u32 v12, v12, v26
    s_mov_b32 s49, 0x07060302
    s_mov_b32 s50, 0xffff
    s_mov_b32 s51, 0xffff
    v_lshlrev_b32 v25, 4, v23
    v_add_u32 v13, 156672, v25
    v_lshlrev_b32 v25, 2, v21
    s_lshl_b32 s26, s20, 8
    s_add_u32 s26, s26, 159744
    v_add_u32 v14, s26, v25
    v_and_b32 v26, 3, v21
    v_lshl_add_u32 v26, v26, 8, v25
    v_add_u32 v15, 159744, v26
    v_mov_b32 v16, 1
    v_mov_b32 v26, 0
    ds_write_b32 v14, v26
    v_mov_b32 v25, 0x3f803f80
    v_and_b32 v26, 6, v23
    v_cmp_eq_u32 vcc, 0, v26
    s_nop 1
    v_cndmask_b32 v25, 0, v25, vcc
    v_cmp_gt_u32 vcc, 8, v23
    s_nop 1
    v_cndmask_b32 v32, 0, v25, vcc
    v_cndmask_b32 v36, v25, 0, vcc
    v_mov_b32 v33, v32
    v_mov_b32 v34, v32
    v_mov_b32 v35, v32
    v_mov_b32 v37, v36
    v_mov_b32 v38, v36
    v_mov_b32 v39, v36
    s_mov_b32 s36, 0x3e0293ee
    s_mov_b32 s37, 0x3e0293ee
    s_mov_b32 s38, 0xffff0000
    s_mov_b32 s39, 0x7b800000
    v_mov_b32 v17, 0x40000000
    s_mov_b32 s25, -6
    v_mov_b32 v252, 0xc2300000
    v_mov_b32 v253, 0xc2300000
    v_mov_b32 v254, 0xc2300000
    v_mov_b32 v255, 0xc2300000
    v_lshrrev_b32 v40, 2, v23
    v_cmp_eq_u32 vcc, v40, v22
    v_and_b32 v41, 1, v23
    v_lshlrev_b32 v41, 4, v41
    v_mov_b32 v42, 0x3e03
    v_mov_b32 v43, 0xb9d8
    v_lshlrev_b32 v42, v41, v42
    v_lshlrev_b32 v43, v41, v43
    v_cndmask_b32 v42, 0, v42, vcc
    v_cndmask_b32 v43, 0, v43, vcc
    v_and_b32 v41, 2, v23
    v_cmp_eq_u32 vcc, 0, v41
    v_mov_b32 v20, 0
    v_mov_b32 v21, 0
    v_mov_b32 v24, 0
    v_cndmask_b32 v22, 0, v42, vcc
    v_cndmask_b32 v23, v42, 0, vcc
    v_cndmask_b32 v26, 0, v43, vcc
    v_cndmask_b32 v27, v43, 0, vcc
    v_mov_b32 v25, 0
    v_mov_b32 v28, 0
    v_mov_b32 v29, 0
    s_mov_b64 exec, 0
    s_cmp_eq_u32 s20, 0
    s_cbranch_scc1 L_pad0_b
    s_cmp_eq_u32 s20, 1
    s_cbranch_scc1 L_pad1_b
    s_cmp_eq_u32 s20, 2
    s_cbranch_scc1 L_pad2_b
    s_branch L_pad3_b
L_hret_b:
    s_mov_b64 exec, -1
    s_nop 3
    s_waitcnt vmcnt(3)
    v_mfma_f32_16x16x32_bf16 v[184:187], v[22:25], a[0:3], 0
    v_mfma_f32_16x16x32_bf16 v[184:187], v[26:29], a[0:3], v[184:187]
    s_xor_b32 s27, s56, 256
    buffer_load_dwordx4 a[16:19], v30, s[12:15], s27 offen offset:0 nt
    v_mfma_f32_16x16x32_bf16 v[188:191], v[20:23], a[0:3], 0
    v_mfma_f32_16x16x32_bf16 v[188:191], v[24:27], a[0:3], v[188:191]
    s_waitcnt vmcnt(3)
    v_mfma_f32_16x16x32_bf16 v[192:195], v[22:25], a[4:7], 0
    v_cvt_pk_bf16_f32 v184, v184, v185
    v_cvt_pk_bf16_f32 v186, v186, v187
    v_mfma_f32_16x16x32_bf16 v[192:195], v[26:29], a[4:7], v[192:195]
    s_xor_b32 s27, s56, 256
    buffer_load_dwordx4 a[20:23], v30, s[12:15], s27 offen offset:64 nt
    v_accvgpr_write_b32 a0, v184
    v_accvgpr_write_b32 a1, v186
    v_mfma_f32_16x16x32_bf16 v[196:199], v[20:23], a[4:7], 0
    v_cvt_pk_bf16_f32 v188, v188, v189
    v_cvt_pk_bf16_f32 v190, v190, v191
    v_mfma_f32_16x16x32_bf16 v[196:199], v[24:27], a[4:7], v[196:199]
    v_accvgpr_write_b32 a2, v188
    v_accvgpr_write_b32 a3, v190
    s_waitcnt vmcnt(3)
    v_mfma_f32_16x16x32_bf16 v[184:187], v[22:25], a[8:11], 0
    v_cvt_pk_bf16_f32 v192, v192, v193
    v_cvt_pk_bf16_f32 v194, v194, v195
    v_mfma_f32_16x16x32_bf16 v[184:187], v[26:29], a[8:11], v[184:187]
    s_xor_b32 s27, s56, 256
    buffer_load_dwordx4 a[24:27], v30, s[12:15], s27 offen offset:128 nt
    v_accvgpr_write_b32 a4, v192
    v_accvgpr_write_b32 a5, v194
    v_mfma_f32_16x16x32_bf16 v[188:191], v[20:23], a[8:11], 0
    v_cvt_pk_bf16_f32 v196, v196, v197
    v_cvt_pk_bf16_f32 v198, v198, v199
    v_mfma_f32_16x16x32_bf16 v[188:191], v[24:27], a[8:11], v[188:191]
    v_accvgpr_write_b32 a6, v196
    v_accvgpr_write_b32 a7, v198
    s_waitcnt vmcnt(3)
    v_mfma_f32_16x16x32_bf16 v[192:195], v[22:25], a[12:15], 0
    v_cvt_pk_bf16_f32 v184, v184, v185
    v_cvt_pk_bf16_f32 v186, v186, v187
    v_mfma_f32_16x16x32_bf16 v[192:195], v[26:29], a[12:15], v[192:195]
    s_xor_b32 s27, s56, 256
    buffer_load_dwordx4 a[28:31], v30, s[12:15], s27 offen offset:192 nt
    v_accvgpr_write_b32 a8, v184
    v_accvgpr_write_b32 a9, v186
    v_mfma_f32_16x16x32_bf16 v[196:199], v[20:23], a[12:15], 0
    v_cvt_pk_bf16_f32 v188, v188, v189
    v_cvt_pk_bf16_f32 v190, v190, v191
    v_mfma_f32_16x16x32_bf16 v[196:199], v[24:27], a[12:15], v[196:199]
    v_accvgpr_write_b32 a10, v188
    v_accvgpr_write_b32 a11, v190
    s_waitcnt vmcnt(3)
    v_mfma_f32_16x16x32_bf16 v[184:187], v[22:25], a[16:19], 0
    v_cvt_pk_bf16_f32 v192, v192, v193
    v_cvt_pk_bf16_f32 v194, v194, v195
    v_mfma_f32_16x16x32_bf16 v[184:187], v[26:29], a[16:19], v[184:187]
    s_mov_b32 s21, 0
    s_add_u32 m0, s23, 0
    s_nop 0
    buffer_load_dwordx4 v9, s[4:7], s21 offen nt lds
    v_accvgpr_write_b32 a12, v192
    v_accvgpr_write_b32 a13, v194
    v_mfma_f32_16x16x32_bf16 v[188:191], v[20:23], a[16:19], 0
    v_cvt_pk_bf16_f32 v196, v196, v197
    v_cvt_pk_bf16_f32 v198, v198, v199
    v_mfma_f32_16x16x32_bf16 v[188:191], v[24:27], a[16:19], v[188:191]
    v_accvgpr_write_b32 a14, v196
    v_accvgpr_write_b32 a15, v198
    s_waitcnt vmcnt(3)
    v_mfma_f32_16x16x32_bf16 v[192:195], v[22:25], a[20:23], 0
    v_cvt_pk_bf16_f32 v184, v184, v185
    v_cvt_pk_bf16_f32 v186, v186, v187
    v_mfma_f32_16x16x32_bf16 v[192:195], v[26:29], a[20:23], v[192:195]
    s_mov_b32 s21, 4096
    s_add_u32 m0, s23, 1024
    s_nop 0
    buffer_load_dwordx4 v9, s[4:7], s21 offen nt lds
    v_accvgpr_write_b32 a16, v184
    v_accvgpr_write_b32 a17, v186
    v_mfma_f32_16x16x32_bf16 v[196:199], v[20:23], a[20:23], 0
    v_cvt_pk_bf16_f32 v188, v188, v189
    v_cvt_pk_bf16_f32 v190, v190, v191
    v_mfma_f32_16x16x32_bf16 v[196:199], v[24:27], a[20:23], v[196:199]
    v_accvgpr_write_b32 a18, v188
    v_accvgpr_write_b32 a19, v190
    s_waitcnt vmcnt(3)
    v_mfma_f32_16x16x32_bf16 v[184:187], v[22:25], a[24:27], 0
    v_cvt_pk_bf16_f32 v192, v192, v193
    v_cvt_pk_bf16_f32 v194, v194, v195
    v_mfma_f32_16x16x32_bf16 v[184:187], v[26:29], a[24:27], v[184:187]
    s_mov_b32 s21, 8192
    s_add_u32 m0, s23, 2048
    s_nop 0
    buffer_load_dwordx4 v9, s[4:7], s21 offen nt lds
    v_accvgpr_write_b32 a20, v192
    v_accvgpr_write_b32 a21, v194
    v_mfma_f32_16x16x32_bf16 v[188:191], v[20:23], a[24:27], 0
    v_cvt_pk_bf16_f32 v196, v196, v197
    v_cvt_pk_bf16_f32 v198, v198, v199
    v_mfma_f32_16x16x32_bf16 v[188:191], v[24:27], a[24:27], v[188:191]
    v_accvgpr_write_b32 a22, v196
    v_accvgpr_write_b32 a23, v198
    s_waitcnt vmcnt(3)
    v_mfma_f32_16x16x32_bf16 v[192:195], v[22:25], a[28:31], 0
    v_cvt_pk_bf16_f32 v184, v184, v185
    v_cvt_pk_bf16_f32 v186, v186, v187
    v_mfma_f32_16x16x32_bf16 v[192:195], v[26:29], a[28:31], v[192:195]
    s_mov_b32 s21, 12288
    s_add_u32 m0, s23, 3072
    s_nop 0
    buffer_load_dwordx4 v9, s[4:7], s21 offen nt lds
    v_accvgpr_write_b32 a24, v184
    v_accvgpr_write_b32 a25, v186
    v_mfma_f32_16x16x32_bf16 v[196:199], v[20:23], a[28:31], 0
    v_cvt_pk_bf16_f32 v188, v188, v189
    v_cvt_pk_bf16_f32 v190, v190, v191
    v_mfma_f32_16x16x32_bf16 v[196:199], v[24:27], a[28:31], v[196:199]
    v_accvgpr_write_b32 a26, v188
    v_accvgpr_write_b32 a27, v190
    v_cvt_pk_bf16_f32 v192, v192, v193
    v_cvt_pk_bf16_f32 v194, v194, v195
    v_accvgpr_write_b32 a28, v192
    v_accvgpr_write_b32 a29, v194
    s_nop 1
    v_cvt_pk_bf16_f32 v196, v196, v197
    v_cvt_pk_bf16_f32 v198, v198, v199
    v_accvgpr_write_b32 a30, v196
    v_accvgpr_write_b32 a31, v198
    s_waitcnt vmcnt(3)
    s_mov_b32 s21, 16384
    s_add_u32 m0, s23, 4096
    s_nop 0
    buffer_load_dwordx4 v9, s[4:7], s21 offen nt lds
    s_waitcnt vmcnt(3)
    s_mov_b32 s21, 20480
    s_add_u32 m0, s23, 5120
    s_nop 0
    buffer_load_dwordx4 v9, s[4:7], s21 offen nt lds
    s_waitcnt vmcnt(3)
    s_mov_b32 s21, 24576
    s_add_u32 m0, s23, 6144
    s_nop 0
    buffer_load_dwordx4 v9, s[4:7], s21 offen nt lds
    s_waitcnt vmcnt(3)
    s_mov_b32 s21, 28672
    s_add_u32 m0, s23, 7168
    s_nop 0
    buffer_load_dwordx4 v9, s[4:7], s21 offen nt lds
    s_waitcnt vmcnt(3)
    s_mov_b32 s21, 32768
    s_add_u32 m0, s23, 8192
    s_nop 0
    buffer_load_dwordx4 v9, s[4:7], s21 offen nt lds
    s_waitcnt vmcnt(3)
    s_mov_b32 s21, 36864
    s_add_u32 m0, s23, 9216
    s_nop 0
    buffer_load_dwordx4 v9, s[4:7], s21 offen nt lds
    s_waitcnt lgkmcnt(0)
    s_waitcnt vmcnt(2)
    s_barrier
    ds_read_b128 v[72:75], v5 offset:0
    ds_read_b128 v[76:79], v6 offset:0
    ds_read_b128 v[80:83], v7 offset:0
    ds_read_b128 v[84:87], v8 offset:0
    s_waitcnt lgkmcnt(3)
    v_mfma_f32_16x16x32_bf16 v[184:187], v[72:75], a[0:3], v[252:255]
    s_waitcnt lgkmcnt(2)
    v_mfma_f32_16x16x32_bf16 v[184:187], v[76:79], a[4:7], v[184:187]
    s_waitcnt lgkmcnt(1)
    ds_read_b128 v[88:91], v5 offset:1024
    v_mfma_f32_16x16x32_bf16 v[184:187], v[80:83], a[8:11], v[184:187]
    s_waitcnt lgkmcnt(1)
    ds_read_b128 v[92:95], v6 offset:1024
    v_mfma_f32_16x16x32_bf16 v[184:187], v[84:87], a[12:15], v[184:187]
    ds_read_b128 v[96:99], v7 offset:1024
    ds_read_b128 v[100:103], v8 offset:1024
    s_mov_b32 s21, 40960
    s_add_u32 m0, s23, 10240
    s_nop 0
    buffer_load_dwordx4 v9, s[4:7], s21 offen nt lds
    v_mfma_f32_16x16x32_bf16 v[188:191], v[72:75], a[16:19], v[252:255]
    v_mfma_f32_16x16x32_bf16 v[188:191], v[76:79], a[20:23], v[188:191]
    v_mfma_f32_16x16x32_bf16 v[188:191], v[80:83], a[24:27], v[188:191]
    v_mfma_f32_16x16x32_bf16 v[188:191], v[84:87], a[28:31], v[188:191]
    s_waitcnt lgkmcnt(3)
    v_mfma_f32_16x16x32_bf16 v[64:67], v[88:91], a[0:3], v[252:255]
    s_waitcnt lgkmcnt(2)
    v_exp_f32 v184, v184
    v_mfma_f32_16x16x32_bf16 v[64:67], v[92:95], a[4:7], v[64:67]
    s_waitcnt lgkmcnt(1)
    v_exp_f32 v185, v185
    ds_read_b128 v[72:75], v5 offset:2048
    v_mfma_f32_16x16x32_bf16 v[64:67], v[96:99], a[8:11], v[64:67]
    s_waitcnt lgkmcnt(1)
    v_exp_f32 v186, v186
    ds_read_b128 v[76:79], v6 offset:2048
    v_mfma_f32_16x16x32_bf16 v[64:67], v[100:103], a[12:15], v[64:67]
    v_exp_f32 v187, v187
    ds_read_b128 v[80:83], v7 offset:2048
    ds_read_b128 v[84:87], v8 offset:2048
    s_mov_b32 s21, 45056
    s_add_u32 m0, s23, 11264
    s_nop 0
    buffer_load_dwordx4 v9, s[4:7], s21 offen nt lds
    v_mfma_f32_16x16x32_bf16 v[68:71], v[88:91], a[16:19], v[252:255]
    v_exp_f32 v188, v188
    v_mfma_f32_16x16x32_bf16 v[68:71], v[92:95], a[20:23], v[68:71]
    v_exp_f32 v189, v189
    v_perm_b32 v108, v188, v184, s49
    v_mfma_f32_16x16x32_bf16 v[68:71], v[96:99], a[24:27], v[68:71]
    ds_write_addtid_b32 v108 offset:3072
    v_exp_f32 v190, v190
    v_perm_b32 v109, v189, v185, s49
    v_mfma_f32_16x16x32_bf16 v[68:71], v[100:103], a[28:31], v[68:71]
    ds_write_addtid_b32 v109 offset:9248
    v_exp_f32 v191, v191
    v_perm_b32 v110, v190, v186, s49
    s_waitcnt lgkmcnt(5)
    ds_write_addtid_b32 v110 offset:15488
    v_perm_b32 v111, v191, v187, s49
    v_mfma_f32_16x16x32_bf16 v[184:187], v[72:75], a[0:3], v[252:255]
    s_waitcnt lgkmcnt(5)
    ds_write_addtid_b32 v111 offset:21664
    ds_read_b128 v[104:107], v0 offset:0
    v_exp_f32 v64, v64
    v_mfma_f32_16x16x32_bf16 v[184:187], v[76:79], a[4:7], v[184:187]
    s_waitcnt lgkmcnt(6)
    v_exp_f32 v65, v65
    ds_read_b128 v[88:91], v5 offset:3072
    v_mfma_f32_16x16x32_bf16 v[184:187], v[80:83], a[8:11], v[184:187]
    s_waitcnt lgkmcnt(6)
    v_exp_f32 v66, v66
    ds_read_b128 v[92:95], v6 offset:3072
    v_mfma_f32_16x16x32_bf16 v[184:187], v[84:87], a[12:15], v[184:187]
    v_exp_f32 v67, v67
    ds_read_b128 v[96:99], v7 offset:3072
    ds_read_b128 v[100:103], v8 offset:3072
    s_xor_b32 s27, s56, 8192
    buffer_load_dwordx4 a[32:35], v30, s[12:15], s27 offen offset:0 nt
    v_mfma_f32_16x16x32_bf16 v[188:191], v[72:75], a[16:19], v[252:255]
    v_exp_f32 v68, v68
    v_mfma_f32_16x16x32_bf16 v[188:191], v[76:79], a[20:23], v[188:191]
    v_exp_f32 v69, v69
    v_perm_b32 v108, v68, v64, s49
    v_mfma_f32_16x16x32_bf16 v[188:191], v[80:83], a[24:27], v[188:191]
    ds_write_addtid_b32 v108 offset:3328
    v_exp_f32 v70, v70
    v_perm_b32 v109, v69, v65, s49
    v_mfma_f32_16x16x32_bf16 v[188:191], v[84:87], a[28:31], v[188:191]
    s_waitcnt lgkmcnt(5)
    ds_write_addtid_b32 v109 offset:9504
    v_exp_f32 v71, v71
    v_perm_b32 v110, v70, v66, s49
    v_mfma_f32_16x16x32_bf16 v[40:43], v[32:35], v[104:107], 0
    s_waitcnt lgkmcnt(5)
    ds_write_addtid_b32 v110 offset:15744
    v_perm_b32 v111, v71, v67, s49
    v_mfma_f32_16x16x32_bf16 v[64:67], v[88:91], a[0:3], v[252:255]
    s_waitcnt lgkmcnt(5)
    ds_write_addtid_b32 v111 offset:21920
    ds_read_b128 v[104:107], v0 offset:256
    v_exp_f32 v184, v184
    v_mfma_f32_16x16x32_bf16 v[64:67], v[92:95], a[4:7], v[64:67]
    s_waitcnt lgkmcnt(6)
    v_exp_f32 v185, v185
    ds_read_b128 v[72:75], v5 offset:4096
    v_mfma_f32_16x16x32_bf16 v[64:67], v[96:99], a[8:11], v[64:67]
    s_waitcnt lgkmcnt(6)
    v_exp_f32 v186, v186
    ds_read_b128 v[76:79], v6 offset:4096
    v_mfma_f32_16x16x32_bf16 v[64:67], v[100:103], a[12:15], v[64:67]
    v_exp_f32 v187, v187
    ds_read_b128 v[80:83], v7 offset:4096
    ds_read_b128 v[84:87], v8 offset:4096
    buffer_load_dwordx4 a[36:39], v30, s[12:15], s27 offen offset:64 nt
    v_mfma_f32_16x16x32_bf16 v[68:71], v[88:91], a[16:19], v[252:255]
    v_exp_f32 v188, v188
    v_mfma_f32_16x16x32_bf16 v[68:71], v[92:95], a[20:23], v[68:71]
    v_exp_f32 v189, v189
    v_perm_b32 v108, v188, v184, s49
    v_mfma_f32_16x16x32_bf16 v[68:71], v[96:99], a[24:27], v[68:71]
    ds_write_addtid_b32 v108 offset:3584
    v_exp_f32 v190, v190
    v_perm_b32 v109, v189, v185, s49
    v_mfma_f32_16x16x32_bf16 v[68:71], v[100:103], a[28:31], v[68:71]
    s_waitcnt lgkmcnt(5)
    ds_write_addtid_b32 v109 offset:9760
    v_exp_f32 v191, v191
    v_perm_b32 v110, v190, v186, s49
    v_mfma_f32_16x16x32_bf16 v[40:43], v[36:39], v[104:107], v[40:43]
    s_waitcnt lgkmcnt(5)
    ds_write_addtid_b32 v110 offset:16000
    v_perm_b32 v111, v191, v187, s49
    v_mfma_f32_16x16x32_bf16 v[184:187], v[72:75], a[0:3], v[252:255]
    s_waitcnt lgkmcnt(5)
    ds_write_addtid_b32 v111 offset:22176
    ds_read_b128 v[104:107], v0 offset:512
    v_exp_f32 v64, v64
    v_mfma_f32_16x16x32_bf16 v[184:187], v[76:79], a[4:7], v[184:187]
    s_waitcnt lgkmcnt(6)
    v_exp_f32 v65, v65
    ds_read_b128 v[88:91], v5 offset:5120
    v_mfma_f32_16x16x32_bf16 v[184:187], v[80:83], a[8:11], v[184:187]
    s_waitcnt lgkmcnt(6)
    v_exp_f32 v66, v66
    ds_read_b128 v[92:95], v6 offset:5120
    v_mfma_f32_16x16x32_bf16 v[184:187], v[84:87], a[12:15], v[184:187]
    v_exp_f32 v67, v67
    ds_read_b128 v[96:99], v7 offset:5120
    ds_read_b128 v[100:103], v8 offset:5120
    buffer_load_dwordx4 a[40:43], v30, s[12:15], s27 offen offset:128 nt
    v_mfma_f32_16x16x32_bf16 v[188:191], v[72:75], a[16:19], v[252:255]
    v_exp_f32 v68, v68
    v_mfma_f32_16x16x32_bf16 v[188:191], v[76:79], a[20:23], v[188:191]
    v_exp_f32 v69, v69
    v_perm_b32 v108, v68, v64, s49
    v_mfma_f32_16x16x32_bf16 v[188:191], v[80:83], a[24:27], v[188:191]
    ds_write_addtid_b32 v108 offset:3840
    v_exp_f32 v70, v70
    v_perm_b32 v109, v69, v65, s49
    v_mfma_f32_16x16x32_bf16 v[188:191], v[84:87], a[28:31], v[188:191]
    s_waitcnt lgkmcnt(5)
    ds_write_addtid_b32 v109 offset:10016
    v_exp_f32 v71, v71
    v_perm_b32 v110, v70, v66, s49
    v_mfma_f32_16x16x32_bf16 v[44:47], v[32:35], v[104:107], 0
    s_waitcnt lgkmcnt(5)
    ds_write_addtid_b32 v110 offset:16256
    v_perm_b32 v111, v71, v67, s49
    v_mfma_f32_16x16x32_bf16 v[64:67], v[88:91], a[0:3], v[252:255]
    s_waitcnt lgkmcnt(5)
    ds_write_addtid_b32 v111 offset:22432
    ds_read_b128 v[104:107], v0 offset:768
    v_exp_f32 v184, v184
    v_mfma_f32_16x16x32_bf16 v[64:67], v[92:95], a[4:7], v[64:67]
    s_waitcnt lgkmcnt(6)
    v_exp_f32 v185, v185
    ds_read_b128 v[72:75], v5 offset:6144
    v_mfma_f32_16x16x32_bf16 v[64:67], v[96:99], a[8:11], v[64:67]
    s_waitcnt lgkmcnt(6)
    v_exp_f32 v186, v186
    ds_read_b128 v[76:79], v6 offset:6144
    v_mfma_f32_16x16x32_bf16 v[64:67], v[100:103], a[12:15], v[64:67]
    v_exp_f32 v187, v187
    ds_read_b128 v[80:83], v7 offset:6144
    ds_read_b128 v[84:87], v8 offset:6144
    buffer_load_dwordx4 a[44:47], v30, s[12:15], s27 offen offset:192 nt
    v_mfma_f32_16x16x32_bf16 v[68:71], v[88:91], a[16:19], v[252:255]
    v_exp_f32 v188, v188
    v_mfma_f32_16x16x32_bf16 v[68:71], v[92:95], a[20:23], v[68:71]
    v_exp_f32 v189, v189
    v_perm_b32 v108, v188, v184, s49
    v_mfma_f32_16x16x32_bf16 v[68:71], v[96:99], a[24:27], v[68:71]
    ds_write_addtid_b32 v108 offset:4096
    v_exp_f32 v190, v190
    v_perm_b32 v109, v189, v185, s49
    v_mfma_f32_16x16x32_bf16 v[68:71], v[100:103], a[28:31], v[68:71]
    s_waitcnt lgkmcnt(5)
    ds_write_addtid_b32 v109 offset:10272
    v_exp_f32 v191, v191
    v_perm_b32 v110, v190, v186, s49
    v_mfma_f32_16x16x32_bf16 v[44:47], v[36:39], v[104:107], v[44:47]
    s_waitcnt vmcnt(4) lgkmcnt(5)
    ds_write_addtid_b32 v110 offset:16512
    v_perm_b32 v111, v191, v187, s49
    ds_add_u32 v14, v16
    s_add_u32 s24, s24, 1
    v_mfma_f32_16x16x32_bf16 v[184:187], v[72:75], a[0:3], v[252:255]
    s_waitcnt lgkmcnt(6)
    ds_write_addtid_b32 v111 offset:22688
    ds_read_b128 v[104:107], v0 offset:1024
    v_exp_f32 v64, v64
    v_mfma_f32_16x16x32_bf16 v[184:187], v[76:79], a[4:7], v[184:187]
    s_waitcnt lgkmcnt(7)
    v_exp_f32 v65, v65
    ds_read_b128 v[88:91], v5 offset:7168
    v_mfma_f32_16x16x32_bf16 v[184:187], v[80:83], a[8:11], v[184:187]
    s_waitcnt lgkmcnt(7)
    v_exp_f32 v66, v66
    ds_read_b128 v[92:95], v6 offset:7168
    v_mfma_f32_16x16x32_bf16 v[184:187], v[84:87], a[12:15], v[184:187]
    v_exp_f32 v67, v67
    ds_read_b128 v[96:99], v7 offset:7168
    ds_read_b32 v19, v15
    ds_read_b128 v[100:103], v8 offset:7168
    s_xor_b32 s27, s56, 8448
    buffer_load_dwordx4 a[48:51], v30, s[12:15], s27 offen offset:0 nt
    v_mfma_f32_16x16x32_bf16 v[188:191], v[72:75], a[16:19], v[252:255]
    v_exp_f32 v68, v68
    v_mfma_f32_16x16x32_bf16 v[188:191], v[76:79], a[20:23], v[188:191]
    v_exp_f32 v69, v69
    v_perm_b32 v108, v68, v64, s49
    v_mfma_f32_16x16x32_bf16 v[188:191], v[80:83], a[24:27], v[188:191]
    s_waitcnt lgkmcnt(1)
    ds_write_addtid_b32 v108 offset:4352
    v_exp_f32 v70, v70
    v_perm_b32 v109, v69, v65, s49
    v_cmp_gt_u32 vcc, s24, v19
    v_mfma_f32_16x16x32_bf16 v[188:191], v[84:87], a[28:31], v[188:191]
    ds_write_addtid_b32 v109 offset:10528
    v_exp_f32 v71, v71
    v_perm_b32 v110, v70, v66, s49
    v_mfma_f32_16x16x32_bf16 v[48:51], v[32:35], v[104:107], 0
    ds_write_addtid_b32 v110 offset:16768
    v_perm_b32 v111, v71, v67, s49
    s_cbranch_vccnz L_retry97_b
L_back97_b:
    v_mfma_f32_16x16x32_bf16 v[64:67], v[88:91], a[0:3], v[252:255]
    ds_write_addtid_b32 v111 offset:22944
    ds_read_b128 v[104:107], v0 offset:1280
    v_exp_f32 v184, v184
    v_mfma_f32_16x16x32_bf16 v[64:67], v[92:95], a[4:7], v[64:67]
    v_exp_f32 v185, v185
    ds_read_b128 v[72:75], v5 offset:8192
    v_mfma_f32_16x16x32_bf16 v[64:67], v[96:99], a[8:11], v[64:67]
    s_waitcnt lgkmcnt(6)
    v_exp_f32 v186, v186
    ds_read_b128 v[76:79], v6 offset:8192
    v_mfma_f32_16x16x32_bf16 v[64:67], v[100:103], a[12:15], v[64:67]
    v_exp_f32 v187, v187
    ds_read_b128 v[80:83], v7 offset:8192
    ds_read_b128 v[84:87], v8 offset:8192
    buffer_load_dwordx4 a[52:55], v30, s[12:15], s27 offen offset:64 nt
    v_mfma_f32_16x16x32_bf16 v[68:71], v[88:91], a[16:19], v[252:255]
    v_exp_f32 v188, v188
    v_mfma_f32_16x16x32_bf16 v[68:71], v[92:95], a[20:23], v[68:71]
    v_exp_f32 v189, v189
    v_perm_b32 v108, v188, v184, s49
    v_mfma_f32_16x16x32_bf16 v[68:71], v[96:99], a[24:27], v[68:71]
    ds_write_addtid_b32 v108 offset:4608
    v_exp_f32 v190, v190
    v_perm_b32 v109, v189, v185, s49
    v_mfma_f32_16x16x32_bf16 v[68:71], v[100:103], a[28:31], v[68:71]
    s_waitcnt lgkmcnt(5)
    ds_write_addtid_b32 v109 offset:10784
    v_exp_f32 v191, v191
    v_perm_b32 v110, v190, v186, s49
    v_mfma_f32_16x16x32_bf16 v[48:51], v[36:39], v[104:107], v[48:51]
    s_waitcnt lgkmcnt(5)
    ds_write_addtid_b32 v110 offset:17024
    v_perm_b32 v111, v191, v187, s49
    v_mfma_f32_16x16x32_bf16 v[184:187], v[72:75], a[0:3], v[252:255]
    s_waitcnt lgkmcnt(5)
    ds_write_addtid_b32 v111 offset:23200
    ds_read_b128 v[104:107], v0 offset:1536
    v_exp_f32 v64, v64
    v_mfma_f32_16x16x32_bf16 v[184:187], v[76:79], a[4:7], v[184:187]
    s_waitcnt lgkmcnt(6)
    v_exp_f32 v65, v65
    ds_read_b128 v[88:91], v5 offset:9216
    v_mfma_f32_16x16x32_bf16 v[184:187], v[80:83], a[8:11], v[184:187]
    s_waitcnt lgkmcnt(6)
    v_exp_f32 v66, v66
    ds_read_b128 v[92:95], v6 offset:9216
    v_mfma_f32_16x16x32_bf16 v[184:187], v[84:87], a[12:15], v[184:187]
    v_exp_f32 v67, v67
    ds_read_b128 v[96:99], v7 offset:9216
    ds_read_b128 v[100:103], v8 offset:9216
    buffer_load_dwordx4 a[56:59], v30, s[12:15], s27 offen offset:128 nt
    v_mfma_f32_16x16x32_bf16 v[188:191], v[72:75], a[16:19], v[252:255]
    v_exp_f32 v68, v68
    v_mfma_f32_16x16x32_bf16 v[188:191], v[76:79], a[20:23], v[188:191]
    v_exp_f32 v69, v69
    v_perm_b32 v108, v68, v64, s49
    v_mfma_f32_16x16x32_bf16 v[188:191], v[80:83], a[24:27], v[188:191]
    ds_write_addtid_b32 v108 offset:4864
    v_exp_f32 v70, v70
    v_perm_b32 v109, v69, v65, s49
    v_mfma_f32_16x16x32_bf16 v[188:191], v[84:87], a[28:31], v[188:191]
    s_waitcnt lgkmcnt(5)
    ds_write_addtid_b32 v109 offset:11040
    v_exp_f32 v71, v71
    v_perm_b32 v110, v70, v66, s49
    v_mfma_f32_16x16x32_bf16 v[52:55], v[32:35], v[104:107], 0
    s_waitcnt lgkmcnt(5)
    ds_write_addtid_b32 v110 offset:17280
    v_perm_b32 v111, v71, v67, s49
    v_mfma_f32_16x16x32_bf16 v[64:67], v[88:91], a[0:3], v[252:255]
    s_waitcnt lgkmcnt(5)
    ds_write_addtid_b32 v111 offset:23456
    ds_read_b128 v[104:107], v0 offset:1792
    v_exp_f32 v184, v184
    v_mfma_f32_16x16x32_bf16 v[64:67], v[92:95], a[4:7], v[64:67]
    s_waitcnt lgkmcnt(6)
    v_exp_f32 v185, v185
    ds_read_b128 v[72:75], v5 offset:10240
    v_mfma_f32_16x16x32_bf16 v[64:67], v[96:99], a[8:11], v[64:67]
    s_waitcnt lgkmcnt(6)
    v_exp_f32 v186, v186
    ds_read_b128 v[76:79], v6 offset:10240
    v_mfma_f32_16x16x32_bf16 v[64:67], v[100:103], a[12:15], v[64:67]
    v_exp_f32 v187, v187
    ds_read_b128 v[80:83], v7 offset:10240
    ds_read_b128 v[84:87], v8 offset:10240
L_pad0_b:
    s_cbranch_execz L_pad4_b
    buffer_load_dwordx4 a[60:63], v30, s[12:15], s27 offen offset:192 nt
    v_mfma_f32_16x16x32_bf16 v[68:71], v[88:91], a[16:19], v[252:255]
    v_exp_f32 v188, v188
    v_mfma_f32_16x16x32_bf16 v[68:71], v[92:95], a[20:23], v[68:71]
    v_exp_f32 v189, v189
    v_perm_b32 v108, v188, v184, s49
    v_mfma_f32_16x16x32_bf16 v[68:71], v[96:99], a[24:27], v[68:71]
    ds_write_addtid_b32 v108 offset:5120
    v_exp_f32 v190, v190
    v_perm_b32 v109, v189, v185, s49
    v_mfma_f32_16x16x32_bf16 v[68:71], v[100:103], a[28:31], v[68:71]
    s_waitcnt lgkmcnt(5)
    ds_write_addtid_b32 v109 offset:11296
    v_exp_f32 v191, v191
    v_perm_b32 v110, v190, v186, s49
    v_mfma_f32_16x16x32_bf16 v[52:55], v[36:39], v[104:107], v[52:55]
    s_waitcnt lgkmcnt(5)
    ds_write_addtid_b32 v110 offset:17536
    v_perm_b32 v111, v191, v187, s49
    ds_add_u32 v14, v16
    s_add_u32 s24, s24, 1
    v_mfma_f32_16x16x32_bf16 v[184:187], v[72:75], a[0:3], v[252:255]
    s_waitcnt lgkmcnt(6)
    ds_write_addtid_b32 v111 offset:23712
    ds_read_b128 v[104:107], v0 offset:2048
    v_exp_f32 v64, v64
    v_mfma_f32_16x16x32_bf16 v[184:187], v[76:79], a[4:7], v[184:187]
    s_waitcnt lgkmcnt(7)
    v_exp_f32 v65, v65
    ds_read_b128 v[88:91], v5 offset:11264
    ds_read_b128 v[168:171], v0 offset:0
    v_mfma_f32_16x16x32_bf16 v[184:187], v[80:83], a[8:11], v[184:187]
    s_waitcnt lgkmcnt(8)
    v_exp_f32 v66, v66
    ds_read_b128 v[92:95], v6 offset:11264
    v_mfma_f32_16x16x32_bf16 v[184:187], v[84:87], a[12:15], v[184:187]
    v_exp_f32 v67, v67
    ds_read_b128 v[96:99], v7 offset:11264
    ds_read_b128 v[100:103], v8 offset:11264
    s_xor_b32 s27, s56, 0
    s_xor_b32 s26, s56, 4096
    buffer_load_dwordx4 a[128:131], v31, s[16:19], s27 offen
    v_mfma_f32_16x16x32_bf16 v[188:191], v[72:75], a[16:19], v[252:255]
    v_exp_f32 v68, v68
    v_mfma_f32_16x16x32_bf16 v[188:191], v[76:79], a[20:23], v[188:191]
    v_exp_f32 v69, v69
    v_perm_b32 v108, v68, v64, s49
    ds_read_b128 v[172:175], v0 offset:256
    v_mfma_f32_16x16x32_bf16 v[188:191], v[80:83], a[24:27], v[188:191]
    ds_write_addtid_b32 v108 offset:5376
    v_exp_f32 v70, v70
    v_perm_b32 v109, v69, v65, s49
    v_mfma_f32_16x16x32_bf16 v[188:191], v[84:87], a[28:31], v[188:191]
    s_waitcnt lgkmcnt(7)
    ds_write_addtid_b32 v109 offset:11552
    v_exp_f32 v71, v71
    v_perm_b32 v110, v70, v66, s49
    v_mfma_f32_16x16x32_bf16 v[56:59], v[32:35], v[104:107], 0
    s_waitcnt lgkmcnt(7)
    ds_write_addtid_b32 v110 offset:17792
    v_perm_b32 v111, v71, v67, s49
    v_mfma_f32_16x16x32_bf16 v[64:67], v[88:91], a[0:3], v[252:255]
    s_waitcnt lgkmcnt(6)
    ds_write_addtid_b32 v111 offset:23968
    ds_read_b128 v[104:107], v0 offset:2304
    v_exp_f32 v184, v184
    v_mfma_f32_16x16x32_bf16 v[64:67], v[92:95], a[4:7], v[64:67]
    s_waitcnt lgkmcnt(7)
    v_exp_f32 v185, v185
    ds_read_b128 v[72:75], v5 offset:0
    ds_read_b128 v[176:179], v0 offset:512
    v_mfma_f32_16x16x32_bf16 v[64:67], v[96:99], a[8:11], v[64:67]
    s_waitcnt lgkmcnt(8)
    v_exp_f32 v186, v186
    ds_read_b128 v[76:79], v6 offset:0
    v_mfma_f32_16x16x32_bf16 v[64:67], v[100:103], a[12:15], v[64:67]
    v_exp_f32 v187, v187
    ds_read_b128 v[80:83], v7 offset:0
    ds_read_b128 v[84:87], v8 offset:0
    buffer_load_dwordx4 a[132:135], v31, s[16:19], s26 offen
    v_mfma_f32_16x16x32_bf16 v[68:71], v[88:91], a[16:19], v[252:255]
    v_exp_f32 v188, v188
    v_mfma_f32_16x16x32_bf16 v[68:71], v[92:95], a[20:23], v[68:71]
    v_exp_f32 v189, v189
    v_perm_b32 v108, v188, v184, s49
    ds_read_b128 v[180:183], v0 offset:768
    v_mfma_f32_16x16x32_bf16 v[68:71], v[96:99], a[24:27], v[68:71]
    ds_write_addtid_b32 v108 offset:5632
    v_exp_f32 v190, v190
    v_perm_b32 v109, v189, v185, s49
    v_mfma_f32_16x16x32_bf16 v[68:71], v[100:103], a[28:31], v[68:71]
    s_waitcnt lgkmcnt(7)
    ds_write_addtid_b32 v109 offset:11808
    v_exp_f32 v191, v191
    v_perm_b32 v110, v190, v186, s49
    v_mfma_f32_16x16x32_bf16 v[56:59], v[36:39], v[104:107], v[56:59]
    ds_write_addtid_b32 v110 offset:18048
    v_perm_b32 v111, v191, v187, s49
    ds_read_b32 v19, v15
    ds_write_addtid_b32 v111 offset:24224
    ds_read_b128 v[104:107], v0 offset:2560
    v_exp_f32 v64, v64
    v_exp_f32 v65, v65
    v_exp_f32 v66, v66
    v_exp_f32 v67, v67
    v_exp_f32 v68, v68
    s_nop 0
    v_perm_b32 v108, v68, v64, s49
    s_waitcnt lgkmcnt(2)
    ds_write_addtid_b32 v108 offset:5888
    v_cmp_gt_u32 vcc, s24, v19
    s_waitcnt lgkmcnt(1)
    v_mfma_f32_16x16x32_bf16 v[60:63], v[32:35], v[104:107], 0
    s_cbranch_vccnz L_retry99_b
L_back99_b:
    s_waitcnt vmcnt(9)
    v_mfma_f32_16x16x32_bf16 v[184:187], v[22:25], a[32:35], 0
    v_mfma_f32_16x16x32_bf16 v[184:187], v[26:29], a[32:35], v[184:187]
    s_xor_b32 s27, s57, 0
    s_xor_b32 s26, s57, 4096
    buffer_load_dwordx4 a[160:163], v31, s[16:19], s27 offen
    v_mfma_f32_16x16x32_bf16 v[188:191], v[20:23], a[32:35], 0
    v_mfma_f32_16x16x32_bf16 v[188:191], v[24:27], a[32:35], v[188:191]
    s_waitcnt vmcnt(9)
    v_mfma_f32_16x16x32_bf16 v[192:195], v[22:25], a[36:39], 0
    v_cvt_pk_bf16_f32 v184, v184, v185
    v_cvt_pk_bf16_f32 v186, v186, v187
    v_mfma_f32_16x16x32_bf16 v[192:195], v[26:29], a[36:39], v[192:195]
    buffer_load_dwordx4 a[164:167], v31, s[16:19], s26 offen
    v_accvgpr_write_b32 a32, v184
    v_accvgpr_write_b32 a33, v186
    v_mfma_f32_16x16x32_bf16 v[196:199], v[20:23], a[36:39], 0
    v_cvt_pk_bf16_f32 v188, v188, v189
    v_cvt_pk_bf16_f32 v190, v190, v191
    v_mfma_f32_16x16x32_bf16 v[196:199], v[24:27], a[36:39], v[196:199]
    v_accvgpr_write_b32 a34, v188
    v_accvgpr_write_b32 a35, v190
    s_waitcnt vmcnt(9)
    v_mfma_f32_16x16x32_bf16 v[184:187], v[22:25], a[40:43], 0
    v_cvt_pk_bf16_f32 v192, v192, v193
    v_cvt_pk_bf16_f32 v194, v194, v195
    v_mfma_f32_16x16x32_bf16 v[184:187], v[26:29], a[40:43], v[184:187]
    s_xor_b32 s27, s58, 0
    s_xor_b32 s26, s58, 4096
    buffer_load_dwordx4 a[192:195], v31, s[16:19], s27 offen
    v_accvgpr_write_b32 a36, v192
    v_accvgpr_write_b32 a37, v194
    v_mfma_f32_16x16x32_bf16 v[188:191], v[20:23], a[40:43], 0
    v_cvt_pk_bf16_f32 v196, v196, v197
    v_cvt_pk_bf16_f32 v198, v198, v199
    v_mfma_f32_16x16x32_bf16 v[188:191], v[24:27], a[40:43], v[188:191]
    v_accvgpr_write_b32 a38, v196
    v_accvgpr_write_b32 a39, v198
    s_waitcnt vmcnt(9)
    v_mfma_f32_16x16x32_bf16 v[192:195], v[22:25], a[44:47], 0
    v_cvt_pk_bf16_f32 v184, v184, v185
    v_cvt_pk_bf16_f32 v186, v186, v187
    v_mfma_f32_16x16x32_bf16 v[192:195], v[26:29], a[44:47], v[192:195]
    buffer_load_dwordx4 a[196:199], v31, s[16:19], s26 offen
    v_accvgpr_write_b32 a40, v184
    v_accvgpr_write_b32 a41, v186
    v_mfma_f32_16x16x32_bf16 v[196:199], v[20:23], a[44:47], 0
    v_cvt_pk_bf16_f32 v188, v188, v189
    v_cvt_pk_bf16_f32 v190, v190, v191
    v_mfma_f32_16x16x32_bf16 v[196:199], v[24:27], a[44:47], v[196:199]
    v_accvgpr_write_b32 a42, v188
    v_accvgpr_write_b32 a43, v190
    s_waitcnt vmcnt(9)
    v_mfma_f32_16x16x32_bf16 v[184:187], v[22:25], a[48:51], 0
    v_cvt_pk_bf16_f32 v192, v192, v193
    v_cvt_pk_bf16_f32 v194, v194, v195
    v_mfma_f32_16x16x32_bf16 v[184:187], v[26:29], a[48:51], v[184:187]
    v_accvgpr_write_b32 a44, v192
    v_accvgpr_write_b32 a45, v194
    v_mfma_f32_16x16x32_bf16 v[188:191], v[20:23], a[48:51], 0
    v_cvt_pk_bf16_f32 v196, v196, v197
    v_cvt_pk_bf16_f32 v198, v198, v199
    v_mfma_f32_16x16x32_bf16 v[188:191], v[24:27], a[48:51], v[188:191]
    v_accvgpr_write_b32 a46, v196
    v_accvgpr_write_b32 a47, v198
    s_waitcnt vmcnt(8)
    v_mfma_f32_16x16x32_bf16 v[192:195], v[22:25], a[52:55], 0
    v_cvt_pk_bf16_f32 v184, v184, v185
    v_cvt_pk_bf16_f32 v186, v186, v187
    v_mfma_f32_16x16x32_bf16 v[192:195], v[26:29], a[52:55], v[192:195]
    v_accvgpr_write_b32 a48, v184
    v_accvgpr_write_b32 a49, v186
    v_mfma_f32_16x16x32_bf16 v[196:199], v[20:23], a[52:55], 0
    v_cvt_pk_bf16_f32 v188, v188, v189
    v_cvt_pk_bf16_f32 v190, v190, v191
    v_mfma_f32_16x16x32_bf16 v[196:199], v[24:27], a[52:55], v[196:199]
    v_accvgpr_write_b32 a50, v188
    v_accvgpr_write_b32 a51, v190
    s_waitcnt vmcnt(7)
    v_mfma_f32_16x16x32_bf16 v[184:187], v[22:25], a[56:59], 0
    v_cvt_pk_bf16_f32 v192, v192, v193
    v_cvt_pk_bf16_f32 v194, v194, v195
    v_mfma_f32_16x16x32_bf16 v[184:187], v[26:29], a[56:59], v[184:187]
    v_accvgpr_write_b32 a52, v192
    v_accvgpr_write_b32 a53, v194
    v_mfma_f32_16x16x32_bf16 v[188:191], v[20:23], a[56:59], 0
    v_cvt_pk_bf16_f32 v196, v196, v197
    v_cvt_pk_bf16_f32 v198, v198, v199
    v_mfma_f32_16x16x32_bf16 v[188:191], v[24:27], a[56:59], v[188:191]
    v_accvgpr_write_b32 a54, v196
    v_accvgpr_write_b32 a55, v198
    s_waitcnt vmcnt(6)
    v_mfma_f32_16x16x32_bf16 v[192:195], v[22:25], a[60:63], 0
    v_cvt_pk_bf16_f32 v184, v184, v185
    v_cvt_pk_bf16_f32 v186, v186, v187
    s_waitcnt vmcnt(5)
    ds_write_b128 v1, a[128:131] offset:3072
    v_mfma_f32_16x16x32_bf16 v[192:195], v[26:29], a[60:63], v[192:195]
    v_accvgpr_write_b32 a56, v184
    v_accvgpr_write_b32 a57, v186
    s_waitcnt vmcnt(4)
    ds_write_b128 v1, a[132:135] offset:15488
    v_mfma_f32_16x16x32_bf16 v[196:199], v[20:23], a[60:63], 0
    v_cvt_pk_bf16_f32 v188, v188, v189
    v_cvt_pk_bf16_f32 v190, v190, v191
    ds_read_b64_tr_b16 a[128:129], v1 offset:3072
    ds_read_b64_tr_b16 a[130:131], v1 offset:15488
    v_mfma_f32_16x16x32_bf16 v[196:199], v[24:27], a[60:63], v[196:199]
    v_accvgpr_write_b32 a58, v188
    v_accvgpr_write_b32 a59, v190
    s_waitcnt vmcnt(3)
    ds_read_b64_tr_b16 a[132:133], v1 offset:3080
    ds_read_b64_tr_b16 a[134:135], v1 offset:15496
    v_cvt_pk_bf16_f32 v192, v192, v193
    v_cvt_pk_bf16_f32 v194, v194, v195
    v_accvgpr_write_b32 a60, v192
    v_accvgpr_write_b32 a61, v194
    v_cvt_pk_bf16_f32 v196, v196, v197
    v_cvt_pk_bf16_f32 v198, v198, v199
    v_accvgpr_write_b32 a62, v196
    v_accvgpr_write_b32 a63, v198
    v_mfma_f32_16x16x32_bf16 v[112:115], v[72:75], a[32:35], v[252:255]
    s_xor_b32 s27, s59, 0
    ds_write_b128 v1, a[160:163] offset:3072
    v_exp_f32 v69, v69
    v_mfma_f32_16x16x32_bf16 v[112:115], v[76:79], a[36:39], v[112:115]
    s_waitcnt vmcnt(2)
    ds_read_b128 v[184:187], v2 offset:0
    v_perm_b32 v109, v69, v65, s49
    v_mfma_f32_16x16x32_bf16 v[112:115], v[80:83], a[40:43], v[112:115]
    s_xor_b32 s26, s59, 4096
    ds_write_b128 v1, a[164:167] offset:15488
    v_exp_f32 v70, v70
    v_mfma_f32_16x16x32_bf16 v[112:115], v[84:87], a[44:47], v[112:115]
    s_waitcnt lgkmcnt(5)
    ds_write_addtid_b32 v109 offset:12064
    v_perm_b32 v110, v70, v66, s49
    v_mfma_f32_16x16x32_bf16 v[120:123], a[128:131], v[168:171], 0
    buffer_load_dwordx4 a[224:227], v31, s[16:19], s27 offen
    buffer_load_dwordx4 a[228:231], v31, s[16:19], s26 offen
    ds_read_b64_tr_b16 a[160:161], v1 offset:3072
    ds_read_b64_tr_b16 a[162:163], v1 offset:15488
    ds_read_b64_tr_b16 a[164:165], v1 offset:3080
    v_exp_f32 v71, v71
    v_mfma_f32_16x16x32_bf16 v[128:131], a[128:131], v[172:175], 0
    s_waitcnt lgkmcnt(7)
    ds_write_addtid_b32 v110 offset:18304
    v_perm_b32 v111, v71, v67, s49
    v_mfma_f32_16x16x32_bf16 v[124:127], a[132:135], v[168:171], 0
    v_exp_f32 v112, v112
    v_mfma_f32_16x16x32_bf16 v[132:135], a[132:135], v[172:175], 0
    ds_write_addtid_b32 v111 offset:24480
    ds_read_b128 v[104:107], v0 offset:2816
    v_mfma_f32_16x16x32_bf16 v[68:71], v[72:75], a[48:51], v[252:255]
    v_exp_f32 v113, v113
    v_mfma_f32_16x16x32_bf16 v[68:71], v[76:79], a[52:55], v[68:71]
    ds_read_b128 v[88:91], v5 offset:1024
    ds_read_b128 v[92:95], v6 offset:1024
    v_mfma_f32_16x16x32_bf16 v[68:71], v[80:83], a[56:59], v[68:71]
    v_exp_f32 v114, v114
    v_mfma_f32_16x16x32_bf16 v[68:71], v[84:87], a[60:63], v[68:71]
    ds_read_b128 v[96:99], v7 offset:1024
    ds_read_b128 v[100:103], v8 offset:1024
    v_mfma_f32_16x16x32_bf16 v[136:139], a[128:131], v[176:179], 0
    v_exp_f32 v115, v115
    v_mfma_f32_16x16x32_bf16 v[144:147], a[128:131], v[180:183], 0
    ds_read_b128 v[188:191], v2 offset:256
    ds_read_b64_tr_b16 a[166:167], v1 offset:15496
    v_mfma_f32_16x16x32_bf16 v[140:143], a[132:135], v[176:179], 0
    v_exp_f32 v68, v68
    v_mfma_f32_16x16x32_bf16 v[148:151], a[132:135], v[180:183], 0
    s_waitcnt lgkmcnt(6)
    ds_read_b128 v[192:195], v2 offset:512
    v_perm_b32 v108, v68, v112, s49
    v_mfma_f32_16x16x32_bf16 v[60:63], v[36:39], v[104:107], v[60:63]
    s_waitcnt vmcnt(3) lgkmcnt(5)
    ds_write_addtid_b32 v108 offset:6144
    ds_read_b128 v[196:199], v2 offset:768
    v_mfma_f32_16x16x32_bf16 v[64:67], v[88:91], a[32:35], v[252:255]
    s_xor_b32 s27, s56, 16384
    ds_write_b128 v1, a[192:195] offset:3072
    v_exp_f32 v69, v69
    v_mfma_f32_16x16x32_bf16 v[64:67], v[92:95], a[36:39], v[64:67]
    s_waitcnt lgkmcnt(7)
    ds_read_b128 v[168:171], v3 offset:0
    v_perm_b32 v109, v69, v113, s49
    v_mfma_f32_16x16x32_bf16 v[64:67], v[96:99], a[40:43], v[64:67]
    s_waitcnt vmcnt(2) lgkmcnt(7)
    ds_write_b128 v1, a[196:199] offset:15488
    v_exp_f32 v70, v70
    v_mfma_f32_16x16x32_bf16 v[64:67], v[100:103], a[44:47], v[64:67]
    ds_write_addtid_b32 v109 offset:12320
    v_perm_b32 v110, v70, v114, s49
    v_mfma_f32_16x16x32_bf16 v[120:123], a[160:163], v[184:187], v[120:123]
    s_waitcnt lgkmcnt(8)
    v_exp_f32 v71, v71
    v_mfma_f32_16x16x32_bf16 v[128:131], a[160:163], v[188:191], v[128:131]
    s_waitcnt lgkmcnt(7)
    ds_write_addtid_b32 v110 offset:18560
    v_perm_b32 v111, v71, v115, s49
    v_mfma_f32_16x16x32_bf16 v[124:127], a[164:167], v[184:187], v[124:127]
    v_exp_f32 v64, v64
    v_mfma_f32_16x16x32_bf16 v[132:135], a[164:167], v[188:191], v[132:135]
    ds_write_addtid_b32 v111 offset:24736
    ds_read_b128 v[104:107], v0 offset:3072
    v_mfma_f32_16x16x32_bf16 v[68:71], v[88:91], a[48:51], v[252:255]
    v_exp_f32 v65, v65
    v_mfma_f32_16x16x32_bf16 v[68:71], v[92:95], a[52:55], v[68:71]
    buffer_load_dwordx4 a[64:67], v30, s[12:15], s27 offen offset:0 nt
    buffer_load_dwordx4 a[68:71], v30, s[12:15], s27 offen offset:64 nt
    ds_read_b128 v[72:75], v5 offset:2048
    ds_read_b128 v[76:79], v6 offset:2048
    ds_read_b64_tr_b16 a[192:193], v1 offset:3072
    ds_read_b64_tr_b16 a[194:195], v1 offset:15488
    ds_read_b64_tr_b16 a[196:197], v1 offset:3080
    v_mfma_f32_16x16x32_bf16 v[68:71], v[96:99], a[56:59], v[68:71]
    v_exp_f32 v66, v66
    v_mfma_f32_16x16x32_bf16 v[68:71], v[100:103], a[60:63], v[68:71]
    s_waitcnt lgkmcnt(14)
    ds_read_b128 v[80:83], v7 offset:2048
    ds_read_b128 v[84:87], v8 offset:2048
    v_mfma_f32_16x16x32_bf16 v[136:139], a[160:163], v[192:195], v[136:139]
    s_waitcnt lgkmcnt(14)
    v_exp_f32 v67, v67
    v_mfma_f32_16x16x32_bf16 v[144:147], a[160:163], v[196:199], v[144:147]
    ds_read_b128 v[172:175], v3 offset:256
    ds_read_b64_tr_b16 a[198:199], v1 offset:15496
    v_mfma_f32_16x16x32_bf16 v[140:143], a[164:167], v[192:195], v[140:143]
    v_exp_f32 v68, v68
    v_mfma_f32_16x16x32_bf16 v[148:151], a[164:167], v[196:199], v[148:151]
    s_waitcnt lgkmcnt(9)
    ds_read_b128 v[176:179], v3 offset:512
    v_perm_b32 v108, v68, v64, s49
    v_mfma_f32_16x16x32_bf16 v[40:43], v[32:35], v[104:107], v[40:43]
    s_waitcnt lgkmcnt(9)
    ds_write_addtid_b32 v108 offset:6400
    ds_read_b128 v[180:183], v3 offset:768
    v_mfma_f32_16x16x32_bf16 v[112:115], v[72:75], a[32:35], v[252:255]
    s_waitcnt vmcnt(3) lgkmcnt(10)
    ds_write_b128 v1, a[224:227] offset:3072
    v_exp_f32 v69, v69
    v_mfma_f32_16x16x32_bf16 v[112:115], v[76:79], a[36:39], v[112:115]
    s_waitcnt lgkmcnt(7)
    ds_read_b128 v[184:187], v4 offset:0
    v_perm_b32 v109, v69, v65, s49
    v_mfma_f32_16x16x32_bf16 v[112:115], v[80:83], a[40:43], v[112:115]
    s_waitcnt vmcnt(2) lgkmcnt(7)
    ds_write_b128 v1, a[228:231] offset:15488
    v_exp_f32 v70, v70
    v_mfma_f32_16x16x32_bf16 v[112:115], v[84:87], a[44:47], v[112:115]
    ds_write_addtid_b32 v109 offset:12576
    v_perm_b32 v110, v70, v66, s49
    v_mfma_f32_16x16x32_bf16 v[120:123], a[192:195], v[168:171], v[120:123]
    s_waitcnt lgkmcnt(8)
    v_exp_f32 v71, v71
    v_mfma_f32_16x16x32_bf16 v[128:131], a[192:195], v[172:175], v[128:131]
    s_waitcnt lgkmcnt(7)
    ds_write_addtid_b32 v110 offset:18816
    v_perm_b32 v111, v71, v67, s49
    v_mfma_f32_16x16x32_bf16 v[124:127], a[196:199], v[168:171], v[124:127]
    v_exp_f32 v112, v112
    v_mfma_f32_16x16x32_bf16 v[132:135], a[196:199], v[172:175], v[132:135]
    ds_write_addtid_b32 v111 offset:24992
    ds_read_b128 v[104:107], v0 offset:3328
    v_mfma_f32_16x16x32_bf16 v[68:71], v[72:75], a[48:51], v[252:255]
    v_exp_f32 v113, v113
    v_mfma_f32_16x16x32_bf16 v[68:71], v[76:79], a[52:55], v[68:71]
    ds_read_b128 v[88:91], v5 offset:3072
    ds_read_b128 v[92:95], v6 offset:3072
    v_mfma_f32_16x16x32_bf16 v[68:71], v[80:83], a[56:59], v[68:71]
    v_exp_f32 v114, v114
    v_mfma_f32_16x16x32_bf16 v[68:71], v[84:87], a[60:63], v[68:71]
    s_waitcnt lgkmcnt(11)
    ds_read_b128 v[96:99], v7 offset:3072
    ds_read_b128 v[100:103], v8 offset:3072
    v_mfma_f32_16x16x32_bf16 v[136:139], a[192:195], v[176:179], v[136:139]
    s_waitcnt lgkmcnt(11)
    v_exp_f32 v115, v115
    v_mfma_f32_16x16x32_bf16 v[144:147], a[192:195], v[180:183], v[144:147]
    ds_read_b128 v[188:191], v4 offset:256
    ds_read_b64_tr_b16 a[224:225], v1 offset:3072
    v_mfma_f32_16x16x32_bf16 v[140:143], a[196:199], v[176:179], v[140:143]
    buffer_load_dwordx4 a[72:75], v30, s[12:15], s27 offen offset:128 nt
    buffer_load_dwordx4 a[76:79], v30, s[12:15], s27 offen offset:192 nt
    ds_read_b64_tr_b16 a[226:227], v1 offset:15488
    ds_read_b64_tr_b16 a[228:229], v1 offset:3080
    ds_read_b64_tr_b16 a[230:231], v1 offset:15496
    v_exp_f32 v68, v68
    v_mfma_f32_16x16x32_bf16 v[148:151], a[196:199], v[180:183], v[148:151]
    s_waitcnt lgkmcnt(9)
    ds_read_b128 v[192:195], v4 offset:512
    v_perm_b32 v108, v68, v112, s49
    v_mfma_f32_16x16x32_bf16 v[40:43], v[36:39], v[104:107], v[40:43]
    s_waitcnt lgkmcnt(9)
    ds_write_addtid_b32 v108 offset:6656
    ds_read_b128 v[196:199], v4 offset:768
    v_mfma_f32_16x16x32_bf16 v[64:67], v[88:91], a[32:35], v[252:255]
    s_waitcnt lgkmcnt(10)
    v_exp_f32 v69, v69
    v_mfma_f32_16x16x32_bf16 v[64:67], v[92:95], a[36:39], v[64:67]
    s_waitcnt lgkmcnt(9)
    ds_read_b128 v[168:171], v0 offset:1024
    v_perm_b32 v109, v69, v113, s49
    v_mfma_f32_16x16x32_bf16 v[64:67], v[96:99], a[40:43], v[64:67]
    s_waitcnt lgkmcnt(9)
    v_exp_f32 v70, v70
    v_mfma_f32_16x16x32_bf16 v[64:67], v[100:103], a[44:47], v[64:67]
    s_waitcnt lgkmcnt(6)
    ds_write_addtid_b32 v109 offset:12832
    v_perm_b32 v110, v70, v114, s49
    v_mfma_f32_16x16x32_bf16 v[120:123], a[224:227], v[184:187], v[120:123]
    v_exp_f32 v71, v71
    v_mfma_f32_16x16x32_bf16 v[128:131], a[224:227], v[188:191], v[128:131]
    s_waitcnt lgkmcnt(5)
    ds_write_addtid_b32 v110 offset:19072
    v_perm_b32 v111, v71, v115, s49
    v_mfma_f32_16x16x32_bf16 v[124:127], a[228:231], v[184:187], v[124:127]
    v_exp_f32 v64, v64
    v_mfma_f32_16x16x32_bf16 v[132:135], a[228:231], v[188:191], v[132:135]
    ds_write_addtid_b32 v111 offset:25248
    ds_read_b128 v[104:107], v0 offset:3584
    v_mfma_f32_16x16x32_bf16 v[68:71], v[88:91], a[48:51], v[252:255]
    v_exp_f32 v65, v65
    v_mfma_f32_16x16x32_bf16 v[68:71], v[92:95], a[52:55], v[68:71]
    ds_read_b128 v[72:75], v5 offset:4096
    ds_read_b128 v[76:79], v6 offset:4096
    v_mfma_f32_16x16x32_bf16 v[68:71], v[96:99], a[56:59], v[68:71]
    v_exp_f32 v66, v66
    v_mfma_f32_16x16x32_bf16 v[68:71], v[100:103], a[60:63], v[68:71]
    s_waitcnt lgkmcnt(9)
    ds_read_b128 v[80:83], v7 offset:4096
    ds_read_b128 v[84:87], v8 offset:4096
    v_mfma_f32_16x16x32_bf16 v[136:139], a[224:227], v[192:195], v[136:139]
    s_waitcnt lgkmcnt(9)
    v_exp_f32 v67, v67
    v_mfma_f32_16x16x32_bf16 v[144:147], a[224:227], v[196:199], v[144:147]
    ds_read_b128 v[172:175], v0 offset:1280
    v_mfma_f32_16x16x32_bf16 v[140:143], a[228:231], v[192:195], v[140:143]
    v_exp_f32 v68, v68
    v_mfma_f32_16x16x32_bf16 v[148:151], a[228:231], v[196:199], v[148:151]
    s_waitcnt lgkmcnt(5)
    ds_read_b128 v[176:179], v0 offset:1536
    v_perm_b32 v108, v68, v64, s49
    v_mfma_f32_16x16x32_bf16 v[44:47], v[32:35], v[104:107], v[44:47]
    s_waitcnt lgkmcnt(4)
    ds_write_addtid_b32 v108 offset:6912
    ds_read_b128 v[180:183], v0 offset:1792
    v_mfma_f32_16x16x32_bf16 v[112:115], v[72:75], a[32:35], v[252:255]
    s_xor_b32 s27, s56, 16640
    v_exp_f32 v69, v69
    v_mfma_f32_16x16x32_bf16 v[112:115], v[76:79], a[36:39], v[112:115]
    s_waitcnt lgkmcnt(5)
    ds_read_b128 v[184:187], v2 offset:1024
    v_perm_b32 v109, v69, v65, s49
    v_mfma_f32_16x16x32_bf16 v[112:115], v[80:83], a[40:43], v[112:115]
    s_waitcnt lgkmcnt(5)
    v_exp_f32 v70, v70
    v_mfma_f32_16x16x32_bf16 v[112:115], v[84:87], a[44:47], v[112:115]
    ds_write_addtid_b32 v109 offset:13088
    v_perm_b32 v110, v70, v66, s49
    v_mfma_f32_16x16x32_bf16 v[152:155], a[128:131], v[168:171], 0
    s_waitcnt lgkmcnt(5)
    v_exp_f32 v71, v71
    v_mfma_f32_16x16x32_bf16 v[160:163], a[128:131], v[172:175], 0
    ds_write_addtid_b32 v110 offset:19328
    v_perm_b32 v111, v71, v67, s49
    v_mfma_f32_16x16x32_bf16 v[156:159], a[132:135], v[168:171], 0
    v_exp_f32 v112, v112
    v_mfma_f32_16x16x32_bf16 v[164:167], a[132:135], v[172:175], 0
    ds_write_addtid_b32 v111 offset:25504
    ds_read_b128 v[104:107], v0 offset:3840
    v_mfma_f32_16x16x32_bf16 v[68:71], v[72:75], a[48:51], v[252:255]
    v_exp_f32 v113, v113
    v_mfma_f32_16x16x32_bf16 v[68:71], v[76:79], a[52:55], v[68:71]
    buffer_load_dwordx4 a[80:83], v30, s[12:15], s27 offen offset:0 nt
    buffer_load_dwordx4 a[84:87], v30, s[12:15], s27 offen offset:64 nt
    ds_read_b128 v[88:91], v5 offset:5120
    ds_read_b128 v[92:95], v6 offset:5120
    v_mfma_f32_16x16x32_bf16 v[68:71], v[80:83], a[56:59], v[68:71]
    v_exp_f32 v114, v114
    v_mfma_f32_16x16x32_bf16 v[68:71], v[84:87], a[60:63], v[68:71]
    s_waitcnt lgkmcnt(9)
    ds_read_b128 v[96:99], v7 offset:5120
    ds_read_b128 v[100:103], v8 offset:5120
    v_mfma_f32_16x16x32_bf16 v[200:203], a[128:131], v[176:179], 0
    s_waitcnt lgkmcnt(9)
    v_exp_f32 v115, v115
    v_mfma_f32_16x16x32_bf16 v[208:211], a[128:131], v[180:183], 0
    ds_read_b128 v[188:191], v2 offset:1280
    v_mfma_f32_16x16x32_bf16 v[204:207], a[132:135], v[176:179], 0
    v_exp_f32 v68, v68
    v_mfma_f32_16x16x32_bf16 v[212:215], a[132:135], v[180:183], 0
    s_waitcnt lgkmcnt(5)
    ds_read_b128 v[192:195], v2 offset:1536
    v_perm_b32 v108, v68, v112, s49
    v_mfma_f32_16x16x32_bf16 v[44:47], v[36:39], v[104:107], v[44:47]
    s_waitcnt lgkmcnt(5)
    ds_write_addtid_b32 v108 offset:7168
    ds_read_b128 v[196:199], v2 offset:1792
    v_mfma_f32_16x16x32_bf16 v[64:67], v[88:91], a[32:35], v[252:255]
    s_waitcnt lgkmcnt(6)
    v_exp_f32 v69, v69
    v_mfma_f32_16x16x32_bf16 v[64:67], v[92:95], a[36:39], v[64:67]
    s_waitcnt lgkmcnt(5)
    ds_read_b128 v[168:171], v3 offset:1024
    v_perm_b32 v109, v69, v113, s49
    v_mfma_f32_16x16x32_bf16 v[64:67], v[96:99], a[40:43], v[64:67]
    s_waitcnt lgkmcnt(5)
    v_exp_f32 v70, v70
    v_mfma_f32_16x16x32_bf16 v[64:67], v[100:103], a[44:47], v[64:67]
    ds_write_addtid_b32 v109 offset:13344
    v_perm_b32 v110, v70, v114, s49
    v_mfma_f32_16x16x32_bf16 v[152:155], a[160:163], v[184:187], v[152:155]
    s_waitcnt lgkmcnt(5)
    v_exp_f32 v71, v71
    v_mfma_f32_16x16x32_bf16 v[160:163], a[160:163], v[188:191], v[160:163]
    ds_write_addtid_b32 v110 offset:19584
    v_perm_b32 v111, v71, v115, s49
    v_mfma_f32_16x16x32_bf16 v[156:159], a[164:167], v[184:187], v[156:159]
    v_exp_f32 v64, v64
    v_mfma_f32_16x16x32_bf16 v[164:167], a[164:167], v[188:191], v[164:167]
    ds_write_addtid_b32 v111 offset:25760
    ds_read_b128 v[104:107], v0 offset:4096
    v_mfma_f32_16x16x32_bf16 v[68:71], v[88:91], a[48:51], v[252:255]
    v_exp_f32 v65, v65
    v_mfma_f32_16x16x32_bf16 v[68:71], v[92:95], a[52:55], v[68:71]
    ds_read_b128 v[72:75], v5 offset:6144
    ds_read_b128 v[76:79], v6 offset:6144
    v_mfma_f32_16x16x32_bf16 v[68:71], v[96:99], a[56:59], v[68:71]
    v_exp_f32 v66, v66
    v_mfma_f32_16x16x32_bf16 v[68:71], v[100:103], a[60:63], v[68:71]
    s_waitcnt lgkmcnt(9)
    ds_read_b128 v[80:83], v7 offset:6144
    ds_read_b128 v[84:87], v8 offset:6144
    v_mfma_f32_16x16x32_bf16 v[200:203], a[160:163], v[192:195], v[200:203]
    s_waitcnt lgkmcnt(9)
    v_exp_f32 v67, v67
    v_mfma_f32_16x16x32_bf16 v[208:211], a[160:163], v[196:199], v[208:211]
    buffer_load_dwordx4 a[88:91], v30, s[12:15], s27 offen offset:128 nt
    ds_read_b128 v[172:175], v3 offset:1280
    ds_add_u32 v14, v16
    v_mfma_f32_16x16x32_bf16 v[204:207], a[164:167], v[192:195], v[204:207]
    v_exp_f32 v68, v68
    v_mfma_f32_16x16x32_bf16 v[212:215], a[164:167], v[196:199], v[212:215]
    s_waitcnt lgkmcnt(6)
    ds_read_b128 v[176:179], v3 offset:1536
    v_perm_b32 v108, v68, v64, s49
    v_mfma_f32_16x16x32_bf16 v[48:51], v[32:35], v[104:107], v[48:51]
    s_waitcnt lgkmcnt(5)
    ds_write_addtid_b32 v108 offset:7424
    ds_read_b128 v[180:183], v3 offset:1792
    v_mfma_f32_16x16x32_bf16 v[112:115], v[72:75], a[32:35], v[252:255]
    s_add_u32 s24, s24, 1
    v_exp_f32 v69, v69
    v_mfma_f32_16x16x32_bf16 v[112:115], v[76:79], a[36:39], v[112:115]
    s_waitcnt lgkmcnt(6)
    ds_read_b128 v[184:187], v4 offset:1024
    v_perm_b32 v109, v69, v65, s49
    v_mfma_f32_16x16x32_bf16 v[112:115], v[80:83], a[40:43], v[112:115]
    s_waitcnt lgkmcnt(6)
    v_exp_f32 v70, v70
    v_mfma_f32_16x16x32_bf16 v[112:115], v[84:87], a[44:47], v[112:115]
    ds_write_addtid_b32 v109 offset:13600
    v_perm_b32 v110, v70, v66, s49
    v_mfma_f32_16x16x32_bf16 v[152:155], a[192:195], v[168:171], v[152:155]
    s_waitcnt lgkmcnt(6)
    v_exp_f32 v71, v71
    v_mfma_f32_16x16x32_bf16 v[160:163], a[192:195], v[172:175], v[160:163]
    ds_write_addtid_b32 v110 offset:19840
    v_perm_b32 v111, v71, v67, s49
    v_mfma_f32_16x16x32_bf16 v[156:159], a[196:199], v[168:171], v[156:159]
    v_exp_f32 v112, v112
    v_mfma_f32_16x16x32_bf16 v[164:167], a[196:199], v[172:175], v[164:167]
    ds_write_addtid_b32 v111 offset:26016
    ds_read_b128 v[104:107], v0 offset:4352
    v_mfma_f32_16x16x32_bf16 v[68:71], v[72:75], a[48:51], v[252:255]
    v_exp_f32 v113, v113
L_pad1_b:
    s_cbranch_execz L_pad5_b
    v_mfma_f32_16x16x32_bf16 v[68:71], v[76:79], a[52:55], v[68:71]
    ds_read_b128 v[88:91], v5 offset:7168
    ds_read_b128 v[92:95], v6 offset:7168
    v_mfma_f32_16x16x32_bf16 v[68:71], v[80:83], a[56:59], v[68:71]
    v_exp_f32 v114, v114
    v_mfma_f32_16x16x32_bf16 v[68:71], v[84:87], a[60:63], v[68:71]
    s_waitcnt lgkmcnt(9)
    ds_read_b128 v[96:99], v7 offset:7168
    ds_read_b128 v[100:103], v8 offset:7168
    v_mfma_f32_16x16x32_bf16 v[200:203], a[192:195], v[176:179], v[200:203]
    s_waitcnt lgkmcnt(9)
    v_exp_f32 v115, v115
    v_mfma_f32_16x16x32_bf16 v[208:211], a[192:195], v[180:183], v[208:211]
    buffer_load_dwordx4 a[92:95], v30, s[12:15], s27 offen offset:192 nt
    ds_read_b128 v[188:191], v4 offset:1280
    v_mfma_f32_16x16x32_bf16 v[204:207], a[196:199], v[176:179], v[204:207]
    v_exp_f32 v68, v68
    v_mfma_f32_16x16x32_bf16 v[212:215], a[196:199], v[180:183], v[212:215]
    s_waitcnt lgkmcnt(5)
    ds_read_b128 v[192:195], v4 offset:1536
    v_perm_b32 v108, v68, v112, s49
    v_mfma_f32_16x16x32_bf16 v[48:51], v[36:39], v[104:107], v[48:51]
    s_waitcnt lgkmcnt(5)
    ds_write_addtid_b32 v108 offset:7680
    ds_read_b128 v[196:199], v4 offset:1792
    ds_read_b32 v19, v15
    v_mfma_f32_16x16x32_bf16 v[64:67], v[88:91], a[32:35], v[252:255]
    s_waitcnt lgkmcnt(7)
    v_exp_f32 v69, v69
    v_mfma_f32_16x16x32_bf16 v[64:67], v[92:95], a[36:39], v[64:67]
    s_waitcnt lgkmcnt(6)
    ds_read_b128 v[168:171], v0 offset:2048
    v_perm_b32 v109, v69, v113, s49
    v_mfma_f32_16x16x32_bf16 v[64:67], v[96:99], a[40:43], v[64:67]
    s_waitcnt lgkmcnt(6)
    v_exp_f32 v70, v70
    v_mfma_f32_16x16x32_bf16 v[64:67], v[100:103], a[44:47], v[64:67]
    ds_write_addtid_b32 v109 offset:13856
    v_perm_b32 v110, v70, v114, s49
    v_mfma_f32_16x16x32_bf16 v[152:155], a[224:227], v[184:187], v[152:155]
    s_waitcnt lgkmcnt(6)
    v_exp_f32 v71, v71
    v_mfma_f32_16x16x32_bf16 v[160:163], a[224:227], v[188:191], v[160:163]
    ds_write_addtid_b32 v110 offset:20096
    v_perm_b32 v111, v71, v115, s49
    v_mfma_f32_16x16x32_bf16 v[156:159], a[228:231], v[184:187], v[156:159]
    v_exp_f32 v64, v64
    v_mfma_f32_16x16x32_bf16 v[164:167], a[228:231], v[188:191], v[164:167]
    ds_write_addtid_b32 v111 offset:26272
    ds_read_b128 v[104:107], v0 offset:4608
    v_mfma_f32_16x16x32_bf16 v[68:71], v[88:91], a[48:51], v[252:255]
    v_exp_f32 v65, v65
    v_mfma_f32_16x16x32_bf16 v[68:71], v[92:95], a[52:55], v[68:71]
    ds_read_b128 v[72:75], v5 offset:8192
    ds_read_b128 v[76:79], v6 offset:8192
    v_mfma_f32_16x16x32_bf16 v[68:71], v[96:99], a[56:59], v[68:71]
    v_exp_f32 v66, v66
    v_mfma_f32_16x16x32_bf16 v[68:71], v[100:103], a[60:63], v[68:71]
    s_waitcnt lgkmcnt(7)
    ds_read_b128 v[80:83], v7 offset:8192
    ds_read_b128 v[84:87], v8 offset:8192
    v_cmp_gt_u32 vcc, s24, v19
    v_mfma_f32_16x16x32_bf16 v[200:203], a[224:227], v[192:195], v[200:203]
    v_exp_f32 v67, v67
    v_mfma_f32_16x16x32_bf16 v[208:211], a[224:227], v[196:199], v[208:211]
    ds_read_b128 v[172:175], v0 offset:2304
    v_mfma_f32_16x16x32_bf16 v[204:207], a[228:231], v[192:195], v[204:207]
    v_exp_f32 v68, v68
    v_mfma_f32_16x16x32_bf16 v[212:215], a[228:231], v[196:199], v[212:215]
    s_waitcnt lgkmcnt(5)
    ds_read_b128 v[176:179], v0 offset:2560
    v_perm_b32 v108, v68, v64, s49
    v_mfma_f32_16x16x32_bf16 v[52:55], v[32:35], v[104:107], v[52:55]
    s_waitcnt lgkmcnt(3)
    ds_write_addtid_b32 v108 offset:7936
    ds_read_b128 v[180:183], v0 offset:2816
    s_cbranch_vccnz L_retry101_b
L_back101_b:
    v_mfma_f32_16x16x32_bf16 v[112:115], v[72:75], a[32:35], v[252:255]
    s_xor_b32 s27, s56, 8192
    v_exp_f32 v69, v69
    v_mfma_f32_16x16x32_bf16 v[112:115], v[76:79], a[36:39], v[112:115]
    s_xor_b32 s26, s56, 12288
    ds_read_b128 v[184:187], v2 offset:2048
    v_perm_b32 v109, v69, v65, s49
    v_mfma_f32_16x16x32_bf16 v[112:115], v[80:83], a[40:43], v[112:115]
    s_waitcnt lgkmcnt(5)
    v_exp_f32 v70, v70
    v_mfma_f32_16x16x32_bf16 v[112:115], v[84:87], a[44:47], v[112:115]
    ds_write_addtid_b32 v109 offset:14112
    v_perm_b32 v110, v70, v66, s49
    v_mfma_f32_16x16x32_bf16 v[216:219], a[128:131], v[168:171], 0
    s_waitcnt lgkmcnt(5)
    v_exp_f32 v71, v71
    v_mfma_f32_16x16x32_bf16 v[224:227], a[128:131], v[172:175], 0
    ds_write_addtid_b32 v110 offset:20352
    v_perm_b32 v111, v71, v67, s49
    v_mfma_f32_16x16x32_bf16 v[220:223], a[132:135], v[168:171], 0
    v_exp_f32 v112, v112
    v_mfma_f32_16x16x32_bf16 v[228:231], a[132:135], v[172:175], 0
    ds_write_addtid_b32 v111 offset:26528
    ds_read_b128 v[104:107], v0 offset:4864
    v_mfma_f32_16x16x32_bf16 v[68:71], v[72:75], a[48:51], v[252:255]
    v_exp_f32 v113, v113
    v_mfma_f32_16x16x32_bf16 v[68:71], v[76:79], a[52:55], v[68:71]
    buffer_load_dwordx4 a[136:139], v31, s[16:19], s27 offen
    buffer_load_dwordx4 a[140:143], v31, s[16:19], s26 offen
    ds_read_b128 v[88:91], v5 offset:9216
    ds_read_b128 v[92:95], v6 offset:9216
    v_mfma_f32_16x16x32_bf16 v[68:71], v[80:83], a[56:59], v[68:71]
    v_exp_f32 v114, v114
    v_mfma_f32_16x16x32_bf16 v[68:71], v[84:87], a[60:63], v[68:71]
    s_waitcnt lgkmcnt(9)
    ds_read_b128 v[96:99], v7 offset:9216
    ds_read_b128 v[100:103], v8 offset:9216
    v_mfma_f32_16x16x32_bf16 v[232:235], a[128:131], v[176:179], 0
    s_waitcnt lgkmcnt(9)
    v_exp_f32 v115, v115
    v_mfma_f32_16x16x32_bf16 v[240:243], a[128:131], v[180:183], 0
    ds_read_b128 v[188:191], v2 offset:2304
    v_mfma_f32_16x16x32_bf16 v[236:239], a[132:135], v[176:179], 0
    v_exp_f32 v68, v68
    v_mfma_f32_16x16x32_bf16 v[244:247], a[132:135], v[180:183], 0
    s_waitcnt lgkmcnt(5)
    ds_read_b128 v[192:195], v2 offset:2560
    v_perm_b32 v108, v68, v112, s49
    v_mfma_f32_16x16x32_bf16 v[52:55], v[36:39], v[104:107], v[52:55]
    s_waitcnt lgkmcnt(5)
    ds_write_addtid_b32 v108 offset:8192
    ds_read_b128 v[196:199], v2 offset:2816
    v_mfma_f32_16x16x32_bf16 v[64:67], v[88:91], a[32:35], v[252:255]
    s_waitcnt lgkmcnt(6)
    v_exp_f32 v69, v69
    v_mfma_f32_16x16x32_bf16 v[64:67], v[92:95], a[36:39], v[64:67]
    s_waitcnt lgkmcnt(5)
    ds_read_b128 v[168:171], v3 offset:2048
    v_perm_b32 v109, v69, v113, s49
    v_mfma_f32_16x16x32_bf16 v[64:67], v[96:99], a[40:43], v[64:67]
    s_waitcnt lgkmcnt(5)
    v_exp_f32 v70, v70
    v_mfma_f32_16x16x32_bf16 v[64:67], v[100:103], a[44:47], v[64:67]
    ds_write_addtid_b32 v109 offset:14368
    v_perm_b32 v110, v70, v114, s49
    v_mfma_f32_16x16x32_bf16 v[216:219], a[160:163], v[184:187], v[216:219]
    s_waitcnt lgkmcnt(5)
    v_exp_f32 v71, v71
    v_mfma_f32_16x16x32_bf16 v[224:227], a[160:163], v[188:191], v[224:227]
    s_xor_b32 s27, s57, 8192
    ds_write_addtid_b32 v110 offset:20608
    v_perm_b32 v111, v71, v115, s49
    v_mfma_f32_16x16x32_bf16 v[220:223], a[164:167], v[184:187], v[220:223]
    s_xor_b32 s26, s57, 12288
    v_exp_f32 v64, v64
    v_mfma_f32_16x16x32_bf16 v[228:231], a[164:167], v[188:191], v[228:231]
    ds_write_addtid_b32 v111 offset:26784
    ds_read_b128 v[104:107], v0 offset:5120
    v_mfma_f32_16x16x32_bf16 v[68:71], v[88:91], a[48:51], v[252:255]
    v_exp_f32 v65, v65
    v_mfma_f32_16x16x32_bf16 v[68:71], v[92:95], a[52:55], v[68:71]
    ds_read_b128 v[72:75], v5 offset:10240
    ds_read_b128 v[76:79], v6 offset:10240
    v_mfma_f32_16x16x32_bf16 v[68:71], v[96:99], a[56:59], v[68:71]
    v_exp_f32 v66, v66
    v_mfma_f32_16x16x32_bf16 v[68:71], v[100:103], a[60:63], v[68:71]
    s_waitcnt lgkmcnt(9)
    ds_read_b128 v[80:83], v7 offset:10240
    ds_read_b128 v[84:87], v8 offset:10240
    v_mfma_f32_16x16x32_bf16 v[232:235], a[160:163], v[192:195], v[232:235]
    s_waitcnt lgkmcnt(9)
    v_exp_f32 v67, v67
    v_mfma_f32_16x16x32_bf16 v[240:243], a[160:163], v[196:199], v[240:243]
    buffer_load_dwordx4 a[168:171], v31, s[16:19], s27 offen
    ds_read_b128 v[172:175], v3 offset:2304
    v_mfma_f32_16x16x32_bf16 v[236:239], a[164:167], v[192:195], v[236:239]
    v_exp_f32 v68, v68
    v_mfma_f32_16x16x32_bf16 v[244:247], a[164:167], v[196:199], v[244:247]
    s_waitcnt lgkmcnt(5)
    ds_read_b128 v[176:179], v3 offset:2560
    v_perm_b32 v108, v68, v64, s49
    v_mfma_f32_16x16x32_bf16 v[56:59], v[32:35], v[104:107], v[56:59]
    s_waitcnt lgkmcnt(5)
    ds_write_addtid_b32 v108 offset:8448
    ds_read_b128 v[180:183], v3 offset:2816
    v_mfma_f32_16x16x32_bf16 v[112:115], v[72:75], a[32:35], v[252:255]
    s_waitcnt lgkmcnt(6)
    v_exp_f32 v69, v69
    v_mfma_f32_16x16x32_bf16 v[112:115], v[76:79], a[36:39], v[112:115]
    s_waitcnt lgkmcnt(5)
    ds_read_b128 v[184:187], v4 offset:2048
    v_perm_b32 v109, v69, v65, s49
    v_mfma_f32_16x16x32_bf16 v[112:115], v[80:83], a[40:43], v[112:115]
    s_waitcnt lgkmcnt(5)
    v_exp_f32 v70, v70
    v_mfma_f32_16x16x32_bf16 v[112:115], v[84:87], a[44:47], v[112:115]
    ds_write_addtid_b32 v109 offset:14624
    v_perm_b32 v110, v70, v66, s49
    v_mfma_f32_16x16x32_bf16 v[216:219], a[192:195], v[168:171], v[216:219]
    s_waitcnt lgkmcnt(5)
    v_exp_f32 v71, v71
    v_mfma_f32_16x16x32_bf16 v[224:227], a[192:195], v[172:175], v[224:227]
    ds_write_addtid_b32 v110 offset:20864
    v_perm_b32 v111, v71, v67, s49
    v_mfma_f32_16x16x32_bf16 v[220:223], a[196:199], v[168:171], v[220:223]
    v_exp_f32 v112, v112
    v_mfma_f32_16x16x32_bf16 v[228:231], a[196:199], v[172:175], v[228:231]
    ds_write_addtid_b32 v111 offset:27040
    ds_read_b128 v[104:107], v0 offset:5376
    v_mfma_f32_16x16x32_bf16 v[68:71], v[72:75], a[48:51], v[252:255]
    v_exp_f32 v113, v113
    v_mfma_f32_16x16x32_bf16 v[68:71], v[76:79], a[52:55], v[68:71]
    ds_read_b128 v[88:91], v5 offset:11264
    ds_read_b128 v[92:95], v6 offset:11264
    v_mfma_f32_16x16x32_bf16 v[68:71], v[80:83], a[56:59], v[68:71]
    v_exp_f32 v114, v114
    v_mfma_f32_16x16x32_bf16 v[68:71], v[84:87], a[60:63], v[68:71]
    s_waitcnt lgkmcnt(9)
    ds_read_b128 v[96:99], v7 offset:11264
    ds_read_b128 v[100:103], v8 offset:11264
    v_mfma_f32_16x16x32_bf16 v[232:235], a[192:195], v[176:179], v[232:235]
    s_waitcnt lgkmcnt(9)
    v_exp_f32 v115, v115
    v_mfma_f32_16x16x32_bf16 v[240:243], a[192:195], v[180:183], v[240:243]
    buffer_load_dwordx4 a[172:175], v31, s[16:19], s26 offen
    ds_read_b128 v[188:191], v4 offset:2304
    v_mfma_f32_16x16x32_bf16 v[236:239], a[196:199], v[176:179], v[236:239]
    v_exp_f32 v68, v68
    v_mfma_f32_16x16x32_bf16 v[244:247], a[196:199], v[180:183], v[244:247]
    s_waitcnt lgkmcnt(5)
    ds_read_b128 v[192:195], v4 offset:2560
    v_perm_b32 v108, v68, v112, s49
    v_mfma_f32_16x16x32_bf16 v[56:59], v[36:39], v[104:107], v[56:59]
    s_waitcnt lgkmcnt(5)
    ds_write_addtid_b32 v108 offset:8704
    ds_read_b128 v[196:199], v4 offset:2816
    v_mfma_f32_16x16x32_bf16 v[64:67], v[88:91], a[32:35], v[252:255]
    s_waitcnt lgkmcnt(6)
    v_exp_f32 v69, v69
    v_mfma_f32_16x16x32_bf16 v[64:67], v[92:95], a[36:39], v[64:67]
    s_waitcnt lgkmcnt(5)
    ds_read_b128 v[168:171], v0 offset:3072
    v_perm_b32 v109, v69, v113, s49
    v_mfma_f32_16x16x32_bf16 v[64:67], v[96:99], a[40:43], v[64:67]
    s_waitcnt lgkmcnt(5)
    v_exp_f32 v70, v70
    v_mfma_f32_16x16x32_bf16 v[64:67], v[100:103], a[44:47], v[64:67]
    ds_write_addtid_b32 v109 offset:14880
    v_perm_b32 v110, v70, v114, s49
    v_mfma_f32_16x16x32_bf16 v[216:219], a[224:227], v[184:187], v[216:219]
    s_waitcnt lgkmcnt(5)
    v_exp_f32 v71, v71
    v_mfma_f32_16x16x32_bf16 v[224:227], a[224:227], v[188:191], v[224:227]
    ds_write_addtid_b32 v110 offset:21120
    v_perm_b32 v111, v71, v115, s49
    v_mfma_f32_16x16x32_bf16 v[220:223], a[228:231], v[184:187], v[220:223]
    v_exp_f32 v64, v64
    v_mfma_f32_16x16x32_bf16 v[228:231], a[228:231], v[188:191], v[228:231]
    ds_write_addtid_b32 v111 offset:27296
    ds_read_b128 v[104:107], v0 offset:5632
    v_mfma_f32_16x16x32_bf16 v[68:71], v[88:91], a[48:51], v[252:255]
    v_exp_f32 v65, v65
    v_mfma_f32_16x16x32_bf16 v[68:71], v[92:95], a[52:55], v[68:71]
    ds_read_b128 v[72:75], v5 offset:0
    ds_read_b128 v[76:79], v6 offset:0
    v_mfma_f32_16x16x32_bf16 v[68:71], v[96:99], a[56:59], v[68:71]
    v_exp_f32 v66, v66
    v_mfma_f32_16x16x32_bf16 v[68:71], v[100:103], a[60:63], v[68:71]
    s_waitcnt lgkmcnt(9)
    ds_read_b128 v[80:83], v7 offset:0
    ds_read_b128 v[84:87], v8 offset:0
    v_mfma_f32_16x16x32_bf16 v[232:235], a[224:227], v[192:195], v[232:235]
    s_waitcnt lgkmcnt(9)
    v_exp_f32 v67, v67
    v_mfma_f32_16x16x32_bf16 v[240:243], a[224:227], v[196:199], v[240:243]
    ds_read_b128 v[172:175], v0 offset:3328
    v_mfma_f32_16x16x32_bf16 v[236:239], a[228:231], v[192:195], v[236:239]
    v_exp_f32 v68, v68
    v_mfma_f32_16x16x32_bf16 v[244:247], a[228:231], v[196:199], v[244:247]
    s_waitcnt lgkmcnt(5)
    ds_read_b128 v[176:179], v0 offset:3584
    v_perm_b32 v108, v68, v64, s49
    v_mfma_f32_16x16x32_bf16 v[60:63], v[32:35], v[104:107], v[60:63]
    ds_write_addtid_b32 v108 offset:8960
    ds_read_b128 v[180:183], v0 offset:3840
    s_waitcnt vmcnt(11)
    v_mfma_f32_16x16x32_bf16 v[184:187], v[22:25], a[64:67], 0
    v_mfma_f32_16x16x32_bf16 v[184:187], v[26:29], a[64:67], v[184:187]
    s_xor_b32 s27, s58, 8192
    s_xor_b32 s26, s58, 12288
    buffer_load_dwordx4 a[200:203], v31, s[16:19], s27 offen
    v_mfma_f32_16x16x32_bf16 v[188:191], v[20:23], a[64:67], 0
    v_mfma_f32_16x16x32_bf16 v[188:191], v[24:27], a[64:67], v[188:191]
    s_waitcnt vmcnt(11)
    v_mfma_f32_16x16x32_bf16 v[192:195], v[22:25], a[68:71], 0
    v_cvt_pk_bf16_f32 v184, v184, v185
    v_cvt_pk_bf16_f32 v186, v186, v187
    v_mfma_f32_16x16x32_bf16 v[192:195], v[26:29], a[68:71], v[192:195]
    buffer_load_dwordx4 a[204:207], v31, s[16:19], s26 offen
    v_accvgpr_write_b32 a64, v184
    v_accvgpr_write_b32 a65, v186
    v_mfma_f32_16x16x32_bf16 v[196:199], v[20:23], a[68:71], 0
    v_cvt_pk_bf16_f32 v188, v188, v189
    v_cvt_pk_bf16_f32 v190, v190, v191
    v_mfma_f32_16x16x32_bf16 v[196:199], v[24:27], a[68:71], v[196:199]
    v_accvgpr_write_b32 a66, v188
    v_accvgpr_write_b32 a67, v190
    s_waitcnt vmcnt(11)
    v_mfma_f32_16x16x32_bf16 v[184:187], v[22:25], a[72:75], 0
    v_cvt_pk_bf16_f32 v192, v192, v193
    v_cvt_pk_bf16_f32 v194, v194, v195
    v_mfma_f32_16x16x32_bf16 v[184:187], v[26:29], a[72:75], v[184:187]
    s_xor_b32 s27, s59, 8192
    s_xor_b32 s26, s59, 12288
    buffer_load_dwordx4 a[232:235], v31, s[16:19], s27 offen
    v_accvgpr_write_b32 a68, v192
    v_accvgpr_write_b32 a69, v194
    v_mfma_f32_16x16x32_bf16 v[188:191], v[20:23], a[72:75], 0
    v_cvt_pk_bf16_f32 v196, v196, v197
    v_cvt_pk_bf16_f32 v198, v198, v199
    v_mfma_f32_16x16x32_bf16 v[188:191], v[24:27], a[72:75], v[188:191]
    v_accvgpr_write_b32 a70, v196
    v_accvgpr_write_b32 a71, v198
    s_waitcnt vmcnt(11)
    v_mfma_f32_16x16x32_bf16 v[192:195], v[22:25], a[76:79], 0
    v_cvt_pk_bf16_f32 v184, v184, v185
    v_cvt_pk_bf16_f32 v186, v186, v187
    v_mfma_f32_16x16x32_bf16 v[192:195], v[26:29], a[76:79], v[192:195]
    buffer_load_dwordx4 a[236:239], v31, s[16:19], s26 offen
    v_accvgpr_write_b32 a72, v184
    v_accvgpr_write_b32 a73, v186
    v_mfma_f32_16x16x32_bf16 v[196:199], v[20:23], a[76:79], 0
    v_cvt_pk_bf16_f32 v188, v188, v189
    v_cvt_pk_bf16_f32 v190, v190, v191
    v_mfma_f32_16x16x32_bf16 v[196:199], v[24:27], a[76:79], v[196:199]
    v_accvgpr_write_b32 a74, v188
    v_accvgpr_write_b32 a75, v190
    s_waitcnt vmcnt(11)
    v_mfma_f32_16x16x32_bf16 v[184:187], v[22:25], a[80:83], 0
    v_cvt_pk_bf16_f32 v192, v192, v193
    v_cvt_pk_bf16_f32 v194, v194, v195
    v_mfma_f32_16x16x32_bf16 v[184:187], v[26:29], a[80:83], v[184:187]
    v_accvgpr_write_b32 a76, v192
    v_accvgpr_write_b32 a77, v194
    v_mfma_f32_16x16x32_bf16 v[188:191], v[20:23], a[80:83], 0
    v_cvt_pk_bf16_f32 v196, v196, v197
    v_cvt_pk_bf16_f32 v198, v198, v199
    v_mfma_f32_16x16x32_bf16 v[188:191], v[24:27], a[80:83], v[188:191]
    v_accvgpr_write_b32 a78, v196
    v_accvgpr_write_b32 a79, v198
    s_waitcnt vmcnt(10)
    v_mfma_f32_16x16x32_bf16 v[192:195], v[22:25], a[84:87], 0
    v_cvt_pk_bf16_f32 v184, v184, v185
    v_cvt_pk_bf16_f32 v186, v186, v187
    v_mfma_f32_16x16x32_bf16 v[192:195], v[26:29], a[84:87], v[192:195]
    v_accvgpr_write_b32 a80, v184
    v_accvgpr_write_b32 a81, v186
    v_mfma_f32_16x16x32_bf16 v[196:199], v[20:23], a[84:87], 0
    v_cvt_pk_bf16_f32 v188, v188, v189
    v_cvt_pk_bf16_f32 v190, v190, v191
    v_mfma_f32_16x16x32_bf16 v[196:199], v[24:27], a[84:87], v[196:199]
    v_accvgpr_write_b32 a82, v188
    v_accvgpr_write_b32 a83, v190
    s_waitcnt vmcnt(9)
    v_mfma_f32_16x16x32_bf16 v[184:187], v[22:25], a[88:91], 0
    v_cvt_pk_bf16_f32 v192, v192, v193
    v_cvt_pk_bf16_f32 v194, v194, v195
    v_mfma_f32_16x16x32_bf16 v[184:187], v[26:29], a[88:91], v[184:187]
    v_accvgpr_write_b32 a84, v192
    v_accvgpr_write_b32 a85, v194
    v_mfma_f32_16x16x32_bf16 v[188:191], v[20:23], a[88:91], 0
    v_cvt_pk_bf16_f32 v196, v196, v197
    v_cvt_pk_bf16_f32 v198, v198, v199
    v_mfma_f32_16x16x32_bf16 v[188:191], v[24:27], a[88:91], v[188:191]
    v_accvgpr_write_b32 a86, v196
    v_accvgpr_write_b32 a87, v198
    s_waitcnt vmcnt(8)
    v_mfma_f32_16x16x32_bf16 v[192:195], v[22:25], a[92:95], 0
    v_cvt_pk_bf16_f32 v184, v184, v185
    v_cvt_pk_bf16_f32 v186, v186, v187
    s_waitcnt vmcnt(7)
    ds_write_b128 v1, a[136:139] offset:0
    v_mfma_f32_16x16x32_bf16 v[192:195], v[26:29], a[92:95], v[192:195]
    v_accvgpr_write_b32 a88, v184
    v_accvgpr_write_b32 a89, v186
    s_waitcnt vmcnt(6)
    ds_write_b128 v1, a[140:143] offset:12416
    v_mfma_f32_16x16x32_bf16 v[196:199], v[20:23], a[92:95], 0
    v_cvt_pk_bf16_f32 v188, v188, v189
    v_cvt_pk_bf16_f32 v190, v190, v191
    ds_read_b64_tr_b16 a[136:137], v1 offset:0
    ds_read_b64_tr_b16 a[138:139], v1 offset:12416
    v_mfma_f32_16x16x32_bf16 v[196:199], v[24:27], a[92:95], v[196:199]
    v_accvgpr_write_b32 a90, v188
    v_accvgpr_write_b32 a91, v190
    s_waitcnt vmcnt(5) lgkmcnt(10)
    ds_read_b64_tr_b16 a[140:141], v1 offset:8
    ds_read_b64_tr_b16 a[142:143], v1 offset:12424
    v_cvt_pk_bf16_f32 v192, v192, v193
    v_cvt_pk_bf16_f32 v194, v194, v195
    v_accvgpr_write_b32 a92, v192
    v_accvgpr_write_b32 a93, v194
    v_cvt_pk_bf16_f32 v196, v196, v197
    v_cvt_pk_bf16_f32 v198, v198, v199
    v_accvgpr_write_b32 a94, v196
    v_accvgpr_write_b32 a95, v198
    v_mfma_f32_16x16x32_bf16 v[112:115], v[72:75], a[64:67], v[252:255]
    s_xor_b32 s27, s56, 24576
    ds_write_b128 v1, a[168:171] offset:0
    v_exp_f32 v69, v69
    v_mfma_f32_16x16x32_bf16 v[112:115], v[76:79], a[68:71], v[112:115]
    s_waitcnt lgkmcnt(12)
    ds_read_b128 v[184:187], v2 offset:3072
    v_perm_b32 v109, v69, v65, s49
    v_mfma_f32_16x16x32_bf16 v[112:115], v[80:83], a[72:75], v[112:115]
    s_waitcnt vmcnt(4) lgkmcnt(12)
    ds_write_b128 v1, a[172:175] offset:12416
    v_exp_f32 v70, v70
    v_mfma_f32_16x16x32_bf16 v[112:115], v[84:87], a[76:79], v[112:115]
    s_waitcnt lgkmcnt(5)
    ds_write_addtid_b32 v109 offset:15136
    v_perm_b32 v110, v70, v66, s49
    v_mfma_f32_16x16x32_bf16 v[120:123], a[136:139], v[168:171], v[120:123]
    v_exp_f32 v71, v71
    v_mfma_f32_16x16x32_bf16 v[128:131], a[136:139], v[172:175], v[128:131]
    s_waitcnt lgkmcnt(4)
    ds_write_addtid_b32 v110 offset:21376
    v_perm_b32 v111, v71, v67, s49
    v_mfma_f32_16x16x32_bf16 v[124:127], a[140:143], v[168:171], v[124:127]
    buffer_load_dwordx4 a[96:99], v30, s[12:15], s27 offen offset:0 nt
    buffer_load_dwordx4 a[100:103], v30, s[12:15], s27 offen offset:64 nt
    ds_read_b64_tr_b16 a[168:169], v1 offset:0
    ds_read_b64_tr_b16 a[170:171], v1 offset:12416
    ds_read_b64_tr_b16 a[172:173], v1 offset:8
    v_exp_f32 v112, v112
    v_mfma_f32_16x16x32_bf16 v[132:135], a[140:143], v[172:175], v[132:135]
    ds_write_addtid_b32 v111 offset:27552
    ds_read_b128 v[104:107], v0 offset:5888
    v_mfma_f32_16x16x32_bf16 v[68:71], v[72:75], a[80:83], v[252:255]
    v_exp_f32 v113, v113
    v_mfma_f32_16x16x32_bf16 v[68:71], v[76:79], a[84:87], v[68:71]
    ds_read_b128 v[88:91], v5 offset:1024
    ds_read_b128 v[92:95], v6 offset:1024
    v_mfma_f32_16x16x32_bf16 v[68:71], v[80:83], a[88:91], v[68:71]
    v_exp_f32 v114, v114
    v_mfma_f32_16x16x32_bf16 v[68:71], v[84:87], a[92:95], v[68:71]
    ds_read_b128 v[96:99], v7 offset:1024
    ds_read_b128 v[100:103], v8 offset:1024
    v_mfma_f32_16x16x32_bf16 v[136:139], a[136:139], v[176:179], v[136:139]
    v_exp_f32 v115, v115
    v_mfma_f32_16x16x32_bf16 v[144:147], a[136:139], v[180:183], v[144:147]
    ds_read_b128 v[188:191], v2 offset:3328
    ds_read_b64_tr_b16 a[174:175], v1 offset:12424
    v_mfma_f32_16x16x32_bf16 v[140:143], a[140:143], v[176:179], v[140:143]
    v_exp_f32 v68, v68
    v_mfma_f32_16x16x32_bf16 v[148:151], a[140:143], v[180:183], v[148:151]
    s_waitcnt lgkmcnt(6)
    ds_read_b128 v[192:195], v2 offset:3584
    v_perm_b32 v108, v68, v112, s49
    v_mfma_f32_16x16x32_bf16 v[60:63], v[36:39], v[104:107], v[60:63]
    s_waitcnt lgkmcnt(6)
    ds_write_addtid_b32 v108 offset:3072
    ds_read_b128 v[196:199], v2 offset:3840
    v_mfma_f32_16x16x32_bf16 v[64:67], v[88:91], a[64:67], v[252:255]
    s_waitcnt vmcnt(5) lgkmcnt(7)
    ds_write_b128 v1, a[200:203] offset:0
    v_exp_f32 v69, v69
    v_mfma_f32_16x16x32_bf16 v[64:67], v[92:95], a[68:71], v[64:67]
    s_waitcnt lgkmcnt(7)
    ds_read_b128 v[168:171], v3 offset:3072
    v_perm_b32 v109, v69, v113, s49
    v_mfma_f32_16x16x32_bf16 v[64:67], v[96:99], a[72:75], v[64:67]
    s_waitcnt vmcnt(4) lgkmcnt(7)
    ds_write_b128 v1, a[204:207] offset:12416
    v_exp_f32 v70, v70
    v_mfma_f32_16x16x32_bf16 v[64:67], v[100:103], a[76:79], v[64:67]
    ds_write_addtid_b32 v109 offset:9248
    ds_read_b64_tr_b16 a[200:201], v1 offset:0
    v_perm_b32 v110, v70, v114, s49
    v_mfma_f32_16x16x32_bf16 v[120:123], a[168:171], v[184:187], v[120:123]
    s_waitcnt lgkmcnt(9)
    ds_read_b64_tr_b16 a[202:203], v1 offset:12416
    v_exp_f32 v71, v71
    v_mfma_f32_16x16x32_bf16 v[128:131], a[168:171], v[188:191], v[128:131]
    s_waitcnt lgkmcnt(9)
    ds_write_addtid_b32 v110 offset:15488
    ds_read_b64_tr_b16 a[204:205], v1 offset:8
    v_perm_b32 v111, v71, v115, s49
    v_mfma_f32_16x16x32_bf16 v[124:127], a[172:175], v[184:187], v[124:127]
    ds_read_b64_tr_b16 a[206:207], v1 offset:12424
    v_exp_f32 v64, v64
    v_mfma_f32_16x16x32_bf16 v[132:135], a[172:175], v[188:191], v[132:135]
    ds_write_addtid_b32 v111 offset:21664
    ds_read_b128 v[104:107], v0 offset:0
    v_mfma_f32_16x16x32_bf16 v[68:71], v[88:91], a[80:83], v[252:255]
    v_exp_f32 v65, v65
    v_mfma_f32_16x16x32_bf16 v[68:71], v[92:95], a[84:87], v[68:71]
    ds_read_b128 v[72:75], v5 offset:2048
    ds_read_b128 v[76:79], v6 offset:2048
    v_mfma_f32_16x16x32_bf16 v[68:71], v[96:99], a[88:91], v[68:71]
    v_exp_f32 v66, v66
    v_mfma_f32_16x16x32_bf16 v[68:71], v[100:103], a[92:95], v[68:71]
    s_waitcnt lgkmcnt(15)
    ds_read_b128 v[80:83], v7 offset:2048
    ds_read_b128 v[84:87], v8 offset:2048
    v_mfma_f32_16x16x32_bf16 v[136:139], a[168:171], v[192:195], v[136:139]
    s_waitcnt lgkmcnt(15)
    v_exp_f32 v67, v67
    v_mfma_f32_16x16x32_bf16 v[144:147], a[168:171], v[196:199], v[144:147]
    ds_read_b128 v[172:175], v3 offset:3328
    ds_add_u32 v14, v16
    v_mfma_f32_16x16x32_bf16 v[140:143], a[172:175], v[192:195], v[140:143]
    v_exp_f32 v68, v68
    v_mfma_f32_16x16x32_bf16 v[148:151], a[172:175], v[196:199], v[148:151]
    s_waitcnt lgkmcnt(6)
    ds_read_b128 v[176:179], v3 offset:3584
    v_perm_b32 v108, v68, v64, s49
    v_mfma_f32_16x16x32_bf16 v[40:43], v[32:35], v[104:107], v[40:43]
    s_waitcnt vmcnt(3) lgkmcnt(5)
    buffer_load_dwordx4 a[104:107], v30, s[12:15], s27 offen offset:128 nt
    buffer_load_dwordx4 a[108:111], v30, s[12:15], s27 offen offset:192 nt
    ds_write_addtid_b32 v108 offset:3328
    ds_read_b128 v[180:183], v3 offset:3840
    v_mfma_f32_16x16x32_bf16 v[112:115], v[72:75], a[64:67], v[252:255]
    s_add_u32 s24, s24, 1
    ds_write_b128 v1, a[232:235] offset:0
    v_exp_f32 v69, v69
    v_mfma_f32_16x16x32_bf16 v[112:115], v[76:79], a[68:71], v[112:115]
    s_waitcnt lgkmcnt(7)
    ds_read_b128 v[184:187], v4 offset:3072
    v_perm_b32 v109, v69, v65, s49
    v_mfma_f32_16x16x32_bf16 v[112:115], v[80:83], a[72:75], v[112:115]
    s_waitcnt lgkmcnt(7)
    v_exp_f32 v70, v70
    v_mfma_f32_16x16x32_bf16 v[112:115], v[84:87], a[76:79], v[112:115]
    ds_write_addtid_b32 v109 offset:9504
    v_perm_b32 v110, v70, v66, s49
    v_mfma_f32_16x16x32_bf16 v[120:123], a[200:203], v[168:171], v[120:123]
    s_waitcnt lgkmcnt(7)
    v_exp_f32 v71, v71
    v_mfma_f32_16x16x32_bf16 v[128:131], a[200:203], v[172:175], v[128:131]
    ds_write_addtid_b32 v110 offset:15744
    v_perm_b32 v111, v71, v67, s49
    v_mfma_f32_16x16x32_bf16 v[124:127], a[204:207], v[168:171], v[124:127]
    v_exp_f32 v112, v112
    v_mfma_f32_16x16x32_bf16 v[132:135], a[204:207], v[172:175], v[132:135]
    s_waitcnt vmcnt(4)
    ds_write_addtid_b32 v111 offset:21920
    ds_read_b128 v[104:107], v0 offset:256
    v_mfma_f32_16x16x32_bf16 v[68:71], v[72:75], a[80:83], v[252:255]
    s_xor_b32 s27, s56, 24832
    ds_write_b128 v1, a[236:239] offset:12416
    v_exp_f32 v113, v113
    v_mfma_f32_16x16x32_bf16 v[68:71], v[76:79], a[84:87], v[68:71]
    ds_read_b128 v[88:91], v5 offset:3072
    ds_read_b128 v[92:95], v6 offset:3072
    ds_read_b64_tr_b16 a[232:233], v1 offset:0
    v_mfma_f32_16x16x32_bf16 v[68:71], v[80:83], a[88:91], v[68:71]
    ds_read_b64_tr_b16 a[234:235], v1 offset:12416
    v_exp_f32 v114, v114
    v_mfma_f32_16x16x32_bf16 v[68:71], v[84:87], a[92:95], v[68:71]
    s_waitcnt lgkmcnt(13)
    ds_read_b128 v[96:99], v7 offset:3072
    ds_read_b128 v[100:103], v8 offset:3072
    ds_read_b64_tr_b16 a[236:237], v1 offset:8
    v_mfma_f32_16x16x32_bf16 v[136:139], a[200:203], v[176:179], v[136:139]
    s_waitcnt lgkmcnt(14)
    v_exp_f32 v115, v115
    v_mfma_f32_16x16x32_bf16 v[144:147], a[200:203], v[180:183], v[144:147]
    ds_read_b128 v[188:191], v4 offset:3328
    ds_read_b64_tr_b16 a[238:239], v1 offset:12424
    v_mfma_f32_16x16x32_bf16 v[140:143], a[204:207], v[176:179], v[140:143]
    v_exp_f32 v68, v68
    v_mfma_f32_16x16x32_bf16 v[148:151], a[204:207], v[180:183], v[148:151]
    s_waitcnt lgkmcnt(10)
    ds_read_b128 v[192:195], v4 offset:3584
    v_perm_b32 v108, v68, v112, s49
    v_mfma_f32_16x16x32_bf16 v[40:43], v[36:39], v[104:107], v[40:43]
    s_waitcnt lgkmcnt(9)
    buffer_load_dwordx4 a[112:115], v30, s[12:15], s27 offen offset:0 nt
    ds_write_addtid_b32 v108 offset:3584
    ds_read_b128 v[196:199], v4 offset:3840
    ds_read_b32 v19, v15
    v_mfma_f32_16x16x32_bf16 v[64:67], v[88:91], a[64:67], v[252:255]
    s_waitcnt lgkmcnt(11)
    v_exp_f32 v69, v69
    v_mfma_f32_16x16x32_bf16 v[64:67], v[92:95], a[68:71], v[64:67]
    s_waitcnt lgkmcnt(8)
L_pad2_b:
    s_cbranch_execz L_pad6_b
    ds_read_b128 v[168:171], v0 offset:4096
    v_perm_b32 v109, v69, v113, s49
    v_mfma_f32_16x16x32_bf16 v[64:67], v[96:99], a[72:75], v[64:67]
    s_waitcnt lgkmcnt(8)
    v_exp_f32 v70, v70
    v_mfma_f32_16x16x32_bf16 v[64:67], v[100:103], a[76:79], v[64:67]
    ds_write_addtid_b32 v109 offset:9760
    v_perm_b32 v110, v70, v114, s49
    v_mfma_f32_16x16x32_bf16 v[120:123], a[232:235], v[184:187], v[120:123]
    s_waitcnt lgkmcnt(7)
    v_exp_f32 v71, v71
    v_mfma_f32_16x16x32_bf16 v[128:131], a[232:235], v[188:191], v[128:131]
    s_waitcnt lgkmcnt(6)
    ds_write_addtid_b32 v110 offset:16000
    v_perm_b32 v111, v71, v115, s49
    v_mfma_f32_16x16x32_bf16 v[124:127], a[236:239], v[184:187], v[124:127]
    v_exp_f32 v64, v64
    v_mfma_f32_16x16x32_bf16 v[132:135], a[236:239], v[188:191], v[132:135]
    ds_write_addtid_b32 v111 offset:22176
    ds_read_b128 v[104:107], v0 offset:512
    v_mfma_f32_16x16x32_bf16 v[68:71], v[88:91], a[80:83], v[252:255]
    v_exp_f32 v65, v65
    v_mfma_f32_16x16x32_bf16 v[68:71], v[92:95], a[84:87], v[68:71]
    ds_read_b128 v[72:75], v5 offset:4096
    ds_read_b128 v[76:79], v6 offset:4096
    v_mfma_f32_16x16x32_bf16 v[68:71], v[96:99], a[88:91], v[68:71]
    v_exp_f32 v66, v66
    v_mfma_f32_16x16x32_bf16 v[68:71], v[100:103], a[92:95], v[68:71]
    s_waitcnt lgkmcnt(7)
    ds_read_b128 v[80:83], v7 offset:4096
    ds_read_b128 v[84:87], v8 offset:4096
    v_cmp_gt_u32 vcc, s24, v19
    v_mfma_f32_16x16x32_bf16 v[136:139], a[232:235], v[192:195], v[136:139]
    v_exp_f32 v67, v67
    v_mfma_f32_16x16x32_bf16 v[144:147], a[232:235], v[196:199], v[144:147]
    ds_read_b128 v[172:175], v0 offset:4352
    v_mfma_f32_16x16x32_bf16 v[140:143], a[236:239], v[192:195], v[140:143]
    v_exp_f32 v68, v68
    v_mfma_f32_16x16x32_bf16 v[148:151], a[236:239], v[196:199], v[148:151]
    s_waitcnt lgkmcnt(5)
    ds_read_b128 v[176:179], v0 offset:4608
    v_perm_b32 v108, v68, v64, s49
    v_mfma_f32_16x16x32_bf16 v[44:47], v[32:35], v[104:107], v[44:47]
    s_waitcnt lgkmcnt(5)
    ds_write_addtid_b32 v108 offset:3840
    ds_read_b128 v[180:183], v0 offset:4864
    s_cbranch_vccnz L_retry103_b
L_back103_b:
    v_mfma_f32_16x16x32_bf16 v[112:115], v[72:75], a[64:67], v[252:255]
    s_waitcnt lgkmcnt(6)
    v_exp_f32 v69, v69
    v_mfma_f32_16x16x32_bf16 v[112:115], v[76:79], a[68:71], v[112:115]
    s_waitcnt lgkmcnt(5)
    ds_read_b128 v[184:187], v2 offset:4096
    v_perm_b32 v109, v69, v65, s49
    v_mfma_f32_16x16x32_bf16 v[112:115], v[80:83], a[72:75], v[112:115]
    s_waitcnt lgkmcnt(5)
    v_exp_f32 v70, v70
    v_mfma_f32_16x16x32_bf16 v[112:115], v[84:87], a[76:79], v[112:115]
    ds_write_addtid_b32 v109 offset:10016
    v_perm_b32 v110, v70, v66, s49
    v_mfma_f32_16x16x32_bf16 v[152:155], a[136:139], v[168:171], v[152:155]
    s_waitcnt lgkmcnt(5)
    v_exp_f32 v71, v71
    v_mfma_f32_16x16x32_bf16 v[160:163], a[136:139], v[172:175], v[160:163]
    ds_write_addtid_b32 v110 offset:16256
    v_perm_b32 v111, v71, v67, s49
    v_mfma_f32_16x16x32_bf16 v[156:159], a[140:143], v[168:171], v[156:159]
    buffer_load_dwordx4 a[116:119], v30, s[12:15], s27 offen offset:64 nt
    buffer_load_dwordx4 a[120:123], v30, s[12:15], s27 offen offset:128 nt
    v_exp_f32 v112, v112
    v_mfma_f32_16x16x32_bf16 v[164:167], a[140:143], v[172:175], v[164:167]
    ds_write_addtid_b32 v111 offset:22432
    ds_read_b128 v[104:107], v0 offset:768
    v_mfma_f32_16x16x32_bf16 v[68:71], v[72:75], a[80:83], v[252:255]
    v_exp_f32 v113, v113
    v_mfma_f32_16x16x32_bf16 v[68:71], v[76:79], a[84:87], v[68:71]
    ds_read_b128 v[88:91], v5 offset:5120
    ds_read_b128 v[92:95], v6 offset:5120
    v_mfma_f32_16x16x32_bf16 v[68:71], v[80:83], a[88:91], v[68:71]
    v_exp_f32 v114, v114
    v_mfma_f32_16x16x32_bf16 v[68:71], v[84:87], a[92:95], v[68:71]
    s_waitcnt lgkmcnt(9)
    ds_read_b128 v[96:99], v7 offset:5120
    ds_read_b128 v[100:103], v8 offset:5120
    v_mfma_f32_16x16x32_bf16 v[200:203], a[136:139], v[176:179], v[200:203]
    s_waitcnt lgkmcnt(9)
    v_exp_f32 v115, v115
    v_mfma_f32_16x16x32_bf16 v[208:211], a[136:139], v[180:183], v[208:211]
    ds_read_b128 v[188:191], v2 offset:4352
    v_mfma_f32_16x16x32_bf16 v[204:207], a[140:143], v[176:179], v[204:207]
    v_exp_f32 v68, v68
    v_mfma_f32_16x16x32_bf16 v[212:215], a[140:143], v[180:183], v[212:215]
    s_waitcnt lgkmcnt(5)
    ds_read_b128 v[192:195], v2 offset:4608
    v_perm_b32 v108, v68, v112, s49
    v_mfma_f32_16x16x32_bf16 v[44:47], v[36:39], v[104:107], v[44:47]
    s_waitcnt lgkmcnt(5)
    ds_write_addtid_b32 v108 offset:4096
    ds_read_b128 v[196:199], v2 offset:4864
    v_mfma_f32_16x16x32_bf16 v[64:67], v[88:91], a[64:67], v[252:255]
    s_waitcnt lgkmcnt(6)
    v_exp_f32 v69, v69
    v_mfma_f32_16x16x32_bf16 v[64:67], v[92:95], a[68:71], v[64:67]
    s_waitcnt lgkmcnt(5)
    ds_read_b128 v[168:171], v3 offset:4096
    v_perm_b32 v109, v69, v113, s49
    v_mfma_f32_16x16x32_bf16 v[64:67], v[96:99], a[72:75], v[64:67]
    s_waitcnt lgkmcnt(5)
    v_exp_f32 v70, v70
    v_mfma_f32_16x16x32_bf16 v[64:67], v[100:103], a[76:79], v[64:67]
    ds_write_addtid_b32 v109 offset:10272
    v_perm_b32 v110, v70, v114, s49
    v_mfma_f32_16x16x32_bf16 v[152:155], a[168:171], v[184:187], v[152:155]
    s_waitcnt lgkmcnt(5)
    v_exp_f32 v71, v71
    v_mfma_f32_16x16x32_bf16 v[160:163], a[168:171], v[188:191], v[160:163]
    ds_write_addtid_b32 v110 offset:16512
    v_perm_b32 v111, v71, v115, s49
    v_mfma_f32_16x16x32_bf16 v[156:159], a[172:175], v[184:187], v[156:159]
    v_exp_f32 v64, v64
    v_mfma_f32_16x16x32_bf16 v[164:167], a[172:175], v[188:191], v[164:167]
    ds_write_addtid_b32 v111 offset:22688
    ds_read_b128 v[104:107], v0 offset:1024
    v_mfma_f32_16x16x32_bf16 v[68:71], v[88:91], a[80:83], v[252:255]
    v_exp_f32 v65, v65
    v_mfma_f32_16x16x32_bf16 v[68:71], v[92:95], a[84:87], v[68:71]
    ds_read_b128 v[72:75], v5 offset:6144
    ds_read_b128 v[76:79], v6 offset:6144
    v_mfma_f32_16x16x32_bf16 v[68:71], v[96:99], a[88:91], v[68:71]
    v_exp_f32 v66, v66
    v_mfma_f32_16x16x32_bf16 v[68:71], v[100:103], a[92:95], v[68:71]
    s_waitcnt lgkmcnt(9)
    ds_read_b128 v[80:83], v7 offset:6144
    ds_read_b128 v[84:87], v8 offset:6144
    v_mfma_f32_16x16x32_bf16 v[200:203], a[168:171], v[192:195], v[200:203]
    s_waitcnt lgkmcnt(9)
    v_exp_f32 v67, v67
    v_mfma_f32_16x16x32_bf16 v[208:211], a[168:171], v[196:199], v[208:211]
    s_waitcnt lgkmcnt(4)
    buffer_load_dwordx4 a[124:127], v30, s[12:15], s27 offen offset:192 nt
    ds_read_b128 v[172:175], v3 offset:4352
    v_mfma_f32_16x16x32_bf16 v[204:207], a[172:175], v[192:195], v[204:207]
    s_mov_b32 s21, 49152
    v_exp_f32 v68, v68
    v_mfma_f32_16x16x32_bf16 v[212:215], a[172:175], v[196:199], v[212:215]
    s_add_u32 m0, s23, 12288
    ds_read_b128 v[176:179], v3 offset:4608
    v_perm_b32 v108, v68, v64, s49
    v_mfma_f32_16x16x32_bf16 v[48:51], v[32:35], v[104:107], v[48:51]
    s_waitcnt lgkmcnt(5)
    buffer_load_dwordx4 v9, s[4:7], s21 offen nt lds
    ds_write_addtid_b32 v108 offset:3328
    ds_read_b128 v[180:183], v3 offset:4864
    v_mfma_f32_16x16x32_bf16 v[112:115], v[72:75], a[64:67], v[252:255]
    s_waitcnt lgkmcnt(6)
    v_exp_f32 v69, v69
    v_mfma_f32_16x16x32_bf16 v[112:115], v[76:79], a[68:71], v[112:115]
    s_waitcnt lgkmcnt(5)
    ds_read_b128 v[184:187], v4 offset:4096
    v_perm_b32 v109, v69, v65, s49
    v_mfma_f32_16x16x32_bf16 v[112:115], v[80:83], a[72:75], v[112:115]
    s_waitcnt lgkmcnt(5)
    v_exp_f32 v70, v70
    v_mfma_f32_16x16x32_bf16 v[112:115], v[84:87], a[76:79], v[112:115]
    ds_write_addtid_b32 v109 offset:9504
    v_perm_b32 v110, v70, v66, s49
    v_mfma_f32_16x16x32_bf16 v[152:155], a[200:203], v[168:171], v[152:155]
    s_waitcnt lgkmcnt(5)
    v_exp_f32 v71, v71
    v_mfma_f32_16x16x32_bf16 v[160:163], a[200:203], v[172:175], v[160:163]
    ds_write_addtid_b32 v110 offset:15744
    v_perm_b32 v111, v71, v67, s49
    v_mfma_f32_16x16x32_bf16 v[156:159], a[204:207], v[168:171], v[156:159]
    v_exp_f32 v112, v112
    v_mfma_f32_16x16x32_bf16 v[164:167], a[204:207], v[172:175], v[164:167]
    ds_write_addtid_b32 v111 offset:21920
    ds_read_b128 v[104:107], v0 offset:1280
    v_mfma_f32_16x16x32_bf16 v[68:71], v[72:75], a[80:83], v[252:255]
    s_mov_b32 s21, 53248
    v_exp_f32 v113, v113
    v_mfma_f32_16x16x32_bf16 v[68:71], v[76:79], a[84:87], v[68:71]
    s_add_u32 m0, s23, 13312
    ds_read_b128 v[88:91], v5 offset:7168
    ds_read_b128 v[92:95], v6 offset:7168
    v_mfma_f32_16x16x32_bf16 v[68:71], v[80:83], a[88:91], v[68:71]
    v_exp_f32 v114, v114
    v_mfma_f32_16x16x32_bf16 v[68:71], v[84:87], a[92:95], v[68:71]
    s_waitcnt lgkmcnt(9)
    ds_read_b128 v[96:99], v7 offset:7168
    ds_read_b128 v[100:103], v8 offset:7168
    v_mfma_f32_16x16x32_bf16 v[200:203], a[200:203], v[176:179], v[200:203]
    s_waitcnt lgkmcnt(9)
    v_exp_f32 v115, v115
    v_mfma_f32_16x16x32_bf16 v[208:211], a[200:203], v[180:183], v[208:211]
    buffer_load_dwordx4 v9, s[4:7], s21 offen nt lds
    ds_read_b128 v[188:191], v4 offset:4352
    v_mfma_f32_16x16x32_bf16 v[204:207], a[204:207], v[176:179], v[204:207]
    v_exp_f32 v68, v68
    v_mfma_f32_16x16x32_bf16 v[212:215], a[204:207], v[180:183], v[212:215]
    s_waitcnt lgkmcnt(5)
    ds_read_b128 v[192:195], v4 offset:4608
    v_perm_b32 v108, v68, v112, s49
    v_mfma_f32_16x16x32_bf16 v[48:51], v[36:39], v[104:107], v[48:51]
    s_waitcnt lgkmcnt(5)
    ds_write_addtid_b32 v108 offset:2560
    ds_read_b128 v[196:199], v4 offset:4864
    v_mfma_f32_16x16x32_bf16 v[64:67], v[88:91], a[64:67], v[252:255]
    s_waitcnt lgkmcnt(6)
    v_exp_f32 v69, v69
    v_mfma_f32_16x16x32_bf16 v[64:67], v[92:95], a[68:71], v[64:67]
    s_waitcnt lgkmcnt(5)
    ds_read_b128 v[168:171], v0 offset:5120
    v_perm_b32 v109, v69, v113, s49
    v_mfma_f32_16x16x32_bf16 v[64:67], v[96:99], a[72:75], v[64:67]
    s_waitcnt lgkmcnt(5)
    v_exp_f32 v70, v70
    v_mfma_f32_16x16x32_bf16 v[64:67], v[100:103], a[76:79], v[64:67]
    ds_write_addtid_b32 v109 offset:8736
    v_perm_b32 v110, v70, v114, s49
    v_mfma_f32_16x16x32_bf16 v[152:155], a[232:235], v[184:187], v[152:155]
    s_waitcnt lgkmcnt(5)
    v_exp_f32 v71, v71
    v_mfma_f32_16x16x32_bf16 v[160:163], a[232:235], v[188:191], v[160:163]
    ds_write_addtid_b32 v110 offset:14976
    v_perm_b32 v111, v71, v115, s49
    v_mfma_f32_16x16x32_bf16 v[156:159], a[236:239], v[184:187], v[156:159]
    v_exp_f32 v64, v64
    v_mfma_f32_16x16x32_bf16 v[164:167], a[236:239], v[188:191], v[164:167]
    ds_write_addtid_b32 v111 offset:21152
    ds_read_b128 v[104:107], v0 offset:1536
    v_mfma_f32_16x16x32_bf16 v[68:71], v[88:91], a[80:83], v[252:255]
    v_exp_f32 v65, v65
    v_mfma_f32_16x16x32_bf16 v[68:71], v[92:95], a[84:87], v[68:71]
    ds_read_b128 v[72:75], v5 offset:8192
    ds_read_b128 v[76:79], v6 offset:8192
    v_mfma_f32_16x16x32_bf16 v[68:71], v[96:99], a[88:91], v[68:71]
    v_exp_f32 v66, v66
    v_mfma_f32_16x16x32_bf16 v[68:71], v[100:103], a[92:95], v[68:71]
    s_waitcnt lgkmcnt(9)
    ds_read_b128 v[80:83], v7 offset:8192
    ds_read_b128 v[84:87], v8 offset:8192
    v_mfma_f32_16x16x32_bf16 v[200:203], a[232:235], v[192:195], v[200:203]
    s_waitcnt lgkmcnt(9)
    v_exp_f32 v67, v67
    v_mfma_f32_16x16x32_bf16 v[208:211], a[232:235], v[196:199], v[208:211]
    ds_read_b128 v[172:175], v0 offset:5376
    v_mfma_f32_16x16x32_bf16 v[204:207], a[236:239], v[192:195], v[204:207]
    v_exp_f32 v68, v68
    v_mfma_f32_16x16x32_bf16 v[212:215], a[236:239], v[196:199], v[212:215]
    s_waitcnt lgkmcnt(5)
    ds_read_b128 v[176:179], v0 offset:5632
    v_perm_b32 v108, v68, v64, s49
    v_mfma_f32_16x16x32_bf16 v[52:55], v[32:35], v[104:107], v[52:55]
    s_waitcnt lgkmcnt(3)
    ds_write_addtid_b32 v108 offset:2816
    ds_read_b128 v[180:183], v0 offset:5888
    v_mfma_f32_16x16x32_bf16 v[112:115], v[72:75], a[64:67], v[252:255]
    s_xor_b32 s27, s56, 16384
    v_exp_f32 v69, v69
    v_mfma_f32_16x16x32_bf16 v[112:115], v[76:79], a[68:71], v[112:115]
    s_xor_b32 s26, s56, 20480
    ds_read_b128 v[184:187], v2 offset:5120
    v_perm_b32 v109, v69, v65, s49
    v_mfma_f32_16x16x32_bf16 v[112:115], v[80:83], a[72:75], v[112:115]
    s_waitcnt lgkmcnt(5)
    v_exp_f32 v70, v70
    v_mfma_f32_16x16x32_bf16 v[112:115], v[84:87], a[76:79], v[112:115]
    ds_write_addtid_b32 v109 offset:8992
    v_perm_b32 v110, v70, v66, s49
    v_mfma_f32_16x16x32_bf16 v[216:219], a[136:139], v[168:171], v[216:219]
    s_waitcnt lgkmcnt(5)
    v_exp_f32 v71, v71
    v_mfma_f32_16x16x32_bf16 v[224:227], a[136:139], v[172:175], v[224:227]
    ds_write_addtid_b32 v110 offset:15232
    v_perm_b32 v111, v71, v67, s49
    v_mfma_f32_16x16x32_bf16 v[220:223], a[140:143], v[168:171], v[220:223]
    v_exp_f32 v112, v112
    v_mfma_f32_16x16x32_bf16 v[228:231], a[140:143], v[172:175], v[228:231]
    ds_write_addtid_b32 v111 offset:21408
    ds_read_b128 v[104:107], v0 offset:1792
    v_mfma_f32_16x16x32_bf16 v[68:71], v[72:75], a[80:83], v[252:255]
    v_exp_f32 v113, v113
    v_mfma_f32_16x16x32_bf16 v[68:71], v[76:79], a[84:87], v[68:71]
    buffer_load_dwordx4 a[144:147], v31, s[16:19], s27 offen
    buffer_load_dwordx4 a[148:151], v31, s[16:19], s26 offen
    ds_read_b128 v[88:91], v5 offset:9216
    ds_read_b128 v[92:95], v6 offset:9216
    v_mfma_f32_16x16x32_bf16 v[68:71], v[80:83], a[88:91], v[68:71]
    v_exp_f32 v114, v114
    v_mfma_f32_16x16x32_bf16 v[68:71], v[84:87], a[92:95], v[68:71]
    s_waitcnt lgkmcnt(9)
    ds_read_b128 v[96:99], v7 offset:9216
    ds_read_b128 v[100:103], v8 offset:9216
    v_mfma_f32_16x16x32_bf16 v[232:235], a[136:139], v[176:179], v[232:235]
    s_waitcnt lgkmcnt(9)
    v_exp_f32 v115, v115
    v_mfma_f32_16x16x32_bf16 v[240:243], a[136:139], v[180:183], v[240:243]
    ds_read_b128 v[188:191], v2 offset:5376
    v_mfma_f32_16x16x32_bf16 v[236:239], a[140:143], v[176:179], v[236:239]
    v_exp_f32 v68, v68
    v_mfma_f32_16x16x32_bf16 v[244:247], a[140:143], v[180:183], v[244:247]
    s_waitcnt lgkmcnt(5)
    ds_read_b128 v[192:195], v2 offset:5632
    v_perm_b32 v108, v68, v112, s49
    v_mfma_f32_16x16x32_bf16 v[52:55], v[36:39], v[104:107], v[52:55]
    s_waitcnt lgkmcnt(5)
    ds_write_addtid_b32 v108 offset:3072
    ds_read_b128 v[196:199], v2 offset:5888
    v_mfma_f32_16x16x32_bf16 v[64:67], v[88:91], a[64:67], v[252:255]
    s_waitcnt lgkmcnt(6)
    v_exp_f32 v69, v69
    v_mfma_f32_16x16x32_bf16 v[64:67], v[92:95], a[68:71], v[64:67]
    s_waitcnt lgkmcnt(5)
    ds_read_b128 v[168:171], v3 offset:5120
    v_perm_b32 v109, v69, v113, s49
    v_mfma_f32_16x16x32_bf16 v[64:67], v[96:99], a[72:75], v[64:67]
    s_waitcnt lgkmcnt(5)
    v_exp_f32 v70, v70
    v_mfma_f32_16x16x32_bf16 v[64:67], v[100:103], a[76:79], v[64:67]
    ds_write_addtid_b32 v109 offset:9248
    v_perm_b32 v110, v70, v114, s49
    v_mfma_f32_16x16x32_bf16 v[216:219], a[168:171], v[184:187], v[216:219]
    s_waitcnt lgkmcnt(5)
    v_exp_f32 v71, v71
    v_mfma_f32_16x16x32_bf16 v[224:227], a[168:171], v[188:191], v[224:227]
    s_xor_b32 s27, s57, 16384
    ds_write_addtid_b32 v110 offset:15488
    v_perm_b32 v111, v71, v115, s49
    v_mfma_f32_16x16x32_bf16 v[220:223], a[172:175], v[184:187], v[220:223]
    s_xor_b32 s26, s57, 20480
    v_exp_f32 v64, v64
    v_mfma_f32_16x16x32_bf16 v[228:231], a[172:175], v[188:191], v[228:231]
    ds_write_addtid_b32 v111 offset:21664
    ds_read_b128 v[104:107], v0 offset:2048
    v_mfma_f32_16x16x32_bf16 v[68:71], v[88:91], a[80:83], v[252:255]
    v_exp_f32 v65, v65
    v_mfma_f32_16x16x32_bf16 v[68:71], v[92:95], a[84:87], v[68:71]
    ds_read_b128 v[72:75], v5 offset:10240
    ds_read_b128 v[76:79], v6 offset:10240
    v_mfma_f32_16x16x32_bf16 v[68:71], v[96:99], a[88:91], v[68:71]
    v_exp_f32 v66, v66
    v_mfma_f32_16x16x32_bf16 v[68:71], v[100:103], a[92:95], v[68:71]
    s_waitcnt lgkmcnt(9)
    ds_read_b128 v[80:83], v7 offset:10240
    ds_read_b128 v[84:87], v8 offset:10240
    v_mfma_f32_16x16x32_bf16 v[232:235], a[168:171], v[192:195], v[232:235]
    s_waitcnt lgkmcnt(9)
    v_exp_f32 v67, v67
    v_mfma_f32_16x16x32_bf16 v[240:243], a[168:171], v[196:199], v[240:243]
    buffer_load_dwordx4 a[176:179], v31, s[16:19], s27 offen
    ds_read_b128 v[172:175], v3 offset:5376
    ds_add_u32 v14, v16
    v_mfma_f32_16x16x32_bf16 v[236:239], a[172:175], v[192:195], v[236:239]
    v_exp_f32 v68, v68
    v_mfma_f32_16x16x32_bf16 v[244:247], a[172:175], v[196:199], v[244:247]
    s_waitcnt lgkmcnt(6)
    ds_read_b128 v[176:179], v3 offset:5632
    v_perm_b32 v108, v68, v64, s49
    v_mfma_f32_16x16x32_bf16 v[56:59], v[32:35], v[104:107], v[56:59]
    s_waitcnt lgkmcnt(5)
    ds_write_addtid_b32 v108 offset:3328
    ds_read_b128 v[180:183], v3 offset:5888
    v_mfma_f32_16x16x32_bf16 v[112:115], v[72:75], a[64:67], v[252:255]
    s_add_u32 s24, s24, 1
    v_exp_f32 v69, v69
    v_mfma_f32_16x16x32_bf16 v[112:115], v[76:79], a[68:71], v[112:115]
    s_waitcnt lgkmcnt(6)
    ds_read_b128 v[184:187], v4 offset:5120
    v_perm_b32 v109, v69, v65, s49
    v_mfma_f32_16x16x32_bf16 v[112:115], v[80:83], a[72:75], v[112:115]
    s_waitcnt lgkmcnt(6)
    v_exp_f32 v70, v70
    v_mfma_f32_16x16x32_bf16 v[112:115], v[84:87], a[76:79], v[112:115]
    ds_write_addtid_b32 v109 offset:9504
    v_perm_b32 v110, v70, v66, s49
    v_mfma_f32_16x16x32_bf16 v[216:219], a[200:203], v[168:171], v[216:219]
    s_waitcnt lgkmcnt(6)
    v_exp_f32 v71, v71
    v_mfma_f32_16x16x32_bf16 v[224:227], a[200:203], v[172:175], v[224:227]
    ds_write_addtid_b32 v110 offset:15744
    v_perm_b32 v111, v71, v67, s49
    v_mfma_f32_16x16x32_bf16 v[220:223], a[204:207], v[168:171], v[220:223]
    v_exp_f32 v112, v112
    v_mfma_f32_16x16x32_bf16 v[228:231], a[204:207], v[172:175], v[228:231]
    ds_write_addtid_b32 v111 offset:21920
    ds_read_b128 v[104:107], v0 offset:2304
    v_mfma_f32_16x16x32_bf16 v[68:71], v[72:75], a[80:83], v[252:255]
    v_exp_f32 v113, v113
    v_mfma_f32_16x16x32_bf16 v[68:71], v[76:79], a[84:87], v[68:71]
    ds_read_b128 v[88:91], v5 offset:11264
    ds_read_b128 v[92:95], v6 offset:11264
    v_mfma_f32_16x16x32_bf16 v[68:71], v[80:83], a[88:91], v[68:71]
    v_exp_f32 v114, v114
    v_mfma_f32_16x16x32_bf16 v[68:71], v[84:87], a[92:95], v[68:71]
    s_waitcnt lgkmcnt(9)
    ds_read_b128 v[96:99], v7 offset:11264
    ds_read_b128 v[100:103], v8 offset:11264
    v_mfma_f32_16x16x32_bf16 v[232:235], a[200:203], v[176:179], v[232:235]
    s_waitcnt lgkmcnt(9)
    v_exp_f32 v115, v115
    v_mfma_f32_16x16x32_bf16 v[240:243], a[200:203], v[180:183], v[240:243]
    buffer_load_dwordx4 a[180:183], v31, s[16:19], s26 offen
    ds_read_b128 v[188:191], v4 offset:5376
    v_mfma_f32_16x16x32_bf16 v[236:239], a[204:207], v[176:179], v[236:239]
    v_exp_f32 v68, v68
    v_mfma_f32_16x16x32_bf16 v[244:247], a[204:207], v[180:183], v[244:247]
    s_waitcnt lgkmcnt(5)
    ds_read_b128 v[192:195], v4 offset:5632
    v_perm_b32 v108, v68, v112, s49
    v_mfma_f32_16x16x32_bf16 v[56:59], v[36:39], v[104:107], v[56:59]
    s_waitcnt lgkmcnt(5)
    ds_write_addtid_b32 v108 offset:3584
    ds_read_b128 v[196:199], v4 offset:5888
    ds_read_b32 v19, v15
    v_mfma_f32_16x16x32_bf16 v[64:67], v[88:91], a[64:67], v[252:255]
    s_waitcnt lgkmcnt(7)
    v_exp_f32 v69, v69
    v_mfma_f32_16x16x32_bf16 v[64:67], v[92:95], a[68:71], v[64:67]
    s_waitcnt lgkmcnt(6)
    ds_read_b128 v[168:171], v0 offset:0
    v_perm_b32 v109, v69, v113, s49
    v_mfma_f32_16x16x32_bf16 v[64:67], v[96:99], a[72:75], v[64:67]
    s_waitcnt lgkmcnt(6)
    v_exp_f32 v70, v70
    v_mfma_f32_16x16x32_bf16 v[64:67], v[100:103], a[76:79], v[64:67]
    ds_write_addtid_b32 v109 offset:9760
    v_perm_b32 v110, v70, v114, s49
    v_mfma_f32_16x16x32_bf16 v[216:219], a[232:235], v[184:187], v[216:219]
    s_waitcnt lgkmcnt(6)
    v_exp_f32 v71, v71
    v_mfma_f32_16x16x32_bf16 v[224:227], a[232:235], v[188:191], v[224:227]
    ds_write_addtid_b32 v110 offset:16000
    v_perm_b32 v111, v71, v115, s49
    v_mfma_f32_16x16x32_bf16 v[220:223], a[236:239], v[184:187], v[220:223]
    v_exp_f32 v64, v64
    v_mfma_f32_16x16x32_bf16 v[228:231], a[236:239], v[188:191], v[228:231]
    ds_write_addtid_b32 v111 offset:22176
    ds_read_b128 v[104:107], v0 offset:2560
    v_mfma_f32_16x16x32_bf16 v[68:71], v[88:91], a[80:83], v[252:255]
    v_exp_f32 v65, v65
    v_mfma_f32_16x16x32_bf16 v[68:71], v[92:95], a[84:87], v[68:71]
    ds_read_b128 v[72:75], v5 offset:0
    ds_read_b128 v[76:79], v6 offset:0
    v_mfma_f32_16x16x32_bf16 v[68:71], v[96:99], a[88:91], v[68:71]
    v_exp_f32 v66, v66
    v_mfma_f32_16x16x32_bf16 v[68:71], v[100:103], a[92:95], v[68:71]
    s_waitcnt lgkmcnt(7)
    ds_read_b128 v[80:83], v7 offset:0
    ds_read_b128 v[84:87], v8 offset:0
    v_cmp_gt_u32 vcc, s24, v19
    v_mfma_f32_16x16x32_bf16 v[232:235], a[232:235], v[192:195], v[232:235]
    v_exp_f32 v67, v67
    v_mfma_f32_16x16x32_bf16 v[240:243], a[232:235], v[196:199], v[240:243]
    ds_read_b128 v[172:175], v0 offset:256
    v_mfma_f32_16x16x32_bf16 v[236:239], a[236:239], v[192:195], v[236:239]
    v_exp_f32 v68, v68
    v_mfma_f32_16x16x32_bf16 v[244:247], a[236:239], v[196:199], v[244:247]
    s_waitcnt lgkmcnt(5)
    ds_read_b128 v[176:179], v0 offset:512
    v_perm_b32 v108, v68, v64, s49
    v_mfma_f32_16x16x32_bf16 v[60:63], v[32:35], v[104:107], v[60:63]
    ds_write_addtid_b32 v108 offset:3840
    ds_read_b128 v[180:183], v0 offset:768
    s_cbranch_vccnz L_retry105_b
L_back105_b:
    s_waitcnt vmcnt(13)
    v_mfma_f32_16x16x32_bf16 v[184:187], v[22:25], a[96:99], 0
    v_mfma_f32_16x16x32_bf16 v[184:187], v[26:29], a[96:99], v[184:187]
    s_xor_b32 s27, s58, 16384
    s_xor_b32 s26, s58, 20480
    buffer_load_dwordx4 a[208:211], v31, s[16:19], s27 offen
    v_mfma_f32_16x16x32_bf16 v[188:191], v[20:23], a[96:99], 0
    v_mfma_f32_16x16x32_bf16 v[188:191], v[24:27], a[96:99], v[188:191]
    s_waitcnt vmcnt(13)
    v_mfma_f32_16x16x32_bf16 v[192:195], v[22:25], a[100:103], 0
    v_cvt_pk_bf16_f32 v184, v184, v185
    v_cvt_pk_bf16_f32 v186, v186, v187
    v_mfma_f32_16x16x32_bf16 v[192:195], v[26:29], a[100:103], v[192:195]
    buffer_load_dwordx4 a[212:215], v31, s[16:19], s26 offen
    v_accvgpr_write_b32 a96, v184
    v_accvgpr_write_b32 a97, v186
    v_mfma_f32_16x16x32_bf16 v[196:199], v[20:23], a[100:103], 0
    v_cvt_pk_bf16_f32 v188, v188, v189
    v_cvt_pk_bf16_f32 v190, v190, v191
    v_mfma_f32_16x16x32_bf16 v[196:199], v[24:27], a[100:103], v[196:199]
    v_accvgpr_write_b32 a98, v188
    v_accvgpr_write_b32 a99, v190
    s_waitcnt vmcnt(13)
    v_mfma_f32_16x16x32_bf16 v[184:187], v[22:25], a[104:107], 0
    v_cvt_pk_bf16_f32 v192, v192, v193
    v_cvt_pk_bf16_f32 v194, v194, v195
    v_mfma_f32_16x16x32_bf16 v[184:187], v[26:29], a[104:107], v[184:187]
    s_xor_b32 s27, s59, 16384
    s_xor_b32 s26, s59, 20480
    buffer_load_dwordx4 a[240:243], v31, s[16:19], s27 offen
    v_accvgpr_write_b32 a100, v192
    v_accvgpr_write_b32 a101, v194
    v_mfma_f32_16x16x32_bf16 v[188:191], v[20:23], a[104:107], 0
    v_cvt_pk_bf16_f32 v196, v196, v197
    v_cvt_pk_bf16_f32 v198, v198, v199
    v_mfma_f32_16x16x32_bf16 v[188:191], v[24:27], a[104:107], v[188:191]
    v_accvgpr_write_b32 a102, v196
    v_accvgpr_write_b32 a103, v198
    s_waitcnt vmcnt(13)
    v_mfma_f32_16x16x32_bf16 v[192:195], v[22:25], a[108:111], 0
    v_cvt_pk_bf16_f32 v184, v184, v185
    v_cvt_pk_bf16_f32 v186, v186, v187
    v_mfma_f32_16x16x32_bf16 v[192:195], v[26:29], a[108:111], v[192:195]
    buffer_load_dwordx4 a[244:247], v31, s[16:19], s26 offen
    v_accvgpr_write_b32 a104, v184
    v_accvgpr_write_b32 a105, v186
    v_mfma_f32_16x16x32_bf16 v[196:199], v[20:23], a[108:111], 0
    v_cvt_pk_bf16_f32 v188, v188, v189
    v_cvt_pk_bf16_f32 v190, v190, v191
    v_mfma_f32_16x16x32_bf16 v[196:199], v[24:27], a[108:111], v[196:199]
    v_accvgpr_write_b32 a106, v188
    v_accvgpr_write_b32 a107, v190
    s_waitcnt vmcnt(13)
    v_mfma_f32_16x16x32_bf16 v[184:187], v[22:25], a[112:115], 0
    v_cvt_pk_bf16_f32 v192, v192, v193
    v_cvt_pk_bf16_f32 v194, v194, v195
    v_mfma_f32_16x16x32_bf16 v[184:187], v[26:29], a[112:115], v[184:187]
    v_accvgpr_write_b32 a108, v192
    v_accvgpr_write_b32 a109, v194
    v_mfma_f32_16x16x32_bf16 v[188:191], v[20:23], a[112:115], 0
    v_cvt_pk_bf16_f32 v196, v196, v197
    v_cvt_pk_bf16_f32 v198, v198, v199
    v_mfma_f32_16x16x32_bf16 v[188:191], v[24:27], a[112:115], v[188:191]
    v_accvgpr_write_b32 a110, v196
    v_accvgpr_write_b32 a111, v198
    s_waitcnt vmcnt(12)
    v_mfma_f32_16x16x32_bf16 v[192:195], v[22:25], a[116:119], 0
    v_cvt_pk_bf16_f32 v184, v184, v185
    v_cvt_pk_bf16_f32 v186, v186, v187
    v_mfma_f32_16x16x32_bf16 v[192:195], v[26:29], a[116:119], v[192:195]
    v_accvgpr_write_b32 a112, v184
    v_accvgpr_write_b32 a113, v186
    v_mfma_f32_16x16x32_bf16 v[196:199], v[20:23], a[116:119], 0
    v_cvt_pk_bf16_f32 v188, v188, v189
    v_cvt_pk_bf16_f32 v190, v190, v191
    v_mfma_f32_16x16x32_bf16 v[196:199], v[24:27], a[116:119], v[196:199]
    v_accvgpr_write_b32 a114, v188
    v_accvgpr_write_b32 a115, v190
    s_waitcnt vmcnt(11)
    v_mfma_f32_16x16x32_bf16 v[184:187], v[22:25], a[120:123], 0
    v_cvt_pk_bf16_f32 v192, v192, v193
    v_cvt_pk_bf16_f32 v194, v194, v195
    v_mfma_f32_16x16x32_bf16 v[184:187], v[26:29], a[120:123], v[184:187]
    v_accvgpr_write_b32 a116, v192
    v_accvgpr_write_b32 a117, v194
    v_mfma_f32_16x16x32_bf16 v[188:191], v[20:23], a[120:123], 0
    v_cvt_pk_bf16_f32 v196, v196, v197
    v_cvt_pk_bf16_f32 v198, v198, v199
    v_mfma_f32_16x16x32_bf16 v[188:191], v[24:27], a[120:123], v[188:191]
    v_accvgpr_write_b32 a118, v196
    v_accvgpr_write_b32 a119, v198
    s_waitcnt vmcnt(10)
    v_mfma_f32_16x16x32_bf16 v[192:195], v[22:25], a[124:127], 0
    v_cvt_pk_bf16_f32 v184, v184, v185
    v_cvt_pk_bf16_f32 v186, v186, v187
    s_waitcnt vmcnt(7)
    ds_write_b128 v1, a[144:147] offset:3072
    v_mfma_f32_16x16x32_bf16 v[192:195], v[26:29], a[124:127], v[192:195]
    v_accvgpr_write_b32 a120, v184
    v_accvgpr_write_b32 a121, v186
    s_waitcnt vmcnt(6)
    ds_write_b128 v1, a[148:151] offset:15488
    v_mfma_f32_16x16x32_bf16 v[196:199], v[20:23], a[124:127], 0
    v_cvt_pk_bf16_f32 v188, v188, v189
    v_cvt_pk_bf16_f32 v190, v190, v191
    ds_read_b64_tr_b16 a[144:145], v1 offset:3072
    ds_read_b64_tr_b16 a[146:147], v1 offset:15488
    v_mfma_f32_16x16x32_bf16 v[196:199], v[24:27], a[124:127], v[196:199]
    v_accvgpr_write_b32 a122, v188
    v_accvgpr_write_b32 a123, v190
    s_waitcnt vmcnt(5) lgkmcnt(10)
    ds_read_b64_tr_b16 a[148:149], v1 offset:3080
    ds_read_b64_tr_b16 a[150:151], v1 offset:15496
    v_cvt_pk_bf16_f32 v192, v192, v193
    v_cvt_pk_bf16_f32 v194, v194, v195
    v_accvgpr_write_b32 a124, v192
    v_accvgpr_write_b32 a125, v194
    v_cvt_pk_bf16_f32 v196, v196, v197
    v_cvt_pk_bf16_f32 v198, v198, v199
    v_accvgpr_write_b32 a126, v196
    v_accvgpr_write_b32 a127, v198
    v_mfma_f32_16x16x32_bf16 v[112:115], v[72:75], a[96:99], v[252:255]
    s_xor_b32 s27, s56, 24576
    ds_write_b128 v1, a[176:179] offset:3072
L_pad3_b:
    s_cbranch_execz L_pad7_b
    v_exp_f32 v69, v69
    v_mfma_f32_16x16x32_bf16 v[112:115], v[76:79], a[100:103], v[112:115]
    s_waitcnt vmcnt(4) lgkmcnt(11)
    ds_read_b128 v[184:187], v2 offset:0
    v_perm_b32 v109, v69, v65, s49
    v_mfma_f32_16x16x32_bf16 v[112:115], v[80:83], a[104:107], v[112:115]
    s_xor_b32 s26, s56, 28672
    ds_write_b128 v1, a[180:183] offset:15488
    v_exp_f32 v70, v70
    v_mfma_f32_16x16x32_bf16 v[112:115], v[84:87], a[108:111], v[112:115]
    s_waitcnt lgkmcnt(5)
    buffer_load_dwordx4 a[152:155], v31, s[16:19], s27 offen
    ds_write_addtid_b32 v109 offset:10016
    ds_read_b64_tr_b16 a[176:177], v1 offset:3072
    ds_read_b64_tr_b16 a[178:179], v1 offset:15488
    ds_read_b64_tr_b16 a[180:181], v1 offset:3080
    v_perm_b32 v110, v70, v66, s49
    v_mfma_f32_16x16x32_bf16 v[120:123], a[144:147], v[168:171], v[120:123]
    v_exp_f32 v71, v71
    v_mfma_f32_16x16x32_bf16 v[128:131], a[144:147], v[172:175], v[128:131]
    s_waitcnt lgkmcnt(7)
    ds_write_addtid_b32 v110 offset:16256
    v_perm_b32 v111, v71, v67, s49
    v_mfma_f32_16x16x32_bf16 v[124:127], a[148:151], v[168:171], v[124:127]
    v_exp_f32 v112, v112
    v_mfma_f32_16x16x32_bf16 v[132:135], a[148:151], v[172:175], v[132:135]
    ds_write_addtid_b32 v111 offset:22432
    ds_read_b128 v[104:107], v0 offset:2816
    v_mfma_f32_16x16x32_bf16 v[68:71], v[72:75], a[112:115], v[252:255]
    v_exp_f32 v113, v113
    v_mfma_f32_16x16x32_bf16 v[68:71], v[76:79], a[116:119], v[68:71]
    ds_read_b128 v[88:91], v5 offset:1024
    ds_read_b128 v[92:95], v6 offset:1024
    v_mfma_f32_16x16x32_bf16 v[68:71], v[80:83], a[120:123], v[68:71]
    v_exp_f32 v114, v114
    v_mfma_f32_16x16x32_bf16 v[68:71], v[84:87], a[124:127], v[68:71]
    ds_read_b128 v[96:99], v7 offset:1024
    ds_read_b128 v[100:103], v8 offset:1024
    v_mfma_f32_16x16x32_bf16 v[136:139], a[144:147], v[176:179], v[136:139]
    v_exp_f32 v115, v115
    v_mfma_f32_16x16x32_bf16 v[144:147], a[144:147], v[180:183], v[144:147]
    ds_read_b128 v[188:191], v2 offset:256
    ds_read_b64_tr_b16 a[182:183], v1 offset:15496
    v_mfma_f32_16x16x32_bf16 v[140:143], a[148:151], v[176:179], v[140:143]
    v_exp_f32 v68, v68
    v_mfma_f32_16x16x32_bf16 v[148:151], a[148:151], v[180:183], v[148:151]
    s_waitcnt lgkmcnt(6)
    ds_read_b128 v[192:195], v2 offset:512
    v_perm_b32 v108, v68, v112, s49
    v_mfma_f32_16x16x32_bf16 v[60:63], v[36:39], v[104:107], v[60:63]
    s_waitcnt lgkmcnt(6)
    ds_write_addtid_b32 v108 offset:4096
    ds_read_b128 v[196:199], v2 offset:768
    v_mfma_f32_16x16x32_bf16 v[64:67], v[88:91], a[96:99], v[252:255]
    s_waitcnt vmcnt(4) lgkmcnt(7)
    ds_write_b128 v1, a[208:211] offset:3072
    v_exp_f32 v69, v69
    v_mfma_f32_16x16x32_bf16 v[64:67], v[92:95], a[100:103], v[64:67]
    s_waitcnt lgkmcnt(7)
    ds_read_b128 v[168:171], v3 offset:0
    v_perm_b32 v109, v69, v113, s49
    v_mfma_f32_16x16x32_bf16 v[64:67], v[96:99], a[104:107], v[64:67]
    s_waitcnt vmcnt(3) lgkmcnt(7)
    ds_write_b128 v1, a[212:215] offset:15488
    v_exp_f32 v70, v70
    v_mfma_f32_16x16x32_bf16 v[64:67], v[100:103], a[108:111], v[64:67]
    buffer_load_dwordx4 a[156:159], v31, s[16:19], s26 offen
    ds_write_addtid_b32 v109 offset:10272
    ds_read_b64_tr_b16 a[208:209], v1 offset:3072
    ds_read_b64_tr_b16 a[210:211], v1 offset:15488
    ds_read_b64_tr_b16 a[212:213], v1 offset:3080
    v_perm_b32 v110, v70, v114, s49
    v_mfma_f32_16x16x32_bf16 v[120:123], a[176:179], v[184:187], v[120:123]
    s_waitcnt lgkmcnt(11)
    v_exp_f32 v71, v71
    v_mfma_f32_16x16x32_bf16 v[128:131], a[176:179], v[188:191], v[128:131]
    s_waitcnt lgkmcnt(10)
    ds_write_addtid_b32 v110 offset:16512
    v_perm_b32 v111, v71, v115, s49
    v_mfma_f32_16x16x32_bf16 v[124:127], a[180:183], v[184:187], v[124:127]
    v_exp_f32 v64, v64
    v_mfma_f32_16x16x32_bf16 v[132:135], a[180:183], v[188:191], v[132:135]
    ds_write_addtid_b32 v111 offset:22688
    ds_read_b128 v[104:107], v0 offset:3072
    v_mfma_f32_16x16x32_bf16 v[68:71], v[88:91], a[112:115], v[252:255]
    v_exp_f32 v65, v65
    v_mfma_f32_16x16x32_bf16 v[68:71], v[92:95], a[116:119], v[68:71]
    ds_read_b128 v[72:75], v5 offset:2048
    ds_read_b128 v[76:79], v6 offset:2048
    v_mfma_f32_16x16x32_bf16 v[68:71], v[96:99], a[120:123], v[68:71]
    v_exp_f32 v66, v66
    v_mfma_f32_16x16x32_bf16 v[68:71], v[100:103], a[124:127], v[68:71]
    s_waitcnt lgkmcnt(14)
    ds_read_b128 v[80:83], v7 offset:2048
    ds_read_b128 v[84:87], v8 offset:2048
    v_mfma_f32_16x16x32_bf16 v[136:139], a[176:179], v[192:195], v[136:139]
    s_waitcnt lgkmcnt(14)
    v_exp_f32 v67, v67
    v_mfma_f32_16x16x32_bf16 v[144:147], a[176:179], v[196:199], v[144:147]
    ds_read_b128 v[172:175], v3 offset:256
    ds_read_b64_tr_b16 a[214:215], v1 offset:15496
    v_mfma_f32_16x16x32_bf16 v[140:143], a[180:183], v[192:195], v[140:143]
    v_exp_f32 v68, v68
    v_mfma_f32_16x16x32_bf16 v[148:151], a[180:183], v[196:199], v[148:151]
    s_waitcnt lgkmcnt(6)
    ds_read_b128 v[176:179], v3 offset:512
    v_perm_b32 v108, v68, v64, s49
    v_mfma_f32_16x16x32_bf16 v[40:43], v[32:35], v[104:107], v[40:43]
    s_waitcnt vmcnt(3) lgkmcnt(5)
    ds_write_addtid_b32 v108 offset:4352
    ds_read_b128 v[180:183], v3 offset:768
    v_mfma_f32_16x16x32_bf16 v[112:115], v[72:75], a[96:99], v[252:255]
    s_xor_b32 s27, s57, 24576
    ds_write_b128 v1, a[240:243] offset:3072
    v_exp_f32 v69, v69
    v_mfma_f32_16x16x32_bf16 v[112:115], v[76:79], a[100:103], v[112:115]
    s_waitcnt vmcnt(2) lgkmcnt(6)
    ds_read_b128 v[184:187], v4 offset:0
    v_perm_b32 v109, v69, v65, s49
    v_mfma_f32_16x16x32_bf16 v[112:115], v[80:83], a[104:107], v[112:115]
    s_xor_b32 s26, s57, 28672
    ds_write_b128 v1, a[244:247] offset:15488
    v_exp_f32 v70, v70
    v_mfma_f32_16x16x32_bf16 v[112:115], v[84:87], a[108:111], v[112:115]
    buffer_load_dwordx4 a[184:187], v31, s[16:19], s27 offen
    ds_write_addtid_b32 v109 offset:10528
    ds_read_b64_tr_b16 a[240:241], v1 offset:3072
    ds_read_b64_tr_b16 a[242:243], v1 offset:15488
    ds_read_b64_tr_b16 a[244:245], v1 offset:3080
    ds_read_b64_tr_b16 a[246:247], v1 offset:15496
    v_perm_b32 v110, v70, v66, s49
    v_mfma_f32_16x16x32_bf16 v[120:123], a[208:211], v[168:171], v[120:123]
    s_waitcnt lgkmcnt(12)
    v_exp_f32 v71, v71
    v_mfma_f32_16x16x32_bf16 v[128:131], a[208:211], v[172:175], v[128:131]
    s_waitcnt lgkmcnt(11)
    ds_write_addtid_b32 v110 offset:16768
    v_perm_b32 v111, v71, v67, s49
    v_mfma_f32_16x16x32_bf16 v[124:127], a[212:215], v[168:171], v[124:127]
    v_exp_f32 v112, v112
    v_mfma_f32_16x16x32_bf16 v[132:135], a[212:215], v[172:175], v[132:135]
    ds_write_addtid_b32 v111 offset:22944
    ds_read_b128 v[104:107], v0 offset:3328
    v_mfma_f32_16x16x32_bf16 v[68:71], v[72:75], a[112:115], v[252:255]
    v_exp_f32 v113, v113
    v_mfma_f32_16x16x32_bf16 v[68:71], v[76:79], a[116:119], v[68:71]
    ds_read_b128 v[88:91], v5 offset:3072
    ds_read_b128 v[92:95], v6 offset:3072
    v_mfma_f32_16x16x32_bf16 v[68:71], v[80:83], a[120:123], v[68:71]
    v_exp_f32 v114, v114
    v_mfma_f32_16x16x32_bf16 v[68:71], v[84:87], a[124:127], v[68:71]
    s_waitcnt lgkmcnt(15)
    ds_read_b128 v[96:99], v7 offset:3072
    ds_read_b128 v[100:103], v8 offset:3072
    v_mfma_f32_16x16x32_bf16 v[136:139], a[208:211], v[176:179], v[136:139]
    s_waitcnt lgkmcnt(15)
    v_exp_f32 v115, v115
    v_mfma_f32_16x16x32_bf16 v[144:147], a[208:211], v[180:183], v[144:147]
    ds_read_b128 v[188:191], v4 offset:256
    v_add_u32 v28, 4096, v12
    v_add_u32 v29, 5632, v12
    v_mfma_f32_16x16x32_bf16 v[140:143], a[212:215], v[176:179], v[140:143]
    v_exp_f32 v68, v68
    v_mfma_f32_16x16x32_bf16 v[148:151], a[212:215], v[180:183], v[148:151]
    s_waitcnt lgkmcnt(5)
    ds_read_b128 v[192:195], v4 offset:512
    v_perm_b32 v108, v68, v112, s49
    v_mfma_f32_16x16x32_bf16 v[40:43], v[36:39], v[104:107], v[40:43]
    s_waitcnt lgkmcnt(5)
    ds_write_addtid_b32 v108 offset:4608
    ds_read_b128 v[196:199], v4 offset:768
    v_mfma_f32_16x16x32_bf16 v[64:67], v[88:91], a[96:99], v[252:255]
    s_waitcnt lgkmcnt(6)
    v_exp_f32 v69, v69
    v_mfma_f32_16x16x32_bf16 v[64:67], v[92:95], a[100:103], v[64:67]
    s_waitcnt lgkmcnt(5)
    ds_read_b128 v[168:171], v0 offset:1024
    v_perm_b32 v109, v69, v113, s49
    v_mfma_f32_16x16x32_bf16 v[64:67], v[96:99], a[104:107], v[64:67]
    s_waitcnt lgkmcnt(5)
    v_exp_f32 v70, v70
    v_mfma_f32_16x16x32_bf16 v[64:67], v[100:103], a[108:111], v[64:67]
    ds_write_addtid_b32 v109 offset:10784
    v_perm_b32 v110, v70, v114, s49
    v_mfma_f32_16x16x32_bf16 v[120:123], a[240:243], v[184:187], v[120:123]
    s_waitcnt lgkmcnt(5)
    v_exp_f32 v71, v71
    v_mfma_f32_16x16x32_bf16 v[128:131], a[240:243], v[188:191], v[128:131]
    ds_write_addtid_b32 v110 offset:17024
    v_perm_b32 v111, v71, v115, s49
    v_mfma_f32_16x16x32_bf16 v[124:127], a[244:247], v[184:187], v[124:127]
    v_exp_f32 v64, v64
    v_mfma_f32_16x16x32_bf16 v[132:135], a[244:247], v[188:191], v[132:135]
    ds_write_addtid_b32 v111 offset:23200
    ds_read_b128 v[104:107], v0 offset:3584
    v_mfma_f32_16x16x32_bf16 v[68:71], v[88:91], a[112:115], v[252:255]
    v_exp_f32 v65, v65
    v_mfma_f32_16x16x32_bf16 v[68:71], v[92:95], a[116:119], v[68:71]
    ds_read_b128 v[72:75], v5 offset:4096
    ds_read_b128 v[76:79], v6 offset:4096
    v_mfma_f32_16x16x32_bf16 v[68:71], v[96:99], a[120:123], v[68:71]
    v_exp_f32 v66, v66
    v_mfma_f32_16x16x32_bf16 v[68:71], v[100:103], a[124:127], v[68:71]
    s_waitcnt lgkmcnt(9)
    ds_read_b128 v[80:83], v7 offset:4096
    ds_read_b128 v[84:87], v8 offset:4096
    v_mfma_f32_16x16x32_bf16 v[136:139], a[240:243], v[192:195], v[136:139]
    s_waitcnt lgkmcnt(9)
    v_exp_f32 v67, v67
    v_mfma_f32_16x16x32_bf16 v[144:147], a[240:243], v[196:199], v[144:147]
    ds_read_b128 v[172:175], v0 offset:1280
    v_cndmask_b32 v28, v12, v28, s[50:51]
    v_cndmask_b32 v29, v12, v29, s[50:51]
    v_mfma_f32_16x16x32_bf16 v[140:143], a[244:247], v[192:195], v[140:143]
    v_exp_f32 v68, v68
    v_mfma_f32_16x16x32_bf16 v[148:151], a[244:247], v[196:199], v[148:151]
    s_waitcnt lgkmcnt(5)
    ds_read_b128 v[176:179], v0 offset:1536
    v_perm_b32 v108, v68, v64, s49
    v_mfma_f32_16x16x32_bf16 v[44:47], v[32:35], v[104:107], v[44:47]
    s_waitcnt lgkmcnt(5)
    ds_write_addtid_b32 v108 offset:4864
    ds_read_b128 v[180:183], v0 offset:1792
    v_mfma_f32_16x16x32_bf16 v[112:115], v[72:75], a[96:99], v[252:255]
    s_waitcnt lgkmcnt(6)
    buffer_load_dwordx4 a[188:191], v31, s[16:19], s26 offen
    v_exp_f32 v69, v69
    v_mfma_f32_16x16x32_bf16 v[112:115], v[76:79], a[100:103], v[112:115]
    s_waitcnt lgkmcnt(5)
    ds_read_b128 v[184:187], v2 offset:1024
    v_perm_b32 v109, v69, v65, s49
    v_mfma_f32_16x16x32_bf16 v[112:115], v[80:83], a[104:107], v[112:115]
    s_waitcnt lgkmcnt(5)
    v_exp_f32 v70, v70
    v_mfma_f32_16x16x32_bf16 v[112:115], v[84:87], a[108:111], v[112:115]
    ds_write_addtid_b32 v109 offset:11040
    v_perm_b32 v110, v70, v66, s49
    v_mfma_f32_16x16x32_bf16 v[152:155], a[144:147], v[168:171], v[152:155]
    s_waitcnt lgkmcnt(5)
    v_exp_f32 v71, v71
    v_mfma_f32_16x16x32_bf16 v[160:163], a[144:147], v[172:175], v[160:163]
    ds_write_addtid_b32 v110 offset:17280
    v_perm_b32 v111, v71, v67, s49
    v_mfma_f32_16x16x32_bf16 v[156:159], a[148:151], v[168:171], v[156:159]
    v_exp_f32 v112, v112
    v_mfma_f32_16x16x32_bf16 v[164:167], a[148:151], v[172:175], v[164:167]
    ds_write_addtid_b32 v111 offset:23456
    ds_read_b128 v[104:107], v0 offset:3840
    v_mfma_f32_16x16x32_bf16 v[68:71], v[72:75], a[112:115], v[252:255]
    v_exp_f32 v113, v113
    v_mfma_f32_16x16x32_bf16 v[68:71], v[76:79], a[116:119], v[68:71]
    ds_read_b128 v[88:91], v5 offset:5120
    ds_read_b128 v[92:95], v6 offset:5120
    v_mfma_f32_16x16x32_bf16 v[68:71], v[80:83], a[120:123], v[68:71]
    s_waitcnt lgkmcnt(7)
    v_exp_f32 v114, v114
    v_mfma_f32_16x16x32_bf16 v[68:71], v[84:87], a[124:127], v[68:71]
    s_xor_b32 s27, s58, 24576
    ds_read_b128 v[96:99], v7 offset:5120
    ds_read_b128 v[100:103], v8 offset:5120
    v_mfma_f32_16x16x32_bf16 v[200:203], a[144:147], v[176:179], v[200:203]
    s_xor_b32 s26, s58, 28672
    v_exp_f32 v115, v115
    v_mfma_f32_16x16x32_bf16 v[208:211], a[144:147], v[180:183], v[208:211]
    ds_read_b128 v[188:191], v2 offset:1280
    ds_write_b32 v28, v40 offset:0
    v_mfma_f32_16x16x32_bf16 v[204:207], a[148:151], v[176:179], v[204:207]
    v_exp_f32 v68, v68
    v_mfma_f32_16x16x32_bf16 v[212:215], a[148:151], v[180:183], v[212:215]
    s_waitcnt lgkmcnt(6)
    ds_read_b128 v[192:195], v2 offset:1536
    v_perm_b32 v108, v68, v112, s49
    v_mfma_f32_16x16x32_bf16 v[44:47], v[36:39], v[104:107], v[44:47]
    s_waitcnt lgkmcnt(6)
    ds_write_addtid_b32 v108 offset:5120
    ds_read_b128 v[196:199], v2 offset:1792
    v_mfma_f32_16x16x32_bf16 v[64:67], v[88:91], a[96:99], v[252:255]
    s_waitcnt lgkmcnt(7)
    v_exp_f32 v69, v69
    v_mfma_f32_16x16x32_bf16 v[64:67], v[92:95], a[100:103], v[64:67]
    s_waitcnt lgkmcnt(6)
    ds_read_b128 v[168:171], v3 offset:1024
    v_perm_b32 v109, v69, v113, s49
    v_mfma_f32_16x16x32_bf16 v[64:67], v[96:99], a[104:107], v[64:67]
    s_waitcnt lgkmcnt(6)
    v_exp_f32 v70, v70
    v_mfma_f32_16x16x32_bf16 v[64:67], v[100:103], a[108:111], v[64:67]
    ds_write_addtid_b32 v109 offset:11296
    v_perm_b32 v110, v70, v114, s49
    v_mfma_f32_16x16x32_bf16 v[152:155], a[176:179], v[184:187], v[152:155]
    s_waitcnt lgkmcnt(6)
    v_exp_f32 v71, v71
    v_mfma_f32_16x16x32_bf16 v[160:163], a[176:179], v[188:191], v[160:163]
    ds_write_addtid_b32 v110 offset:17536
    v_perm_b32 v111, v71, v115, s49
    v_mfma_f32_16x16x32_bf16 v[156:159], a[180:183], v[184:187], v[156:159]
    v_exp_f32 v64, v64
    v_mfma_f32_16x16x32_bf16 v[164:167], a[180:183], v[188:191], v[164:167]
    ds_write_addtid_b32 v111 offset:23712
    ds_read_b128 v[104:107], v0 offset:4096
    v_mfma_f32_16x16x32_bf16 v[68:71], v[88:91], a[112:115], v[252:255]
    v_exp_f32 v65, v65
    v_mfma_f32_16x16x32_bf16 v[68:71], v[92:95], a[116:119], v[68:71]
    ds_read_b128 v[72:75], v5 offset:6144
    ds_read_b128 v[76:79], v6 offset:6144
    v_mfma_f32_16x16x32_bf16 v[68:71], v[96:99], a[120:123], v[68:71]
    v_exp_f32 v66, v66
    v_mfma_f32_16x16x32_bf16 v[68:71], v[100:103], a[124:127], v[68:71]
    s_waitcnt lgkmcnt(9)
    buffer_load_dwordx4 a[216:219], v31, s[16:19], s27 offen
    ds_read_b128 v[80:83], v7 offset:6144
    ds_read_b128 v[84:87], v8 offset:6144
    ds_write_b32 v28, v44 offset:512
    v_mfma_f32_16x16x32_bf16 v[200:203], a[176:179], v[192:195], v[200:203]
    s_waitcnt lgkmcnt(10)
    v_exp_f32 v67, v67
    v_mfma_f32_16x16x32_bf16 v[208:211], a[176:179], v[196:199], v[208:211]
    ds_read_b128 v[172:175], v3 offset:1280
    ds_add_u32 v14, v16
    v_mfma_f32_16x16x32_bf16 v[204:207], a[180:183], v[192:195], v[204:207]
    v_exp_f32 v68, v68
    v_mfma_f32_16x16x32_bf16 v[212:215], a[180:183], v[196:199], v[212:215]
    s_waitcnt lgkmcnt(7)
    ds_read_b128 v[176:179], v3 offset:1536
    v_perm_b32 v108, v68, v64, s49
    v_mfma_f32_16x16x32_bf16 v[48:51], v[32:35], v[104:107], v[48:51]
    s_waitcnt lgkmcnt(6)
    ds_write_addtid_b32 v108 offset:5376
    ds_read_b128 v[180:183], v3 offset:1792
    v_mfma_f32_16x16x32_bf16 v[112:115], v[72:75], a[96:99], v[252:255]
    s_add_u32 s24, s24, 1
    v_exp_f32 v69, v69
    v_mfma_f32_16x16x32_bf16 v[112:115], v[76:79], a[100:103], v[112:115]
    s_waitcnt lgkmcnt(7)
    ds_read_b128 v[184:187], v4 offset:1024
    v_perm_b32 v109, v69, v65, s49
    v_mfma_f32_16x16x32_bf16 v[112:115], v[80:83], a[104:107], v[112:115]
    s_waitcnt lgkmcnt(7)
    v_exp_f32 v70, v70
    v_mfma_f32_16x16x32_bf16 v[112:115], v[84:87], a[108:111], v[112:115]
    ds_write_addtid_b32 v109 offset:11552
    v_perm_b32 v110, v70, v66, s49
    v_mfma_f32_16x16x32_bf16 v[152:155], a[208:211], v[168:171], v[152:155]
    s_waitcnt lgkmcnt(6)
    v_exp_f32 v71, v71
    v_mfma_f32_16x16x32_bf16 v[160:163], a[208:211], v[172:175], v[160:163]
    ds_write_addtid_b32 v110 offset:17792
    v_perm_b32 v111, v71, v67, s49
    v_mfma_f32_16x16x32_bf16 v[156:159], a[212:215], v[168:171], v[156:159]
    v_exp_f32 v112, v112
    v_mfma_f32_16x16x32_bf16 v[164:167], a[212:215], v[172:175], v[164:167]
    ds_write_addtid_b32 v111 offset:23968
    ds_read_b128 v[104:107], v0 offset:4352
    v_mfma_f32_16x16x32_bf16 v[68:71], v[72:75], a[112:115], v[252:255]
    v_exp_f32 v113, v113
    v_mfma_f32_16x16x32_bf16 v[68:71], v[76:79], a[116:119], v[68:71]
    ds_read_b128 v[88:91], v5 offset:7168
    ds_read_b128 v[92:95], v6 offset:7168
    v_mfma_f32_16x16x32_bf16 v[68:71], v[80:83], a[120:123], v[68:71]
    v_exp_f32 v114, v114
    v_mfma_f32_16x16x32_bf16 v[68:71], v[84:87], a[124:127], v[68:71]
    s_waitcnt lgkmcnt(9)
    ds_read_b128 v[96:99], v7 offset:7168
    ds_read_b128 v[100:103], v8 offset:7168
    v_mfma_f32_16x16x32_bf16 v[200:203], a[208:211], v[176:179], v[200:203]
    s_waitcnt lgkmcnt(9)
    v_exp_f32 v115, v115
    v_mfma_f32_16x16x32_bf16 v[208:211], a[208:211], v[180:183], v[208:211]
    buffer_load_dwordx4 a[220:223], v31, s[16:19], s26 offen
    ds_read_b128 v[188:191], v4 offset:1280
    v_mfma_f32_16x16x32_bf16 v[204:207], a[212:215], v[176:179], v[204:207]
    v_exp_f32 v68, v68
    v_mfma_f32_16x16x32_bf16 v[212:215], a[212:215], v[180:183], v[212:215]
    s_waitcnt lgkmcnt(5)
    ds_read_b128 v[192:195], v4 offset:1536
    v_perm_b32 v108, v68, v112, s49
    v_mfma_f32_16x16x32_bf16 v[48:51], v[36:39], v[104:107], v[48:51]
    s_waitcnt lgkmcnt(5)
    ds_write_addtid_b32 v108 offset:5632
    ds_read_b128 v[196:199], v4 offset:1792
    ds_read_b32 v19, v15
    v_mfma_f32_16x16x32_bf16 v[64:67], v[88:91], a[96:99], v[252:255]
    s_waitcnt lgkmcnt(7)
    v_exp_f32 v69, v69
    v_mfma_f32_16x16x32_bf16 v[64:67], v[92:95], a[100:103], v[64:67]
    s_waitcnt lgkmcnt(6)
    ds_read_b128 v[168:171], v0 offset:2048
    v_perm_b32 v109, v69, v113, s49
    v_mfma_f32_16x16x32_bf16 v[64:67], v[96:99], a[104:107], v[64:67]
    s_waitcnt lgkmcnt(6)
    v_exp_f32 v70, v70
    v_mfma_f32_16x16x32_bf16 v[64:67], v[100:103], a[108:111], v[64:67]
    ds_write_addtid_b32 v109 offset:11808
    v_perm_b32 v110, v70, v114, s49
    v_mfma_f32_16x16x32_bf16 v[152:155], a[240:243], v[184:187], v[152:155]
    s_waitcnt lgkmcnt(6)
    v_exp_f32 v71, v71
    v_mfma_f32_16x16x32_bf16 v[160:163], a[240:243], v[188:191], v[160:163]
    ds_write_addtid_b32 v110 offset:18048
    v_perm_b32 v111, v71, v115, s49
    v_mfma_f32_16x16x32_bf16 v[156:159], a[244:247], v[184:187], v[156:159]
    v_exp_f32 v64, v64
    v_mfma_f32_16x16x32_bf16 v[164:167], a[244:247], v[188:191], v[164:167]
    ds_write_addtid_b32 v111 offset:24224
    ds_read_b128 v[104:107], v0 offset:4608
    v_mfma_f32_16x16x32_bf16 v[68:71], v[88:91], a[112:115], v[252:255]
    v_exp_f32 v65, v65
    v_mfma_f32_16x16x32_bf16 v[68:71], v[92:95], a[116:119], v[68:71]
    ds_read_b128 v[72:75], v5 offset:8192
    ds_read_b128 v[76:79], v6 offset:8192
    v_mfma_f32_16x16x32_bf16 v[68:71], v[96:99], a[120:123], v[68:71]
    v_exp_f32 v66, v66
    v_mfma_f32_16x16x32_bf16 v[68:71], v[100:103], a[124:127], v[68:71]
    s_waitcnt lgkmcnt(7)
    ds_read_b128 v[80:83], v7 offset:8192
    ds_read_b128 v[84:87], v8 offset:8192
    v_cmp_gt_u32 vcc, s24, v19
    v_mfma_f32_16x16x32_bf16 v[200:203], a[240:243], v[192:195], v[200:203]
    v_exp_f32 v67, v67
    v_mfma_f32_16x16x32_bf16 v[208:211], a[240:243], v[196:199], v[208:211]
    ds_read_b128 v[172:175], v0 offset:2304
    v_mfma_f32_16x16x32_bf16 v[204:207], a[244:247], v[192:195], v[204:207]
    v_exp_f32 v68, v68
    v_mfma_f32_16x16x32_bf16 v[212:215], a[244:247], v[196:199], v[212:215]
    s_waitcnt lgkmcnt(5)
    ds_read_b128 v[176:179], v0 offset:2560
    v_perm_b32 v108, v68, v64, s49
    v_mfma_f32_16x16x32_bf16 v[52:55], v[32:35], v[104:107], v[52:55]
    s_waitcnt lgkmcnt(2)
    ds_write_addtid_b32 v108 offset:5888
    ds_read_b128 v[180:183], v0 offset:2816
    s_cbranch_vccnz L_retry107_b
L_back107_b:
    v_mfma_f32_16x16x32_bf16 v[112:115], v[72:75], a[96:99], v[252:255]
    s_xor_b32 s27, s59, 24576
    v_exp_f32 v69, v69
    v_mfma_f32_16x16x32_bf16 v[112:115], v[76:79], a[100:103], v[112:115]
    s_mov_b32 s21, 57344
    ds_read_b128 v[184:187], v2 offset:2048
    v_perm_b32 v109, v69, v65, s49
    v_mfma_f32_16x16x32_bf16 v[112:115], v[80:83], a[104:107], v[112:115]
    s_add_u32 m0, s23, 2048
    v_exp_f32 v70, v70
    v_mfma_f32_16x16x32_bf16 v[112:115], v[84:87], a[108:111], v[112:115]
    s_xor_b32 s26, s59, 28672
    ds_write_addtid_b32 v109 offset:23328
    v_perm_b32 v110, v70, v66, s49
    v_mfma_f32_16x16x32_bf16 v[216:219], a[144:147], v[168:171], v[216:219]
    s_waitcnt lgkmcnt(5)
    buffer_load_dwordx4 a[248:251], v31, s[16:19], s27 offen
    v_exp_f32 v71, v71
    v_mfma_f32_16x16x32_bf16 v[224:227], a[144:147], v[172:175], v[224:227]
    ds_write_addtid_b32 v110 offset:29568
    v_perm_b32 v111, v71, v67, s49
    v_mfma_f32_16x16x32_bf16 v[220:223], a[148:151], v[168:171], v[220:223]
    v_exp_f32 v112, v112
    v_mfma_f32_16x16x32_bf16 v[228:231], a[148:151], v[172:175], v[228:231]
    ds_write_addtid_b32 v111 offset:35744
    ds_read_b128 v[104:107], v0 offset:4864
    v_mfma_f32_16x16x32_bf16 v[68:71], v[72:75], a[112:115], v[252:255]
    v_exp_f32 v113, v113
    v_mfma_f32_16x16x32_bf16 v[68:71], v[76:79], a[116:119], v[68:71]
    ds_read_b128 v[88:91], v5 offset:9216
    ds_read_b128 v[92:95], v6 offset:9216
    v_mfma_f32_16x16x32_bf16 v[68:71], v[80:83], a[120:123], v[68:71]
    v_exp_f32 v114, v114
    v_mfma_f32_16x16x32_bf16 v[68:71], v[84:87], a[124:127], v[68:71]
    s_waitcnt lgkmcnt(9)
    ds_read_b128 v[96:99], v7 offset:9216
    ds_read_b128 v[100:103], v8 offset:9216
    v_mfma_f32_16x16x32_bf16 v[232:235], a[144:147], v[176:179], v[232:235]
    s_waitcnt lgkmcnt(9)
    v_exp_f32 v115, v115
    v_mfma_f32_16x16x32_bf16 v[240:243], a[144:147], v[180:183], v[240:243]
    s_waitcnt lgkmcnt(4)
    buffer_load_dwordx4 v9, s[4:7], s21 offen nt lds
    ds_read_b128 v[188:191], v2 offset:2304
    v_mfma_f32_16x16x32_bf16 v[236:239], a[148:151], v[176:179], v[236:239]
    s_mov_b32 s21, 61440
    v_exp_f32 v68, v68
    v_mfma_f32_16x16x32_bf16 v[244:247], a[148:151], v[180:183], v[244:247]
    s_add_u32 m0, s23, 3072
    ds_read_b128 v[192:195], v2 offset:2560
    v_perm_b32 v108, v68, v112, s49
    v_mfma_f32_16x16x32_bf16 v[52:55], v[36:39], v[104:107], v[52:55]
    s_waitcnt lgkmcnt(5)
    ds_write_addtid_b32 v108 offset:16384
    ds_read_b128 v[196:199], v2 offset:2816
    v_mfma_f32_16x16x32_bf16 v[64:67], v[88:91], a[96:99], v[252:255]
    s_waitcnt lgkmcnt(6)
    v_exp_f32 v69, v69
    v_mfma_f32_16x16x32_bf16 v[64:67], v[92:95], a[100:103], v[64:67]
    s_waitcnt lgkmcnt(5)
    ds_read_b128 v[168:171], v3 offset:2048
    v_perm_b32 v109, v69, v113, s49
    v_mfma_f32_16x16x32_bf16 v[64:67], v[96:99], a[104:107], v[64:67]
    s_waitcnt lgkmcnt(5)
    v_exp_f32 v70, v70
    v_mfma_f32_16x16x32_bf16 v[64:67], v[100:103], a[108:111], v[64:67]
    ds_write_addtid_b32 v109 offset:22560
    v_perm_b32 v110, v70, v114, s49
    v_mfma_f32_16x16x32_bf16 v[216:219], a[176:179], v[184:187], v[216:219]
    s_waitcnt lgkmcnt(5)
    v_exp_f32 v71, v71
    v_mfma_f32_16x16x32_bf16 v[224:227], a[176:179], v[188:191], v[224:227]
    ds_write_addtid_b32 v110 offset:28800
    v_perm_b32 v111, v71, v115, s49
    v_mfma_f32_16x16x32_bf16 v[220:223], a[180:183], v[184:187], v[220:223]
    v_exp_f32 v64, v64
    v_mfma_f32_16x16x32_bf16 v[228:231], a[180:183], v[188:191], v[228:231]
    ds_write_addtid_b32 v111 offset:34976
    ds_read_b128 v[104:107], v0 offset:5120
    v_mfma_f32_16x16x32_bf16 v[68:71], v[88:91], a[112:115], v[252:255]
    v_exp_f32 v65, v65
    v_mfma_f32_16x16x32_bf16 v[68:71], v[92:95], a[116:119], v[68:71]
    ds_read_b128 v[72:75], v5 offset:10240
    ds_read_b128 v[76:79], v6 offset:10240
    v_mfma_f32_16x16x32_bf16 v[68:71], v[96:99], a[120:123], v[68:71]
    v_exp_f32 v66, v66
    v_mfma_f32_16x16x32_bf16 v[68:71], v[100:103], a[124:127], v[68:71]
    s_waitcnt lgkmcnt(9)
    ds_read_b128 v[80:83], v7 offset:10240
    ds_read_b128 v[84:87], v8 offset:10240
    v_mfma_f32_16x16x32_bf16 v[232:235], a[176:179], v[192:195], v[232:235]
    s_waitcnt lgkmcnt(9)
    v_exp_f32 v67, v67
    v_mfma_f32_16x16x32_bf16 v[240:243], a[176:179], v[196:199], v[240:243]
    buffer_load_dwordx4 a[252:255], v31, s[16:19], s26 offen
    ds_read_b128 v[172:175], v3 offset:2304
    v_mfma_f32_16x16x32_bf16 v[236:239], a[180:183], v[192:195], v[236:239]
    v_exp_f32 v68, v68
    v_mfma_f32_16x16x32_bf16 v[244:247], a[180:183], v[196:199], v[244:247]
    s_waitcnt lgkmcnt(5)
    ds_read_b128 v[176:179], v3 offset:2560
    v_perm_b32 v108, v68, v64, s49
    v_mfma_f32_16x16x32_bf16 v[56:59], v[32:35], v[104:107], v[56:59]
    s_waitcnt lgkmcnt(5)
    ds_write_addtid_b32 v108 offset:16640
    ds_read_b128 v[180:183], v3 offset:2816
    v_mfma_f32_16x16x32_bf16 v[112:115], v[72:75], a[96:99], v[252:255]
    s_waitcnt lgkmcnt(6)
    v_exp_f32 v69, v69
    v_mfma_f32_16x16x32_bf16 v[112:115], v[76:79], a[100:103], v[112:115]
    s_waitcnt lgkmcnt(5)
    ds_read_b128 v[184:187], v4 offset:2048
    v_perm_b32 v109, v69, v65, s49
    v_mfma_f32_16x16x32_bf16 v[112:115], v[80:83], a[104:107], v[112:115]
    s_waitcnt lgkmcnt(5)
    v_exp_f32 v70, v70
    v_mfma_f32_16x16x32_bf16 v[112:115], v[84:87], a[108:111], v[112:115]
    ds_write_addtid_b32 v109 offset:22816
    v_perm_b32 v110, v70, v66, s49
    v_mfma_f32_16x16x32_bf16 v[216:219], a[208:211], v[168:171], v[216:219]
    s_waitcnt lgkmcnt(5)
    v_exp_f32 v71, v71
    v_mfma_f32_16x16x32_bf16 v[224:227], a[208:211], v[172:175], v[224:227]
    ds_write_addtid_b32 v110 offset:29056
    v_perm_b32 v111, v71, v67, s49
    v_mfma_f32_16x16x32_bf16 v[220:223], a[212:215], v[168:171], v[220:223]
    v_exp_f32 v112, v112
    v_mfma_f32_16x16x32_bf16 v[228:231], a[212:215], v[172:175], v[228:231]
    ds_write_addtid_b32 v111 offset:35232
    ds_read_b128 v[104:107], v0 offset:5376
    v_mfma_f32_16x16x32_bf16 v[68:71], v[72:75], a[112:115], v[252:255]
    v_exp_f32 v113, v113
    v_mfma_f32_16x16x32_bf16 v[68:71], v[76:79], a[116:119], v[68:71]
    ds_read_b128 v[88:91], v5 offset:11264
    ds_read_b128 v[92:95], v6 offset:11264
    v_mfma_f32_16x16x32_bf16 v[68:71], v[80:83], a[120:123], v[68:71]
    v_exp_f32 v114, v114
    v_mfma_f32_16x16x32_bf16 v[68:71], v[84:87], a[124:127], v[68:71]
    s_waitcnt lgkmcnt(9)
    ds_read_b128 v[96:99], v7 offset:11264
    ds_read_b128 v[100:103], v8 offset:11264
    v_mfma_f32_16x16x32_bf16 v[232:235], a[208:211], v[176:179], v[232:235]
    s_waitcnt lgkmcnt(9)
    v_exp_f32 v115, v115
    v_mfma_f32_16x16x32_bf16 v[240:243], a[208:211], v[180:183], v[240:243]
    s_waitcnt lgkmcnt(4)
    buffer_load_dwordx4 v9, s[4:7], s21 offen nt lds
    ds_read_b128 v[188:191], v4 offset:2304
    v_mfma_f32_16x16x32_bf16 v[236:239], a[212:215], v[176:179], v[236:239]
    s_mov_b32 s21, 65536
    v_exp_f32 v68, v68
    v_mfma_f32_16x16x32_bf16 v[244:247], a[212:215], v[180:183], v[244:247]
    s_add_u32 m0, s23, 4096
    ds_read_b128 v[192:195], v4 offset:2560
    v_perm_b32 v108, v68, v112, s49
    v_mfma_f32_16x16x32_bf16 v[56:59], v[36:39], v[104:107], v[56:59]
    s_waitcnt lgkmcnt(5)
    ds_write_addtid_b32 v108 offset:15872
    ds_read_b128 v[196:199], v4 offset:2816
    v_mfma_f32_16x16x32_bf16 v[64:67], v[88:91], a[96:99], v[252:255]
    s_waitcnt lgkmcnt(6)
    v_exp_f32 v69, v69
    v_mfma_f32_16x16x32_bf16 v[64:67], v[92:95], a[100:103], v[64:67]
    s_waitcnt lgkmcnt(5)
    ds_read_b128 v[168:171], v0 offset:3072
    v_perm_b32 v109, v69, v113, s49
L_pad4_b:
    s_cbranch_execz L_pad8_b
    v_mfma_f32_16x16x32_bf16 v[64:67], v[96:99], a[104:107], v[64:67]
    s_waitcnt lgkmcnt(5)
    v_exp_f32 v70, v70
    v_mfma_f32_16x16x32_bf16 v[64:67], v[100:103], a[108:111], v[64:67]
    ds_write_addtid_b32 v109 offset:22048
    v_perm_b32 v110, v70, v114, s49
    v_mfma_f32_16x16x32_bf16 v[216:219], a[240:243], v[184:187], v[216:219]
    s_waitcnt lgkmcnt(5)
    v_exp_f32 v71, v71
    v_mfma_f32_16x16x32_bf16 v[224:227], a[240:243], v[188:191], v[224:227]
    ds_write_addtid_b32 v110 offset:28288
    v_perm_b32 v111, v71, v115, s49
    v_mfma_f32_16x16x32_bf16 v[220:223], a[244:247], v[184:187], v[220:223]
    v_exp_f32 v64, v64
    v_mfma_f32_16x16x32_bf16 v[228:231], a[244:247], v[188:191], v[228:231]
    ds_write_addtid_b32 v111 offset:34464
    ds_read_b128 v[104:107], v0 offset:5632
    v_mfma_f32_16x16x32_bf16 v[68:71], v[88:91], a[112:115], v[252:255]
    v_exp_f32 v65, v65
    v_mfma_f32_16x16x32_bf16 v[68:71], v[92:95], a[116:119], v[68:71]
    ds_read_b128 v[72:75], v5 offset:12288
    ds_read_b128 v[76:79], v6 offset:12288
    v_mfma_f32_16x16x32_bf16 v[68:71], v[96:99], a[120:123], v[68:71]
    v_exp_f32 v66, v66
    v_mfma_f32_16x16x32_bf16 v[68:71], v[100:103], a[124:127], v[68:71]
    s_waitcnt lgkmcnt(9)
    ds_read_b128 v[80:83], v7 offset:12288
    ds_read_b128 v[84:87], v8 offset:12288
    v_mfma_f32_16x16x32_bf16 v[232:235], a[240:243], v[192:195], v[232:235]
    s_waitcnt lgkmcnt(9)
    v_exp_f32 v67, v67
    v_mfma_f32_16x16x32_bf16 v[240:243], a[240:243], v[196:199], v[240:243]
    buffer_load_dwordx4 v9, s[4:7], s21 offen nt lds
    ds_read_b128 v[172:175], v0 offset:3328
    v_mfma_f32_16x16x32_bf16 v[236:239], a[244:247], v[192:195], v[236:239]
    v_exp_f32 v68, v68
    v_mfma_f32_16x16x32_bf16 v[244:247], a[244:247], v[196:199], v[244:247]
    s_waitcnt lgkmcnt(5)
    ds_read_b128 v[176:179], v0 offset:3584
    v_perm_b32 v108, v68, v64, s49
    v_mfma_f32_16x16x32_bf16 v[60:63], v[32:35], v[104:107], v[60:63]
    ds_write_addtid_b32 v108 offset:16128
    ds_read_b128 v[180:183], v0 offset:3840
    s_waitcnt vmcnt(9) lgkmcnt(7)
    ds_write_b128 v1, a[152:155] offset:0
    ds_write_b128 v1, a[156:159] offset:12416
    ds_read_b64_tr_b16 a[152:153], v1 offset:0
    ds_read_b64_tr_b16 a[154:155], v1 offset:12416
    ds_read_b64_tr_b16 a[156:157], v1 offset:8
    ds_read_b64_tr_b16 a[158:159], v1 offset:12424
    v_mfma_f32_16x16x32_bf16 v[112:115], v[72:75], a[0:3], v[252:255]
    s_waitcnt vmcnt(8) lgkmcnt(12)
    ds_write_b128 v1, a[184:187] offset:0
    v_exp_f32 v69, v69
    v_mfma_f32_16x16x32_bf16 v[112:115], v[76:79], a[4:7], v[112:115]
    s_waitcnt vmcnt(7) lgkmcnt(11)
    ds_read_b128 v[184:187], v2 offset:3072
    v_perm_b32 v109, v69, v65, s49
    v_mfma_f32_16x16x32_bf16 v[112:115], v[80:83], a[8:11], v[112:115]
    s_mov_b32 s21, 69632
    ds_write_b128 v1, a[188:191] offset:12416
    v_exp_f32 v70, v70
    v_mfma_f32_16x16x32_bf16 v[112:115], v[84:87], a[12:15], v[112:115]
    s_waitcnt lgkmcnt(5)
    ds_write_addtid_b32 v109 offset:22304
    ds_read_b64_tr_b16 a[184:185], v1 offset:0
    v_perm_b32 v110, v70, v66, s49
    v_mfma_f32_16x16x32_bf16 v[120:123], a[152:155], v[168:171], v[120:123]
    ds_read_b64_tr_b16 a[186:187], v1 offset:12416
    v_exp_f32 v71, v71
    v_mfma_f32_16x16x32_bf16 v[128:131], a[152:155], v[172:175], v[128:131]
    s_waitcnt lgkmcnt(6)
    ds_write_addtid_b32 v110 offset:28544
    ds_read_b64_tr_b16 a[188:189], v1 offset:8
    v_perm_b32 v111, v71, v67, s49
    v_mfma_f32_16x16x32_bf16 v[124:127], a[156:159], v[168:171], v[124:127]
    ds_read_b64_tr_b16 a[190:191], v1 offset:12424
    v_exp_f32 v112, v112
    v_mfma_f32_16x16x32_bf16 v[132:135], a[156:159], v[172:175], v[132:135]
    ds_write_addtid_b32 v111 offset:34720
    ds_read_b128 v[104:107], v0 offset:5888
    v_mfma_f32_16x16x32_bf16 v[68:71], v[72:75], a[16:19], v[252:255]
    v_exp_f32 v113, v113
    v_mfma_f32_16x16x32_bf16 v[68:71], v[76:79], a[20:23], v[68:71]
    ds_read_b128 v[88:91], v5 offset:13312
    ds_write_b32 v28, v48 offset:1024
    v_mfma_f32_16x16x32_bf16 v[68:71], v[80:83], a[24:27], v[68:71]
    v_exp_f32 v114, v114
    v_mfma_f32_16x16x32_bf16 v[68:71], v[84:87], a[28:31], v[68:71]
    ds_write_b32 v29, v52 offset:0
    v_mfma_f32_16x16x32_bf16 v[136:139], a[152:155], v[176:179], v[136:139]
    v_exp_f32 v115, v115
    v_mfma_f32_16x16x32_bf16 v[144:147], a[152:155], v[180:183], v[144:147]
    ds_read_b128 v[188:191], v2 offset:3328
    ds_write_b32 v29, v56 offset:512
    v_mfma_f32_16x16x32_bf16 v[140:143], a[156:159], v[176:179], v[140:143]
    v_exp_f32 v68, v68
    v_mfma_f32_16x16x32_bf16 v[148:151], a[156:159], v[180:183], v[148:151]
    s_waitcnt lgkmcnt(5)
    ds_read_b128 v[192:195], v2 offset:3584
    v_perm_b32 v108, v68, v112, s49
    v_mfma_f32_16x16x32_bf16 v[60:63], v[36:39], v[104:107], v[60:63]
    s_waitcnt vmcnt(6)
    ds_write_addtid_b32 v108 offset:10240
    ds_read_b128 v[196:199], v2 offset:3840
    v_mfma_f32_16x16x32_bf16 v[64:67], v[72:75], a[32:35], v[252:255]
    s_add_u32 m0, s23, 5120
    ds_write_b128 v1, a[216:219] offset:0
    v_exp_f32 v69, v69
    v_mfma_f32_16x16x32_bf16 v[64:67], v[76:79], a[36:39], v[64:67]
    ds_read_b128 v[168:171], v3 offset:3072
    v_perm_b32 v109, v69, v113, s49
    v_mfma_f32_16x16x32_bf16 v[64:67], v[80:83], a[40:43], v[64:67]
    s_waitcnt vmcnt(5)
    ds_write_b128 v1, a[220:223] offset:12416
    v_exp_f32 v70, v70
    v_mfma_f32_16x16x32_bf16 v[64:67], v[84:87], a[44:47], v[64:67]
    ds_write_addtid_b32 v109 offset:15392
    ds_read_b64_tr_b16 a[216:217], v1 offset:0
    v_perm_b32 v110, v70, v114, s49
    v_mfma_f32_16x16x32_bf16 v[120:123], a[184:187], v[184:187], v[120:123]
    s_waitcnt lgkmcnt(9)
    ds_read_b64_tr_b16 a[218:219], v1 offset:12416
    v_exp_f32 v71, v71
    v_mfma_f32_16x16x32_bf16 v[128:131], a[184:187], v[188:191], v[128:131]
    ds_write_addtid_b32 v110 offset:21632
    ds_read_b64_tr_b16 a[220:221], v1 offset:8
    v_perm_b32 v111, v71, v115, s49
    v_mfma_f32_16x16x32_bf16 v[124:127], a[188:191], v[184:187], v[124:127]
    v_exp_f32 v64, v64
    v_mfma_f32_16x16x32_bf16 v[132:135], a[188:191], v[188:191], v[132:135]
    ds_write_addtid_b32 v111 offset:27808
    ds_read_b128 v[104:107], v0 offset:0
    v_mfma_f32_16x16x32_bf16 v[68:71], v[72:75], a[48:51], v[252:255]
    v_exp_f32 v65, v65
    v_mfma_f32_16x16x32_bf16 v[68:71], v[76:79], a[52:55], v[68:71]
    ds_read_b128 v[92:95], v6 offset:13312
    ds_read_b64_tr_b16 a[222:223], v1 offset:12424
    v_mfma_f32_16x16x32_bf16 v[68:71], v[80:83], a[56:59], v[68:71]
    v_exp_f32 v66, v66
    v_mfma_f32_16x16x32_bf16 v[68:71], v[84:87], a[60:63], v[68:71]
    s_waitcnt lgkmcnt(14)
    ds_write_b32 v29, v60 offset:1024
    v_mfma_f32_16x16x32_bf16 v[136:139], a[184:187], v[192:195], v[136:139]
    s_waitcnt lgkmcnt(13)
    v_exp_f32 v67, v67
    v_mfma_f32_16x16x32_bf16 v[144:147], a[184:187], v[196:199], v[144:147]
    s_waitcnt vmcnt(1)
    ds_read_b128 v[172:175], v3 offset:3328
    ds_add_u32 v14, v16
    v_mfma_f32_16x16x32_bf16 v[140:143], a[188:191], v[192:195], v[140:143]
    v_exp_f32 v68, v68
    v_mfma_f32_16x16x32_bf16 v[148:151], a[188:191], v[196:199], v[148:151]
    s_waitcnt lgkmcnt(5)
    ds_read_b128 v[176:179], v3 offset:3584
    v_perm_b32 v108, v68, v64, s49
    v_mfma_f32_16x16x32_bf16 v[40:43], v[32:35], v[104:107], 0
    ds_write_addtid_b32 v108 offset:9472
    ds_read_b128 v[180:183], v3 offset:3840
    v_mfma_f32_16x16x32_bf16 v[112:115], v[72:75], a[64:67], v[252:255]
    s_add_u32 s24, s24, 1
    ds_write_b128 v1, a[248:251] offset:0
    v_exp_f32 v69, v69
    v_mfma_f32_16x16x32_bf16 v[112:115], v[76:79], a[68:71], v[112:115]
    ds_read_b128 v[184:187], v4 offset:3072
    v_perm_b32 v109, v69, v65, s49
    v_mfma_f32_16x16x32_bf16 v[112:115], v[80:83], a[72:75], v[112:115]
    ds_write_b128 v1, a[252:255] offset:12416
    v_exp_f32 v70, v70
    v_mfma_f32_16x16x32_bf16 v[112:115], v[84:87], a[76:79], v[112:115]
    ds_write_addtid_b32 v109 offset:15648
    ds_read_b64_tr_b16 a[248:249], v1 offset:0
    v_perm_b32 v110, v70, v66, s49
    v_mfma_f32_16x16x32_bf16 v[120:123], a[216:219], v[168:171], v[120:123]
    s_waitcnt lgkmcnt(9)
    v_exp_f32 v71, v71
    v_mfma_f32_16x16x32_bf16 v[128:131], a[216:219], v[172:175], v[128:131]
    ds_write_addtid_b32 v110 offset:21888
    v_perm_b32 v111, v71, v67, s49
    v_mfma_f32_16x16x32_bf16 v[124:127], a[220:223], v[168:171], v[124:127]
    v_exp_f32 v112, v112
    v_mfma_f32_16x16x32_bf16 v[132:135], a[220:223], v[172:175], v[132:135]
    ds_write_addtid_b32 v111 offset:28064
    ds_read_b128 v[104:107], v0 offset:256
    v_mfma_f32_16x16x32_bf16 v[68:71], v[72:75], a[80:83], v[252:255]
    v_exp_f32 v113, v113
    v_mfma_f32_16x16x32_bf16 v[68:71], v[76:79], a[84:87], v[68:71]
    ds_read_b128 v[96:99], v7 offset:13312
    ds_read_b64_tr_b16 a[250:251], v1 offset:12416
    v_mfma_f32_16x16x32_bf16 v[68:71], v[80:83], a[88:91], v[68:71]
    v_exp_f32 v114, v114
    v_mfma_f32_16x16x32_bf16 v[68:71], v[84:87], a[92:95], v[68:71]
    s_waitcnt lgkmcnt(12)
    ds_read_b128 v[100:103], v8 offset:13312
    ds_read_b64_tr_b16 a[252:253], v1 offset:8
    v_mfma_f32_16x16x32_bf16 v[136:139], a[216:219], v[176:179], v[136:139]
    s_waitcnt lgkmcnt(12)
    v_exp_f32 v115, v115
    v_mfma_f32_16x16x32_bf16 v[144:147], a[216:219], v[180:183], v[144:147]
    ds_read_b128 v[188:191], v4 offset:3328
    ds_read_b64_tr_b16 a[254:255], v1 offset:12424
    v_mfma_f32_16x16x32_bf16 v[140:143], a[220:223], v[176:179], v[140:143]
    v_exp_f32 v68, v68
    v_mfma_f32_16x16x32_bf16 v[148:151], a[220:223], v[180:183], v[148:151]
    s_waitcnt lgkmcnt(6)
    ds_read_b128 v[192:195], v4 offset:3584
    v_perm_b32 v108, v68, v112, s49
    v_mfma_f32_16x16x32_bf16 v[40:43], v[32:35], v[104:107], v[40:43]
    ds_write_addtid_b32 v108 offset:9728
    ds_read_b128 v[196:199], v4 offset:3840
    ds_read_b32 v19, v15
    v_mfma_f32_16x16x32_bf16 v[64:67], v[72:75], a[96:99], v[252:255]
    v_exp_f32 v69, v69
    v_mfma_f32_16x16x32_bf16 v[64:67], v[76:79], a[100:103], v[64:67]
    ds_read_b128 v[168:171], v0 offset:4096
    v_perm_b32 v109, v69, v113, s49
    v_mfma_f32_16x16x32_bf16 v[64:67], v[80:83], a[104:107], v[64:67]
    v_exp_f32 v70, v70
    v_mfma_f32_16x16x32_bf16 v[64:67], v[84:87], a[108:111], v[64:67]
    s_waitcnt lgkmcnt(9)
    ds_write_addtid_b32 v109 offset:15904
    v_perm_b32 v110, v70, v114, s49
    v_mfma_f32_16x16x32_bf16 v[120:123], a[248:251], v[184:187], v[120:123]
    s_waitcnt lgkmcnt(7)
    v_exp_f32 v71, v71
    v_mfma_f32_16x16x32_bf16 v[128:131], a[248:251], v[188:191], v[128:131]
    s_waitcnt lgkmcnt(6)
    ds_write_addtid_b32 v110 offset:22144
    v_perm_b32 v111, v71, v115, s49
    v_mfma_f32_16x16x32_bf16 v[124:127], a[252:255], v[184:187], v[124:127]
    v_exp_f32 v64, v64
    v_mfma_f32_16x16x32_bf16 v[132:135], a[252:255], v[188:191], v[132:135]
    ds_write_addtid_b32 v111 offset:28320
    ds_read_b128 v[104:107], v0 offset:512
    v_mfma_f32_16x16x32_bf16 v[68:71], v[72:75], a[112:115], v[252:255]
    v_exp_f32 v65, v65
    v_mfma_f32_16x16x32_bf16 v[68:71], v[76:79], a[116:119], v[68:71]
    buffer_load_dwordx4 v9, s[4:7], s21 offen nt lds
    v_mfma_f32_16x16x32_bf16 v[68:71], v[80:83], a[120:123], v[68:71]
    v_exp_f32 v66, v66
    v_mfma_f32_16x16x32_bf16 v[68:71], v[84:87], a[124:127], v[68:71]
    s_waitcnt lgkmcnt(5)
    v_cmp_gt_u32 vcc, s24, v19
    v_mfma_f32_16x16x32_bf16 v[136:139], a[248:251], v[192:195], v[136:139]
    v_exp_f32 v67, v67
    v_mfma_f32_16x16x32_bf16 v[144:147], a[248:251], v[196:199], v[144:147]
    ds_read_b128 v[172:175], v0 offset:4352
    v_mfma_f32_16x16x32_bf16 v[140:143], a[252:255], v[192:195], v[140:143]
    v_exp_f32 v68, v68
    v_mfma_f32_16x16x32_bf16 v[148:151], a[252:255], v[196:199], v[148:151]
    s_waitcnt lgkmcnt(1)
    ds_read_b128 v[176:179], v0 offset:4608
    v_perm_b32 v108, v68, v64, s49
    v_mfma_f32_16x16x32_bf16 v[40:43], v[32:35], v[104:107], v[40:43]
    ds_write_addtid_b32 v108 offset:9984
    ds_read_b128 v[180:183], v0 offset:4864
    s_cbranch_vccnz L_retry109_b
L_back109_b:
    v_mfma_f32_16x16x32_bf16 v[112:115], v[88:91], a[0:3], v[252:255]
    s_waitcnt lgkmcnt(3)
    v_exp_f32 v69, v69
    v_mfma_f32_16x16x32_bf16 v[112:115], v[92:95], a[4:7], v[112:115]
    s_mov_b32 s26, 0
    ds_read_b128 v[184:187], v2 offset:4096
    ds_read_b128 v[24:27], v13 offset:4096
    v_perm_b32 v109, v69, v65, s49
    v_mfma_f32_16x16x32_bf16 v[112:115], v[96:99], a[8:11], v[112:115]
    s_mov_b32 s27, 4096
    v_exp_f32 v70, v70
    v_mfma_f32_16x16x32_bf16 v[112:115], v[100:103], a[12:15], v[112:115]
    s_mov_b32 s21, 73728
    ds_write_addtid_b32 v109 offset:16160
    v_perm_b32 v110, v70, v66, s49
    v_mfma_f32_16x16x32_bf16 v[152:155], a[152:155], v[168:171], v[152:155]
    s_add_u32 m0, s23, 6144
    v_exp_f32 v71, v71
    v_mfma_f32_16x16x32_bf16 v[160:163], a[152:155], v[172:175], v[160:163]
    ds_write_addtid_b32 v110 offset:21376
    v_perm_b32 v111, v71, v67, s49
    v_mfma_f32_16x16x32_bf16 v[156:159], a[156:159], v[168:171], v[156:159]
    v_exp_f32 v112, v112
    v_mfma_f32_16x16x32_bf16 v[164:167], a[156:159], v[172:175], v[164:167]
    ds_write_addtid_b32 v111 offset:27552
    ds_read_b128 v[104:107], v0 offset:768
    v_mfma_f32_16x16x32_bf16 v[68:71], v[88:91], a[16:19], v[252:255]
    v_exp_f32 v113, v113
    v_mfma_f32_16x16x32_bf16 v[68:71], v[92:95], a[20:23], v[68:71]
    s_waitcnt lgkmcnt(4)
    ds_read_b128 v[72:75], v5 offset:2048
    v_add_f32 v24, v24, v25
    v_add_f32 v26, v26, v27
    v_mfma_f32_16x16x32_bf16 v[68:71], v[96:99], a[24:27], v[68:71]
    v_exp_f32 v114, v114
    v_add_f32 v248, v24, v26
    v_mfma_f32_16x16x32_bf16 v[68:71], v[100:103], a[28:31], v[68:71]
    ds_read_b128 v[24:27], v13 offset:4352
    v_rcp_f32 v248, v248
    v_mfma_f32_16x16x32_bf16 v[200:203], a[152:155], v[176:179], v[200:203]
    v_exp_f32 v115, v115
    v_mul_f32 v120, v248, v120
    v_mfma_f32_16x16x32_bf16 v[208:211], a[152:155], v[180:183], v[208:211]
    ds_read_b128 v[188:191], v2 offset:4352
    v_mul_f32 v121, v248, v121
    v_mul_f32 v122, v248, v122
    v_mfma_f32_16x16x32_bf16 v[204:207], a[156:159], v[176:179], v[204:207]
    v_exp_f32 v68, v68
    v_mul_f32 v123, v248, v123
    v_mfma_f32_16x16x32_bf16 v[212:215], a[156:159], v[180:183], v[212:215]
    s_waitcnt lgkmcnt(3)
    ds_read_b128 v[192:195], v2 offset:4608
    v_perm_b32 v108, v68, v112, s49
    v_mul_f32 v124, v248, v124
    v_mfma_f32_16x16x32_bf16 v[40:43], v[32:35], v[104:107], v[40:43]
    ds_write_addtid_b32 v108 offset:9216
    ds_read_b128 v[196:199], v2 offset:4864
    v_mul_f32 v125, v248, v125
    v_mfma_f32_16x16x32_bf16 v[64:67], v[88:91], a[32:35], v[252:255]
    v_exp_f32 v69, v69
    v_mul_f32 v126, v248, v126
    v_mfma_f32_16x16x32_bf16 v[64:67], v[92:95], a[36:39], v[64:67]
    ds_read_b128 v[168:171], v3 offset:4096
    v_perm_b32 v109, v69, v113, s49
    v_mul_f32 v127, v248, v127
    v_mfma_f32_16x16x32_bf16 v[64:67], v[96:99], a[40:43], v[64:67]
    v_exp_f32 v70, v70
    v_bitop3_b32 v17, v17, v248, s29 bitop3:0xe8
    v_mfma_f32_16x16x32_bf16 v[64:67], v[100:103], a[44:47], v[64:67]
    ds_write_addtid_b32 v109 offset:15392
    v_perm_b32 v110, v70, v114, s49
    v_cvt_pk_bf16_f32 v120, v120, v121
    v_mfma_f32_16x16x32_bf16 v[152:155], a[184:187], v[184:187], v[152:155]
    s_waitcnt lgkmcnt(5)
    v_exp_f32 v71, v71
    v_cvt_pk_bf16_f32 v121, v122, v123
    v_mfma_f32_16x16x32_bf16 v[160:163], a[184:187], v[188:191], v[160:163]
    ds_write_addtid_b32 v110 offset:21632
    v_perm_b32 v111, v71, v115, s49
    v_cvt_pk_bf16_f32 v122, v124, v125
    v_mfma_f32_16x16x32_bf16 v[156:159], a[188:191], v[184:187], v[156:159]
    v_exp_f32 v64, v64
    v_cvt_pk_bf16_f32 v123, v126, v127
    v_mfma_f32_16x16x32_bf16 v[164:167], a[188:191], v[188:191], v[164:167]
    buffer_store_dwordx4 v[120:123], v11, s[8:11], s26 offen nt
    buffer_load_dwordx4 v9, s[4:7], s21 offen nt lds
    ds_write_addtid_b32 v111 offset:27808
    ds_read_b128 v[104:107], v0 offset:1024
    v_add_f32 v24, v24, v25
    v_add_f32 v26, v26, v27
    v_add_f32 v249, v24, v26
    v_rcp_f32 v249, v249
    v_mfma_f32_16x16x32_bf16 v[68:71], v[88:91], a[48:51], v[252:255]
    s_mov_b32 s21, 77824
    v_exp_f32 v65, v65
    v_mul_f32 v128, v249, v128
    v_mfma_f32_16x16x32_bf16 v[68:71], v[92:95], a[52:55], v[68:71]
    s_add_u32 m0, s23, 7168
    ds_read_b128 v[76:79], v6 offset:2048
    v_mul_f32 v129, v249, v129
    v_mfma_f32_16x16x32_bf16 v[68:71], v[96:99], a[56:59], v[68:71]
    v_exp_f32 v66, v66
    v_mfma_f32_16x16x32_bf16 v[68:71], v[100:103], a[60:63], v[68:71]
    s_waitcnt lgkmcnt(8)
    v_mul_f32 v130, v249, v130
    v_mul_f32 v131, v249, v131
    v_mfma_f32_16x16x32_bf16 v[200:203], a[184:187], v[192:195], v[200:203]
    s_waitcnt lgkmcnt(6)
    v_exp_f32 v67, v67
    v_mfma_f32_16x16x32_bf16 v[208:211], a[184:187], v[196:199], v[208:211]
    ds_read_b128 v[172:175], v3 offset:4352
    v_mul_f32 v132, v249, v132
    v_mfma_f32_16x16x32_bf16 v[204:207], a[188:191], v[192:195], v[204:207]
    v_exp_f32 v68, v68
    v_mfma_f32_16x16x32_bf16 v[212:215], a[188:191], v[196:199], v[212:215]
    s_waitcnt lgkmcnt(2)
    ds_read_b128 v[176:179], v3 offset:4608
    v_perm_b32 v108, v68, v64, s49
    v_mfma_f32_16x16x32_bf16 v[40:43], v[36:39], v[104:107], v[40:43]
    ds_write_addtid_b32 v108 offset:8448
    ds_read_b128 v[180:183], v3 offset:4864
    v_mfma_f32_16x16x32_bf16 v[112:115], v[88:91], a[64:67], v[252:255]
    v_exp_f32 v69, v69
    v_mfma_f32_16x16x32_bf16 v[112:115], v[92:95], a[68:71], v[112:115]
    ds_read_b128 v[184:187], v4 offset:4096
    v_perm_b32 v109, v69, v65, s49
    v_mfma_f32_16x16x32_bf16 v[112:115], v[96:99], a[72:75], v[112:115]
    v_exp_f32 v70, v70
    v_mfma_f32_16x16x32_bf16 v[112:115], v[100:103], a[76:79], v[112:115]
    ds_write_addtid_b32 v109 offset:14624
    v_perm_b32 v110, v70, v66, s49
    v_mfma_f32_16x16x32_bf16 v[152:155], a[216:219], v[168:171], v[152:155]
    s_waitcnt lgkmcnt(5)
    v_exp_f32 v71, v71
    v_mfma_f32_16x16x32_bf16 v[160:163], a[216:219], v[172:175], v[160:163]
    ds_write_addtid_b32 v110 offset:20864
    v_perm_b32 v111, v71, v67, s49
    v_mfma_f32_16x16x32_bf16 v[156:159], a[220:223], v[168:171], v[156:159]
    v_exp_f32 v112, v112
    v_mfma_f32_16x16x32_bf16 v[164:167], a[220:223], v[172:175], v[164:167]
    ds_write_addtid_b32 v111 offset:27040
    ds_read_b128 v[104:107], v0 offset:1280
    v_mfma_f32_16x16x32_bf16 v[68:71], v[88:91], a[80:83], v[252:255]
    v_exp_f32 v113, v113
    v_mfma_f32_16x16x32_bf16 v[68:71], v[92:95], a[84:87], v[68:71]
    ds_read_b128 v[80:83], v7 offset:2048
    v_mul_f32 v133, v249, v133
    v_mfma_f32_16x16x32_bf16 v[68:71], v[96:99], a[88:91], v[68:71]
    v_exp_f32 v114, v114
    v_mfma_f32_16x16x32_bf16 v[68:71], v[100:103], a[92:95], v[68:71]
    s_waitcnt lgkmcnt(8)
    ds_read_b128 v[84:87], v8 offset:2048
    v_mul_f32 v134, v249, v134
    v_mfma_f32_16x16x32_bf16 v[200:203], a[216:219], v[176:179], v[200:203]
    s_waitcnt lgkmcnt(7)
    v_exp_f32 v115, v115
    v_mfma_f32_16x16x32_bf16 v[208:211], a[216:219], v[180:183], v[208:211]
    ds_read_b128 v[188:191], v4 offset:4352
    v_mul_f32 v135, v249, v135
    v_mfma_f32_16x16x32_bf16 v[204:207], a[220:223], v[176:179], v[204:207]
    v_exp_f32 v68, v68
    v_mfma_f32_16x16x32_bf16 v[212:215], a[220:223], v[180:183], v[212:215]
    s_waitcnt lgkmcnt(3)
    ds_read_b128 v[192:195], v4 offset:4608
    v_perm_b32 v108, v68, v112, s49
    v_mfma_f32_16x16x32_bf16 v[40:43], v[36:39], v[104:107], v[40:43]
    ds_write_addtid_b32 v108 offset:8704
    ds_read_b128 v[196:199], v4 offset:4864
    v_mfma_f32_16x16x32_bf16 v[64:67], v[88:91], a[96:99], v[252:255]
    v_exp_f32 v69, v69
    v_mfma_f32_16x16x32_bf16 v[64:67], v[92:95], a[100:103], v[64:67]
    ds_read_b128 v[168:171], v0 offset:5120
    v_perm_b32 v109, v69, v113, s49
    v_mfma_f32_16x16x32_bf16 v[64:67], v[96:99], a[104:107], v[64:67]
    v_exp_f32 v70, v70
    v_mfma_f32_16x16x32_bf16 v[64:67], v[100:103], a[108:111], v[64:67]
    ds_write_addtid_b32 v109 offset:14880
    v_perm_b32 v110, v70, v114, s49
    v_mfma_f32_16x16x32_bf16 v[152:155], a[248:251], v[184:187], v[152:155]
    s_waitcnt lgkmcnt(5)
    v_exp_f32 v71, v71
    v_mfma_f32_16x16x32_bf16 v[160:163], a[248:251], v[188:191], v[160:163]
    ds_write_addtid_b32 v110 offset:21120
    v_perm_b32 v111, v71, v115, s49
    v_mfma_f32_16x16x32_bf16 v[156:159], a[252:255], v[184:187], v[156:159]
    v_exp_f32 v64, v64
    v_mfma_f32_16x16x32_bf16 v[164:167], a[252:255], v[188:191], v[164:167]
    ds_write_addtid_b32 v111 offset:27296
    ds_read_b128 v[104:107], v0 offset:1536
    v_mfma_f32_16x16x32_bf16 v[68:71], v[88:91], a[112:115], v[252:255]
    v_exp_f32 v65, v65
    v_mfma_f32_16x16x32_bf16 v[68:71], v[92:95], a[116:119], v[68:71]
    v_bitop3_b32 v17, v17, v249, s29 bitop3:0xe8
    v_cvt_pk_bf16_f32 v128, v128, v129
    v_mfma_f32_16x16x32_bf16 v[68:71], v[96:99], a[120:123], v[68:71]
    v_exp_f32 v66, v66
    v_mfma_f32_16x16x32_bf16 v[68:71], v[100:103], a[124:127], v[68:71]
    s_waitcnt lgkmcnt(7)
    v_cvt_pk_bf16_f32 v129, v130, v131
    v_cvt_pk_bf16_f32 v130, v132, v133
    v_mfma_f32_16x16x32_bf16 v[200:203], a[248:251], v[192:195], v[200:203]
    s_waitcnt lgkmcnt(5)
    v_exp_f32 v67, v67
    v_mfma_f32_16x16x32_bf16 v[208:211], a[248:251], v[196:199], v[208:211]
    ds_read_b128 v[172:175], v0 offset:5376
    v_cvt_pk_bf16_f32 v131, v134, v135
    v_mfma_f32_16x16x32_bf16 v[204:207], a[252:255], v[192:195], v[204:207]
    buffer_store_dwordx4 v[128:131], v11, s[8:11], s27 offen nt
    buffer_load_dwordx4 v9, s[4:7], s21 offen nt lds
    v_exp_f32 v68, v68
    v_mfma_f32_16x16x32_bf16 v[212:215], a[252:255], v[196:199], v[212:215]
    s_waitcnt lgkmcnt(1)
    ds_read_b128 v[176:179], v0 offset:5632
    v_perm_b32 v108, v68, v64, s49
    v_mfma_f32_16x16x32_bf16 v[40:43], v[36:39], v[104:107], v[40:43]
    ds_write_addtid_b32 v108 offset:8960
    ds_read_b128 v[180:183], v0 offset:5888
    v_mfma_f32_16x16x32_bf16 v[112:115], v[72:75], a[0:3], v[252:255]
    s_waitcnt lgkmcnt(3)
    v_exp_f32 v69, v69
    v_mfma_f32_16x16x32_bf16 v[112:115], v[76:79], a[4:7], v[112:115]
    s_mov_b32 s26, 8192
    ds_read_b128 v[184:187], v2 offset:5120
    ds_read_b128 v[24:27], v13 offset:4608
    v_perm_b32 v109, v69, v65, s49
    v_mfma_f32_16x16x32_bf16 v[112:115], v[80:83], a[8:11], v[112:115]
    s_mov_b32 s27, 12288
    v_exp_f32 v70, v70
    v_mfma_f32_16x16x32_bf16 v[112:115], v[84:87], a[12:15], v[112:115]
    s_mov_b32 s21, 81920
    ds_write_addtid_b32 v109 offset:15136
    v_perm_b32 v110, v70, v66, s49
    v_mfma_f32_16x16x32_bf16 v[216:219], a[152:155], v[168:171], v[216:219]
    s_add_u32 m0, s23, 8192
    v_exp_f32 v71, v71
    v_mfma_f32_16x16x32_bf16 v[224:227], a[152:155], v[172:175], v[224:227]
    ds_write_addtid_b32 v110 offset:20352
    v_perm_b32 v111, v71, v67, s49
    v_mfma_f32_16x16x32_bf16 v[220:223], a[156:159], v[168:171], v[220:223]
    v_exp_f32 v112, v112
    v_mfma_f32_16x16x32_bf16 v[228:231], a[156:159], v[172:175], v[228:231]
    ds_write_addtid_b32 v111 offset:26528
    ds_read_b128 v[104:107], v0 offset:1792
    v_mfma_f32_16x16x32_bf16 v[68:71], v[72:75], a[16:19], v[252:255]
    v_exp_f32 v113, v113
    v_mfma_f32_16x16x32_bf16 v[68:71], v[76:79], a[20:23], v[68:71]
    s_waitcnt lgkmcnt(4)
    ds_read_b128 v[88:91], v5 offset:3072
    v_add_f32 v24, v24, v25
    v_add_f32 v26, v26, v27
    v_mfma_f32_16x16x32_bf16 v[68:71], v[80:83], a[24:27], v[68:71]
    v_exp_f32 v114, v114
    v_add_f32 v248, v24, v26
    v_mfma_f32_16x16x32_bf16 v[68:71], v[84:87], a[28:31], v[68:71]
    ds_read_b128 v[24:27], v13 offset:4864
    v_rcp_f32 v248, v248
    v_mfma_f32_16x16x32_bf16 v[232:235], a[152:155], v[176:179], v[232:235]
    v_exp_f32 v115, v115
    v_mul_f32 v136, v248, v136
    v_mul_f32 v137, v248, v137
    v_mfma_f32_16x16x32_bf16 v[240:243], a[152:155], v[180:183], v[240:243]
    v_bfe_i32 v1, v14, 2, 1
    v_and_b32 v1, 0xaaaaaaaa, v1
    ds_read_b128 v[188:191], v2 offset:5376
    v_mfma_f32_16x16x32_bf16 v[236:239], a[156:159], v[176:179], v[236:239]
    v_exp_f32 v68, v68
    v_mul_f32 v138, v248, v138
    v_mfma_f32_16x16x32_bf16 v[244:247], a[156:159], v[180:183], v[244:247]
    s_waitcnt lgkmcnt(3)
    ds_read_b128 v[192:195], v2 offset:5632
    v_perm_b32 v108, v68, v112, s49
    v_mul_f32 v139, v248, v139
    v_mfma_f32_16x16x32_bf16 v[40:43], v[36:39], v[104:107], v[40:43]
    ds_write_addtid_b32 v108 offset:8192
    ds_read_b128 v[196:199], v2 offset:5888
    v_mul_f32 v140, v248, v140
    v_mfma_f32_16x16x32_bf16 v[64:67], v[72:75], a[32:35], v[252:255]
    v_exp_f32 v69, v69
    v_mul_f32 v141, v248, v141
    v_mfma_f32_16x16x32_bf16 v[64:67], v[76:79], a[36:39], v[64:67]
    ds_read_b128 v[168:171], v3 offset:5120
    v_perm_b32 v109, v69, v113, s49
    v_mul_f32 v142, v248, v142
    v_mfma_f32_16x16x32_bf16 v[64:67], v[80:83], a[40:43], v[64:67]
    v_exp_f32 v70, v70
    v_mul_f32 v143, v248, v143
    v_mfma_f32_16x16x32_bf16 v[64:67], v[84:87], a[44:47], v[64:67]
    ds_write_addtid_b32 v109 offset:14368
    v_perm_b32 v110, v70, v114, s49
    v_bitop3_b32 v17, v17, v248, s29 bitop3:0xe8
    v_mfma_f32_16x16x32_bf16 v[216:219], a[184:187], v[184:187], v[216:219]
    s_waitcnt lgkmcnt(5)
    v_exp_f32 v71, v71
    v_cvt_pk_bf16_f32 v136, v136, v137
    v_mfma_f32_16x16x32_bf16 v[224:227], a[184:187], v[188:191], v[224:227]
    ds_write_addtid_b32 v110 offset:20608
    v_perm_b32 v111, v71, v115, s49
    v_cvt_pk_bf16_f32 v137, v138, v139
    v_mfma_f32_16x16x32_bf16 v[220:223], a[188:191], v[184:187], v[220:223]
    v_exp_f32 v64, v64
    v_cvt_pk_bf16_f32 v138, v140, v141
    v_mfma_f32_16x16x32_bf16 v[228:231], a[188:191], v[188:191], v[228:231]
    ds_write_addtid_b32 v111 offset:26784
    ds_read_b128 v[104:107], v0 offset:2048
    v_cvt_pk_bf16_f32 v139, v142, v143
    v_mfma_f32_16x16x32_bf16 v[68:71], v[72:75], a[48:51], v[252:255]
    buffer_store_dwordx4 v[136:139], v11, s[8:11], s26 offen nt
    buffer_load_dwordx4 v9, s[4:7], s21 offen nt lds
    v_exp_f32 v65, v65
    v_add_f32 v24, v24, v25
    v_add_f32 v26, v26, v27
    v_add_f32 v249, v24, v26
    v_rcp_f32 v249, v249
    v_mfma_f32_16x16x32_bf16 v[68:71], v[76:79], a[52:55], v[68:71]
    s_mov_b32 s21, 86016
    ds_read_b128 v[92:95], v6 offset:3072
    v_mul_f32 v144, v249, v144
    v_mul_f32 v145, v249, v145
    v_mfma_f32_16x16x32_bf16 v[68:71], v[80:83], a[56:59], v[68:71]
    s_add_u32 m0, s23, 9216
    v_exp_f32 v66, v66
    v_mul_f32 v146, v249, v146
    v_mfma_f32_16x16x32_bf16 v[68:71], v[84:87], a[60:63], v[68:71]
    s_waitcnt lgkmcnt(8)
    ds_write_b32 v12, v40 offset:0
    v_mul_f32 v147, v249, v147
    v_mfma_f32_16x16x32_bf16 v[232:235], a[184:187], v[192:195], v[232:235]
    s_waitcnt lgkmcnt(7)
    v_exp_f32 v67, v67
    v_mul_f32 v148, v249, v148
    v_mfma_f32_16x16x32_bf16 v[240:243], a[184:187], v[196:199], v[240:243]
    s_waitcnt vmcnt(6)
    ds_read_b128 v[172:175], v3 offset:5376
    ds_add_u32 v14, v16
    v_mfma_f32_16x16x32_bf16 v[236:239], a[188:191], v[192:195], v[236:239]
    v_exp_f32 v68, v68
    v_mul_f32 v149, v249, v149
    v_mfma_f32_16x16x32_bf16 v[244:247], a[188:191], v[196:199], v[244:247]
    s_waitcnt lgkmcnt(4)
    ds_read_b128 v[176:179], v3 offset:5632
    v_perm_b32 v108, v68, v64, s49
    v_mul_f32 v150, v249, v150
    v_mfma_f32_16x16x32_bf16 v[44:47], v[32:35], v[104:107], 0
    ds_write_addtid_b32 v108 offset:7424
    ds_read_b128 v[180:183], v3 offset:5888
    v_mul_f32 v151, v249, v151
    v_mfma_f32_16x16x32_bf16 v[112:115], v[72:75], a[64:67], v[252:255]
    s_add_u32 s24, s24, 1
    v_exp_f32 v69, v69
    v_mfma_f32_16x16x32_bf16 v[112:115], v[76:79], a[68:71], v[112:115]
L_pad5_b:
    s_cbranch_execz L_pad9_b
    ds_read_b128 v[184:187], v4 offset:5120
    v_perm_b32 v109, v69, v65, s49
    v_mfma_f32_16x16x32_bf16 v[112:115], v[80:83], a[72:75], v[112:115]
    v_exp_f32 v70, v70
    v_mfma_f32_16x16x32_bf16 v[112:115], v[84:87], a[76:79], v[112:115]
    ds_write_addtid_b32 v109 offset:13600
    v_perm_b32 v110, v70, v66, s49
    v_mfma_f32_16x16x32_bf16 v[216:219], a[216:219], v[168:171], v[216:219]
    s_waitcnt lgkmcnt(6)
    v_exp_f32 v71, v71
    v_mfma_f32_16x16x32_bf16 v[224:227], a[216:219], v[172:175], v[224:227]
    ds_write_addtid_b32 v110 offset:19840
    v_perm_b32 v111, v71, v67, s49
    v_mfma_f32_16x16x32_bf16 v[220:223], a[220:223], v[168:171], v[220:223]
    v_exp_f32 v112, v112
    v_mfma_f32_16x16x32_bf16 v[228:231], a[220:223], v[172:175], v[228:231]
    ds_write_addtid_b32 v111 offset:26016
    ds_read_b128 v[104:107], v0 offset:2304
    v_mfma_f32_16x16x32_bf16 v[68:71], v[72:75], a[80:83], v[252:255]
    v_exp_f32 v113, v113
    v_mfma_f32_16x16x32_bf16 v[68:71], v[76:79], a[84:87], v[68:71]
    ds_read_b128 v[96:99], v7 offset:3072
    v_bitop3_b32 v17, v17, v249, s29 bitop3:0xe8
    v_mfma_f32_16x16x32_bf16 v[68:71], v[80:83], a[88:91], v[68:71]
    v_exp_f32 v114, v114
    v_mfma_f32_16x16x32_bf16 v[68:71], v[84:87], a[92:95], v[68:71]
    s_waitcnt lgkmcnt(8)
    ds_read_b128 v[100:103], v8 offset:3072
    v_cvt_pk_bf16_f32 v144, v144, v145
    v_mfma_f32_16x16x32_bf16 v[232:235], a[216:219], v[176:179], v[232:235]
    s_waitcnt lgkmcnt(7)
    v_exp_f32 v115, v115
    v_mfma_f32_16x16x32_bf16 v[240:243], a[216:219], v[180:183], v[240:243]
    v_or_b32 v1, 0x44444444, v1
    ds_read_b128 v[188:191], v4 offset:5376
    v_mfma_f32_16x16x32_bf16 v[236:239], a[220:223], v[176:179], v[236:239]
    v_exp_f32 v68, v68
    v_mfma_f32_16x16x32_bf16 v[244:247], a[220:223], v[180:183], v[244:247]
    s_waitcnt lgkmcnt(3)
    ds_read_b128 v[192:195], v4 offset:5632
    v_perm_b32 v108, v68, v112, s49
    v_mfma_f32_16x16x32_bf16 v[44:47], v[32:35], v[104:107], v[44:47]
    ds_write_addtid_b32 v108 offset:7680
    ds_read_b128 v[196:199], v4 offset:5888
    ds_read_b32 v19, v15
    v_mfma_f32_16x16x32_bf16 v[64:67], v[72:75], a[96:99], v[252:255]
    v_exp_f32 v69, v69
    v_mfma_f32_16x16x32_bf16 v[64:67], v[76:79], a[100:103], v[64:67]
    ds_read_b128 v[168:171], v0 offset:0
    v_perm_b32 v109, v69, v113, s49
    v_mfma_f32_16x16x32_bf16 v[64:67], v[80:83], a[104:107], v[64:67]
    v_exp_f32 v70, v70
    v_mfma_f32_16x16x32_bf16 v[64:67], v[84:87], a[108:111], v[64:67]
    ds_write_addtid_b32 v109 offset:13856
    v_perm_b32 v110, v70, v114, s49
    v_mfma_f32_16x16x32_bf16 v[216:219], a[248:251], v[184:187], v[216:219]
    s_waitcnt lgkmcnt(6)
    v_exp_f32 v71, v71
    v_mfma_f32_16x16x32_bf16 v[224:227], a[248:251], v[188:191], v[224:227]
    ds_write_addtid_b32 v110 offset:20096
    v_perm_b32 v111, v71, v115, s49
    v_mfma_f32_16x16x32_bf16 v[220:223], a[252:255], v[184:187], v[220:223]
    v_exp_f32 v64, v64
    v_mfma_f32_16x16x32_bf16 v[228:231], a[252:255], v[188:191], v[228:231]
    ds_write_addtid_b32 v111 offset:26272
    ds_read_b128 v[104:107], v0 offset:2560
    v_mfma_f32_16x16x32_bf16 v[68:71], v[72:75], a[112:115], v[252:255]
    v_exp_f32 v65, v65
    v_mfma_f32_16x16x32_bf16 v[68:71], v[76:79], a[116:119], v[68:71]
    v_cvt_pk_bf16_f32 v145, v146, v147
    v_cvt_pk_bf16_f32 v146, v148, v149
    v_mfma_f32_16x16x32_bf16 v[68:71], v[80:83], a[120:123], v[68:71]
    v_exp_f32 v66, v66
    v_mfma_f32_16x16x32_bf16 v[68:71], v[84:87], a[124:127], v[68:71]
    s_waitcnt lgkmcnt(5)
    v_cmp_gt_u32 vcc, s24, v19
    v_cvt_pk_bf16_f32 v147, v150, v151
    v_mfma_f32_16x16x32_bf16 v[232:235], a[248:251], v[192:195], v[232:235]
    buffer_store_dwordx4 v[144:147], v11, s[8:11], s27 offen nt
    buffer_load_dwordx4 v9, s[4:7], s21 offen nt lds
    v_exp_f32 v67, v67
    v_mfma_f32_16x16x32_bf16 v[240:243], a[248:251], v[196:199], v[240:243]
    v_mov_b64 v[40:41], 0
    ds_read_b128 v[172:175], v0 offset:256
    v_mfma_f32_16x16x32_bf16 v[236:239], a[252:255], v[192:195], v[236:239]
    v_exp_f32 v68, v68
    v_mfma_f32_16x16x32_bf16 v[244:247], a[252:255], v[196:199], v[244:247]
    s_waitcnt lgkmcnt(1)
    ds_read_b128 v[176:179], v0 offset:512
    v_perm_b32 v108, v68, v64, s49
    v_mfma_f32_16x16x32_bf16 v[44:47], v[32:35], v[104:107], v[44:47]
    ds_write_addtid_b32 v108 offset:7936
    ds_read_b128 v[180:183], v0 offset:768
    s_cbranch_vccnz L_retry111_b
L_back111_b:
    v_mfma_f32_16x16x32_bf16 v[112:115], v[88:91], a[0:3], v[252:255]
    s_waitcnt lgkmcnt(3)
    v_exp_f32 v69, v69
    v_mfma_f32_16x16x32_bf16 v[112:115], v[92:95], a[4:7], v[112:115]
    s_mov_b32 s26, 16384
    ds_read_b128 v[184:187], v2 offset:0
    ds_read_b128 v[120:123], v13 offset:5120
    v_perm_b32 v109, v69, v65, s49
    v_mfma_f32_16x16x32_bf16 v[112:115], v[96:99], a[8:11], v[112:115]
    s_mov_b32 s27, 20480
    v_exp_f32 v70, v70
    v_mfma_f32_16x16x32_bf16 v[112:115], v[100:103], a[12:15], v[112:115]
    s_mov_b32 s21, 90112
    ds_write_addtid_b32 v109 offset:14112
    v_perm_b32 v110, v70, v66, s49
    v_mfma_f32_16x16x32_bf16 v[48:51], a[128:131], v[168:171], 0
    s_add_u32 m0, s23, 10240
    v_exp_f32 v71, v71
    v_mfma_f32_16x16x32_bf16 v[48:51], a[136:139], v[172:175], v[48:51]
    ds_write_addtid_b32 v110 offset:19328
    v_perm_b32 v111, v71, v67, s49
    v_mfma_f32_16x16x32_bf16 v[52:55], a[132:135], v[168:171], 0
    v_exp_f32 v112, v112
    v_mfma_f32_16x16x32_bf16 v[52:55], a[140:143], v[172:175], v[52:55]
    ds_write_addtid_b32 v111 offset:25504
    ds_read_b128 v[104:107], v0 offset:2816
    v_mfma_f32_16x16x32_bf16 v[68:71], v[88:91], a[16:19], v[252:255]
    v_exp_f32 v113, v113
    v_mfma_f32_16x16x32_bf16 v[68:71], v[92:95], a[20:23], v[68:71]
    s_waitcnt lgkmcnt(4)
    ds_read_b128 v[72:75], v5 offset:4096
    ds_read_b128 v[24:27], v18 offset:0
    v_add_f32 v120, v120, v121
    v_mfma_f32_16x16x32_bf16 v[68:71], v[96:99], a[24:27], v[68:71]
    v_exp_f32 v114, v114
    v_mfma_f32_16x16x32_bf16 v[68:71], v[100:103], a[28:31], v[68:71]
    v_add_f32 v122, v122, v123
    v_add_f32 v248, v120, v122
    v_mfma_f32_16x16x32_bf16 v[48:51], a[144:147], v[176:179], v[48:51]
    v_exp_f32 v115, v115
    v_mfma_f32_16x16x32_bf16 v[48:51], a[152:155], v[180:183], v[48:51]
    ds_read_b128 v[188:191], v2 offset:256
    ds_read_b128 v[120:123], v13 offset:5376
    v_mfma_f32_16x16x32_bf16 v[52:55], a[148:151], v[176:179], v[52:55]
    v_exp_f32 v68, v68
    v_mfma_f32_16x16x32_bf16 v[52:55], a[156:159], v[180:183], v[52:55]
    s_waitcnt lgkmcnt(4)
    ds_read_b128 v[192:195], v2 offset:512
    v_perm_b32 v108, v68, v112, s49
    v_mfma_f32_16x16x32_bf16 v[44:47], v[32:35], v[104:107], v[44:47]
    ds_write_addtid_b32 v108 offset:7168
    ds_read_b128 v[196:199], v2 offset:768
    v_mfma_f32_16x16x32_bf16 v[64:67], v[88:91], a[32:35], v[252:255]
    s_waitcnt lgkmcnt(5)
    v_exp_f32 v69, v69
    v_add_f32 v24, v24, v25
    v_mfma_f32_16x16x32_bf16 v[64:67], v[92:95], a[36:39], v[64:67]
    ds_read_b128 v[168:171], v3 offset:0
    v_perm_b32 v109, v69, v113, s49
    v_add_f32 v26, v26, v27
    v_mfma_f32_16x16x32_bf16 v[64:67], v[96:99], a[40:43], v[64:67]
    v_exp_f32 v70, v70
    v_add_f32 v24, v24, v26
    v_mfma_f32_16x16x32_bf16 v[64:67], v[100:103], a[44:47], v[64:67]
    ds_write_addtid_b32 v109 offset:13344
    v_perm_b32 v110, v70, v114, s49
    v_rcp_f32 v248, v248
    v_mfma_f32_16x16x32_bf16 v[48:51], a[160:163], v[184:187], v[48:51]
    s_waitcnt lgkmcnt(6)
    v_exp_f32 v71, v71
    v_mul_f32 v152, v248, v152
    v_mfma_f32_16x16x32_bf16 v[48:51], a[168:171], v[188:191], v[48:51]
    ds_write_addtid_b32 v110 offset:19584
    v_perm_b32 v111, v71, v115, s49
    v_mul_f32 v153, v248, v153
    v_mfma_f32_16x16x32_bf16 v[52:55], a[164:167], v[184:187], v[52:55]
    v_exp_f32 v64, v64
    v_mul_f32 v154, v248, v154
    v_mfma_f32_16x16x32_bf16 v[52:55], a[172:175], v[188:191], v[52:55]
    ds_write_addtid_b32 v111 offset:25760
    ds_read_b128 v[104:107], v0 offset:3072
    v_mul_f32 v155, v248, v155
    v_mfma_f32_16x16x32_bf16 v[68:71], v[88:91], a[48:51], v[252:255]
    v_exp_f32 v65, v65
    v_mul_f32 v156, v248, v156
    v_mfma_f32_16x16x32_bf16 v[68:71], v[92:95], a[52:55], v[68:71]
    ds_read_b128 v[76:79], v6 offset:4096
    v_mul_f32 v157, v248, v157
    v_mul_f32 v158, v248, v158
    v_mfma_f32_16x16x32_bf16 v[68:71], v[96:99], a[56:59], v[68:71]
    v_exp_f32 v66, v66
    v_mul_f32 v159, v248, v159
    v_mfma_f32_16x16x32_bf16 v[68:71], v[100:103], a[60:63], v[68:71]
    s_waitcnt lgkmcnt(8)
    v_bitop3_b32 v17, v17, v248, s29 bitop3:0xe8
    v_cvt_pk_bf16_f32 v152, v152, v153
    v_cvt_pk_bf16_f32 v153, v154, v155
    v_mfma_f32_16x16x32_bf16 v[48:51], a[176:179], v[192:195], v[48:51]
    s_waitcnt lgkmcnt(6)
    v_exp_f32 v67, v67
    v_cvt_pk_bf16_f32 v154, v156, v157
    v_mfma_f32_16x16x32_bf16 v[48:51], a[184:187], v[196:199], v[48:51]
    ds_read_b128 v[172:175], v3 offset:256
    v_cvt_pk_bf16_f32 v155, v158, v159
    v_mfma_f32_16x16x32_bf16 v[52:55], a[180:183], v[192:195], v[52:55]
    buffer_store_dwordx4 v[152:155], v11, s[8:11], s26 offen nt
    v_exp_f32 v68, v68
    v_rcp_f32 v20, v24
    v_mfma_f32_16x16x32_bf16 v[52:55], a[188:191], v[196:199], v[52:55]
    s_waitcnt lgkmcnt(2)
    ds_read_b128 v[176:179], v3 offset:512
    v_perm_b32 v108, v68, v64, s49
    v_bitop3_b32 v17, v17, v20, s29 bitop3:0xe8
    v_mfma_f32_16x16x32_bf16 v[44:47], v[36:39], v[104:107], v[44:47]
    ds_write_addtid_b32 v108 offset:7424
    ds_read_b128 v[180:183], v3 offset:768
    v_mov_b32 v21, v20
    v_mfma_f32_16x16x32_bf16 v[112:115], v[88:91], a[64:67], v[252:255]
    v_exp_f32 v69, v69
    v_permlane32_swap_b32 v20, v21
    v_mfma_f32_16x16x32_bf16 v[112:115], v[92:95], a[68:71], v[112:115]
    ds_read_b128 v[184:187], v4 offset:0
    v_perm_b32 v109, v69, v65, s49
    v_add_f32 v120, v120, v121
    v_mfma_f32_16x16x32_bf16 v[112:115], v[96:99], a[72:75], v[112:115]
    v_exp_f32 v70, v70
    v_add_f32 v122, v122, v123
    v_mfma_f32_16x16x32_bf16 v[112:115], v[100:103], a[76:79], v[112:115]
    ds_write_addtid_b32 v109 offset:13600
    v_perm_b32 v110, v70, v66, s49
    v_add_f32 v249, v120, v122
    v_mfma_f32_16x16x32_bf16 v[48:51], a[192:195], v[168:171], v[48:51]
    s_waitcnt lgkmcnt(5)
    v_exp_f32 v71, v71
    v_mfma_f32_16x16x32_bf16 v[48:51], a[200:203], v[172:175], v[48:51]
    ds_write_addtid_b32 v110 offset:19840
    v_perm_b32 v111, v71, v67, s49
    v_mfma_f32_16x16x32_bf16 v[52:55], a[196:199], v[168:171], v[52:55]
    v_exp_f32 v112, v112
    v_mfma_f32_16x16x32_bf16 v[52:55], a[204:207], v[172:175], v[52:55]
    ds_write_addtid_b32 v111 offset:26016
    ds_read_b128 v[104:107], v0 offset:3328
    v_mfma_f32_16x16x32_bf16 v[68:71], v[88:91], a[80:83], v[252:255]
    v_exp_f32 v113, v113
    v_mfma_f32_16x16x32_bf16 v[68:71], v[92:95], a[84:87], v[68:71]
    ds_read_b128 v[80:83], v7 offset:4096
    v_rcp_f32 v249, v249
    v_mfma_f32_16x16x32_bf16 v[68:71], v[96:99], a[88:91], v[68:71]
    v_exp_f32 v114, v114
    v_mul_f32 v160, v249, v160
    v_mfma_f32_16x16x32_bf16 v[68:71], v[100:103], a[92:95], v[68:71]
    s_waitcnt lgkmcnt(8)
    ds_read_b128 v[84:87], v8 offset:4096
    v_mul_f32 v161, v249, v161
    v_mul_f32 v162, v249, v162
    v_mfma_f32_16x16x32_bf16 v[48:51], a[208:211], v[176:179], v[48:51]
    s_waitcnt lgkmcnt(7)
    v_exp_f32 v115, v115
    v_mul_f32 v163, v249, v163
    v_mfma_f32_16x16x32_bf16 v[48:51], a[216:219], v[180:183], v[48:51]
    ds_read_b128 v[188:191], v4 offset:256
    v_mul_f32 v164, v249, v164
    v_mul_f32 v165, v249, v165
    v_mfma_f32_16x16x32_bf16 v[52:55], a[212:215], v[176:179], v[52:55]
    v_exp_f32 v68, v68
    v_mul_f32 v166, v249, v166
    v_mfma_f32_16x16x32_bf16 v[52:55], a[220:223], v[180:183], v[52:55]
    s_waitcnt lgkmcnt(3)
    ds_read_b128 v[192:195], v4 offset:512
    v_perm_b32 v108, v68, v112, s49
    v_mul_f32 v167, v249, v167
    v_mfma_f32_16x16x32_bf16 v[44:47], v[36:39], v[104:107], v[44:47]
    ds_write_addtid_b32 v108 offset:7680
    ds_read_b128 v[196:199], v4 offset:768
    v_mfma_f32_16x16x32_bf16 v[64:67], v[88:91], a[96:99], v[252:255]
    v_exp_f32 v69, v69
    v_mfma_f32_16x16x32_bf16 v[64:67], v[92:95], a[100:103], v[64:67]
    ds_read_b128 v[168:171], v0 offset:1024
    v_perm_b32 v109, v69, v113, s49
    v_mfma_f32_16x16x32_bf16 v[64:67], v[96:99], a[104:107], v[64:67]
    v_exp_f32 v70, v70
    v_mfma_f32_16x16x32_bf16 v[64:67], v[100:103], a[108:111], v[64:67]
    ds_write_addtid_b32 v109 offset:13856
    v_perm_b32 v110, v70, v114, s49
    v_mfma_f32_16x16x32_bf16 v[48:51], a[224:227], v[184:187], v[48:51]
    s_waitcnt lgkmcnt(5)
    v_exp_f32 v71, v71
    v_mfma_f32_16x16x32_bf16 v[48:51], a[232:235], v[188:191], v[48:51]
    ds_write_addtid_b32 v110 offset:20096
    v_perm_b32 v111, v71, v115, s49
    v_mfma_f32_16x16x32_bf16 v[52:55], a[228:231], v[184:187], v[52:55]
    v_exp_f32 v64, v64
    v_mfma_f32_16x16x32_bf16 v[52:55], a[236:239], v[188:191], v[52:55]
    ds_write_addtid_b32 v111 offset:26272
    ds_read_b128 v[104:107], v0 offset:3584
    v_mfma_f32_16x16x32_bf16 v[68:71], v[88:91], a[112:115], v[252:255]
    v_exp_f32 v65, v65
    v_mfma_f32_16x16x32_bf16 v[68:71], v[92:95], a[116:119], v[68:71]
    v_bitop3_b32 v17, v17, v249, s29 bitop3:0xe8
    v_cvt_pk_bf16_f32 v160, v160, v161
    v_mfma_f32_16x16x32_bf16 v[68:71], v[96:99], a[120:123], v[68:71]
    v_exp_f32 v66, v66
    v_mfma_f32_16x16x32_bf16 v[68:71], v[100:103], a[124:127], v[68:71]
    s_waitcnt lgkmcnt(7)
    v_cvt_pk_bf16_f32 v161, v162, v163
    v_cvt_pk_bf16_f32 v162, v164, v165
    v_mfma_f32_16x16x32_bf16 v[48:51], a[240:243], v[192:195], v[48:51]
    s_waitcnt lgkmcnt(5)
    v_exp_f32 v67, v67
    v_mfma_f32_16x16x32_bf16 v[48:51], a[248:251], v[196:199], v[48:51]
    ds_read_b128 v[172:175], v0 offset:1280
    v_cvt_pk_bf16_f32 v163, v166, v167
    v_mfma_f32_16x16x32_bf16 v[52:55], a[244:247], v[192:195], v[52:55]
    buffer_store_dwordx4 v[160:163], v11, s[8:11], s27 offen nt
    buffer_load_dwordx4 v9, s[4:7], s21 offen nt lds
    v_exp_f32 v68, v68
    v_mfma_f32_16x16x32_bf16 v[52:55], a[252:255], v[196:199], v[52:55]
    s_waitcnt lgkmcnt(1)
    ds_read_b128 v[176:179], v0 offset:1536
    v_perm_b32 v108, v68, v64, s49
    v_mfma_f32_16x16x32_bf16 v[44:47], v[36:39], v[104:107], v[44:47]
    ds_write_addtid_b32 v108 offset:7936
    ds_read_b128 v[180:183], v0 offset:1792
    v_mfma_f32_16x16x32_bf16 v[164:167], v[72:75], a[0:3], v[252:255]
    s_waitcnt lgkmcnt(3)
    v_exp_f32 v69, v69
    v_mfma_f32_16x16x32_bf16 v[164:167], v[76:79], a[4:7], v[164:167]
    s_mov_b32 s26, 24576
    ds_read_b128 v[184:187], v2 offset:1024
    ds_read_b128 v[120:123], v13 offset:5632
    v_perm_b32 v109, v69, v65, s49
    v_mfma_f32_16x16x32_bf16 v[164:167], v[80:83], a[8:11], v[164:167]
    s_mov_b32 s27, 28672
    v_exp_f32 v70, v70
    v_mfma_f32_16x16x32_bf16 v[164:167], v[84:87], a[12:15], v[164:167]
    s_mov_b32 s21, 94208
    ds_write_addtid_b32 v109 offset:14112
    v_perm_b32 v110, v70, v66, s49
    v_mul_f32 v48, v20, v48
    v_mfma_f32_16x16x32_bf16 v[56:59], a[128:131], v[168:171], 0
    s_add_u32 m0, s23, 11264
    v_exp_f32 v71, v71
    v_mul_f32 v49, v20, v49
    v_mfma_f32_16x16x32_bf16 v[56:59], a[136:139], v[172:175], v[56:59]
    ds_write_addtid_b32 v110 offset:19328
    v_perm_b32 v111, v71, v67, s49
    v_mul_f32 v50, v20, v50
    v_mfma_f32_16x16x32_bf16 v[60:63], a[132:135], v[168:171], 0
    v_exp_f32 v164, v164
    v_mul_f32 v51, v20, v51
    v_mfma_f32_16x16x32_bf16 v[60:63], a[140:143], v[172:175], v[60:63]
    ds_write_addtid_b32 v111 offset:25504
    ds_read_b128 v[104:107], v0 offset:3840
    v_mul_f32 v52, v20, v52
    v_mfma_f32_16x16x32_bf16 v[68:71], v[72:75], a[16:19], v[252:255]
    v_exp_f32 v165, v165
    v_mul_f32 v53, v20, v53
    v_mfma_f32_16x16x32_bf16 v[68:71], v[76:79], a[20:23], v[68:71]
    ds_read_b128 v[88:91], v5 offset:5120
    v_mul_f32 v54, v20, v54
    v_mul_f32 v55, v20, v55
    v_mfma_f32_16x16x32_bf16 v[68:71], v[80:83], a[24:27], v[68:71]
    v_exp_f32 v166, v166
    v_cvt_pk_bf16_f32 v28, v48, v49
    v_mfma_f32_16x16x32_bf16 v[68:71], v[84:87], a[28:31], v[68:71]
    s_waitcnt lgkmcnt(5)
    v_add_f32 v120, v120, v121
    v_add_f32 v122, v122, v123
    v_add_f32 v248, v120, v122
    v_mfma_f32_16x16x32_bf16 v[56:59], a[144:147], v[176:179], v[56:59]
    ds_read_b128 v[120:123], v13 offset:5888
    v_exp_f32 v167, v167
    v_mfma_f32_16x16x32_bf16 v[56:59], a[152:155], v[180:183], v[56:59]
    ds_read_b128 v[188:191], v2 offset:1280
    v_cvt_pk_bf16_f32 v29, v50, v51
    v_cvt_pk_bf16_f32 v30, v52, v53
    v_mfma_f32_16x16x32_bf16 v[60:63], a[148:151], v[176:179], v[60:63]
    s_waitcnt lgkmcnt(3)
    v_exp_f32 v68, v68
    v_cvt_pk_bf16_f32 v31, v54, v55
    v_mfma_f32_16x16x32_bf16 v[60:63], a[156:159], v[180:183], v[60:63]
    buffer_store_dwordx4 v[28:31], v11, s[8:11], s22 offen nt
    ds_read_b128 v[192:195], v2 offset:1536
    v_perm_b32 v160, v68, v164, s49
    v_rcp_f32 v248, v248
    v_mfma_f32_16x16x32_bf16 v[44:47], v[36:39], v[104:107], v[44:47]
    s_add_u32 s22, s22, 4096
    ds_write_addtid_b32 v160 offset:7168
    ds_read_b128 v[196:199], v2 offset:1792
    v_mul_f32 v200, v248, v200
    v_mfma_f32_16x16x32_bf16 v[64:67], v[72:75], a[32:35], v[252:255]
    v_exp_f32 v69, v69
    v_mul_f32 v201, v248, v201
    v_mfma_f32_16x16x32_bf16 v[64:67], v[76:79], a[36:39], v[64:67]
    ds_read_b128 v[168:171], v3 offset:1024
    v_perm_b32 v161, v69, v165, s49
    v_mul_f32 v202, v248, v202
    v_mfma_f32_16x16x32_bf16 v[64:67], v[80:83], a[40:43], v[64:67]
    v_exp_f32 v70, v70
    v_mul_f32 v203, v248, v203
    v_mfma_f32_16x16x32_bf16 v[64:67], v[84:87], a[44:47], v[64:67]
    ds_write_addtid_b32 v161 offset:13344
    v_perm_b32 v162, v70, v166, s49
    v_mul_f32 v204, v248, v204
    v_mfma_f32_16x16x32_bf16 v[56:59], a[160:163], v[184:187], v[56:59]
    s_waitcnt lgkmcnt(5)
    v_exp_f32 v71, v71
    v_mul_f32 v205, v248, v205
    v_mfma_f32_16x16x32_bf16 v[56:59], a[168:171], v[188:191], v[56:59]
    ds_write_addtid_b32 v162 offset:19584
    v_perm_b32 v163, v71, v167, s49
    v_mul_f32 v206, v248, v206
    v_mfma_f32_16x16x32_bf16 v[60:63], a[164:167], v[184:187], v[60:63]
    v_exp_f32 v64, v64
    v_mul_f32 v207, v248, v207
    v_mfma_f32_16x16x32_bf16 v[60:63], a[172:175], v[188:191], v[60:63]
    ds_write_addtid_b32 v163 offset:25760
    ds_read_b128 v[104:107], v0 offset:4096
    v_bitop3_b32 v17, v17, v248, s29 bitop3:0xe8
    v_mfma_f32_16x16x32_bf16 v[68:71], v[72:75], a[48:51], v[252:255]
    v_exp_f32 v65, v65
    v_cvt_pk_bf16_f32 v200, v200, v201
    v_mfma_f32_16x16x32_bf16 v[68:71], v[76:79], a[52:55], v[68:71]
    ds_read_b128 v[92:95], v6 offset:5120
    v_cvt_pk_bf16_f32 v201, v202, v203
    v_cvt_pk_bf16_f32 v202, v204, v205
    v_mfma_f32_16x16x32_bf16 v[68:71], v[80:83], a[56:59], v[68:71]
    s_waitcnt lgkmcnt(8)
    v_exp_f32 v66, v66
    v_cvt_pk_bf16_f32 v203, v206, v207
    v_mfma_f32_16x16x32_bf16 v[68:71], v[84:87], a[60:63], v[68:71]
    buffer_store_dwordx4 v[200:203], v11, s[8:11], s26 offen nt
    ds_write_b32 v12, v44 offset:512
    v_add_f32 v120, v120, v121
    v_add_f32 v122, v122, v123
    v_add_f32 v249, v120, v122
    v_rcp_f32 v249, v249
    v_mfma_f32_16x16x32_bf16 v[56:59], a[176:179], v[192:195], v[56:59]
    s_waitcnt lgkmcnt(7)
    v_exp_f32 v67, v67
    v_mul_f32 v208, v249, v208
    v_mfma_f32_16x16x32_bf16 v[56:59], a[184:187], v[196:199], v[56:59]
    s_waitcnt vmcnt(9)
    ds_read_b128 v[172:175], v3 offset:1280
    ds_add_u32 v14, v16
    v_mfma_f32_16x16x32_bf16 v[60:63], a[180:183], v[192:195], v[60:63]
    v_exp_f32 v68, v68
    v_mul_f32 v209, v249, v209
    v_mfma_f32_16x16x32_bf16 v[60:63], a[188:191], v[196:199], v[60:63]
    ds_read_b128 v[176:179], v3 offset:1536
    v_perm_b32 v160, v68, v64, s49
    ds_read_b128 v[180:183], v3 offset:1792
    v_mfma_f32_16x16x32_bf16 v[164:167], v[72:75], a[64:67], v[252:255]
    s_add_u32 s24, s24, 1
    ds_write_addtid_b32 v160 offset:7424
    v_exp_f32 v69, v69
    v_mfma_f32_16x16x32_bf16 v[164:167], v[76:79], a[68:71], v[164:167]
    ds_read_b128 v[184:187], v4 offset:1024
    v_perm_b32 v161, v69, v65, s49
    v_mul_f32 v210, v249, v210
    v_mfma_f32_16x16x32_bf16 v[164:167], v[80:83], a[72:75], v[164:167]
    v_exp_f32 v70, v70
    v_mul_f32 v211, v249, v211
    v_mfma_f32_16x16x32_bf16 v[164:167], v[84:87], a[76:79], v[164:167]
    s_waitcnt lgkmcnt(12)
    ds_write_addtid_b32 v161 offset:13600
    v_perm_b32 v162, v70, v66, s49
    v_mul_f32 v212, v249, v212
    v_mfma_f32_16x16x32_bf16 v[56:59], a[192:195], v[168:171], v[56:59]
    s_waitcnt lgkmcnt(6)
    v_exp_f32 v71, v71
    v_mul_f32 v213, v249, v213
    v_mfma_f32_16x16x32_bf16 v[56:59], a[200:203], v[172:175], v[56:59]
    ds_write_addtid_b32 v162 offset:19840
    v_perm_b32 v163, v71, v67, s49
    v_mul_f32 v214, v249, v214
    v_mfma_f32_16x16x32_bf16 v[60:63], a[196:199], v[168:171], v[60:63]
    v_exp_f32 v164, v164
    v_mfma_f32_16x16x32_bf16 v[60:63], a[204:207], v[172:175], v[60:63]
    ds_write_addtid_b32 v163 offset:26016
    ds_read_b128 v[108:111], v0 offset:4352
    v_mfma_f32_16x16x32_bf16 v[68:71], v[72:75], a[80:83], v[252:255]
    v_exp_f32 v165, v165
    v_mfma_f32_16x16x32_bf16 v[68:71], v[76:79], a[84:87], v[68:71]
    ds_read_b128 v[96:99], v7 offset:5120
    v_mul_f32 v215, v249, v215
    v_mfma_f32_16x16x32_bf16 v[68:71], v[80:83], a[88:91], v[68:71]
    v_exp_f32 v166, v166
    v_mfma_f32_16x16x32_bf16 v[68:71], v[84:87], a[92:95], v[68:71]
    s_waitcnt lgkmcnt(8)
    ds_read_b128 v[100:103], v8 offset:5120
    v_bitop3_b32 v17, v17, v249, s29 bitop3:0xe8
    v_mfma_f32_16x16x32_bf16 v[56:59], a[208:211], v[176:179], v[56:59]
    s_waitcnt lgkmcnt(8)
    v_exp_f32 v167, v167
    v_mfma_f32_16x16x32_bf16 v[56:59], a[216:219], v[180:183], v[56:59]
    ds_read_b128 v[188:191], v4 offset:1280
    v_cvt_pk_bf16_f32 v208, v208, v209
    v_mfma_f32_16x16x32_bf16 v[60:63], a[212:215], v[176:179], v[60:63]
    v_exp_f32 v68, v68
    v_mfma_f32_16x16x32_bf16 v[60:63], a[220:223], v[180:183], v[60:63]
    s_waitcnt lgkmcnt(3)
    ds_read_b128 v[192:195], v4 offset:1536
    v_perm_b32 v160, v68, v164, s49
    v_smfmac_f32_16x16x64_bf16 v[40:43], v[32:35], v[104:111], v1
    ds_write_addtid_b32 v160 offset:7680
    ds_read_b128 v[196:199], v4 offset:1792
    ds_read_b32 v19, v15
    v_mfma_f32_16x16x32_bf16 v[64:67], v[72:75], a[96:99], v[252:255]
    v_exp_f32 v69, v69
    v_mfma_f32_16x16x32_bf16 v[64:67], v[76:79], a[100:103], v[64:67]
    ds_read_b128 v[168:171], v0 offset:2048
    v_perm_b32 v161, v69, v165, s49
    v_mfma_f32_16x16x32_bf16 v[64:67], v[80:83], a[104:107], v[64:67]
    v_exp_f32 v70, v70
    v_mfma_f32_16x16x32_bf16 v[64:67], v[84:87], a[108:111], v[64:67]
    ds_write_addtid_b32 v161 offset:13856
    v_perm_b32 v162, v70, v166, s49
    v_mfma_f32_16x16x32_bf16 v[56:59], a[224:227], v[184:187], v[56:59]
    s_waitcnt lgkmcnt(6)
    v_exp_f32 v71, v71
    v_mfma_f32_16x16x32_bf16 v[56:59], a[232:235], v[188:191], v[56:59]
    ds_write_addtid_b32 v162 offset:20096
    v_perm_b32 v163, v71, v167, s49
    v_mfma_f32_16x16x32_bf16 v[60:63], a[228:231], v[184:187], v[60:63]
    v_exp_f32 v64, v64
    v_mfma_f32_16x16x32_bf16 v[60:63], a[236:239], v[188:191], v[60:63]
    ds_write_addtid_b32 v163 offset:26272
    ds_read_b128 v[112:115], v0 offset:4608
    v_mfma_f32_16x16x32_bf16 v[68:71], v[72:75], a[112:115], v[252:255]
    v_exp_f32 v65, v65
    v_mfma_f32_16x16x32_bf16 v[68:71], v[76:79], a[116:119], v[68:71]
    v_cvt_pk_bf16_f32 v209, v210, v211
    v_cvt_pk_bf16_f32 v210, v212, v213
    v_mfma_f32_16x16x32_bf16 v[68:71], v[80:83], a[120:123], v[68:71]
    v_exp_f32 v66, v66
    v_mfma_f32_16x16x32_bf16 v[68:71], v[84:87], a[124:127], v[68:71]
    s_waitcnt lgkmcnt(5)
    v_cmp_gt_u32 vcc, s24, v19
    v_cvt_pk_bf16_f32 v211, v214, v215
    v_mfma_f32_16x16x32_bf16 v[56:59], a[240:243], v[192:195], v[56:59]
    v_exp_f32 v67, v67
    v_mfma_f32_16x16x32_bf16 v[56:59], a[248:251], v[196:199], v[56:59]
    v_mov_b64 v[44:45], 0
    ds_read_b128 v[172:175], v0 offset:2304
    v_mfma_f32_16x16x32_bf16 v[60:63], a[244:247], v[192:195], v[60:63]
    v_exp_f32 v68, v68
    v_mfma_f32_16x16x32_bf16 v[60:63], a[252:255], v[196:199], v[60:63]
    buffer_store_dwordx4 v[208:211], v11, s[8:11], s27 offen nt
    buffer_load_dwordx4 v9, s[4:7], s21 offen nt lds
    ds_read_b128 v[176:179], v0 offset:2560
    v_perm_b32 v160, v68, v64, s49
    ds_read_b128 v[180:183], v0 offset:2816
    s_cbranch_vccnz L_retry113_b
L_back113_b:
    v_mfma_f32_16x16x32_bf16 v[164:167], v[88:91], a[0:3], v[252:255]
    s_waitcnt lgkmcnt(2)
    ds_write_addtid_b32 v160 offset:7936
    v_exp_f32 v69, v69
    v_mfma_f32_16x16x32_bf16 v[164:167], v[92:95], a[4:7], v[164:167]
    s_mov_b32 s26, 32768
    ds_read_b128 v[184:187], v2 offset:2048
    ds_read_b128 v[204:207], v13 offset:6144
    v_perm_b32 v161, v69, v65, s49
    v_mfma_f32_16x16x32_bf16 v[164:167], v[96:99], a[8:11], v[164:167]
    s_mov_b32 s27, 36864
    v_exp_f32 v70, v70
    v_mfma_f32_16x16x32_bf16 v[164:167], v[100:103], a[12:15], v[164:167]
    s_mov_b32 s21, 98304
    ds_write_addtid_b32 v161 offset:14112
    v_perm_b32 v162, v70, v66, s49
    v_mul_f32 v56, v21, v56
    v_mfma_f32_16x16x32_bf16 v[48:51], a[128:131], v[168:171], 0
    s_add_u32 m0, s23, 0
    v_exp_f32 v71, v71
    v_mul_f32 v57, v21, v57
    v_mfma_f32_16x16x32_bf16 v[48:51], a[136:139], v[172:175], v[48:51]
    ds_write_addtid_b32 v162 offset:31616
    v_perm_b32 v163, v71, v67, s49
    v_mul_f32 v58, v21, v58
    v_mfma_f32_16x16x32_bf16 v[52:55], a[132:135], v[168:171], 0
    v_exp_f32 v164, v164
    v_mul_f32 v59, v21, v59
    v_mfma_f32_16x16x32_bf16 v[52:55], a[140:143], v[172:175], v[52:55]
    ds_write_addtid_b32 v163 offset:37792
    ds_read_b128 v[116:119], v0 offset:4864
    v_mul_f32 v60, v21, v60
    v_mfma_f32_16x16x32_bf16 v[68:71], v[88:91], a[16:19], v[252:255]
    v_exp_f32 v165, v165
    v_mul_f32 v61, v21, v61
    v_mfma_f32_16x16x32_bf16 v[68:71], v[92:95], a[20:23], v[68:71]
    ds_read_b128 v[72:75], v5 offset:6144
    ds_read_b128 v[24:27], v18 offset:512
    v_mul_f32 v62, v21, v62
    v_mfma_f32_16x16x32_bf16 v[68:71], v[96:99], a[24:27], v[68:71]
    v_exp_f32 v166, v166
    v_mul_f32 v63, v21, v63
    v_mfma_f32_16x16x32_bf16 v[68:71], v[100:103], a[28:31], v[68:71]
    s_waitcnt lgkmcnt(6)
    v_cvt_pk_bf16_f32 v28, v56, v57
    v_add_f32 v204, v204, v205
    v_add_f32 v206, v206, v207
    v_mfma_f32_16x16x32_bf16 v[48:51], a[144:147], v[176:179], v[48:51]
    v_exp_f32 v167, v167
    v_add_f32 v248, v204, v206
    v_mfma_f32_16x16x32_bf16 v[48:51], a[152:155], v[180:183], v[48:51]
    ds_read_b128 v[188:191], v2 offset:2304
    ds_read_b128 v[204:207], v13 offset:6400
    v_cvt_pk_bf16_f32 v29, v58, v59
    v_mfma_f32_16x16x32_bf16 v[52:55], a[148:151], v[176:179], v[52:55]
    v_exp_f32 v68, v68
    v_cvt_pk_bf16_f32 v30, v60, v61
    v_mfma_f32_16x16x32_bf16 v[52:55], a[156:159], v[180:183], v[52:55]
    s_waitcnt lgkmcnt(4)
    ds_read_b128 v[192:195], v2 offset:2560
    v_perm_b32 v160, v68, v164, s49
    v_cvt_pk_bf16_f32 v31, v62, v63
    v_smfmac_f32_16x16x64_bf16 v[40:43], v[32:35], v[112:119], v1
    s_waitcnt lgkmcnt(3)
    ds_write_addtid_b32 v160 offset:19456
    ds_read_b128 v[196:199], v2 offset:2816
    v_mfma_f32_16x16x32_bf16 v[64:67], v[88:91], a[32:35], v[252:255]
    buffer_store_dwordx4 v[28:31], v11, s[8:11], s22 offen nt
L_pad6_b:
    s_cbranch_execz L_pad10_b
    v_exp_f32 v69, v69
    v_add_f32 v24, v24, v25
    v_add_f32 v26, v26, v27
    v_add_f32 v24, v24, v26
    v_rcp_f32 v248, v248
    v_mfma_f32_16x16x32_bf16 v[64:67], v[92:95], a[36:39], v[64:67]
    s_add_u32 s22, s22, 4096
    ds_read_b128 v[168:171], v3 offset:2048
    v_perm_b32 v161, v69, v165, s49
    v_mul_f32 v216, v248, v216
    v_mfma_f32_16x16x32_bf16 v[64:67], v[96:99], a[40:43], v[64:67]
    v_exp_f32 v70, v70
    v_mul_f32 v217, v248, v217
    v_mfma_f32_16x16x32_bf16 v[64:67], v[100:103], a[44:47], v[64:67]
    ds_write_addtid_b32 v161 offset:25632
    v_perm_b32 v162, v70, v166, s49
    v_mul_f32 v218, v248, v218
    v_mfma_f32_16x16x32_bf16 v[48:51], a[160:163], v[184:187], v[48:51]
    s_waitcnt lgkmcnt(6)
    v_exp_f32 v71, v71
    v_mul_f32 v219, v248, v219
    v_mfma_f32_16x16x32_bf16 v[48:51], a[168:171], v[188:191], v[48:51]
    ds_write_addtid_b32 v162 offset:31872
    v_perm_b32 v163, v71, v167, s49
    v_mul_f32 v220, v248, v220
    v_mfma_f32_16x16x32_bf16 v[52:55], a[164:167], v[184:187], v[52:55]
    v_exp_f32 v64, v64
    v_mul_f32 v221, v248, v221
    v_mfma_f32_16x16x32_bf16 v[52:55], a[172:175], v[188:191], v[52:55]
    ds_write_addtid_b32 v163 offset:38048
    ds_read_b128 v[120:123], v0 offset:5120
    v_mul_f32 v222, v248, v222
    v_mfma_f32_16x16x32_bf16 v[68:71], v[88:91], a[48:51], v[252:255]
    v_exp_f32 v65, v65
    v_mul_f32 v223, v248, v223
    v_mfma_f32_16x16x32_bf16 v[68:71], v[92:95], a[52:55], v[68:71]
    ds_read_b128 v[76:79], v6 offset:6144
    v_bitop3_b32 v17, v17, v248, s29 bitop3:0xe8
    v_cvt_pk_bf16_f32 v216, v216, v217
    v_mfma_f32_16x16x32_bf16 v[68:71], v[96:99], a[56:59], v[68:71]
    v_exp_f32 v66, v66
    v_cvt_pk_bf16_f32 v217, v218, v219
    v_mfma_f32_16x16x32_bf16 v[68:71], v[100:103], a[60:63], v[68:71]
    s_waitcnt lgkmcnt(6)
    v_cvt_pk_bf16_f32 v218, v220, v221
    v_cvt_pk_bf16_f32 v219, v222, v223
    v_mfma_f32_16x16x32_bf16 v[48:51], a[176:179], v[192:195], v[48:51]
    buffer_store_dwordx4 v[216:219], v11, s[8:11], s26 offen nt
    v_exp_f32 v67, v67
    v_rcp_f32 v22, v24
    v_mfma_f32_16x16x32_bf16 v[48:51], a[184:187], v[196:199], v[48:51]
    ds_read_b128 v[172:175], v3 offset:2304
    v_bitop3_b32 v17, v17, v22, s29 bitop3:0xe8
    v_mov_b32 v23, v22
    v_mfma_f32_16x16x32_bf16 v[52:55], a[180:183], v[192:195], v[52:55]
    v_exp_f32 v68, v68
    v_permlane32_swap_b32 v22, v23
    v_mfma_f32_16x16x32_bf16 v[52:55], a[188:191], v[196:199], v[52:55]
    ds_read_b128 v[176:179], v3 offset:2560
    v_perm_b32 v160, v68, v64, s49
    ds_read_b128 v[180:183], v3 offset:2816
    v_mfma_f32_16x16x32_bf16 v[164:167], v[88:91], a[64:67], v[252:255]
    ds_write_addtid_b32 v160 offset:19712
    v_exp_f32 v69, v69
    v_mfma_f32_16x16x32_bf16 v[164:167], v[92:95], a[68:71], v[164:167]
    ds_read_b128 v[184:187], v4 offset:2048
    v_perm_b32 v161, v69, v65, s49
    v_add_f32 v204, v204, v205
    v_mfma_f32_16x16x32_bf16 v[164:167], v[96:99], a[72:75], v[164:167]
    v_exp_f32 v70, v70
    v_add_f32 v206, v206, v207
    v_mfma_f32_16x16x32_bf16 v[164:167], v[100:103], a[76:79], v[164:167]
    s_waitcnt lgkmcnt(10)
    ds_write_addtid_b32 v161 offset:25888
    v_perm_b32 v162, v70, v66, s49
    v_add_f32 v249, v204, v206
    v_mfma_f32_16x16x32_bf16 v[48:51], a[192:195], v[168:171], v[48:51]
    s_waitcnt lgkmcnt(5)
    v_exp_f32 v71, v71
    v_mfma_f32_16x16x32_bf16 v[48:51], a[200:203], v[172:175], v[48:51]
    ds_write_addtid_b32 v162 offset:32128
    v_perm_b32 v163, v71, v67, s49
    v_mfma_f32_16x16x32_bf16 v[52:55], a[196:199], v[168:171], v[52:55]
    v_exp_f32 v164, v164
    v_mfma_f32_16x16x32_bf16 v[52:55], a[204:207], v[172:175], v[52:55]
    ds_write_addtid_b32 v163 offset:38304
    ds_read_b128 v[124:127], v0 offset:5376
    v_mfma_f32_16x16x32_bf16 v[68:71], v[88:91], a[80:83], v[252:255]
    v_exp_f32 v165, v165
    v_mfma_f32_16x16x32_bf16 v[68:71], v[92:95], a[84:87], v[68:71]
    ds_read_b128 v[80:83], v7 offset:6144
    v_rcp_f32 v249, v249
    v_mfma_f32_16x16x32_bf16 v[68:71], v[96:99], a[88:91], v[68:71]
    v_exp_f32 v166, v166
    v_mul_f32 v224, v249, v224
    v_mfma_f32_16x16x32_bf16 v[68:71], v[100:103], a[92:95], v[68:71]
    s_waitcnt lgkmcnt(8)
    ds_read_b128 v[84:87], v8 offset:6144
    v_mul_f32 v225, v249, v225
    v_mul_f32 v226, v249, v226
    v_mfma_f32_16x16x32_bf16 v[48:51], a[208:211], v[176:179], v[48:51]
    s_waitcnt lgkmcnt(8)
    v_exp_f32 v167, v167
    v_mul_f32 v227, v249, v227
    v_mfma_f32_16x16x32_bf16 v[48:51], a[216:219], v[180:183], v[48:51]
    ds_read_b128 v[188:191], v4 offset:2304
    v_mul_f32 v228, v249, v228
    v_mul_f32 v229, v249, v229
    v_mfma_f32_16x16x32_bf16 v[52:55], a[212:215], v[176:179], v[52:55]
    v_exp_f32 v68, v68
    v_mul_f32 v230, v249, v230
    v_mfma_f32_16x16x32_bf16 v[52:55], a[220:223], v[180:183], v[52:55]
    s_waitcnt lgkmcnt(3)
    ds_read_b128 v[192:195], v4 offset:2560
    v_perm_b32 v160, v68, v164, s49
    v_mul_f32 v231, v249, v231
    v_smfmac_f32_16x16x64_bf16 v[40:43], v[36:39], v[120:127], v1
    ds_write_addtid_b32 v160 offset:19968
    ds_read_b128 v[196:199], v4 offset:2816
    v_mfma_f32_16x16x32_bf16 v[64:67], v[88:91], a[96:99], v[252:255]
    v_exp_f32 v69, v69
    v_mfma_f32_16x16x32_bf16 v[64:67], v[92:95], a[100:103], v[64:67]
    ds_read_b128 v[168:171], v0 offset:3072
    v_perm_b32 v161, v69, v165, s49
    v_mfma_f32_16x16x32_bf16 v[64:67], v[96:99], a[104:107], v[64:67]
    v_exp_f32 v70, v70
    v_mfma_f32_16x16x32_bf16 v[64:67], v[100:103], a[108:111], v[64:67]
    ds_write_addtid_b32 v161 offset:26144
    v_perm_b32 v162, v70, v166, s49
    v_mfma_f32_16x16x32_bf16 v[48:51], a[224:227], v[184:187], v[48:51]
    s_waitcnt lgkmcnt(5)
    v_exp_f32 v71, v71
    v_mfma_f32_16x16x32_bf16 v[48:51], a[232:235], v[188:191], v[48:51]
    ds_write_addtid_b32 v162 offset:32384
    v_perm_b32 v163, v71, v167, s49
    v_mfma_f32_16x16x32_bf16 v[52:55], a[228:231], v[184:187], v[52:55]
    v_exp_f32 v64, v64
    v_mfma_f32_16x16x32_bf16 v[52:55], a[236:239], v[188:191], v[52:55]
    ds_write_addtid_b32 v163 offset:38560
    ds_read_b128 v[128:131], v0 offset:5632
    v_mfma_f32_16x16x32_bf16 v[68:71], v[88:91], a[112:115], v[252:255]
    v_exp_f32 v65, v65
    v_mfma_f32_16x16x32_bf16 v[68:71], v[92:95], a[116:119], v[68:71]
    v_bitop3_b32 v17, v17, v249, s29 bitop3:0xe8
    v_cvt_pk_bf16_f32 v224, v224, v225
    v_mfma_f32_16x16x32_bf16 v[68:71], v[96:99], a[120:123], v[68:71]
    v_exp_f32 v66, v66
    v_mfma_f32_16x16x32_bf16 v[68:71], v[100:103], a[124:127], v[68:71]
    s_waitcnt lgkmcnt(7)
    v_cvt_pk_bf16_f32 v225, v226, v227
    v_cvt_pk_bf16_f32 v226, v228, v229
    v_mfma_f32_16x16x32_bf16 v[48:51], a[240:243], v[192:195], v[48:51]
    s_waitcnt lgkmcnt(5)
    v_exp_f32 v67, v67
    v_mfma_f32_16x16x32_bf16 v[48:51], a[248:251], v[196:199], v[48:51]
    ds_read_b128 v[172:175], v0 offset:3328
    v_cvt_pk_bf16_f32 v227, v230, v231
    v_mfma_f32_16x16x32_bf16 v[52:55], a[244:247], v[192:195], v[52:55]
    v_exp_f32 v68, v68
    v_mfma_f32_16x16x32_bf16 v[52:55], a[252:255], v[196:199], v[52:55]
    buffer_store_dwordx4 v[224:227], v11, s[8:11], s27 offen nt
    buffer_load_dwordx4 v9, s[4:7], s21 offen nt lds
    ds_read_b128 v[176:179], v0 offset:3584
    v_perm_b32 v160, v68, v64, s49
    ds_read_b128 v[180:183], v0 offset:3840
    v_mfma_f32_16x16x32_bf16 v[164:167], v[72:75], a[0:3], v[252:255]
    s_waitcnt lgkmcnt(7)
    ds_write_addtid_b32 v160 offset:20224
    v_exp_f32 v69, v69
    v_mfma_f32_16x16x32_bf16 v[164:167], v[76:79], a[4:7], v[164:167]
    s_mov_b32 s26, 40960
    ds_read_b128 v[184:187], v2 offset:3072
    ds_read_b128 v[204:207], v13 offset:6656
    v_perm_b32 v161, v69, v65, s49
    v_mfma_f32_16x16x32_bf16 v[164:167], v[80:83], a[8:11], v[164:167]
    s_mov_b32 s21, 102400
    v_exp_f32 v70, v70
    v_mfma_f32_16x16x32_bf16 v[164:167], v[84:87], a[12:15], v[164:167]
    s_add_u32 m0, s23, 1024
    s_nop 0
    ds_write_addtid_b32 v161 offset:25376
    v_perm_b32 v162, v70, v66, s49
    v_mul_f32 v48, v22, v48
    v_mfma_f32_16x16x32_bf16 v[56:59], a[128:131], v[168:171], 0
    s_waitcnt lgkmcnt(6)
    v_exp_f32 v71, v71
    v_mul_f32 v49, v22, v49
    v_mfma_f32_16x16x32_bf16 v[56:59], a[136:139], v[172:175], v[56:59]
    ds_write_addtid_b32 v162 offset:31616
    v_perm_b32 v163, v71, v67, s49
    v_mul_f32 v50, v22, v50
    v_mfma_f32_16x16x32_bf16 v[60:63], a[132:135], v[168:171], 0
    v_exp_f32 v164, v164
    v_mul_f32 v51, v22, v51
    v_mfma_f32_16x16x32_bf16 v[60:63], a[140:143], v[172:175], v[60:63]
    ds_write_addtid_b32 v163 offset:37792
    ds_read_b128 v[132:135], v0 offset:5888
    v_mul_f32 v52, v22, v52
    v_mfma_f32_16x16x32_bf16 v[68:71], v[72:75], a[16:19], v[252:255]
    v_exp_f32 v165, v165
    v_mul_f32 v53, v22, v53
    v_mfma_f32_16x16x32_bf16 v[68:71], v[76:79], a[20:23], v[68:71]
    ds_read_b128 v[88:91], v5 offset:7168
    v_mul_f32 v54, v22, v54
    v_mul_f32 v55, v22, v55
    v_mfma_f32_16x16x32_bf16 v[68:71], v[80:83], a[24:27], v[68:71]
    v_exp_f32 v166, v166
    v_cvt_pk_bf16_f32 v28, v48, v49
    v_mfma_f32_16x16x32_bf16 v[68:71], v[84:87], a[28:31], v[68:71]
    s_waitcnt lgkmcnt(5)
    v_cvt_pk_bf16_f32 v29, v50, v51
    v_cvt_pk_bf16_f32 v30, v52, v53
    v_cvt_pk_bf16_f32 v31, v54, v55
    v_mfma_f32_16x16x32_bf16 v[56:59], a[144:147], v[176:179], v[56:59]
    buffer_store_dwordx4 v[28:31], v11, s[8:11], s22 offen nt
    v_exp_f32 v167, v167
    v_add_f32 v204, v204, v205
    v_add_f32 v206, v206, v207
    v_add_f32 v248, v204, v206
    v_rcp_f32 v248, v248
    v_mfma_f32_16x16x32_bf16 v[56:59], a[152:155], v[180:183], v[56:59]
    s_add_u32 s22, s22, 4096
    ds_read_b128 v[188:191], v2 offset:3328
    v_mul_f32 v232, v248, v232
    v_mul_f32 v233, v248, v233
    v_mfma_f32_16x16x32_bf16 v[60:63], a[148:151], v[176:179], v[60:63]
    v_exp_f32 v68, v68
    v_mul_f32 v234, v248, v234
    v_mfma_f32_16x16x32_bf16 v[60:63], a[156:159], v[180:183], v[60:63]
    s_waitcnt lgkmcnt(2)
    ds_read_b128 v[192:195], v2 offset:3584
    v_perm_b32 v160, v68, v164, s49
    v_mul_f32 v235, v248, v235
    v_smfmac_f32_16x16x64_bf16 v[40:43], v[36:39], v[128:135], v1
    ds_write_addtid_b32 v160 offset:13312
    ds_read_b128 v[196:199], v2 offset:3840
    v_mfma_f32_16x16x32_bf16 v[64:67], v[72:75], a[32:35], v[252:255]
    v_exp_f32 v69, v69
    v_mfma_f32_16x16x32_bf16 v[64:67], v[76:79], a[36:39], v[64:67]
    ds_read_b128 v[168:171], v3 offset:3072
    v_perm_b32 v161, v69, v165, s49
    v_mfma_f32_16x16x32_bf16 v[64:67], v[80:83], a[40:43], v[64:67]
    v_exp_f32 v70, v70
    v_mfma_f32_16x16x32_bf16 v[64:67], v[84:87], a[44:47], v[64:67]
    ds_write_addtid_b32 v161 offset:19488
    v_perm_b32 v162, v70, v166, s49
    v_mfma_f32_16x16x32_bf16 v[56:59], a[160:163], v[184:187], v[56:59]
    s_waitcnt lgkmcnt(5)
    v_exp_f32 v71, v71
    v_mfma_f32_16x16x32_bf16 v[56:59], a[168:171], v[188:191], v[56:59]
    ds_write_addtid_b32 v162 offset:25728
    v_perm_b32 v163, v71, v167, s49
    v_add_f32 v40, v40, v41
    v_mfma_f32_16x16x32_bf16 v[60:63], a[164:167], v[184:187], v[60:63]
    v_exp_f32 v64, v64
    v_mfma_f32_16x16x32_bf16 v[60:63], a[172:175], v[188:191], v[60:63]
    ds_write_addtid_b32 v163 offset:31904
    ds_read_b128 v[136:139], v0 offset:0
    v_mfma_f32_16x16x32_bf16 v[68:71], v[72:75], a[48:51], v[252:255]
    v_exp_f32 v65, v65
    v_mfma_f32_16x16x32_bf16 v[68:71], v[76:79], a[52:55], v[68:71]
    ds_read_b128 v[92:95], v6 offset:7168
    v_mul_f32 v236, v248, v236
    v_mfma_f32_16x16x32_bf16 v[68:71], v[80:83], a[56:59], v[68:71]
    v_exp_f32 v66, v66
    v_mfma_f32_16x16x32_bf16 v[68:71], v[84:87], a[60:63], v[68:71]
    s_waitcnt lgkmcnt(8)
    ds_write_b32 v12, v40 offset:1024
    v_mfma_f32_16x16x32_bf16 v[56:59], a[176:179], v[192:195], v[56:59]
    s_waitcnt lgkmcnt(7)
    v_exp_f32 v67, v67
    v_mfma_f32_16x16x32_bf16 v[56:59], a[184:187], v[196:199], v[56:59]
    s_waitcnt vmcnt(12)
    ds_read_b128 v[172:175], v3 offset:3328
    ds_add_u32 v14, v16
    v_mfma_f32_16x16x32_bf16 v[60:63], a[180:183], v[192:195], v[60:63]
    v_exp_f32 v68, v68
    v_mfma_f32_16x16x32_bf16 v[60:63], a[188:191], v[196:199], v[60:63]
    ds_read_b128 v[176:179], v3 offset:3584
    v_perm_b32 v160, v68, v64, s49
    ds_read_b128 v[180:183], v3 offset:3840
    v_mfma_f32_16x16x32_bf16 v[164:167], v[72:75], a[64:67], v[252:255]
    s_add_u32 s24, s24, 1
    ds_write_addtid_b32 v160 offset:13568
    v_exp_f32 v69, v69
    v_mfma_f32_16x16x32_bf16 v[164:167], v[76:79], a[68:71], v[164:167]
    ds_read_b128 v[184:187], v4 offset:3072
    v_perm_b32 v161, v69, v65, s49
    v_mfma_f32_16x16x32_bf16 v[164:167], v[80:83], a[72:75], v[164:167]
    v_exp_f32 v70, v70
    v_mfma_f32_16x16x32_bf16 v[164:167], v[84:87], a[76:79], v[164:167]
    s_waitcnt lgkmcnt(12)
    ds_write_addtid_b32 v161 offset:19744
    v_perm_b32 v162, v70, v66, s49
    v_mfma_f32_16x16x32_bf16 v[56:59], a[192:195], v[168:171], v[56:59]
    s_waitcnt lgkmcnt(6)
    v_exp_f32 v71, v71
    v_mfma_f32_16x16x32_bf16 v[56:59], a[200:203], v[172:175], v[56:59]
    ds_write_addtid_b32 v162 offset:25984
    v_perm_b32 v163, v71, v67, s49
    v_mfma_f32_16x16x32_bf16 v[60:63], a[196:199], v[168:171], v[60:63]
    v_exp_f32 v164, v164
    v_mfma_f32_16x16x32_bf16 v[60:63], a[204:207], v[172:175], v[60:63]
    ds_write_addtid_b32 v163 offset:32160
    ds_read_b128 v[140:143], v0 offset:256
    v_mfma_f32_16x16x32_bf16 v[68:71], v[72:75], a[80:83], v[252:255]
    v_exp_f32 v165, v165
    v_mfma_f32_16x16x32_bf16 v[68:71], v[76:79], a[84:87], v[68:71]
    ds_read_b128 v[96:99], v7 offset:7168
    v_mul_f32 v237, v248, v237
    v_mfma_f32_16x16x32_bf16 v[68:71], v[80:83], a[88:91], v[68:71]
    v_exp_f32 v166, v166
    v_mfma_f32_16x16x32_bf16 v[68:71], v[84:87], a[92:95], v[68:71]
    s_waitcnt lgkmcnt(8)
    ds_read_b128 v[100:103], v8 offset:7168
    v_mul_f32 v238, v248, v238
    v_mfma_f32_16x16x32_bf16 v[56:59], a[208:211], v[176:179], v[56:59]
    s_waitcnt lgkmcnt(8)
    v_exp_f32 v167, v167
    v_mfma_f32_16x16x32_bf16 v[56:59], a[216:219], v[180:183], v[56:59]
    ds_read_b128 v[188:191], v4 offset:3328
    v_mul_f32 v239, v248, v239
    v_mfma_f32_16x16x32_bf16 v[60:63], a[212:215], v[176:179], v[60:63]
    v_exp_f32 v68, v68
    v_mfma_f32_16x16x32_bf16 v[60:63], a[220:223], v[180:183], v[60:63]
    s_waitcnt lgkmcnt(3)
    ds_read_b128 v[192:195], v4 offset:3584
    v_perm_b32 v160, v68, v164, s49
    v_smfmac_f32_16x16x64_bf16 v[44:47], v[32:35], v[136:143], v1
    ds_write_addtid_b32 v160 offset:13824
    ds_read_b128 v[196:199], v4 offset:3840
    ds_read_b32 v19, v15
    v_mfma_f32_16x16x32_bf16 v[64:67], v[72:75], a[96:99], v[252:255]
    v_exp_f32 v69, v69
    v_mfma_f32_16x16x32_bf16 v[64:67], v[76:79], a[100:103], v[64:67]
    v_perm_b32 v161, v69, v165, s49
    v_bitop3_b32 v17, v17, v248, s29 bitop3:0xe8
    v_mfma_f32_16x16x32_bf16 v[64:67], v[80:83], a[104:107], v[64:67]
    v_exp_f32 v70, v70
    v_mfma_f32_16x16x32_bf16 v[64:67], v[84:87], a[108:111], v[64:67]
    ds_write_addtid_b32 v161 offset:20000
    v_perm_b32 v162, v70, v166, s49
    v_mfma_f32_16x16x32_bf16 v[56:59], a[224:227], v[184:187], v[56:59]
    s_waitcnt lgkmcnt(5)
    v_exp_f32 v71, v71
    v_mfma_f32_16x16x32_bf16 v[56:59], a[232:235], v[188:191], v[56:59]
    ds_write_addtid_b32 v162 offset:26240
    v_perm_b32 v163, v71, v167, s49
    v_mfma_f32_16x16x32_bf16 v[60:63], a[228:231], v[184:187], v[60:63]
    v_exp_f32 v64, v64
    v_mfma_f32_16x16x32_bf16 v[60:63], a[236:239], v[188:191], v[60:63]
    ds_write_addtid_b32 v163 offset:32416
    ds_read_b128 v[144:147], v0 offset:512
    v_mfma_f32_16x16x32_bf16 v[68:71], v[72:75], a[112:115], v[252:255]
    v_exp_f32 v65, v65
    v_mfma_f32_16x16x32_bf16 v[68:71], v[76:79], a[116:119], v[68:71]
    v_cvt_pk_bf16_f32 v232, v232, v233
    v_cvt_pk_bf16_f32 v233, v234, v235
    v_mfma_f32_16x16x32_bf16 v[68:71], v[80:83], a[120:123], v[68:71]
    v_exp_f32 v66, v66
    v_mfma_f32_16x16x32_bf16 v[68:71], v[84:87], a[124:127], v[68:71]
    s_waitcnt lgkmcnt(4)
    v_cmp_gt_u32 vcc, s24, v19
    v_cvt_pk_bf16_f32 v234, v236, v237
    v_mfma_f32_16x16x32_bf16 v[56:59], a[240:243], v[192:195], v[56:59]
    v_exp_f32 v67, v67
    v_mfma_f32_16x16x32_bf16 v[56:59], a[248:251], v[196:199], v[56:59]
    v_mov_b64 v[40:41], 0
    v_cvt_pk_bf16_f32 v235, v238, v239
    v_mfma_f32_16x16x32_bf16 v[60:63], a[244:247], v[192:195], v[60:63]
    buffer_store_dwordx4 v[232:235], v11, s[8:11], s26 offen nt
    buffer_load_dwordx4 v9, s[4:7], s21 offen nt lds
    v_exp_f32 v68, v68
    v_mfma_f32_16x16x32_bf16 v[60:63], a[252:255], v[196:199], v[60:63]
    v_perm_b32 v160, v68, v64, s49
    s_cbranch_vccnz L_retry115_b
L_back115_b:
    v_mfma_f32_16x16x32_bf16 v[220:223], v[88:91], a[0:3], v[252:255]
    ds_write_addtid_b32 v160 offset:14080
    v_exp_f32 v69, v69
    v_mfma_f32_16x16x32_bf16 v[220:223], v[92:95], a[4:7], v[220:223]
    s_mov_b32 s26, 45056
    ds_read_b128 v[168:171], v2 offset:4096
    ds_read_b128 v[204:207], v13 offset:6912
    v_perm_b32 v161, v69, v65, s49
    v_mfma_f32_16x16x32_bf16 v[220:223], v[96:99], a[8:11], v[220:223]
    s_mov_b32 s21, 106496
    v_exp_f32 v70, v70
    v_mfma_f32_16x16x32_bf16 v[220:223], v[100:103], a[12:15], v[220:223]
    s_add_u32 m0, s23, 2048
    s_nop 0
    ds_write_addtid_b32 v161 offset:19232
    v_perm_b32 v162, v70, v66, s49
    v_mul_f32 v56, v23, v56
    v_mfma_f32_16x16x32_bf16 v[48:51], a[128:131], v[104:107], 0
    v_exp_f32 v71, v71
    v_mul_f32 v57, v23, v57
    v_mfma_f32_16x16x32_bf16 v[48:51], a[136:139], v[108:111], v[48:51]
    ds_write_addtid_b32 v162 offset:25472
    v_perm_b32 v163, v71, v67, s49
    v_mul_f32 v58, v23, v58
    v_mfma_f32_16x16x32_bf16 v[48:51], a[144:147], v[112:115], v[48:51]
    v_exp_f32 v220, v220
    v_mul_f32 v59, v23, v59
    v_mfma_f32_16x16x32_bf16 v[48:51], a[152:155], v[116:119], v[48:51]
    ds_write_addtid_b32 v163 offset:31648
    ds_read_b128 v[148:151], v0 offset:768
    v_mul_f32 v60, v23, v60
    v_mfma_f32_16x16x32_bf16 v[68:71], v[88:91], a[16:19], v[252:255]
    v_exp_f32 v221, v221
    v_mul_f32 v61, v23, v61
    v_mfma_f32_16x16x32_bf16 v[68:71], v[92:95], a[20:23], v[68:71]
    ds_read_b128 v[172:175], v2 offset:4352
    ds_read_b128 v[72:75], v5 offset:8192
    v_mul_f32 v62, v23, v62
    v_mfma_f32_16x16x32_bf16 v[68:71], v[96:99], a[24:27], v[68:71]
    v_exp_f32 v222, v222
    v_mul_f32 v63, v23, v63
    v_mfma_f32_16x16x32_bf16 v[68:71], v[100:103], a[28:31], v[68:71]
    ds_read_b128 v[176:179], v2 offset:4608
    ds_read_b128 v[24:27], v18 offset:1024
    v_cvt_pk_bf16_f32 v28, v56, v57
    v_mfma_f32_16x16x32_bf16 v[52:55], a[132:135], v[104:107], 0
    v_exp_f32 v223, v223
    v_mfma_f32_16x16x32_bf16 v[52:55], a[140:143], v[108:111], v[52:55]
    v_cvt_pk_bf16_f32 v29, v58, v59
    v_cvt_pk_bf16_f32 v30, v60, v61
    v_mfma_f32_16x16x32_bf16 v[52:55], a[148:151], v[112:115], v[52:55]
    v_exp_f32 v68, v68
    v_mfma_f32_16x16x32_bf16 v[52:55], a[156:159], v[116:119], v[52:55]
    s_waitcnt lgkmcnt(4)
    ds_read_b128 v[180:183], v2 offset:4864
    v_perm_b32 v216, v68, v220, s49
    v_smfmac_f32_16x16x64_bf16 v[44:47], v[32:35], v[144:151], v1
    ds_write_addtid_b32 v216 offset:13312
    v_cvt_pk_bf16_f32 v31, v62, v63
    v_mfma_f32_16x16x32_bf16 v[64:67], v[88:91], a[32:35], v[252:255]
    v_exp_f32 v69, v69
    v_mfma_f32_16x16x32_bf16 v[64:67], v[92:95], a[36:39], v[64:67]
    s_waitcnt lgkmcnt(2)
    ds_read_b128 v[184:187], v3 offset:4096
    v_perm_b32 v217, v69, v221, s49
    v_mfma_f32_16x16x32_bf16 v[64:67], v[96:99], a[40:43], v[64:67]
    buffer_store_dwordx4 v[28:31], v11, s[8:11], s22 offen nt
    v_exp_f32 v70, v70
    v_add_f32 v24, v24, v25
    v_add_f32 v26, v26, v27
    v_add_f32 v24, v24, v26
    v_rcp_f32 v20, v24
    v_mfma_f32_16x16x32_bf16 v[64:67], v[100:103], a[44:47], v[64:67]
    s_add_u32 s22, s22, 4096
    ds_write_addtid_b32 v217 offset:19488
    v_perm_b32 v218, v70, v222, s49
    v_bitop3_b32 v17, v17, v20, s29 bitop3:0xe8
    v_mfma_f32_16x16x32_bf16 v[48:51], a[160:163], v[168:171], v[48:51]
    v_exp_f32 v71, v71
    v_mov_b32 v21, v20
    v_mfma_f32_16x16x32_bf16 v[48:51], a[168:171], v[172:175], v[48:51]
    ds_write_addtid_b32 v218 offset:25728
    v_perm_b32 v219, v71, v223, s49
    v_permlane32_swap_b32 v20, v21
    v_mfma_f32_16x16x32_bf16 v[48:51], a[176:179], v[176:179], v[48:51]
    s_waitcnt lgkmcnt(4)
    v_exp_f32 v64, v64
    v_add_f32 v204, v204, v205
    v_mfma_f32_16x16x32_bf16 v[48:51], a[184:187], v[180:183], v[48:51]
    ds_write_addtid_b32 v219 offset:31904
    ds_read_b128 v[152:155], v0 offset:1024
    v_add_f32 v206, v206, v207
    v_mfma_f32_16x16x32_bf16 v[68:71], v[88:91], a[48:51], v[252:255]
    v_exp_f32 v65, v65
    v_add_f32 v248, v204, v206
    v_mfma_f32_16x16x32_bf16 v[68:71], v[92:95], a[52:55], v[68:71]
    ds_read_b128 v[188:191], v3 offset:4352
    ds_read_b128 v[76:79], v6 offset:8192
    v_mfma_f32_16x16x32_bf16 v[68:71], v[96:99], a[56:59], v[68:71]
    v_exp_f32 v66, v66
    v_mfma_f32_16x16x32_bf16 v[68:71], v[100:103], a[60:63], v[68:71]
    ds_read_b128 v[192:195], v3 offset:4608
    v_rcp_f32 v248, v248
    v_mfma_f32_16x16x32_bf16 v[52:55], a[164:167], v[168:171], v[52:55]
    v_exp_f32 v67, v67
    v_mul_f32 v240, v248, v240
    v_mfma_f32_16x16x32_bf16 v[52:55], a[172:175], v[172:175], v[52:55]
    v_mul_f32 v241, v248, v241
    v_mul_f32 v242, v248, v242
    v_mul_f32 v243, v248, v243
    v_mfma_f32_16x16x32_bf16 v[52:55], a[180:183], v[176:179], v[52:55]
    v_exp_f32 v68, v68
    v_mul_f32 v244, v248, v244
    v_mfma_f32_16x16x32_bf16 v[52:55], a[188:191], v[180:183], v[52:55]
    ds_read_b128 v[196:199], v3 offset:4864
    v_perm_b32 v216, v68, v64, s49
    v_mul_f32 v245, v248, v245
    v_mfma_f32_16x16x32_bf16 v[220:223], v[88:91], a[64:67], v[252:255]
    ds_write_addtid_b32 v216 offset:13568
    v_exp_f32 v69, v69
    v_mfma_f32_16x16x32_bf16 v[220:223], v[92:95], a[68:71], v[220:223]
    ds_read_b128 v[224:227], v4 offset:4096
    v_perm_b32 v217, v69, v65, s49
    v_mfma_f32_16x16x32_bf16 v[220:223], v[96:99], a[72:75], v[220:223]
    v_exp_f32 v70, v70
    v_mfma_f32_16x16x32_bf16 v[220:223], v[100:103], a[76:79], v[220:223]
    s_waitcnt lgkmcnt(10)
    ds_write_addtid_b32 v217 offset:19744
    v_perm_b32 v218, v70, v66, s49
    v_mfma_f32_16x16x32_bf16 v[48:51], a[192:195], v[184:187], v[48:51]
    s_waitcnt lgkmcnt(6)
    v_exp_f32 v71, v71
    v_mfma_f32_16x16x32_bf16 v[48:51], a[200:203], v[188:191], v[48:51]
    s_waitcnt lgkmcnt(4)
    ds_write_addtid_b32 v218 offset:25984
    v_perm_b32 v219, v71, v67, s49
    v_mfma_f32_16x16x32_bf16 v[48:51], a[208:211], v[192:195], v[48:51]
    s_waitcnt lgkmcnt(4)
    v_exp_f32 v220, v220
    v_mfma_f32_16x16x32_bf16 v[48:51], a[216:219], v[196:199], v[48:51]
    ds_write_addtid_b32 v219 offset:32160
    ds_read_b128 v[156:159], v0 offset:1280
    v_mfma_f32_16x16x32_bf16 v[68:71], v[88:91], a[80:83], v[252:255]
    v_exp_f32 v221, v221
    v_mfma_f32_16x16x32_bf16 v[68:71], v[92:95], a[84:87], v[68:71]
    ds_read_b128 v[228:231], v4 offset:4352
    ds_read_b128 v[80:83], v7 offset:8192
    v_mfma_f32_16x16x32_bf16 v[68:71], v[96:99], a[88:91], v[68:71]
    v_exp_f32 v222, v222
    v_mfma_f32_16x16x32_bf16 v[68:71], v[100:103], a[92:95], v[68:71]
    ds_read_b128 v[232:235], v4 offset:4608
    ds_read_b128 v[84:87], v8 offset:8192
    v_mfma_f32_16x16x32_bf16 v[52:55], a[196:199], v[184:187], v[52:55]
    v_exp_f32 v223, v223
    v_mfma_f32_16x16x32_bf16 v[52:55], a[204:207], v[188:191], v[52:55]
    v_mul_f32 v246, v248, v246
    v_mul_f32 v247, v248, v247
    v_mfma_f32_16x16x32_bf16 v[52:55], a[212:215], v[192:195], v[52:55]
    v_exp_f32 v68, v68
    v_mfma_f32_16x16x32_bf16 v[52:55], a[220:223], v[196:199], v[52:55]
    s_waitcnt lgkmcnt(4)
    ds_read_b128 v[236:239], v4 offset:4864
    v_perm_b32 v216, v68, v220, s49
    v_smfmac_f32_16x16x64_bf16 v[44:47], v[36:39], v[152:159], v1
    ds_write_addtid_b32 v216 offset:13824
    v_bitop3_b32 v17, v17, v248, s29 bitop3:0xe8
    v_mfma_f32_16x16x32_bf16 v[64:67], v[88:91], a[96:99], v[252:255]
    v_exp_f32 v69, v69
    v_mfma_f32_16x16x32_bf16 v[64:67], v[92:95], a[100:103], v[64:67]
    v_perm_b32 v217, v69, v221, s49
    v_cvt_pk_bf16_f32 v240, v240, v241
    v_mfma_f32_16x16x32_bf16 v[64:67], v[96:99], a[104:107], v[64:67]
    v_exp_f32 v70, v70
    v_mfma_f32_16x16x32_bf16 v[64:67], v[100:103], a[108:111], v[64:67]
    ds_write_addtid_b32 v217 offset:20000
    v_perm_b32 v218, v70, v222, s49
    v_mfma_f32_16x16x32_bf16 v[48:51], a[224:227], v[224:227], v[48:51]
    s_waitcnt lgkmcnt(6)
    v_exp_f32 v71, v71
    v_mfma_f32_16x16x32_bf16 v[48:51], a[232:235], v[228:231], v[48:51]
    s_waitcnt lgkmcnt(4)
    ds_write_addtid_b32 v218 offset:26240
    v_perm_b32 v219, v71, v223, s49
    v_mfma_f32_16x16x32_bf16 v[48:51], a[240:243], v[232:235], v[48:51]
    s_waitcnt lgkmcnt(3)
    v_exp_f32 v64, v64
    v_mfma_f32_16x16x32_bf16 v[48:51], a[248:251], v[236:239], v[48:51]
    ds_write_addtid_b32 v219 offset:32416
    ds_read_b128 v[160:163], v0 offset:1536
    v_mfma_f32_16x16x32_bf16 v[68:71], v[88:91], a[112:115], v[252:255]
    v_exp_f32 v65, v65
    v_mfma_f32_16x16x32_bf16 v[68:71], v[92:95], a[116:119], v[68:71]
    v_cvt_pk_bf16_f32 v241, v242, v243
    v_cvt_pk_bf16_f32 v242, v244, v245
    v_mfma_f32_16x16x32_bf16 v[68:71], v[96:99], a[120:123], v[68:71]
    v_exp_f32 v66, v66
    v_mfma_f32_16x16x32_bf16 v[68:71], v[100:103], a[124:127], v[68:71]
    v_mul_f32 v48, v20, v48
    v_cvt_pk_bf16_f32 v243, v246, v247
    v_mfma_f32_16x16x32_bf16 v[52:55], a[228:231], v[224:227], v[52:55]
    v_exp_f32 v67, v67
    v_mfma_f32_16x16x32_bf16 v[52:55], a[236:239], v[228:231], v[52:55]
    v_mul_f32 v49, v20, v49
    v_mul_f32 v50, v20, v50
    v_mfma_f32_16x16x32_bf16 v[52:55], a[244:247], v[232:235], v[52:55]
    v_exp_f32 v68, v68
    v_mfma_f32_16x16x32_bf16 v[52:55], a[252:255], v[236:239], v[52:55]
    buffer_store_dwordx4 v[240:243], v11, s[8:11], s26 offen nt
    buffer_load_dwordx4 v9, s[4:7], s21 offen nt lds
    v_mul_f32 v51, v20, v51
    v_perm_b32 v216, v68, v64, s49
    v_cvt_pk_bf16_f32 v28, v48, v49
.p2align 6
L_loop_b:
    v_mfma_f32_16x16x32_bf16 v[220:223], v[72:75], a[0:3], v[252:255]
    ds_write_addtid_b32 v216 offset:14080
    v_exp_f32 v69, v69
    v_mfma_f32_16x16x32_bf16 v[220:223], v[76:79], a[4:7], v[220:223]
    ds_read_b128 v[168:171], v2 offset:5120
    v_perm_b32 v217, v69, v65, s49
    v_mfma_f32_16x16x32_bf16 v[220:223], v[80:83], a[8:11], v[220:223]
    s_waitcnt lgkmcnt(2)
    v_exp_f32 v70, v70
    v_mfma_f32_16x16x32_bf16 v[220:223], v[84:87], a[12:15], v[220:223]
    ds_write_addtid_b32 v217 offset:20256
    v_perm_b32 v218, v70, v66, s49
    v_mfma_f32_16x16x32_bf16 v[56:59], a[128:131], v[120:123], 0
    v_exp_f32 v71, v71
    v_mfma_f32_16x16x32_bf16 v[56:59], a[136:139], v[124:127], v[56:59]
    ds_write_addtid_b32 v218 offset:26496
    v_perm_b32 v219, v71, v67, s49
    v_mfma_f32_16x16x32_bf16 v[56:59], a[144:147], v[128:131], v[56:59]
    v_exp_f32 v220, v220
    v_mfma_f32_16x16x32_bf16 v[56:59], a[152:155], v[132:135], v[56:59]
    ds_write_addtid_b32 v219 offset:32672
    ds_read_b128 v[164:167], v0 offset:1792
    v_mfma_f32_16x16x32_bf16 v[68:71], v[72:75], a[16:19], v[252:255]
    v_exp_f32 v221, v221
    v_mfma_f32_16x16x32_bf16 v[68:71], v[76:79], a[20:23], v[68:71]
    ds_read_b128 v[172:175], v2 offset:5376
    v_mul_f32 v52, v20, v52
    v_mfma_f32_16x16x32_bf16 v[68:71], v[80:83], a[24:27], v[68:71]
L_pad7_b:
    s_cbranch_execz L_pad11_b
    v_exp_f32 v222, v222
    v_mfma_f32_16x16x32_bf16 v[68:71], v[84:87], a[28:31], v[68:71]
    ds_read_b128 v[176:179], v2 offset:5632
    v_mul_f32 v53, v20, v53
    v_mfma_f32_16x16x32_bf16 v[60:63], a[132:135], v[120:123], 0
    v_exp_f32 v223, v223
    v_mfma_f32_16x16x32_bf16 v[60:63], a[140:143], v[124:127], v[60:63]
    ds_read_b128 v[184:187], v3 offset:5120
    v_mul_f32 v54, v20, v54
    v_mfma_f32_16x16x32_bf16 v[60:63], a[148:151], v[128:131], v[60:63]
    s_waitcnt lgkmcnt(3)
    v_exp_f32 v68, v68
    v_mfma_f32_16x16x32_bf16 v[60:63], a[156:159], v[132:135], v[60:63]
    ds_read_b128 v[180:183], v2 offset:5888
    v_perm_b32 v216, v68, v220, s49
    v_smfmac_f32_16x16x64_bf16 v[44:47], v[36:39], v[160:167], v1
    ds_write_addtid_b32 v216 offset:14336
    v_mul_f32 v55, v20, v55
    v_mfma_f32_16x16x32_bf16 v[64:67], v[72:75], a[32:35], v[252:255]
    v_exp_f32 v69, v69
    v_mfma_f32_16x16x32_bf16 v[64:67], v[76:79], a[36:39], v[64:67]
    ds_read_b128 v[188:191], v3 offset:5376
    v_perm_b32 v217, v69, v221, s49
    v_mfma_f32_16x16x32_bf16 v[64:67], v[80:83], a[40:43], v[64:67]
    v_exp_f32 v70, v70
    v_mfma_f32_16x16x32_bf16 v[64:67], v[84:87], a[44:47], v[64:67]
    ds_write_addtid_b32 v217 offset:20512
    v_perm_b32 v218, v70, v222, s49
    v_mfma_f32_16x16x32_bf16 v[56:59], a[160:163], v[168:171], v[56:59]
    s_waitcnt lgkmcnt(5)
    v_exp_f32 v71, v71
    v_mfma_f32_16x16x32_bf16 v[56:59], a[168:171], v[172:175], v[56:59]
    ds_write_addtid_b32 v218 offset:26752
    v_perm_b32 v219, v71, v223, s49
    v_add_f32 v44, v44, v45
    v_mfma_f32_16x16x32_bf16 v[56:59], a[176:179], v[176:179], v[56:59]
    s_waitcnt lgkmcnt(4)
    v_exp_f32 v64, v64
    v_mfma_f32_16x16x32_bf16 v[56:59], a[184:187], v[180:183], v[56:59]
    ds_write_addtid_b32 v219 offset:32928
    ds_read_b128 v[104:107], v0 offset:2048
    v_mfma_f32_16x16x32_bf16 v[68:71], v[72:75], a[48:51], v[252:255]
    v_exp_f32 v65, v65
    v_mfma_f32_16x16x32_bf16 v[68:71], v[76:79], a[52:55], v[68:71]
    ds_write_b32 v12, v44 offset:0
    v_mfma_f32_16x16x32_bf16 v[68:71], v[80:83], a[56:59], v[68:71]
    s_waitcnt vmcnt(6)
    v_exp_f32 v66, v66
    v_mfma_f32_16x16x32_bf16 v[68:71], v[84:87], a[60:63], v[68:71]
    ds_add_u32 v14, v16
    v_mfma_f32_16x16x32_bf16 v[60:63], a[164:167], v[168:171], v[60:63]
    s_add_u32 s24, s24, 1
    v_exp_f32 v67, v67
    v_mfma_f32_16x16x32_bf16 v[60:63], a[172:175], v[172:175], v[60:63]
    ds_read_b128 v[192:195], v3 offset:5632
    v_cvt_pk_bf16_f32 v29, v50, v51
    v_mfma_f32_16x16x32_bf16 v[60:63], a[180:183], v[176:179], v[60:63]
    v_exp_f32 v68, v68
    v_mfma_f32_16x16x32_bf16 v[60:63], a[188:191], v[180:183], v[60:63]
    ds_read_b128 v[196:199], v3 offset:5888
    v_perm_b32 v216, v68, v64, s49
    v_cvt_pk_bf16_f32 v30, v52, v53
    v_mfma_f32_16x16x32_bf16 v[220:223], v[72:75], a[64:67], v[252:255]
    ds_write_addtid_b32 v216 offset:14592
    v_exp_f32 v69, v69
    v_mfma_f32_16x16x32_bf16 v[220:223], v[76:79], a[68:71], v[220:223]
    ds_read_b128 v[224:227], v4 offset:5120
    v_perm_b32 v217, v69, v65, s49
    v_mfma_f32_16x16x32_bf16 v[220:223], v[80:83], a[72:75], v[220:223]
    v_exp_f32 v70, v70
    v_mfma_f32_16x16x32_bf16 v[220:223], v[84:87], a[76:79], v[220:223]
    ds_write_addtid_b32 v217 offset:20768
    v_perm_b32 v218, v70, v66, s49
    v_mfma_f32_16x16x32_bf16 v[56:59], a[192:195], v[184:187], v[56:59]
    s_waitcnt lgkmcnt(4)
    v_exp_f32 v71, v71
    v_mfma_f32_16x16x32_bf16 v[56:59], a[200:203], v[188:191], v[56:59]
    ds_write_addtid_b32 v218 offset:27008
    v_perm_b32 v219, v71, v67, s49
    v_mfma_f32_16x16x32_bf16 v[56:59], a[208:211], v[192:195], v[56:59]
    s_waitcnt lgkmcnt(4)
    v_exp_f32 v220, v220
    v_mfma_f32_16x16x32_bf16 v[56:59], a[216:219], v[196:199], v[56:59]
    ds_write_addtid_b32 v219 offset:33184
    ds_read_b128 v[108:111], v0 offset:2304
    v_mfma_f32_16x16x32_bf16 v[68:71], v[72:75], a[80:83], v[252:255]
    v_exp_f32 v221, v221
    v_mfma_f32_16x16x32_bf16 v[68:71], v[76:79], a[84:87], v[68:71]
    ds_read_b128 v[228:231], v4 offset:5376
    v_cvt_pk_bf16_f32 v31, v54, v55
    v_mfma_f32_16x16x32_bf16 v[68:71], v[80:83], a[88:91], v[68:71]
    v_exp_f32 v222, v222
    v_mfma_f32_16x16x32_bf16 v[68:71], v[84:87], a[92:95], v[68:71]
    ds_read_b128 v[232:235], v4 offset:5632
    ds_read_b128 v[88:91], v5 offset:9216
    v_mfma_f32_16x16x32_bf16 v[60:63], a[196:199], v[184:187], v[60:63]
    v_exp_f32 v223, v223
    v_mfma_f32_16x16x32_bf16 v[60:63], a[204:207], v[188:191], v[60:63]
    ds_read_b128 v[92:95], v6 offset:9216
    ds_read_b128 v[96:99], v7 offset:9216
    v_mfma_f32_16x16x32_bf16 v[60:63], a[212:215], v[192:195], v[60:63]
    s_waitcnt lgkmcnt(5)
    v_exp_f32 v68, v68
    v_mfma_f32_16x16x32_bf16 v[60:63], a[220:223], v[196:199], v[60:63]
    ds_read_b128 v[236:239], v4 offset:5888
    v_perm_b32 v216, v68, v220, s49
    v_smfmac_f32_16x16x64_bf16 v[40:43], v[32:35], v[104:111], v1
    ds_write_addtid_b32 v216 offset:14848
    ds_read_b128 v[100:103], v8 offset:9216
    v_mfma_f32_16x16x32_bf16 v[64:67], v[72:75], a[96:99], v[252:255]
    v_exp_f32 v69, v69
    v_mfma_f32_16x16x32_bf16 v[64:67], v[76:79], a[100:103], v[64:67]
    ds_read_b32 v19, v15
    v_perm_b32 v217, v69, v221, s49
    v_mfma_f32_16x16x32_bf16 v[64:67], v[80:83], a[104:107], v[64:67]
    v_exp_f32 v70, v70
    v_mfma_f32_16x16x32_bf16 v[64:67], v[84:87], a[108:111], v[64:67]
    ds_write_addtid_b32 v217 offset:21024
    v_perm_b32 v218, v70, v222, s49
    v_mfma_f32_16x16x32_bf16 v[56:59], a[224:227], v[224:227], v[56:59]
    s_waitcnt lgkmcnt(8)
    v_exp_f32 v71, v71
    v_mfma_f32_16x16x32_bf16 v[56:59], a[232:235], v[228:231], v[56:59]
    ds_write_addtid_b32 v218 offset:27264
    v_perm_b32 v219, v71, v223, s49
    v_mfma_f32_16x16x32_bf16 v[56:59], a[240:243], v[232:235], v[56:59]
    s_waitcnt lgkmcnt(5)
    v_exp_f32 v64, v64
    v_mfma_f32_16x16x32_bf16 v[56:59], a[248:251], v[236:239], v[56:59]
    ds_write_addtid_b32 v219 offset:33440
    ds_read_b128 v[112:115], v0 offset:2560
    v_mfma_f32_16x16x32_bf16 v[68:71], v[72:75], a[112:115], v[252:255]
    v_exp_f32 v65, v65
    v_mfma_f32_16x16x32_bf16 v[68:71], v[76:79], a[116:119], v[68:71]
    v_mul_f32 v56, v21, v56
    v_mul_f32 v57, v21, v57
    v_mfma_f32_16x16x32_bf16 v[68:71], v[80:83], a[120:123], v[68:71]
    v_exp_f32 v66, v66
    v_mfma_f32_16x16x32_bf16 v[68:71], v[84:87], a[124:127], v[68:71]
    s_waitcnt lgkmcnt(4)
    v_cmp_gt_u32 vcc, s24, v19
    v_mul_f32 v58, v21, v58
    v_mfma_f32_16x16x32_bf16 v[60:63], a[228:231], v[224:227], v[60:63]
    s_add_u32 m0, s23, 3072
    v_exp_f32 v67, v67
    v_mfma_f32_16x16x32_bf16 v[60:63], a[236:239], v[228:231], v[60:63]
    buffer_store_dwordx4 v[28:31], v11, s[8:11], s22 offen nt
    buffer_load_dwordx4 v10, s[4:7], s22 offen nt lds
    v_mul_f32 v59, v21, v59
    v_mov_b64 v[44:45], 0
    s_cbranch_vccnz L_retry5_b
L_back5_b:
    v_mfma_f32_16x16x32_bf16 v[60:63], a[244:247], v[232:235], v[60:63]
    v_exp_f32 v68, v68
    v_mfma_f32_16x16x32_bf16 v[60:63], a[252:255], v[236:239], v[60:63]
    v_cvt_pk_bf16_f32 v28, v56, v57
    v_perm_b32 v216, v68, v64, s49
    v_cvt_pk_bf16_f32 v29, v58, v59
    v_mfma_f32_16x16x32_bf16 v[220:223], v[88:91], a[0:3], v[252:255]
    ds_write_addtid_b32 v216 offset:14080
    v_exp_f32 v69, v69
    v_mfma_f32_16x16x32_bf16 v[220:223], v[92:95], a[4:7], v[220:223]
    ds_read_b128 v[168:171], v2 offset:0
    v_perm_b32 v217, v69, v65, s49
    v_mfma_f32_16x16x32_bf16 v[220:223], v[96:99], a[8:11], v[220:223]
    v_exp_f32 v70, v70
    v_mfma_f32_16x16x32_bf16 v[220:223], v[100:103], a[12:15], v[220:223]
    ds_write_addtid_b32 v217 offset:20256
    v_perm_b32 v218, v70, v66, s49
    v_mfma_f32_16x16x32_bf16 v[48:51], a[128:131], v[136:139], 0
    v_exp_f32 v71, v71
    v_mfma_f32_16x16x32_bf16 v[48:51], a[136:139], v[140:143], v[48:51]
    ds_write_addtid_b32 v218 offset:26496
    v_perm_b32 v219, v71, v67, s49
    v_mfma_f32_16x16x32_bf16 v[48:51], a[144:147], v[144:147], v[48:51]
    v_exp_f32 v220, v220
    v_mfma_f32_16x16x32_bf16 v[48:51], a[152:155], v[148:151], v[48:51]
    ds_write_addtid_b32 v219 offset:32672
    ds_read_b128 v[116:119], v0 offset:2816
    v_mfma_f32_16x16x32_bf16 v[68:71], v[88:91], a[16:19], v[252:255]
    s_add_u32 s22, s22, 4096
    v_exp_f32 v221, v221
    v_mfma_f32_16x16x32_bf16 v[68:71], v[92:95], a[20:23], v[68:71]
    ds_read_b128 v[172:175], v2 offset:256
    v_mul_f32 v60, v21, v60
    v_mfma_f32_16x16x32_bf16 v[68:71], v[96:99], a[24:27], v[68:71]
    v_exp_f32 v222, v222
    v_mfma_f32_16x16x32_bf16 v[68:71], v[100:103], a[28:31], v[68:71]
    ds_read_b128 v[176:179], v2 offset:512
    v_mul_f32 v61, v21, v61
    v_mfma_f32_16x16x32_bf16 v[52:55], a[132:135], v[136:139], 0
    v_exp_f32 v223, v223
    v_mfma_f32_16x16x32_bf16 v[52:55], a[140:143], v[140:143], v[52:55]
    ds_read_b128 v[24:27], v18 offset:0
    v_mul_f32 v62, v21, v62
    v_mfma_f32_16x16x32_bf16 v[52:55], a[148:151], v[144:147], v[52:55]
    s_waitcnt lgkmcnt(3)
    v_exp_f32 v68, v68
    v_mfma_f32_16x16x32_bf16 v[52:55], a[156:159], v[148:151], v[52:55]
    ds_read_b128 v[180:183], v2 offset:768
    v_perm_b32 v216, v68, v220, s49
    v_smfmac_f32_16x16x64_bf16 v[40:43], v[32:35], v[112:119], v1
    ds_write_addtid_b32 v216 offset:14336
    v_mul_f32 v63, v21, v63
    v_mfma_f32_16x16x32_bf16 v[64:67], v[88:91], a[32:35], v[252:255]
    v_exp_f32 v69, v69
    v_mfma_f32_16x16x32_bf16 v[64:67], v[92:95], a[36:39], v[64:67]
    ds_read_b128 v[184:187], v3 offset:0
    v_perm_b32 v217, v69, v221, s49
    v_mfma_f32_16x16x32_bf16 v[64:67], v[96:99], a[40:43], v[64:67]
    v_exp_f32 v70, v70
    v_mfma_f32_16x16x32_bf16 v[64:67], v[100:103], a[44:47], v[64:67]
    ds_write_addtid_b32 v217 offset:20512
    v_perm_b32 v218, v70, v222, s49
    v_mfma_f32_16x16x32_bf16 v[48:51], a[160:163], v[168:171], v[48:51]
    s_waitcnt lgkmcnt(5)
    v_exp_f32 v71, v71
    v_mfma_f32_16x16x32_bf16 v[48:51], a[168:171], v[172:175], v[48:51]
    ds_write_addtid_b32 v218 offset:26752
    v_perm_b32 v219, v71, v223, s49
    v_mfma_f32_16x16x32_bf16 v[48:51], a[176:179], v[176:179], v[48:51]
    s_waitcnt lgkmcnt(4)
    v_exp_f32 v64, v64
    v_mfma_f32_16x16x32_bf16 v[48:51], a[184:187], v[180:183], v[48:51]
    ds_write_addtid_b32 v219 offset:32928
    ds_read_b128 v[120:123], v0 offset:3072
    v_mfma_f32_16x16x32_bf16 v[68:71], v[88:91], a[48:51], v[252:255]
    v_exp_f32 v65, v65
    v_mfma_f32_16x16x32_bf16 v[68:71], v[92:95], a[52:55], v[68:71]
    ds_read_b128 v[188:191], v3 offset:256
    v_cvt_pk_bf16_f32 v30, v60, v61
    v_mfma_f32_16x16x32_bf16 v[68:71], v[96:99], a[56:59], v[68:71]
    v_exp_f32 v66, v66
    v_mfma_f32_16x16x32_bf16 v[68:71], v[100:103], a[60:63], v[68:71]
    ds_read_b128 v[192:195], v3 offset:512
    v_cvt_pk_bf16_f32 v31, v62, v63
    v_mfma_f32_16x16x32_bf16 v[52:55], a[164:167], v[168:171], v[52:55]
    s_add_u32 m0, s23, 4096
    v_exp_f32 v67, v67
    v_mfma_f32_16x16x32_bf16 v[52:55], a[172:175], v[172:175], v[52:55]
    buffer_store_dwordx4 v[28:31], v11, s[8:11], s22 offen nt
    buffer_load_dwordx4 v10, s[4:7], s22 offen nt lds
    v_add_f32 v24, v24, v25
    v_add_f32 v26, v26, v27
    v_add_f32 v24, v24, v26
    v_mfma_f32_16x16x32_bf16 v[52:55], a[180:183], v[176:179], v[52:55]
    v_exp_f32 v68, v68
    v_mfma_f32_16x16x32_bf16 v[52:55], a[188:191], v[180:183], v[52:55]
    ds_read_b128 v[196:199], v3 offset:768
    v_perm_b32 v216, v68, v64, s49
    ds_read_b128 v[72:75], v5 offset:10240
    v_mfma_f32_16x16x32_bf16 v[220:223], v[88:91], a[64:67], v[252:255]
    ds_write_addtid_b32 v216 offset:13568
    v_exp_f32 v69, v69
    v_mfma_f32_16x16x32_bf16 v[220:223], v[92:95], a[68:71], v[220:223]
    ds_read_b128 v[224:227], v4 offset:0
    v_perm_b32 v217, v69, v65, s49
    v_mfma_f32_16x16x32_bf16 v[220:223], v[96:99], a[72:75], v[220:223]
    s_waitcnt lgkmcnt(10)
    v_exp_f32 v70, v70
    v_mfma_f32_16x16x32_bf16 v[220:223], v[100:103], a[76:79], v[220:223]
    ds_write_addtid_b32 v217 offset:19744
    v_perm_b32 v218, v70, v66, s49
    v_mfma_f32_16x16x32_bf16 v[48:51], a[192:195], v[184:187], v[48:51]
    s_waitcnt lgkmcnt(5)
    v_exp_f32 v71, v71
    v_mfma_f32_16x16x32_bf16 v[48:51], a[200:203], v[188:191], v[48:51]
    ds_write_addtid_b32 v218 offset:25984
    v_perm_b32 v219, v71, v67, s49
    v_mfma_f32_16x16x32_bf16 v[48:51], a[208:211], v[192:195], v[48:51]
    s_waitcnt lgkmcnt(5)
    v_exp_f32 v220, v220
    v_mfma_f32_16x16x32_bf16 v[48:51], a[216:219], v[196:199], v[48:51]
    ds_write_addtid_b32 v219 offset:32160
    ds_read_b128 v[124:127], v0 offset:3328
    v_mfma_f32_16x16x32_bf16 v[68:71], v[88:91], a[80:83], v[252:255]
    s_add_u32 s22, s22, 4096
    v_exp_f32 v221, v221
    v_mfma_f32_16x16x32_bf16 v[68:71], v[92:95], a[84:87], v[68:71]
    v_rcp_f32 v22, v24
    v_mfma_f32_16x16x32_bf16 v[68:71], v[96:99], a[88:91], v[68:71]
    v_exp_f32 v222, v222
    v_mfma_f32_16x16x32_bf16 v[68:71], v[100:103], a[92:95], v[68:71]
    ds_read_b128 v[228:231], v4 offset:256
    v_bitop3_b32 v17, v17, v22, s29 bitop3:0xe8
    v_mfma_f32_16x16x32_bf16 v[52:55], a[196:199], v[184:187], v[52:55]
    v_exp_f32 v223, v223
    v_mfma_f32_16x16x32_bf16 v[52:55], a[204:207], v[188:191], v[52:55]
    ds_read_b128 v[232:235], v4 offset:512
    v_mov_b32 v23, v22
    v_mfma_f32_16x16x32_bf16 v[52:55], a[212:215], v[192:195], v[52:55]
    s_waitcnt lgkmcnt(2)
    v_exp_f32 v68, v68
    v_mfma_f32_16x16x32_bf16 v[52:55], a[220:223], v[196:199], v[52:55]
    ds_read_b128 v[236:239], v4 offset:768
    v_perm_b32 v216, v68, v220, s49
    v_smfmac_f32_16x16x64_bf16 v[40:43], v[36:39], v[120:127], v1
    ds_write_addtid_b32 v216 offset:13824
    ds_read_b128 v[76:79], v6 offset:10240
    v_mfma_f32_16x16x32_bf16 v[64:67], v[88:91], a[96:99], v[252:255]
    v_exp_f32 v69, v69
    v_mfma_f32_16x16x32_bf16 v[64:67], v[92:95], a[100:103], v[64:67]
    ds_read_b128 v[80:83], v7 offset:10240
    v_perm_b32 v217, v69, v221, s49
    v_mfma_f32_16x16x32_bf16 v[64:67], v[96:99], a[104:107], v[64:67]
    v_exp_f32 v70, v70
    v_mfma_f32_16x16x32_bf16 v[64:67], v[100:103], a[108:111], v[64:67]
    ds_write_addtid_b32 v217 offset:20000
    v_perm_b32 v218, v70, v222, s49
    v_mfma_f32_16x16x32_bf16 v[48:51], a[224:227], v[224:227], v[48:51]
    s_waitcnt lgkmcnt(5)
    v_exp_f32 v71, v71
    v_mfma_f32_16x16x32_bf16 v[48:51], a[232:235], v[228:231], v[48:51]
    ds_write_addtid_b32 v218 offset:26240
    v_perm_b32 v219, v71, v223, s49
    v_mfma_f32_16x16x32_bf16 v[48:51], a[240:243], v[232:235], v[48:51]
    s_waitcnt lgkmcnt(5)
    v_exp_f32 v64, v64
    v_mfma_f32_16x16x32_bf16 v[48:51], a[248:251], v[236:239], v[48:51]
    ds_write_addtid_b32 v219 offset:32416
    ds_read_b128 v[128:131], v0 offset:3584
    v_mfma_f32_16x16x32_bf16 v[68:71], v[88:91], a[112:115], v[252:255]
    v_exp_f32 v65, v65
    v_mfma_f32_16x16x32_bf16 v[68:71], v[92:95], a[116:119], v[68:71]
    v_permlane32_swap_b32 v22, v23
    v_mfma_f32_16x16x32_bf16 v[68:71], v[96:99], a[120:123], v[68:71]
    v_exp_f32 v66, v66
    v_mfma_f32_16x16x32_bf16 v[68:71], v[100:103], a[124:127], v[68:71]
    ds_read_b128 v[84:87], v8 offset:10240
    v_mul_f32 v48, v22, v48
    v_mfma_f32_16x16x32_bf16 v[52:55], a[228:231], v[224:227], v[52:55]
    v_exp_f32 v67, v67
    v_mfma_f32_16x16x32_bf16 v[52:55], a[236:239], v[228:231], v[52:55]
    v_mul_f32 v49, v22, v49
    v_mul_f32 v50, v22, v50
    v_mfma_f32_16x16x32_bf16 v[52:55], a[244:247], v[232:235], v[52:55]
    v_exp_f32 v68, v68
    v_mfma_f32_16x16x32_bf16 v[52:55], a[252:255], v[236:239], v[52:55]
    s_waitcnt lgkmcnt(5)
    v_mul_f32 v51, v22, v51
    v_perm_b32 v216, v68, v64, s49
    v_cvt_pk_bf16_f32 v28, v48, v49
    v_mfma_f32_16x16x32_bf16 v[220:223], v[72:75], a[0:3], v[252:255]
    ds_write_addtid_b32 v216 offset:14080
    v_exp_f32 v69, v69
    v_mfma_f32_16x16x32_bf16 v[220:223], v[76:79], a[4:7], v[220:223]
    ds_read_b128 v[168:171], v2 offset:1024
    v_perm_b32 v217, v69, v65, s49
    v_mfma_f32_16x16x32_bf16 v[220:223], v[80:83], a[8:11], v[220:223]
    s_waitcnt lgkmcnt(2)
    v_exp_f32 v70, v70
    v_mfma_f32_16x16x32_bf16 v[220:223], v[84:87], a[12:15], v[220:223]
    ds_write_addtid_b32 v217 offset:20256
    v_perm_b32 v218, v70, v66, s49
    v_mfma_f32_16x16x32_bf16 v[56:59], a[128:131], v[152:155], 0
    v_exp_f32 v71, v71
    v_mfma_f32_16x16x32_bf16 v[56:59], a[136:139], v[156:159], v[56:59]
    ds_write_addtid_b32 v218 offset:26496
    v_perm_b32 v219, v71, v67, s49
    v_mfma_f32_16x16x32_bf16 v[56:59], a[144:147], v[160:163], v[56:59]
    v_exp_f32 v220, v220
    v_mfma_f32_16x16x32_bf16 v[56:59], a[152:155], v[164:167], v[56:59]
    ds_write_addtid_b32 v219 offset:32672
    ds_read_b128 v[132:135], v0 offset:3840
    v_mfma_f32_16x16x32_bf16 v[68:71], v[72:75], a[16:19], v[252:255]
    v_exp_f32 v221, v221
    v_mfma_f32_16x16x32_bf16 v[68:71], v[76:79], a[20:23], v[68:71]
    ds_read_b128 v[172:175], v2 offset:1280
    v_mul_f32 v52, v22, v52
    v_mfma_f32_16x16x32_bf16 v[68:71], v[80:83], a[24:27], v[68:71]
    v_exp_f32 v222, v222
    v_mfma_f32_16x16x32_bf16 v[68:71], v[84:87], a[28:31], v[68:71]
    ds_read_b128 v[176:179], v2 offset:1536
    v_mul_f32 v53, v22, v53
    v_mfma_f32_16x16x32_bf16 v[60:63], a[132:135], v[152:155], 0
    v_exp_f32 v223, v223
    v_mfma_f32_16x16x32_bf16 v[60:63], a[140:143], v[156:159], v[60:63]
    ds_read_b128 v[184:187], v3 offset:1024
    v_mul_f32 v54, v22, v54
    v_mfma_f32_16x16x32_bf16 v[60:63], a[148:151], v[160:163], v[60:63]
    s_waitcnt lgkmcnt(3)
    v_exp_f32 v68, v68
    v_mfma_f32_16x16x32_bf16 v[60:63], a[156:159], v[164:167], v[60:63]
    ds_read_b128 v[180:183], v2 offset:1792
    v_perm_b32 v216, v68, v220, s49
    v_smfmac_f32_16x16x64_bf16 v[40:43], v[36:39], v[128:135], v1
    ds_write_addtid_b32 v216 offset:14336
    v_mul_f32 v55, v22, v55
    v_mfma_f32_16x16x32_bf16 v[64:67], v[72:75], a[32:35], v[252:255]
    v_exp_f32 v69, v69
    v_mfma_f32_16x16x32_bf16 v[64:67], v[76:79], a[36:39], v[64:67]
    ds_read_b128 v[188:191], v3 offset:1280
    v_perm_b32 v217, v69, v221, s49
    v_mfma_f32_16x16x32_bf16 v[64:67], v[80:83], a[40:43], v[64:67]
    v_exp_f32 v70, v70
    v_mfma_f32_16x16x32_bf16 v[64:67], v[84:87], a[44:47], v[64:67]
    ds_write_addtid_b32 v217 offset:20512
    v_perm_b32 v218, v70, v222, s49
    v_mfma_f32_16x16x32_bf16 v[56:59], a[160:163], v[168:171], v[56:59]
    s_waitcnt lgkmcnt(5)
    v_exp_f32 v71, v71
    v_mfma_f32_16x16x32_bf16 v[56:59], a[168:171], v[172:175], v[56:59]
    ds_write_addtid_b32 v218 offset:26752
    v_perm_b32 v219, v71, v223, s49
    v_add_f32 v40, v40, v41
    v_mfma_f32_16x16x32_bf16 v[56:59], a[176:179], v[176:179], v[56:59]
    s_waitcnt lgkmcnt(4)
    v_exp_f32 v64, v64
    v_mfma_f32_16x16x32_bf16 v[56:59], a[184:187], v[180:183], v[56:59]
    ds_write_addtid_b32 v219 offset:32928
    ds_read_b128 v[136:139], v0 offset:4096
    v_mfma_f32_16x16x32_bf16 v[68:71], v[72:75], a[48:51], v[252:255]
    v_exp_f32 v65, v65
    v_mfma_f32_16x16x32_bf16 v[68:71], v[76:79], a[52:55], v[68:71]
    ds_write_b32 v12, v40 offset:512
    v_mfma_f32_16x16x32_bf16 v[68:71], v[80:83], a[56:59], v[68:71]
    s_waitcnt vmcnt(6)
    v_exp_f32 v66, v66
    v_mfma_f32_16x16x32_bf16 v[68:71], v[84:87], a[60:63], v[68:71]
    ds_add_u32 v14, v16
    v_mfma_f32_16x16x32_bf16 v[60:63], a[164:167], v[168:171], v[60:63]
    s_add_u32 s24, s24, 1
    v_exp_f32 v67, v67
    v_mfma_f32_16x16x32_bf16 v[60:63], a[172:175], v[172:175], v[60:63]
    ds_read_b128 v[192:195], v3 offset:1536
    v_cvt_pk_bf16_f32 v29, v50, v51
    v_mfma_f32_16x16x32_bf16 v[60:63], a[180:183], v[176:179], v[60:63]
    v_exp_f32 v68, v68
    v_mfma_f32_16x16x32_bf16 v[60:63], a[188:191], v[180:183], v[60:63]
    ds_read_b128 v[196:199], v3 offset:1792
    v_perm_b32 v216, v68, v64, s49
    v_cvt_pk_bf16_f32 v30, v52, v53
    v_mfma_f32_16x16x32_bf16 v[220:223], v[72:75], a[64:67], v[252:255]
    ds_write_addtid_b32 v216 offset:14592
    v_exp_f32 v69, v69
    v_mfma_f32_16x16x32_bf16 v[220:223], v[76:79], a[68:71], v[220:223]
    ds_read_b128 v[224:227], v4 offset:1024
    v_perm_b32 v217, v69, v65, s49
    v_mfma_f32_16x16x32_bf16 v[220:223], v[80:83], a[72:75], v[220:223]
    v_exp_f32 v70, v70
    v_mfma_f32_16x16x32_bf16 v[220:223], v[84:87], a[76:79], v[220:223]
    ds_write_addtid_b32 v217 offset:20768
    v_perm_b32 v218, v70, v66, s49
    v_mfma_f32_16x16x32_bf16 v[56:59], a[192:195], v[184:187], v[56:59]
    s_waitcnt lgkmcnt(4)
    v_exp_f32 v71, v71
    v_mfma_f32_16x16x32_bf16 v[56:59], a[200:203], v[188:191], v[56:59]
    ds_write_addtid_b32 v218 offset:27008
    v_perm_b32 v219, v71, v67, s49
    v_mfma_f32_16x16x32_bf16 v[56:59], a[208:211], v[192:195], v[56:59]
    s_waitcnt lgkmcnt(4)
    v_exp_f32 v220, v220
    v_mfma_f32_16x16x32_bf16 v[56:59], a[216:219], v[196:199], v[56:59]
    ds_write_addtid_b32 v219 offset:33184
    ds_read_b128 v[140:143], v0 offset:4352
    v_mfma_f32_16x16x32_bf16 v[68:71], v[72:75], a[80:83], v[252:255]
    v_exp_f32 v221, v221
    v_mfma_f32_16x16x32_bf16 v[68:71], v[76:79], a[84:87], v[68:71]
    ds_read_b128 v[228:231], v4 offset:1280
    v_cvt_pk_bf16_f32 v31, v54, v55
    v_mfma_f32_16x16x32_bf16 v[68:71], v[80:83], a[88:91], v[68:71]
    v_exp_f32 v222, v222
    v_mfma_f32_16x16x32_bf16 v[68:71], v[84:87], a[92:95], v[68:71]
    ds_read_b128 v[232:235], v4 offset:1536
    ds_read_b128 v[88:91], v5 offset:11264
    v_mfma_f32_16x16x32_bf16 v[60:63], a[196:199], v[184:187], v[60:63]
    v_exp_f32 v223, v223
    v_mfma_f32_16x16x32_bf16 v[60:63], a[204:207], v[188:191], v[60:63]
    ds_read_b128 v[92:95], v6 offset:11264
    ds_read_b128 v[96:99], v7 offset:11264
    v_mfma_f32_16x16x32_bf16 v[60:63], a[212:215], v[192:195], v[60:63]
    s_waitcnt lgkmcnt(5)
    v_exp_f32 v68, v68
    v_mfma_f32_16x16x32_bf16 v[60:63], a[220:223], v[196:199], v[60:63]
    ds_read_b128 v[236:239], v4 offset:1792
    v_perm_b32 v216, v68, v220, s49
    v_smfmac_f32_16x16x64_bf16 v[44:47], v[32:35], v[136:143], v1
    ds_write_addtid_b32 v216 offset:14848
    ds_read_b128 v[100:103], v8 offset:11264
    v_mfma_f32_16x16x32_bf16 v[64:67], v[72:75], a[96:99], v[252:255]
    v_exp_f32 v69, v69
    v_mfma_f32_16x16x32_bf16 v[64:67], v[76:79], a[100:103], v[64:67]
    ds_read_b32 v19, v15
    v_perm_b32 v217, v69, v221, s49
    v_mfma_f32_16x16x32_bf16 v[64:67], v[80:83], a[104:107], v[64:67]
    v_exp_f32 v70, v70
    v_mfma_f32_16x16x32_bf16 v[64:67], v[84:87], a[108:111], v[64:67]
    ds_write_addtid_b32 v217 offset:21024
    v_perm_b32 v218, v70, v222, s49
    v_mfma_f32_16x16x32_bf16 v[56:59], a[224:227], v[224:227], v[56:59]
    s_waitcnt lgkmcnt(8)
    v_exp_f32 v71, v71
    v_mfma_f32_16x16x32_bf16 v[56:59], a[232:235], v[228:231], v[56:59]
    ds_write_addtid_b32 v218 offset:27264
    v_perm_b32 v219, v71, v223, s49
    v_mfma_f32_16x16x32_bf16 v[56:59], a[240:243], v[232:235], v[56:59]
    s_waitcnt lgkmcnt(5)
    v_exp_f32 v64, v64
    v_mfma_f32_16x16x32_bf16 v[56:59], a[248:251], v[236:239], v[56:59]
    ds_write_addtid_b32 v219 offset:33440
    ds_read_b128 v[144:147], v0 offset:4608
    v_mfma_f32_16x16x32_bf16 v[68:71], v[72:75], a[112:115], v[252:255]
    v_exp_f32 v65, v65
    v_mfma_f32_16x16x32_bf16 v[68:71], v[76:79], a[116:119], v[68:71]
    v_mul_f32 v56, v23, v56
    v_mul_f32 v57, v23, v57
    v_mfma_f32_16x16x32_bf16 v[68:71], v[80:83], a[120:123], v[68:71]
    v_exp_f32 v66, v66
    v_mfma_f32_16x16x32_bf16 v[68:71], v[84:87], a[124:127], v[68:71]
    s_waitcnt lgkmcnt(4)
    v_cmp_gt_u32 vcc, s24, v19
    v_mul_f32 v58, v23, v58
    v_mfma_f32_16x16x32_bf16 v[60:63], a[228:231], v[224:227], v[60:63]
    s_add_u32 m0, s23, 5120
    v_exp_f32 v67, v67
    v_mfma_f32_16x16x32_bf16 v[60:63], a[236:239], v[228:231], v[60:63]
    buffer_store_dwordx4 v[28:31], v11, s[8:11], s22 offen nt
    buffer_load_dwordx4 v10, s[4:7], s22 offen nt lds
    v_mul_f32 v59, v23, v59
    v_mov_b64 v[40:41], 0
    s_cbranch_vccnz L_retry7_b
L_back7_b:
    v_mfma_f32_16x16x32_bf16 v[60:63], a[244:247], v[232:235], v[60:63]
    v_exp_f32 v68, v68
    v_mfma_f32_16x16x32_bf16 v[60:63], a[252:255], v[236:239], v[60:63]
    v_cvt_pk_bf16_f32 v28, v56, v57
    v_perm_b32 v216, v68, v64, s49
    v_cvt_pk_bf16_f32 v29, v58, v59
    v_mfma_f32_16x16x32_bf16 v[220:223], v[88:91], a[0:3], v[252:255]
    ds_write_addtid_b32 v216 offset:14080
    v_exp_f32 v69, v69
    v_mfma_f32_16x16x32_bf16 v[220:223], v[92:95], a[4:7], v[220:223]
    ds_read_b128 v[168:171], v2 offset:2048
    v_perm_b32 v217, v69, v65, s49
    v_mfma_f32_16x16x32_bf16 v[220:223], v[96:99], a[8:11], v[220:223]
    v_exp_f32 v70, v70
    v_mfma_f32_16x16x32_bf16 v[220:223], v[100:103], a[12:15], v[220:223]
    ds_write_addtid_b32 v217 offset:20256
    v_perm_b32 v218, v70, v66, s49
    v_mfma_f32_16x16x32_bf16 v[48:51], a[128:131], v[104:107], 0
    v_exp_f32 v71, v71
    v_mfma_f32_16x16x32_bf16 v[48:51], a[136:139], v[108:111], v[48:51]
    ds_write_addtid_b32 v218 offset:26496
    v_perm_b32 v219, v71, v67, s49
    v_mfma_f32_16x16x32_bf16 v[48:51], a[144:147], v[112:115], v[48:51]
    v_exp_f32 v220, v220
    v_mfma_f32_16x16x32_bf16 v[48:51], a[152:155], v[116:119], v[48:51]
    ds_write_addtid_b32 v219 offset:32672
    ds_read_b128 v[148:151], v0 offset:4864
    v_mfma_f32_16x16x32_bf16 v[68:71], v[88:91], a[16:19], v[252:255]
    s_add_u32 s22, s22, 4096
    v_exp_f32 v221, v221
    v_mfma_f32_16x16x32_bf16 v[68:71], v[92:95], a[20:23], v[68:71]
    ds_read_b128 v[172:175], v2 offset:2304
    v_mul_f32 v60, v23, v60
    v_mfma_f32_16x16x32_bf16 v[68:71], v[96:99], a[24:27], v[68:71]
    v_exp_f32 v222, v222
    v_mfma_f32_16x16x32_bf16 v[68:71], v[100:103], a[28:31], v[68:71]
    ds_read_b128 v[176:179], v2 offset:2560
    v_mul_f32 v61, v23, v61
    v_mfma_f32_16x16x32_bf16 v[52:55], a[132:135], v[104:107], 0
    v_exp_f32 v223, v223
    v_mfma_f32_16x16x32_bf16 v[52:55], a[140:143], v[108:111], v[52:55]
    ds_read_b128 v[24:27], v18 offset:512
    v_mul_f32 v62, v23, v62
    v_mfma_f32_16x16x32_bf16 v[52:55], a[148:151], v[112:115], v[52:55]
    s_waitcnt lgkmcnt(3)
    v_exp_f32 v68, v68
    v_mfma_f32_16x16x32_bf16 v[52:55], a[156:159], v[116:119], v[52:55]
    ds_read_b128 v[180:183], v2 offset:2816
    v_perm_b32 v216, v68, v220, s49
    v_smfmac_f32_16x16x64_bf16 v[44:47], v[32:35], v[144:151], v1
    ds_write_addtid_b32 v216 offset:14336
    v_mul_f32 v63, v23, v63
    v_mfma_f32_16x16x32_bf16 v[64:67], v[88:91], a[32:35], v[252:255]
    v_exp_f32 v69, v69
    v_mfma_f32_16x16x32_bf16 v[64:67], v[92:95], a[36:39], v[64:67]
    ds_read_b128 v[184:187], v3 offset:2048
    v_perm_b32 v217, v69, v221, s49
    v_mfma_f32_16x16x32_bf16 v[64:67], v[96:99], a[40:43], v[64:67]
    v_exp_f32 v70, v70
    v_mfma_f32_16x16x32_bf16 v[64:67], v[100:103], a[44:47], v[64:67]
    ds_write_addtid_b32 v217 offset:20512
    v_perm_b32 v218, v70, v222, s49
    v_mfma_f32_16x16x32_bf16 v[48:51], a[160:163], v[168:171], v[48:51]
    s_waitcnt lgkmcnt(5)
    v_exp_f32 v71, v71
    v_mfma_f32_16x16x32_bf16 v[48:51], a[168:171], v[172:175], v[48:51]
    ds_write_addtid_b32 v218 offset:26752
    v_perm_b32 v219, v71, v223, s49
    v_mfma_f32_16x16x32_bf16 v[48:51], a[176:179], v[176:179], v[48:51]
    s_waitcnt lgkmcnt(4)
    v_exp_f32 v64, v64
    v_mfma_f32_16x16x32_bf16 v[48:51], a[184:187], v[180:183], v[48:51]
    ds_write_addtid_b32 v219 offset:32928
    ds_read_b128 v[152:155], v0 offset:5120
    v_mfma_f32_16x16x32_bf16 v[68:71], v[88:91], a[48:51], v[252:255]
    v_exp_f32 v65, v65
    v_mfma_f32_16x16x32_bf16 v[68:71], v[92:95], a[52:55], v[68:71]
    ds_read_b128 v[188:191], v3 offset:2304
    v_cvt_pk_bf16_f32 v30, v60, v61
    v_mfma_f32_16x16x32_bf16 v[68:71], v[96:99], a[56:59], v[68:71]
    v_exp_f32 v66, v66
    v_mfma_f32_16x16x32_bf16 v[68:71], v[100:103], a[60:63], v[68:71]
L_pad8_b:
    s_cbranch_execz L_hret_b
    ds_read_b128 v[192:195], v3 offset:2560
    v_cvt_pk_bf16_f32 v31, v62, v63
    v_mfma_f32_16x16x32_bf16 v[52:55], a[164:167], v[168:171], v[52:55]
    s_add_u32 m0, s23, 6144
    v_exp_f32 v67, v67
    v_mfma_f32_16x16x32_bf16 v[52:55], a[172:175], v[172:175], v[52:55]
    buffer_store_dwordx4 v[28:31], v11, s[8:11], s22 offen nt
    buffer_load_dwordx4 v10, s[4:7], s22 offen nt lds
    v_add_f32 v24, v24, v25
    v_add_f32 v26, v26, v27
    v_add_f32 v24, v24, v26
    v_mfma_f32_16x16x32_bf16 v[52:55], a[180:183], v[176:179], v[52:55]
    v_exp_f32 v68, v68
    v_mfma_f32_16x16x32_bf16 v[52:55], a[188:191], v[180:183], v[52:55]
    ds_read_b128 v[196:199], v3 offset:2816
    v_perm_b32 v216, v68, v64, s49
    ds_read_b128 v[72:75], v5 offset:0
    v_mfma_f32_16x16x32_bf16 v[220:223], v[88:91], a[64:67], v[252:255]
    ds_write_addtid_b32 v216 offset:13568
    v_exp_f32 v69, v69
    v_mfma_f32_16x16x32_bf16 v[220:223], v[92:95], a[68:71], v[220:223]
    ds_read_b128 v[224:227], v4 offset:2048
    v_perm_b32 v217, v69, v65, s49
    v_mfma_f32_16x16x32_bf16 v[220:223], v[96:99], a[72:75], v[220:223]
    s_waitcnt lgkmcnt(10)
    v_exp_f32 v70, v70
    v_mfma_f32_16x16x32_bf16 v[220:223], v[100:103], a[76:79], v[220:223]
    ds_write_addtid_b32 v217 offset:19744
    v_perm_b32 v218, v70, v66, s49
    v_mfma_f32_16x16x32_bf16 v[48:51], a[192:195], v[184:187], v[48:51]
    s_waitcnt lgkmcnt(5)
    v_exp_f32 v71, v71
    v_mfma_f32_16x16x32_bf16 v[48:51], a[200:203], v[188:191], v[48:51]
    ds_write_addtid_b32 v218 offset:25984
    v_perm_b32 v219, v71, v67, s49
    v_mfma_f32_16x16x32_bf16 v[48:51], a[208:211], v[192:195], v[48:51]
    s_waitcnt lgkmcnt(5)
    v_exp_f32 v220, v220
    v_mfma_f32_16x16x32_bf16 v[48:51], a[216:219], v[196:199], v[48:51]
    ds_write_addtid_b32 v219 offset:32160
    ds_read_b128 v[156:159], v0 offset:5376
    v_mfma_f32_16x16x32_bf16 v[68:71], v[88:91], a[80:83], v[252:255]
    s_add_u32 s22, s22, 4096
    v_exp_f32 v221, v221
    v_mfma_f32_16x16x32_bf16 v[68:71], v[92:95], a[84:87], v[68:71]
    v_rcp_f32 v20, v24
    v_mfma_f32_16x16x32_bf16 v[68:71], v[96:99], a[88:91], v[68:71]
    v_exp_f32 v222, v222
    v_mfma_f32_16x16x32_bf16 v[68:71], v[100:103], a[92:95], v[68:71]
    ds_read_b128 v[228:231], v4 offset:2304
    v_bitop3_b32 v17, v17, v20, s29 bitop3:0xe8
    v_mfma_f32_16x16x32_bf16 v[52:55], a[196:199], v[184:187], v[52:55]
    v_exp_f32 v223, v223
    v_mfma_f32_16x16x32_bf16 v[52:55], a[204:207], v[188:191], v[52:55]
    ds_read_b128 v[232:235], v4 offset:2560
    v_mov_b32 v21, v20
    v_mfma_f32_16x16x32_bf16 v[52:55], a[212:215], v[192:195], v[52:55]
    s_waitcnt lgkmcnt(2)
    v_exp_f32 v68, v68
    v_mfma_f32_16x16x32_bf16 v[52:55], a[220:223], v[196:199], v[52:55]
    ds_read_b128 v[236:239], v4 offset:2816
    v_perm_b32 v216, v68, v220, s49
    v_smfmac_f32_16x16x64_bf16 v[44:47], v[36:39], v[152:159], v1
    ds_write_addtid_b32 v216 offset:13824
    ds_read_b128 v[76:79], v6 offset:0
    v_mfma_f32_16x16x32_bf16 v[64:67], v[88:91], a[96:99], v[252:255]
    v_exp_f32 v69, v69
    v_mfma_f32_16x16x32_bf16 v[64:67], v[92:95], a[100:103], v[64:67]
    ds_read_b128 v[80:83], v7 offset:0
    v_perm_b32 v217, v69, v221, s49
    v_mfma_f32_16x16x32_bf16 v[64:67], v[96:99], a[104:107], v[64:67]
    v_exp_f32 v70, v70
    v_mfma_f32_16x16x32_bf16 v[64:67], v[100:103], a[108:111], v[64:67]
    ds_write_addtid_b32 v217 offset:20000
    v_perm_b32 v218, v70, v222, s49
    v_mfma_f32_16x16x32_bf16 v[48:51], a[224:227], v[224:227], v[48:51]
    s_waitcnt lgkmcnt(5)
    v_exp_f32 v71, v71
    v_mfma_f32_16x16x32_bf16 v[48:51], a[232:235], v[228:231], v[48:51]
    ds_write_addtid_b32 v218 offset:26240
    v_perm_b32 v219, v71, v223, s49
    v_mfma_f32_16x16x32_bf16 v[48:51], a[240:243], v[232:235], v[48:51]
    s_waitcnt lgkmcnt(5)
    v_exp_f32 v64, v64
    v_mfma_f32_16x16x32_bf16 v[48:51], a[248:251], v[236:239], v[48:51]
    ds_write_addtid_b32 v219 offset:32416
    ds_read_b128 v[160:163], v0 offset:5632
    v_mfma_f32_16x16x32_bf16 v[68:71], v[88:91], a[112:115], v[252:255]
    v_exp_f32 v65, v65
    v_mfma_f32_16x16x32_bf16 v[68:71], v[92:95], a[116:119], v[68:71]
    v_permlane32_swap_b32 v20, v21
    v_mfma_f32_16x16x32_bf16 v[68:71], v[96:99], a[120:123], v[68:71]
    v_exp_f32 v66, v66
    v_mfma_f32_16x16x32_bf16 v[68:71], v[100:103], a[124:127], v[68:71]
    ds_read_b128 v[84:87], v8 offset:0
    v_mul_f32 v48, v20, v48
    v_mfma_f32_16x16x32_bf16 v[52:55], a[228:231], v[224:227], v[52:55]
    v_exp_f32 v67, v67
    v_mfma_f32_16x16x32_bf16 v[52:55], a[236:239], v[228:231], v[52:55]
    v_mul_f32 v49, v20, v49
    v_mul_f32 v50, v20, v50
    v_mfma_f32_16x16x32_bf16 v[52:55], a[244:247], v[232:235], v[52:55]
    v_exp_f32 v68, v68
    v_mfma_f32_16x16x32_bf16 v[52:55], a[252:255], v[236:239], v[52:55]
    s_waitcnt lgkmcnt(5)
    v_mul_f32 v51, v20, v51
    v_perm_b32 v216, v68, v64, s49
    v_cvt_pk_bf16_f32 v28, v48, v49
    v_mfma_f32_16x16x32_bf16 v[220:223], v[72:75], a[0:3], v[252:255]
    ds_write_addtid_b32 v216 offset:14080
    v_exp_f32 v69, v69
    v_mfma_f32_16x16x32_bf16 v[220:223], v[76:79], a[4:7], v[220:223]
    ds_read_b128 v[168:171], v2 offset:3072
    v_perm_b32 v217, v69, v65, s49
    v_mfma_f32_16x16x32_bf16 v[220:223], v[80:83], a[8:11], v[220:223]
    s_waitcnt lgkmcnt(2)
    v_exp_f32 v70, v70
    v_mfma_f32_16x16x32_bf16 v[220:223], v[84:87], a[12:15], v[220:223]
    ds_write_addtid_b32 v217 offset:20256
    v_perm_b32 v218, v70, v66, s49
    v_mfma_f32_16x16x32_bf16 v[56:59], a[128:131], v[120:123], 0
    v_exp_f32 v71, v71
    v_mfma_f32_16x16x32_bf16 v[56:59], a[136:139], v[124:127], v[56:59]
    ds_write_addtid_b32 v218 offset:26496
    v_perm_b32 v219, v71, v67, s49
    v_mfma_f32_16x16x32_bf16 v[56:59], a[144:147], v[128:131], v[56:59]
    v_exp_f32 v220, v220
    v_mfma_f32_16x16x32_bf16 v[56:59], a[152:155], v[132:135], v[56:59]
    ds_write_addtid_b32 v219 offset:32672
    ds_read_b128 v[164:167], v0 offset:5888
    v_mfma_f32_16x16x32_bf16 v[68:71], v[72:75], a[16:19], v[252:255]
    v_exp_f32 v221, v221
    v_mfma_f32_16x16x32_bf16 v[68:71], v[76:79], a[20:23], v[68:71]
    ds_read_b128 v[172:175], v2 offset:3328
    v_mul_f32 v52, v20, v52
    v_mfma_f32_16x16x32_bf16 v[68:71], v[80:83], a[24:27], v[68:71]
    v_exp_f32 v222, v222
    v_mfma_f32_16x16x32_bf16 v[68:71], v[84:87], a[28:31], v[68:71]
    ds_read_b128 v[176:179], v2 offset:3584
    v_mul_f32 v53, v20, v53
    v_mfma_f32_16x16x32_bf16 v[60:63], a[132:135], v[120:123], 0
    v_exp_f32 v223, v223
    v_mfma_f32_16x16x32_bf16 v[60:63], a[140:143], v[124:127], v[60:63]
    ds_read_b128 v[184:187], v3 offset:3072
    v_mul_f32 v54, v20, v54
    v_mfma_f32_16x16x32_bf16 v[60:63], a[148:151], v[128:131], v[60:63]
    s_waitcnt lgkmcnt(3)
    v_exp_f32 v68, v68
    v_mfma_f32_16x16x32_bf16 v[60:63], a[156:159], v[132:135], v[60:63]
    ds_read_b128 v[180:183], v2 offset:3840
    v_perm_b32 v216, v68, v220, s49
    v_smfmac_f32_16x16x64_bf16 v[44:47], v[36:39], v[160:167], v1
    ds_write_addtid_b32 v216 offset:8192
    v_mul_f32 v55, v20, v55
    v_mfma_f32_16x16x32_bf16 v[64:67], v[72:75], a[32:35], v[252:255]
    v_exp_f32 v69, v69
    v_mfma_f32_16x16x32_bf16 v[64:67], v[76:79], a[36:39], v[64:67]
    ds_read_b128 v[188:191], v3 offset:3328
    v_perm_b32 v217, v69, v221, s49
    v_mfma_f32_16x16x32_bf16 v[64:67], v[80:83], a[40:43], v[64:67]
    v_exp_f32 v70, v70
    v_mfma_f32_16x16x32_bf16 v[64:67], v[84:87], a[44:47], v[64:67]
    ds_write_addtid_b32 v217 offset:14368
    v_perm_b32 v218, v70, v222, s49
    v_mfma_f32_16x16x32_bf16 v[56:59], a[160:163], v[168:171], v[56:59]
    s_waitcnt lgkmcnt(5)
    v_exp_f32 v71, v71
    v_mfma_f32_16x16x32_bf16 v[56:59], a[168:171], v[172:175], v[56:59]
    ds_write_addtid_b32 v218 offset:20608
    v_perm_b32 v219, v71, v223, s49
    v_add_f32 v44, v44, v45
    v_mfma_f32_16x16x32_bf16 v[56:59], a[176:179], v[176:179], v[56:59]
    s_waitcnt lgkmcnt(4)
    v_exp_f32 v64, v64
    v_mfma_f32_16x16x32_bf16 v[56:59], a[184:187], v[180:183], v[56:59]
    ds_write_addtid_b32 v219 offset:26784
    ds_read_b128 v[104:107], v0 offset:0
    v_mfma_f32_16x16x32_bf16 v[68:71], v[72:75], a[48:51], v[252:255]
    v_exp_f32 v65, v65
    v_mfma_f32_16x16x32_bf16 v[68:71], v[76:79], a[52:55], v[68:71]
    ds_write_b32 v12, v44 offset:1024
    v_mfma_f32_16x16x32_bf16 v[68:71], v[80:83], a[56:59], v[68:71]
    s_waitcnt vmcnt(6)
    v_exp_f32 v66, v66
    v_mfma_f32_16x16x32_bf16 v[68:71], v[84:87], a[60:63], v[68:71]
    ds_add_u32 v14, v16
    v_mfma_f32_16x16x32_bf16 v[60:63], a[164:167], v[168:171], v[60:63]
    s_add_u32 s24, s24, 1
    v_exp_f32 v67, v67
    v_mfma_f32_16x16x32_bf16 v[60:63], a[172:175], v[172:175], v[60:63]
    ds_read_b128 v[192:195], v3 offset:3584
    v_cvt_pk_bf16_f32 v29, v50, v51
    v_mfma_f32_16x16x32_bf16 v[60:63], a[180:183], v[176:179], v[60:63]
    v_exp_f32 v68, v68
    v_mfma_f32_16x16x32_bf16 v[60:63], a[188:191], v[180:183], v[60:63]
    ds_read_b128 v[196:199], v3 offset:3840
    v_perm_b32 v216, v68, v64, s49
    v_cvt_pk_bf16_f32 v30, v52, v53
    v_mfma_f32_16x16x32_bf16 v[220:223], v[72:75], a[64:67], v[252:255]
    ds_write_addtid_b32 v216 offset:8448
    v_exp_f32 v69, v69
    v_mfma_f32_16x16x32_bf16 v[220:223], v[76:79], a[68:71], v[220:223]
    ds_read_b128 v[224:227], v4 offset:3072
    v_perm_b32 v217, v69, v65, s49
    v_mfma_f32_16x16x32_bf16 v[220:223], v[80:83], a[72:75], v[220:223]
    v_exp_f32 v70, v70
    v_mfma_f32_16x16x32_bf16 v[220:223], v[84:87], a[76:79], v[220:223]
    ds_write_addtid_b32 v217 offset:14624
    v_perm_b32 v218, v70, v66, s49
    v_mfma_f32_16x16x32_bf16 v[56:59], a[192:195], v[184:187], v[56:59]
    s_waitcnt lgkmcnt(4)
    v_exp_f32 v71, v71
    v_mfma_f32_16x16x32_bf16 v[56:59], a[200:203], v[188:191], v[56:59]
    ds_write_addtid_b32 v218 offset:20864
    v_perm_b32 v219, v71, v67, s49
    v_mfma_f32_16x16x32_bf16 v[56:59], a[208:211], v[192:195], v[56:59]
    s_waitcnt lgkmcnt(4)
    v_exp_f32 v220, v220
    v_mfma_f32_16x16x32_bf16 v[56:59], a[216:219], v[196:199], v[56:59]
    ds_write_addtid_b32 v219 offset:27040
    ds_read_b128 v[108:111], v0 offset:256
    v_mfma_f32_16x16x32_bf16 v[68:71], v[72:75], a[80:83], v[252:255]
    v_exp_f32 v221, v221
    v_mfma_f32_16x16x32_bf16 v[68:71], v[76:79], a[84:87], v[68:71]
    ds_read_b128 v[228:231], v4 offset:3328
    v_cvt_pk_bf16_f32 v31, v54, v55
    v_mfma_f32_16x16x32_bf16 v[68:71], v[80:83], a[88:91], v[68:71]
    v_exp_f32 v222, v222
    v_mfma_f32_16x16x32_bf16 v[68:71], v[84:87], a[92:95], v[68:71]
    ds_read_b128 v[232:235], v4 offset:3584
    ds_read_b128 v[88:91], v5 offset:1024
    v_mfma_f32_16x16x32_bf16 v[60:63], a[196:199], v[184:187], v[60:63]
    v_exp_f32 v223, v223
    v_mfma_f32_16x16x32_bf16 v[60:63], a[204:207], v[188:191], v[60:63]
    ds_read_b128 v[92:95], v6 offset:1024
    ds_read_b128 v[96:99], v7 offset:1024
    v_mfma_f32_16x16x32_bf16 v[60:63], a[212:215], v[192:195], v[60:63]
    s_waitcnt lgkmcnt(5)
    v_exp_f32 v68, v68
    v_mfma_f32_16x16x32_bf16 v[60:63], a[220:223], v[196:199], v[60:63]
    ds_read_b128 v[236:239], v4 offset:3840
    v_perm_b32 v216, v68, v220, s49
    v_smfmac_f32_16x16x64_bf16 v[40:43], v[32:35], v[104:111], v1
    ds_write_addtid_b32 v216 offset:8704
    ds_read_b128 v[100:103], v8 offset:1024
    v_mfma_f32_16x16x32_bf16 v[64:67], v[72:75], a[96:99], v[252:255]
    v_exp_f32 v69, v69
    v_mfma_f32_16x16x32_bf16 v[64:67], v[76:79], a[100:103], v[64:67]
    ds_read_b32 v19, v15
    v_perm_b32 v217, v69, v221, s49
    v_mfma_f32_16x16x32_bf16 v[64:67], v[80:83], a[104:107], v[64:67]
    v_exp_f32 v70, v70
    v_mfma_f32_16x16x32_bf16 v[64:67], v[84:87], a[108:111], v[64:67]
    ds_write_addtid_b32 v217 offset:14880
    v_perm_b32 v218, v70, v222, s49
    v_mfma_f32_16x16x32_bf16 v[56:59], a[224:227], v[224:227], v[56:59]
    s_waitcnt lgkmcnt(8)
    v_exp_f32 v71, v71
    v_mfma_f32_16x16x32_bf16 v[56:59], a[232:235], v[228:231], v[56:59]
    ds_write_addtid_b32 v218 offset:21120
    v_perm_b32 v219, v71, v223, s49
    v_mfma_f32_16x16x32_bf16 v[56:59], a[240:243], v[232:235], v[56:59]
    s_waitcnt lgkmcnt(5)
    v_exp_f32 v64, v64
    v_mfma_f32_16x16x32_bf16 v[56:59], a[248:251], v[236:239], v[56:59]
    ds_write_addtid_b32 v219 offset:27296
    ds_read_b128 v[112:115], v0 offset:512
    v_mfma_f32_16x16x32_bf16 v[68:71], v[72:75], a[112:115], v[252:255]
    v_exp_f32 v65, v65
    v_mfma_f32_16x16x32_bf16 v[68:71], v[76:79], a[116:119], v[68:71]
    v_mul_f32 v56, v21, v56
    v_mul_f32 v57, v21, v57
    v_mfma_f32_16x16x32_bf16 v[68:71], v[80:83], a[120:123], v[68:71]
    v_exp_f32 v66, v66
    v_mfma_f32_16x16x32_bf16 v[68:71], v[84:87], a[124:127], v[68:71]
    s_waitcnt lgkmcnt(4)
    v_cmp_gt_u32 vcc, s24, v19
    v_mul_f32 v58, v21, v58
    v_mfma_f32_16x16x32_bf16 v[60:63], a[228:231], v[224:227], v[60:63]
    s_add_u32 m0, s23, 7168
    v_exp_f32 v67, v67
    v_mfma_f32_16x16x32_bf16 v[60:63], a[236:239], v[228:231], v[60:63]
    buffer_store_dwordx4 v[28:31], v11, s[8:11], s22 offen nt
    buffer_load_dwordx4 v10, s[4:7], s22 offen nt lds
    v_mul_f32 v59, v21, v59
    v_mov_b64 v[44:45], 0
    s_cbranch_vccnz L_retry9_b
L_back9_b:
    v_mfma_f32_16x16x32_bf16 v[60:63], a[244:247], v[232:235], v[60:63]
    v_exp_f32 v68, v68
    v_mfma_f32_16x16x32_bf16 v[60:63], a[252:255], v[236:239], v[60:63]
    v_cvt_pk_bf16_f32 v28, v56, v57
    v_perm_b32 v216, v68, v64, s49
    v_cvt_pk_bf16_f32 v29, v58, v59
    v_mfma_f32_16x16x32_bf16 v[220:223], v[88:91], a[0:3], v[252:255]
    ds_write_addtid_b32 v216 offset:7936
    v_exp_f32 v69, v69
    v_mfma_f32_16x16x32_bf16 v[220:223], v[92:95], a[4:7], v[220:223]
    ds_read_b128 v[168:171], v2 offset:4096
    v_perm_b32 v217, v69, v65, s49
    v_mfma_f32_16x16x32_bf16 v[220:223], v[96:99], a[8:11], v[220:223]
    v_exp_f32 v70, v70
    v_mfma_f32_16x16x32_bf16 v[220:223], v[100:103], a[12:15], v[220:223]
    ds_write_addtid_b32 v217 offset:14112
    v_perm_b32 v218, v70, v66, s49
    v_mfma_f32_16x16x32_bf16 v[48:51], a[128:131], v[136:139], 0
    v_exp_f32 v71, v71
    v_mfma_f32_16x16x32_bf16 v[48:51], a[136:139], v[140:143], v[48:51]
    ds_write_addtid_b32 v218 offset:20352
    v_perm_b32 v219, v71, v67, s49
    v_mfma_f32_16x16x32_bf16 v[48:51], a[144:147], v[144:147], v[48:51]
    v_exp_f32 v220, v220
    v_mfma_f32_16x16x32_bf16 v[48:51], a[152:155], v[148:151], v[48:51]
    ds_write_addtid_b32 v219 offset:26528
    ds_read_b128 v[116:119], v0 offset:768
    v_mfma_f32_16x16x32_bf16 v[68:71], v[88:91], a[16:19], v[252:255]
    s_add_u32 s22, s22, 4096
    v_exp_f32 v221, v221
    v_mfma_f32_16x16x32_bf16 v[68:71], v[92:95], a[20:23], v[68:71]
    ds_read_b128 v[172:175], v2 offset:4352
    v_mul_f32 v60, v21, v60
    v_mfma_f32_16x16x32_bf16 v[68:71], v[96:99], a[24:27], v[68:71]
    v_exp_f32 v222, v222
    v_mfma_f32_16x16x32_bf16 v[68:71], v[100:103], a[28:31], v[68:71]
    ds_read_b128 v[176:179], v2 offset:4608
    v_mul_f32 v61, v21, v61
    v_mfma_f32_16x16x32_bf16 v[52:55], a[132:135], v[136:139], 0
    v_exp_f32 v223, v223
    v_mfma_f32_16x16x32_bf16 v[52:55], a[140:143], v[140:143], v[52:55]
    ds_read_b128 v[24:27], v18 offset:1024
    v_mul_f32 v62, v21, v62
    v_mfma_f32_16x16x32_bf16 v[52:55], a[148:151], v[144:147], v[52:55]
    s_waitcnt lgkmcnt(3)
    v_exp_f32 v68, v68
    v_mfma_f32_16x16x32_bf16 v[52:55], a[156:159], v[148:151], v[52:55]
    ds_read_b128 v[180:183], v2 offset:4864
    v_perm_b32 v216, v68, v220, s49
    v_smfmac_f32_16x16x64_bf16 v[40:43], v[32:35], v[112:119], v1
    ds_write_addtid_b32 v216 offset:8192
    v_mul_f32 v63, v21, v63
    v_mfma_f32_16x16x32_bf16 v[64:67], v[88:91], a[32:35], v[252:255]
    v_exp_f32 v69, v69
    v_mfma_f32_16x16x32_bf16 v[64:67], v[92:95], a[36:39], v[64:67]
    ds_read_b128 v[184:187], v3 offset:4096
    v_perm_b32 v217, v69, v221, s49
    v_mfma_f32_16x16x32_bf16 v[64:67], v[96:99], a[40:43], v[64:67]
    v_exp_f32 v70, v70
    v_mfma_f32_16x16x32_bf16 v[64:67], v[100:103], a[44:47], v[64:67]
    ds_write_addtid_b32 v217 offset:14368
    v_perm_b32 v218, v70, v222, s49
    v_mfma_f32_16x16x32_bf16 v[48:51], a[160:163], v[168:171], v[48:51]
    s_waitcnt lgkmcnt(5)
    v_exp_f32 v71, v71
    v_mfma_f32_16x16x32_bf16 v[48:51], a[168:171], v[172:175], v[48:51]
    ds_write_addtid_b32 v218 offset:20608
    v_perm_b32 v219, v71, v223, s49
    v_mfma_f32_16x16x32_bf16 v[48:51], a[176:179], v[176:179], v[48:51]
    s_waitcnt lgkmcnt(4)
    v_exp_f32 v64, v64
    v_mfma_f32_16x16x32_bf16 v[48:51], a[184:187], v[180:183], v[48:51]
    ds_write_addtid_b32 v219 offset:26784
    ds_read_b128 v[120:123], v0 offset:1024
    v_mfma_f32_16x16x32_bf16 v[68:71], v[88:91], a[48:51], v[252:255]
    v_exp_f32 v65, v65
    v_mfma_f32_16x16x32_bf16 v[68:71], v[92:95], a[52:55], v[68:71]
    ds_read_b128 v[188:191], v3 offset:4352
    v_cvt_pk_bf16_f32 v30, v60, v61
    v_mfma_f32_16x16x32_bf16 v[68:71], v[96:99], a[56:59], v[68:71]
    v_exp_f32 v66, v66
    v_mfma_f32_16x16x32_bf16 v[68:71], v[100:103], a[60:63], v[68:71]
    ds_read_b128 v[192:195], v3 offset:4608
    v_cvt_pk_bf16_f32 v31, v62, v63
    v_mfma_f32_16x16x32_bf16 v[52:55], a[164:167], v[168:171], v[52:55]
    s_add_u32 m0, s23, 8192
    v_exp_f32 v67, v67
    v_mfma_f32_16x16x32_bf16 v[52:55], a[172:175], v[172:175], v[52:55]
    buffer_store_dwordx4 v[28:31], v11, s[8:11], s22 offen nt
    buffer_load_dwordx4 v10, s[4:7], s22 offen nt lds
    v_add_f32 v24, v24, v25
    v_add_f32 v26, v26, v27
    v_add_f32 v24, v24, v26
    v_mfma_f32_16x16x32_bf16 v[52:55], a[180:183], v[176:179], v[52:55]
    v_exp_f32 v68, v68
    v_mfma_f32_16x16x32_bf16 v[52:55], a[188:191], v[180:183], v[52:55]
    ds_read_b128 v[196:199], v3 offset:4864
    v_perm_b32 v216, v68, v64, s49
    ds_read_b128 v[72:75], v5 offset:2048
    v_mfma_f32_16x16x32_bf16 v[220:223], v[88:91], a[64:67], v[252:255]
    ds_write_addtid_b32 v216 offset:7424
    v_exp_f32 v69, v69
    v_mfma_f32_16x16x32_bf16 v[220:223], v[92:95], a[68:71], v[220:223]
    ds_read_b128 v[224:227], v4 offset:4096
    v_perm_b32 v217, v69, v65, s49
    v_mfma_f32_16x16x32_bf16 v[220:223], v[96:99], a[72:75], v[220:223]
    s_waitcnt lgkmcnt(10)
    v_exp_f32 v70, v70
    v_mfma_f32_16x16x32_bf16 v[220:223], v[100:103], a[76:79], v[220:223]
    ds_write_addtid_b32 v217 offset:13600
    v_perm_b32 v218, v70, v66, s49
    v_mfma_f32_16x16x32_bf16 v[48:51], a[192:195], v[184:187], v[48:51]
    s_waitcnt lgkmcnt(5)
    v_exp_f32 v71, v71
    v_mfma_f32_16x16x32_bf16 v[48:51], a[200:203], v[188:191], v[48:51]
    ds_write_addtid_b32 v218 offset:19840
    v_perm_b32 v219, v71, v67, s49
    v_mfma_f32_16x16x32_bf16 v[48:51], a[208:211], v[192:195], v[48:51]
    s_waitcnt lgkmcnt(5)
    v_exp_f32 v220, v220
    v_mfma_f32_16x16x32_bf16 v[48:51], a[216:219], v[196:199], v[48:51]
    ds_write_addtid_b32 v219 offset:26016
    ds_read_b128 v[124:127], v0 offset:1280
    v_mfma_f32_16x16x32_bf16 v[68:71], v[88:91], a[80:83], v[252:255]
    s_add_u32 s22, s22, 4096
    v_exp_f32 v221, v221
    v_mfma_f32_16x16x32_bf16 v[68:71], v[92:95], a[84:87], v[68:71]
    v_rcp_f32 v22, v24
    v_mfma_f32_16x16x32_bf16 v[68:71], v[96:99], a[88:91], v[68:71]
    v_exp_f32 v222, v222
    v_mfma_f32_16x16x32_bf16 v[68:71], v[100:103], a[92:95], v[68:71]
    ds_read_b128 v[228:231], v4 offset:4352
    v_bitop3_b32 v17, v17, v22, s29 bitop3:0xe8
    v_mfma_f32_16x16x32_bf16 v[52:55], a[196:199], v[184:187], v[52:55]
    v_exp_f32 v223, v223
    v_mfma_f32_16x16x32_bf16 v[52:55], a[204:207], v[188:191], v[52:55]
    ds_read_b128 v[232:235], v4 offset:4608
    v_mov_b32 v23, v22
    v_mfma_f32_16x16x32_bf16 v[52:55], a[212:215], v[192:195], v[52:55]
    s_waitcnt lgkmcnt(2)
    v_exp_f32 v68, v68
    v_mfma_f32_16x16x32_bf16 v[52:55], a[220:223], v[196:199], v[52:55]
    ds_read_b128 v[236:239], v4 offset:4864
    v_perm_b32 v216, v68, v220, s49
    v_smfmac_f32_16x16x64_bf16 v[40:43], v[36:39], v[120:127], v1
    ds_write_addtid_b32 v216 offset:7680
    ds_read_b128 v[76:79], v6 offset:2048
    v_mfma_f32_16x16x32_bf16 v[64:67], v[88:91], a[96:99], v[252:255]
    v_exp_f32 v69, v69
    v_mfma_f32_16x16x32_bf16 v[64:67], v[92:95], a[100:103], v[64:67]
    ds_read_b128 v[80:83], v7 offset:2048
    v_perm_b32 v217, v69, v221, s49
    v_mfma_f32_16x16x32_bf16 v[64:67], v[96:99], a[104:107], v[64:67]
    v_exp_f32 v70, v70
    v_mfma_f32_16x16x32_bf16 v[64:67], v[100:103], a[108:111], v[64:67]
    ds_write_addtid_b32 v217 offset:13856
    v_perm_b32 v218, v70, v222, s49
    v_mfma_f32_16x16x32_bf16 v[48:51], a[224:227], v[224:227], v[48:51]
    s_waitcnt lgkmcnt(5)
    v_exp_f32 v71, v71
    v_mfma_f32_16x16x32_bf16 v[48:51], a[232:235], v[228:231], v[48:51]
    ds_write_addtid_b32 v218 offset:20096
    v_perm_b32 v219, v71, v223, s49
    v_mfma_f32_16x16x32_bf16 v[48:51], a[240:243], v[232:235], v[48:51]
    s_waitcnt lgkmcnt(5)
    v_exp_f32 v64, v64
    v_mfma_f32_16x16x32_bf16 v[48:51], a[248:251], v[236:239], v[48:51]
    ds_write_addtid_b32 v219 offset:26272
    ds_read_b128 v[128:131], v0 offset:1536
    v_mfma_f32_16x16x32_bf16 v[68:71], v[88:91], a[112:115], v[252:255]
    v_exp_f32 v65, v65
    v_mfma_f32_16x16x32_bf16 v[68:71], v[92:95], a[116:119], v[68:71]
    v_permlane32_swap_b32 v22, v23
    v_mfma_f32_16x16x32_bf16 v[68:71], v[96:99], a[120:123], v[68:71]
    v_exp_f32 v66, v66
    v_mfma_f32_16x16x32_bf16 v[68:71], v[100:103], a[124:127], v[68:71]
    ds_read_b128 v[84:87], v8 offset:2048
    v_mul_f32 v48, v22, v48
    v_mfma_f32_16x16x32_bf16 v[52:55], a[228:231], v[224:227], v[52:55]
    v_exp_f32 v67, v67
    v_mfma_f32_16x16x32_bf16 v[52:55], a[236:239], v[228:231], v[52:55]
    v_mul_f32 v49, v22, v49
    v_mul_f32 v50, v22, v50
    v_mfma_f32_16x16x32_bf16 v[52:55], a[244:247], v[232:235], v[52:55]
    v_exp_f32 v68, v68
    v_mfma_f32_16x16x32_bf16 v[52:55], a[252:255], v[236:239], v[52:55]
    s_waitcnt lgkmcnt(5)
    v_mul_f32 v51, v22, v51
    v_perm_b32 v216, v68, v64, s49
    v_cvt_pk_bf16_f32 v28, v48, v49
    v_mfma_f32_16x16x32_bf16 v[220:223], v[72:75], a[0:3], v[252:255]
    ds_write_addtid_b32 v216 offset:7936
    v_exp_f32 v69, v69
    v_mfma_f32_16x16x32_bf16 v[220:223], v[76:79], a[4:7], v[220:223]
    ds_read_b128 v[168:171], v2 offset:5120
    v_perm_b32 v217, v69, v65, s49
    v_mfma_f32_16x16x32_bf16 v[220:223], v[80:83], a[8:11], v[220:223]
    s_waitcnt lgkmcnt(2)
    v_exp_f32 v70, v70
    v_mfma_f32_16x16x32_bf16 v[220:223], v[84:87], a[12:15], v[220:223]
    ds_write_addtid_b32 v217 offset:14112
    v_perm_b32 v218, v70, v66, s49
    v_mfma_f32_16x16x32_bf16 v[56:59], a[128:131], v[152:155], 0
    v_exp_f32 v71, v71
    v_mfma_f32_16x16x32_bf16 v[56:59], a[136:139], v[156:159], v[56:59]
    ds_write_addtid_b32 v218 offset:20352
    v_perm_b32 v219, v71, v67, s49
    v_mfma_f32_16x16x32_bf16 v[56:59], a[144:147], v[160:163], v[56:59]
    v_exp_f32 v220, v220
    v_mfma_f32_16x16x32_bf16 v[56:59], a[152:155], v[164:167], v[56:59]
    ds_write_addtid_b32 v219 offset:26528
    ds_read_b128 v[132:135], v0 offset:1792
    v_mfma_f32_16x16x32_bf16 v[68:71], v[72:75], a[16:19], v[252:255]
    v_exp_f32 v221, v221
    v_mfma_f32_16x16x32_bf16 v[68:71], v[76:79], a[20:23], v[68:71]
    ds_read_b128 v[172:175], v2 offset:5376
    v_mul_f32 v52, v22, v52
    v_mfma_f32_16x16x32_bf16 v[68:71], v[80:83], a[24:27], v[68:71]
    v_exp_f32 v222, v222
    v_mfma_f32_16x16x32_bf16 v[68:71], v[84:87], a[28:31], v[68:71]
    ds_read_b128 v[176:179], v2 offset:5632
    v_mul_f32 v53, v22, v53
    v_mfma_f32_16x16x32_bf16 v[60:63], a[132:135], v[152:155], 0
    v_exp_f32 v223, v223
    v_mfma_f32_16x16x32_bf16 v[60:63], a[140:143], v[156:159], v[60:63]
    ds_read_b128 v[184:187], v3 offset:5120
    v_mul_f32 v54, v22, v54
    v_mfma_f32_16x16x32_bf16 v[60:63], a[148:151], v[160:163], v[60:63]
    s_waitcnt lgkmcnt(3)
    v_exp_f32 v68, v68
    v_mfma_f32_16x16x32_bf16 v[60:63], a[156:159], v[164:167], v[60:63]
    ds_read_b128 v[180:183], v2 offset:5888
    v_perm_b32 v216, v68, v220, s49
    v_smfmac_f32_16x16x64_bf16 v[40:43], v[36:39], v[128:135], v1
    ds_write_addtid_b32 v216 offset:8192
    v_mul_f32 v55, v22, v55
    v_mfma_f32_16x16x32_bf16 v[64:67], v[72:75], a[32:35], v[252:255]
    v_exp_f32 v69, v69
    v_mfma_f32_16x16x32_bf16 v[64:67], v[76:79], a[36:39], v[64:67]
    ds_read_b128 v[188:191], v3 offset:5376
    v_perm_b32 v217, v69, v221, s49
    v_mfma_f32_16x16x32_bf16 v[64:67], v[80:83], a[40:43], v[64:67]
    v_exp_f32 v70, v70
    v_mfma_f32_16x16x32_bf16 v[64:67], v[84:87], a[44:47], v[64:67]
    ds_write_addtid_b32 v217 offset:14368
    v_perm_b32 v218, v70, v222, s49
    v_mfma_f32_16x16x32_bf16 v[56:59], a[160:163], v[168:171], v[56:59]
    s_waitcnt lgkmcnt(5)
    v_exp_f32 v71, v71
    v_mfma_f32_16x16x32_bf16 v[56:59], a[168:171], v[172:175], v[56:59]
    ds_write_addtid_b32 v218 offset:20608
    v_perm_b32 v219, v71, v223, s49
    v_add_f32 v40, v40, v41
    v_mfma_f32_16x16x32_bf16 v[56:59], a[176:179], v[176:179], v[56:59]
    s_waitcnt lgkmcnt(4)
    v_exp_f32 v64, v64
    v_mfma_f32_16x16x32_bf16 v[56:59], a[184:187], v[180:183], v[56:59]
    ds_write_addtid_b32 v219 offset:26784
    ds_read_b128 v[136:139], v0 offset:2048
    v_mfma_f32_16x16x32_bf16 v[68:71], v[72:75], a[48:51], v[252:255]
    v_exp_f32 v65, v65
    v_mfma_f32_16x16x32_bf16 v[68:71], v[76:79], a[52:55], v[68:71]
    ds_write_b32 v12, v40 offset:0
    v_mfma_f32_16x16x32_bf16 v[68:71], v[80:83], a[56:59], v[68:71]
    s_waitcnt vmcnt(6)
    v_exp_f32 v66, v66
    v_mfma_f32_16x16x32_bf16 v[68:71], v[84:87], a[60:63], v[68:71]
    ds_add_u32 v14, v16
    v_mfma_f32_16x16x32_bf16 v[60:63], a[164:167], v[168:171], v[60:63]
    s_add_u32 s24, s24, 1
    v_exp_f32 v67, v67
    v_mfma_f32_16x16x32_bf16 v[60:63], a[172:175], v[172:175], v[60:63]
    ds_read_b128 v[192:195], v3 offset:5632
    v_cvt_pk_bf16_f32 v29, v50, v51
    v_mfma_f32_16x16x32_bf16 v[60:63], a[180:183], v[176:179], v[60:63]
    v_exp_f32 v68, v68
    v_mfma_f32_16x16x32_bf16 v[60:63], a[188:191], v[180:183], v[60:63]
    ds_read_b128 v[196:199], v3 offset:5888
    v_perm_b32 v216, v68, v64, s49
    v_cvt_pk_bf16_f32 v30, v52, v53
    v_mfma_f32_16x16x32_bf16 v[220:223], v[72:75], a[64:67], v[252:255]
    ds_write_addtid_b32 v216 offset:8448
    v_exp_f32 v69, v69
    v_mfma_f32_16x16x32_bf16 v[220:223], v[76:79], a[68:71], v[220:223]
    ds_read_b128 v[224:227], v4 offset:5120
    v_perm_b32 v217, v69, v65, s49
    v_mfma_f32_16x16x32_bf16 v[220:223], v[80:83], a[72:75], v[220:223]
    v_exp_f32 v70, v70
    v_mfma_f32_16x16x32_bf16 v[220:223], v[84:87], a[76:79], v[220:223]
    ds_write_addtid_b32 v217 offset:14624
    v_perm_b32 v218, v70, v66, s49
    v_mfma_f32_16x16x32_bf16 v[56:59], a[192:195], v[184:187], v[56:59]
    s_waitcnt lgkmcnt(4)
    v_exp_f32 v71, v71
    v_mfma_f32_16x16x32_bf16 v[56:59], a[200:203], v[188:191], v[56:59]
    ds_write_addtid_b32 v218 offset:20864
    v_perm_b32 v219, v71, v67, s49
    v_mfma_f32_16x16x32_bf16 v[56:59], a[208:211], v[192:195], v[56:59]
    s_waitcnt lgkmcnt(4)
    v_exp_f32 v220, v220
    v_mfma_f32_16x16x32_bf16 v[56:59], a[216:219], v[196:199], v[56:59]
    ds_write_addtid_b32 v219 offset:27040
    ds_read_b128 v[140:143], v0 offset:2304
    v_mfma_f32_16x16x32_bf16 v[68:71], v[72:75], a[80:83], v[252:255]
    v_exp_f32 v221, v221
    v_mfma_f32_16x16x32_bf16 v[68:71], v[76:79], a[84:87], v[68:71]
    ds_read_b128 v[228:231], v4 offset:5376
    v_cvt_pk_bf16_f32 v31, v54, v55
    v_mfma_f32_16x16x32_bf16 v[68:71], v[80:83], a[88:91], v[68:71]
    v_exp_f32 v222, v222
    v_mfma_f32_16x16x32_bf16 v[68:71], v[84:87], a[92:95], v[68:71]
    ds_read_b128 v[232:235], v4 offset:5632
    ds_read_b128 v[88:91], v5 offset:3072
    v_mfma_f32_16x16x32_bf16 v[60:63], a[196:199], v[184:187], v[60:63]
    v_exp_f32 v223, v223
    v_mfma_f32_16x16x32_bf16 v[60:63], a[204:207], v[188:191], v[60:63]
L_pad9_b:
    s_cbranch_execz L_hret_b
    ds_read_b128 v[92:95], v6 offset:3072
    ds_read_b128 v[96:99], v7 offset:3072
    v_mfma_f32_16x16x32_bf16 v[60:63], a[212:215], v[192:195], v[60:63]
    s_waitcnt lgkmcnt(5)
    v_exp_f32 v68, v68
    v_mfma_f32_16x16x32_bf16 v[60:63], a[220:223], v[196:199], v[60:63]
    ds_read_b128 v[236:239], v4 offset:5888
    v_perm_b32 v216, v68, v220, s49
    v_smfmac_f32_16x16x64_bf16 v[44:47], v[32:35], v[136:143], v1
    ds_write_addtid_b32 v216 offset:8704
    ds_read_b128 v[100:103], v8 offset:3072
    v_mfma_f32_16x16x32_bf16 v[64:67], v[72:75], a[96:99], v[252:255]
    v_exp_f32 v69, v69
    v_mfma_f32_16x16x32_bf16 v[64:67], v[76:79], a[100:103], v[64:67]
    ds_read_b32 v19, v15
    v_perm_b32 v217, v69, v221, s49
    v_mfma_f32_16x16x32_bf16 v[64:67], v[80:83], a[104:107], v[64:67]
    v_exp_f32 v70, v70
    v_mfma_f32_16x16x32_bf16 v[64:67], v[84:87], a[108:111], v[64:67]
    ds_write_addtid_b32 v217 offset:14880
    v_perm_b32 v218, v70, v222, s49
    v_mfma_f32_16x16x32_bf16 v[56:59], a[224:227], v[224:227], v[56:59]
    s_waitcnt lgkmcnt(8)
    v_exp_f32 v71, v71
    v_mfma_f32_16x16x32_bf16 v[56:59], a[232:235], v[228:231], v[56:59]
    ds_write_addtid_b32 v218 offset:21120
    v_perm_b32 v219, v71, v223, s49
    v_mfma_f32_16x16x32_bf16 v[56:59], a[240:243], v[232:235], v[56:59]
    s_waitcnt lgkmcnt(5)
    v_exp_f32 v64, v64
    v_mfma_f32_16x16x32_bf16 v[56:59], a[248:251], v[236:239], v[56:59]
    ds_write_addtid_b32 v219 offset:27296
    ds_read_b128 v[144:147], v0 offset:2560
    v_mfma_f32_16x16x32_bf16 v[68:71], v[72:75], a[112:115], v[252:255]
    v_exp_f32 v65, v65
    v_mfma_f32_16x16x32_bf16 v[68:71], v[76:79], a[116:119], v[68:71]
    v_mul_f32 v56, v23, v56
    v_mul_f32 v57, v23, v57
    v_mfma_f32_16x16x32_bf16 v[68:71], v[80:83], a[120:123], v[68:71]
    v_exp_f32 v66, v66
    v_mfma_f32_16x16x32_bf16 v[68:71], v[84:87], a[124:127], v[68:71]
    s_waitcnt lgkmcnt(4)
    v_cmp_gt_u32 vcc, s24, v19
    v_mul_f32 v58, v23, v58
    v_mfma_f32_16x16x32_bf16 v[60:63], a[228:231], v[224:227], v[60:63]
    s_add_u32 m0, s23, 9216
    v_exp_f32 v67, v67
    v_mfma_f32_16x16x32_bf16 v[60:63], a[236:239], v[228:231], v[60:63]
    buffer_store_dwordx4 v[28:31], v11, s[8:11], s22 offen nt
    buffer_load_dwordx4 v10, s[4:7], s22 offen nt lds
    v_mul_f32 v59, v23, v59
    v_mov_b64 v[40:41], 0
    s_cbranch_vccnz L_retry11_b
L_back11_b:
    v_mfma_f32_16x16x32_bf16 v[60:63], a[244:247], v[232:235], v[60:63]
    v_exp_f32 v68, v68
    v_mfma_f32_16x16x32_bf16 v[60:63], a[252:255], v[236:239], v[60:63]
    v_cvt_pk_bf16_f32 v28, v56, v57
    v_perm_b32 v216, v68, v64, s49
    v_cvt_pk_bf16_f32 v29, v58, v59
    v_mfma_f32_16x16x32_bf16 v[220:223], v[88:91], a[0:3], v[252:255]
    ds_write_addtid_b32 v216 offset:7936
    v_exp_f32 v69, v69
    v_mfma_f32_16x16x32_bf16 v[220:223], v[92:95], a[4:7], v[220:223]
    ds_read_b128 v[168:171], v2 offset:0
    v_perm_b32 v217, v69, v65, s49
    v_mfma_f32_16x16x32_bf16 v[220:223], v[96:99], a[8:11], v[220:223]
    v_exp_f32 v70, v70
    v_mfma_f32_16x16x32_bf16 v[220:223], v[100:103], a[12:15], v[220:223]
    ds_write_addtid_b32 v217 offset:14112
    v_perm_b32 v218, v70, v66, s49
    v_mfma_f32_16x16x32_bf16 v[48:51], a[128:131], v[104:107], 0
    v_exp_f32 v71, v71
    v_mfma_f32_16x16x32_bf16 v[48:51], a[136:139], v[108:111], v[48:51]
    ds_write_addtid_b32 v218 offset:20352
    v_perm_b32 v219, v71, v67, s49
    v_mfma_f32_16x16x32_bf16 v[48:51], a[144:147], v[112:115], v[48:51]
    v_exp_f32 v220, v220
    v_mfma_f32_16x16x32_bf16 v[48:51], a[152:155], v[116:119], v[48:51]
    ds_write_addtid_b32 v219 offset:26528
    ds_read_b128 v[148:151], v0 offset:2816
    v_mfma_f32_16x16x32_bf16 v[68:71], v[88:91], a[16:19], v[252:255]
    s_add_u32 s22, s22, 4096
    v_exp_f32 v221, v221
    v_mfma_f32_16x16x32_bf16 v[68:71], v[92:95], a[20:23], v[68:71]
    ds_read_b128 v[172:175], v2 offset:256
    v_mul_f32 v60, v23, v60
    v_mfma_f32_16x16x32_bf16 v[68:71], v[96:99], a[24:27], v[68:71]
    v_exp_f32 v222, v222
    v_mfma_f32_16x16x32_bf16 v[68:71], v[100:103], a[28:31], v[68:71]
    ds_read_b128 v[176:179], v2 offset:512
    v_mul_f32 v61, v23, v61
    v_mfma_f32_16x16x32_bf16 v[52:55], a[132:135], v[104:107], 0
    v_exp_f32 v223, v223
    v_mfma_f32_16x16x32_bf16 v[52:55], a[140:143], v[108:111], v[52:55]
    ds_read_b128 v[24:27], v18 offset:0
    v_mul_f32 v62, v23, v62
    v_mfma_f32_16x16x32_bf16 v[52:55], a[148:151], v[112:115], v[52:55]
    s_waitcnt lgkmcnt(3)
    v_exp_f32 v68, v68
    v_mfma_f32_16x16x32_bf16 v[52:55], a[156:159], v[116:119], v[52:55]
    ds_read_b128 v[180:183], v2 offset:768
    v_perm_b32 v216, v68, v220, s49
    v_smfmac_f32_16x16x64_bf16 v[44:47], v[32:35], v[144:151], v1
    ds_write_addtid_b32 v216 offset:8192
    v_mul_f32 v63, v23, v63
    v_mfma_f32_16x16x32_bf16 v[64:67], v[88:91], a[32:35], v[252:255]
    v_exp_f32 v69, v69
    v_mfma_f32_16x16x32_bf16 v[64:67], v[92:95], a[36:39], v[64:67]
    ds_read_b128 v[184:187], v3 offset:0
    v_perm_b32 v217, v69, v221, s49
    v_mfma_f32_16x16x32_bf16 v[64:67], v[96:99], a[40:43], v[64:67]
    v_exp_f32 v70, v70
    v_mfma_f32_16x16x32_bf16 v[64:67], v[100:103], a[44:47], v[64:67]
    ds_write_addtid_b32 v217 offset:14368
    v_perm_b32 v218, v70, v222, s49
    v_mfma_f32_16x16x32_bf16 v[48:51], a[160:163], v[168:171], v[48:51]
    s_waitcnt lgkmcnt(5)
    v_exp_f32 v71, v71
    v_mfma_f32_16x16x32_bf16 v[48:51], a[168:171], v[172:175], v[48:51]
    ds_write_addtid_b32 v218 offset:20608
    v_perm_b32 v219, v71, v223, s49
    v_mfma_f32_16x16x32_bf16 v[48:51], a[176:179], v[176:179], v[48:51]
    s_waitcnt lgkmcnt(4)
    v_exp_f32 v64, v64
    v_mfma_f32_16x16x32_bf16 v[48:51], a[184:187], v[180:183], v[48:51]
    ds_write_addtid_b32 v219 offset:26784
    ds_read_b128 v[152:155], v0 offset:3072
    v_mfma_f32_16x16x32_bf16 v[68:71], v[88:91], a[48:51], v[252:255]
    v_exp_f32 v65, v65
    v_mfma_f32_16x16x32_bf16 v[68:71], v[92:95], a[52:55], v[68:71]
    ds_read_b128 v[188:191], v3 offset:256
    v_cvt_pk_bf16_f32 v30, v60, v61
    v_mfma_f32_16x16x32_bf16 v[68:71], v[96:99], a[56:59], v[68:71]
    v_exp_f32 v66, v66
    v_mfma_f32_16x16x32_bf16 v[68:71], v[100:103], a[60:63], v[68:71]
    ds_read_b128 v[192:195], v3 offset:512
    v_cvt_pk_bf16_f32 v31, v62, v63
    v_mfma_f32_16x16x32_bf16 v[52:55], a[164:167], v[168:171], v[52:55]
    s_add_u32 m0, s23, 10240
    v_exp_f32 v67, v67
    v_mfma_f32_16x16x32_bf16 v[52:55], a[172:175], v[172:175], v[52:55]
    buffer_store_dwordx4 v[28:31], v11, s[8:11], s22 offen nt
    buffer_load_dwordx4 v10, s[4:7], s22 offen nt lds
    v_add_f32 v24, v24, v25
    v_add_f32 v26, v26, v27
    v_add_f32 v24, v24, v26
    v_mfma_f32_16x16x32_bf16 v[52:55], a[180:183], v[176:179], v[52:55]
    v_exp_f32 v68, v68
    v_mfma_f32_16x16x32_bf16 v[52:55], a[188:191], v[180:183], v[52:55]
    ds_read_b128 v[196:199], v3 offset:768
    v_perm_b32 v216, v68, v64, s49
    ds_read_b128 v[72:75], v5 offset:4096
    v_mfma_f32_16x16x32_bf16 v[220:223], v[88:91], a[64:67], v[252:255]
    ds_write_addtid_b32 v216 offset:7424
    v_exp_f32 v69, v69
    v_mfma_f32_16x16x32_bf16 v[220:223], v[92:95], a[68:71], v[220:223]
    ds_read_b128 v[224:227], v4 offset:0
    v_perm_b32 v217, v69, v65, s49
    v_mfma_f32_16x16x32_bf16 v[220:223], v[96:99], a[72:75], v[220:223]
    s_waitcnt lgkmcnt(10)
    v_exp_f32 v70, v70
    v_mfma_f32_16x16x32_bf16 v[220:223], v[100:103], a[76:79], v[220:223]
    ds_write_addtid_b32 v217 offset:13600
    v_perm_b32 v218, v70, v66, s49
    v_mfma_f32_16x16x32_bf16 v[48:51], a[192:195], v[184:187], v[48:51]
    s_waitcnt lgkmcnt(5)
    v_exp_f32 v71, v71
    v_mfma_f32_16x16x32_bf16 v[48:51], a[200:203], v[188:191], v[48:51]
    ds_write_addtid_b32 v218 offset:19840
    v_perm_b32 v219, v71, v67, s49
    v_mfma_f32_16x16x32_bf16 v[48:51], a[208:211], v[192:195], v[48:51]
    s_waitcnt lgkmcnt(5)
    v_exp_f32 v220, v220
    v_mfma_f32_16x16x32_bf16 v[48:51], a[216:219], v[196:199], v[48:51]
    ds_write_addtid_b32 v219 offset:26016
    ds_read_b128 v[156:159], v0 offset:3328
    v_mfma_f32_16x16x32_bf16 v[68:71], v[88:91], a[80:83], v[252:255]
    s_add_u32 s22, s22, 4096
    v_exp_f32 v221, v221
    v_mfma_f32_16x16x32_bf16 v[68:71], v[92:95], a[84:87], v[68:71]
    v_rcp_f32 v20, v24
    v_mfma_f32_16x16x32_bf16 v[68:71], v[96:99], a[88:91], v[68:71]
    v_exp_f32 v222, v222
    v_mfma_f32_16x16x32_bf16 v[68:71], v[100:103], a[92:95], v[68:71]
    ds_read_b128 v[228:231], v4 offset:256
    v_bitop3_b32 v17, v17, v20, s29 bitop3:0xe8
    v_mfma_f32_16x16x32_bf16 v[52:55], a[196:199], v[184:187], v[52:55]
    v_exp_f32 v223, v223
    v_mfma_f32_16x16x32_bf16 v[52:55], a[204:207], v[188:191], v[52:55]
    ds_read_b128 v[232:235], v4 offset:512
    v_mov_b32 v21, v20
    v_mfma_f32_16x16x32_bf16 v[52:55], a[212:215], v[192:195], v[52:55]
    s_waitcnt lgkmcnt(2)
    v_exp_f32 v68, v68
    v_mfma_f32_16x16x32_bf16 v[52:55], a[220:223], v[196:199], v[52:55]
    ds_read_b128 v[236:239], v4 offset:768
    v_perm_b32 v216, v68, v220, s49
    v_smfmac_f32_16x16x64_bf16 v[44:47], v[36:39], v[152:159], v1
    ds_write_addtid_b32 v216 offset:7680
    ds_read_b128 v[76:79], v6 offset:4096
    v_mfma_f32_16x16x32_bf16 v[64:67], v[88:91], a[96:99], v[252:255]
    v_exp_f32 v69, v69
    v_mfma_f32_16x16x32_bf16 v[64:67], v[92:95], a[100:103], v[64:67]
    ds_read_b128 v[80:83], v7 offset:4096
    v_perm_b32 v217, v69, v221, s49
    v_mfma_f32_16x16x32_bf16 v[64:67], v[96:99], a[104:107], v[64:67]
    v_exp_f32 v70, v70
    v_mfma_f32_16x16x32_bf16 v[64:67], v[100:103], a[108:111], v[64:67]
    ds_write_addtid_b32 v217 offset:13856
    v_perm_b32 v218, v70, v222, s49
    v_mfma_f32_16x16x32_bf16 v[48:51], a[224:227], v[224:227], v[48:51]
    s_waitcnt lgkmcnt(5)
    v_exp_f32 v71, v71
    v_mfma_f32_16x16x32_bf16 v[48:51], a[232:235], v[228:231], v[48:51]
    ds_write_addtid_b32 v218 offset:20096
    v_perm_b32 v219, v71, v223, s49
    v_mfma_f32_16x16x32_bf16 v[48:51], a[240:243], v[232:235], v[48:51]
    s_waitcnt lgkmcnt(5)
    v_exp_f32 v64, v64
    v_mfma_f32_16x16x32_bf16 v[48:51], a[248:251], v[236:239], v[48:51]
    ds_write_addtid_b32 v219 offset:26272
    ds_read_b128 v[160:163], v0 offset:3584
    v_mfma_f32_16x16x32_bf16 v[68:71], v[88:91], a[112:115], v[252:255]
    v_exp_f32 v65, v65
    v_mfma_f32_16x16x32_bf16 v[68:71], v[92:95], a[116:119], v[68:71]
    v_permlane32_swap_b32 v20, v21
    v_mfma_f32_16x16x32_bf16 v[68:71], v[96:99], a[120:123], v[68:71]
    v_exp_f32 v66, v66
    v_mfma_f32_16x16x32_bf16 v[68:71], v[100:103], a[124:127], v[68:71]
    ds_read_b128 v[84:87], v8 offset:4096
    v_mul_f32 v48, v20, v48
    v_mfma_f32_16x16x32_bf16 v[52:55], a[228:231], v[224:227], v[52:55]
    v_exp_f32 v67, v67
    v_mfma_f32_16x16x32_bf16 v[52:55], a[236:239], v[228:231], v[52:55]
    v_mul_f32 v49, v20, v49
    v_mul_f32 v50, v20, v50
    v_mfma_f32_16x16x32_bf16 v[52:55], a[244:247], v[232:235], v[52:55]
    v_exp_f32 v68, v68
    v_mfma_f32_16x16x32_bf16 v[52:55], a[252:255], v[236:239], v[52:55]
    s_waitcnt lgkmcnt(5)
    v_mul_f32 v51, v20, v51
    v_perm_b32 v216, v68, v64, s49
    v_cvt_pk_bf16_f32 v28, v48, v49
    v_mfma_f32_16x16x32_bf16 v[220:223], v[72:75], a[0:3], v[252:255]
    ds_write_addtid_b32 v216 offset:7936
    v_exp_f32 v69, v69
    v_mfma_f32_16x16x32_bf16 v[220:223], v[76:79], a[4:7], v[220:223]
    ds_read_b128 v[168:171], v2 offset:1024
    v_perm_b32 v217, v69, v65, s49
    v_mfma_f32_16x16x32_bf16 v[220:223], v[80:83], a[8:11], v[220:223]
    s_waitcnt lgkmcnt(2)
    v_exp_f32 v70, v70
    v_mfma_f32_16x16x32_bf16 v[220:223], v[84:87], a[12:15], v[220:223]
    ds_write_addtid_b32 v217 offset:14112
    v_perm_b32 v218, v70, v66, s49
    v_mfma_f32_16x16x32_bf16 v[56:59], a[128:131], v[120:123], 0
    v_exp_f32 v71, v71
    v_mfma_f32_16x16x32_bf16 v[56:59], a[136:139], v[124:127], v[56:59]
    ds_write_addtid_b32 v218 offset:20352
    v_perm_b32 v219, v71, v67, s49
    v_mfma_f32_16x16x32_bf16 v[56:59], a[144:147], v[128:131], v[56:59]
    v_exp_f32 v220, v220
    v_mfma_f32_16x16x32_bf16 v[56:59], a[152:155], v[132:135], v[56:59]
    ds_write_addtid_b32 v219 offset:26528
    ds_read_b128 v[164:167], v0 offset:3840
    v_mfma_f32_16x16x32_bf16 v[68:71], v[72:75], a[16:19], v[252:255]
    v_exp_f32 v221, v221
    v_mfma_f32_16x16x32_bf16 v[68:71], v[76:79], a[20:23], v[68:71]
    ds_read_b128 v[172:175], v2 offset:1280
    v_mul_f32 v52, v20, v52
    v_mfma_f32_16x16x32_bf16 v[68:71], v[80:83], a[24:27], v[68:71]
    v_exp_f32 v222, v222
    v_mfma_f32_16x16x32_bf16 v[68:71], v[84:87], a[28:31], v[68:71]
    ds_read_b128 v[176:179], v2 offset:1536
    v_mul_f32 v53, v20, v53
    v_mfma_f32_16x16x32_bf16 v[60:63], a[132:135], v[120:123], 0
    v_exp_f32 v223, v223
    v_mfma_f32_16x16x32_bf16 v[60:63], a[140:143], v[124:127], v[60:63]
    ds_read_b128 v[184:187], v3 offset:1024
    v_mul_f32 v54, v20, v54
    v_mfma_f32_16x16x32_bf16 v[60:63], a[148:151], v[128:131], v[60:63]
    s_waitcnt lgkmcnt(3)
    v_exp_f32 v68, v68
    v_mfma_f32_16x16x32_bf16 v[60:63], a[156:159], v[132:135], v[60:63]
    ds_read_b128 v[180:183], v2 offset:1792
    v_perm_b32 v216, v68, v220, s49
    v_smfmac_f32_16x16x64_bf16 v[44:47], v[36:39], v[160:167], v1
    ds_write_addtid_b32 v216 offset:8192
    v_mul_f32 v55, v20, v55
    v_mfma_f32_16x16x32_bf16 v[64:67], v[72:75], a[32:35], v[252:255]
    v_exp_f32 v69, v69
    v_mfma_f32_16x16x32_bf16 v[64:67], v[76:79], a[36:39], v[64:67]
    ds_read_b128 v[188:191], v3 offset:1280
    v_perm_b32 v217, v69, v221, s49
    v_mfma_f32_16x16x32_bf16 v[64:67], v[80:83], a[40:43], v[64:67]
    v_exp_f32 v70, v70
    v_mfma_f32_16x16x32_bf16 v[64:67], v[84:87], a[44:47], v[64:67]
    ds_write_addtid_b32 v217 offset:14368
    v_perm_b32 v218, v70, v222, s49
    v_mfma_f32_16x16x32_bf16 v[56:59], a[160:163], v[168:171], v[56:59]
    s_waitcnt lgkmcnt(5)
    v_exp_f32 v71, v71
    v_mfma_f32_16x16x32_bf16 v[56:59], a[168:171], v[172:175], v[56:59]
    ds_write_addtid_b32 v218 offset:20608
    v_perm_b32 v219, v71, v223, s49
    v_add_f32 v44, v44, v45
    v_mfma_f32_16x16x32_bf16 v[56:59], a[176:179], v[176:179], v[56:59]
    s_waitcnt lgkmcnt(4)
    v_exp_f32 v64, v64
    v_mfma_f32_16x16x32_bf16 v[56:59], a[184:187], v[180:183], v[56:59]
    ds_write_addtid_b32 v219 offset:26784
    ds_read_b128 v[104:107], v0 offset:4096
    v_mfma_f32_16x16x32_bf16 v[68:71], v[72:75], a[48:51], v[252:255]
    v_exp_f32 v65, v65
    v_mfma_f32_16x16x32_bf16 v[68:71], v[76:79], a[52:55], v[68:71]
    ds_write_b32 v12, v44 offset:512
    v_mfma_f32_16x16x32_bf16 v[68:71], v[80:83], a[56:59], v[68:71]
    s_waitcnt vmcnt(6)
    v_exp_f32 v66, v66
    v_mfma_f32_16x16x32_bf16 v[68:71], v[84:87], a[60:63], v[68:71]
    ds_add_u32 v14, v16
    v_mfma_f32_16x16x32_bf16 v[60:63], a[164:167], v[168:171], v[60:63]
    s_add_u32 s24, s24, 1
    v_exp_f32 v67, v67
    v_mfma_f32_16x16x32_bf16 v[60:63], a[172:175], v[172:175], v[60:63]
    ds_read_b128 v[192:195], v3 offset:1536
    v_cvt_pk_bf16_f32 v29, v50, v51
    v_mfma_f32_16x16x32_bf16 v[60:63], a[180:183], v[176:179], v[60:63]
    v_exp_f32 v68, v68
    v_mfma_f32_16x16x32_bf16 v[60:63], a[188:191], v[180:183], v[60:63]
    ds_read_b128 v[196:199], v3 offset:1792
    v_perm_b32 v216, v68, v64, s49
    v_cvt_pk_bf16_f32 v30, v52, v53
    v_mfma_f32_16x16x32_bf16 v[220:223], v[72:75], a[64:67], v[252:255]
    ds_write_addtid_b32 v216 offset:8448
    v_exp_f32 v69, v69
    v_mfma_f32_16x16x32_bf16 v[220:223], v[76:79], a[68:71], v[220:223]
    ds_read_b128 v[224:227], v4 offset:1024
    v_perm_b32 v217, v69, v65, s49
    v_mfma_f32_16x16x32_bf16 v[220:223], v[80:83], a[72:75], v[220:223]
    v_exp_f32 v70, v70
    v_mfma_f32_16x16x32_bf16 v[220:223], v[84:87], a[76:79], v[220:223]
    ds_write_addtid_b32 v217 offset:14624
    v_perm_b32 v218, v70, v66, s49
    v_mfma_f32_16x16x32_bf16 v[56:59], a[192:195], v[184:187], v[56:59]
    s_waitcnt lgkmcnt(4)
    v_exp_f32 v71, v71
    v_mfma_f32_16x16x32_bf16 v[56:59], a[200:203], v[188:191], v[56:59]
    ds_write_addtid_b32 v218 offset:20864
    v_perm_b32 v219, v71, v67, s49
    v_mfma_f32_16x16x32_bf16 v[56:59], a[208:211], v[192:195], v[56:59]
    s_waitcnt lgkmcnt(4)
    v_exp_f32 v220, v220
    v_mfma_f32_16x16x32_bf16 v[56:59], a[216:219], v[196:199], v[56:59]
    ds_write_addtid_b32 v219 offset:27040
    ds_read_b128 v[108:111], v0 offset:4352
    v_mfma_f32_16x16x32_bf16 v[68:71], v[72:75], a[80:83], v[252:255]
    v_exp_f32 v221, v221
    v_mfma_f32_16x16x32_bf16 v[68:71], v[76:79], a[84:87], v[68:71]
    ds_read_b128 v[228:231], v4 offset:1280
    v_cvt_pk_bf16_f32 v31, v54, v55
    v_mfma_f32_16x16x32_bf16 v[68:71], v[80:83], a[88:91], v[68:71]
    v_exp_f32 v222, v222
    v_mfma_f32_16x16x32_bf16 v[68:71], v[84:87], a[92:95], v[68:71]
    ds_read_b128 v[232:235], v4 offset:1536
    ds_read_b128 v[88:91], v5 offset:5120
    v_mfma_f32_16x16x32_bf16 v[60:63], a[196:199], v[184:187], v[60:63]
    v_exp_f32 v223, v223
    v_mfma_f32_16x16x32_bf16 v[60:63], a[204:207], v[188:191], v[60:63]
    ds_read_b128 v[92:95], v6 offset:5120
    ds_read_b128 v[96:99], v7 offset:5120
    v_mfma_f32_16x16x32_bf16 v[60:63], a[212:215], v[192:195], v[60:63]
    s_waitcnt lgkmcnt(5)
    v_exp_f32 v68, v68
    v_mfma_f32_16x16x32_bf16 v[60:63], a[220:223], v[196:199], v[60:63]
    ds_read_b128 v[236:239], v4 offset:1792
    v_perm_b32 v216, v68, v220, s49
    v_smfmac_f32_16x16x64_bf16 v[40:43], v[32:35], v[104:111], v1
    ds_write_addtid_b32 v216 offset:8704
    ds_read_b128 v[100:103], v8 offset:5120
    v_mfma_f32_16x16x32_bf16 v[64:67], v[72:75], a[96:99], v[252:255]
    v_exp_f32 v69, v69
    v_mfma_f32_16x16x32_bf16 v[64:67], v[76:79], a[100:103], v[64:67]
    ds_read_b32 v19, v15
    v_perm_b32 v217, v69, v221, s49
    v_mfma_f32_16x16x32_bf16 v[64:67], v[80:83], a[104:107], v[64:67]
    v_exp_f32 v70, v70
    v_mfma_f32_16x16x32_bf16 v[64:67], v[84:87], a[108:111], v[64:67]
    ds_write_addtid_b32 v217 offset:14880
    v_perm_b32 v218, v70, v222, s49
    v_mfma_f32_16x16x32_bf16 v[56:59], a[224:227], v[224:227], v[56:59]
    s_waitcnt lgkmcnt(8)
    v_exp_f32 v71, v71
    v_mfma_f32_16x16x32_bf16 v[56:59], a[232:235], v[228:231], v[56:59]
    ds_write_addtid_b32 v218 offset:21120
    v_perm_b32 v219, v71, v223, s49
    v_mfma_f32_16x16x32_bf16 v[56:59], a[240:243], v[232:235], v[56:59]
    s_waitcnt lgkmcnt(5)
    v_exp_f32 v64, v64
    v_mfma_f32_16x16x32_bf16 v[56:59], a[248:251], v[236:239], v[56:59]
    ds_write_addtid_b32 v219 offset:27296
    ds_read_b128 v[112:115], v0 offset:4608
    v_mfma_f32_16x16x32_bf16 v[68:71], v[72:75], a[112:115], v[252:255]
    v_exp_f32 v65, v65
    v_mfma_f32_16x16x32_bf16 v[68:71], v[76:79], a[116:119], v[68:71]
    v_mul_f32 v56, v21, v56
    v_mul_f32 v57, v21, v57
    v_mfma_f32_16x16x32_bf16 v[68:71], v[80:83], a[120:123], v[68:71]
    v_exp_f32 v66, v66
    v_mfma_f32_16x16x32_bf16 v[68:71], v[84:87], a[124:127], v[68:71]
    s_waitcnt lgkmcnt(4)
    v_cmp_gt_u32 vcc, s24, v19
    v_mul_f32 v58, v21, v58
    v_mfma_f32_16x16x32_bf16 v[60:63], a[228:231], v[224:227], v[60:63]
    s_add_u32 m0, s23, 11264
    v_exp_f32 v67, v67
    v_mfma_f32_16x16x32_bf16 v[60:63], a[236:239], v[228:231], v[60:63]
    buffer_store_dwordx4 v[28:31], v11, s[8:11], s22 offen nt
    buffer_load_dwordx4 v10, s[4:7], s22 offen nt lds
    v_mul_f32 v59, v21, v59
    v_mov_b64 v[44:45], 0
    s_cbranch_vccnz L_retry1_b
L_back1_b:
    v_mfma_f32_16x16x32_bf16 v[60:63], a[244:247], v[232:235], v[60:63]
    v_exp_f32 v68, v68
    v_mfma_f32_16x16x32_bf16 v[60:63], a[252:255], v[236:239], v[60:63]
    v_cvt_pk_bf16_f32 v28, v56, v57
    v_perm_b32 v216, v68, v64, s49
    v_cvt_pk_bf16_f32 v29, v58, v59
    v_mfma_f32_16x16x32_bf16 v[220:223], v[88:91], a[0:3], v[252:255]
    ds_write_addtid_b32 v216 offset:7936
    v_exp_f32 v69, v69
    v_mfma_f32_16x16x32_bf16 v[220:223], v[92:95], a[4:7], v[220:223]
    ds_read_b128 v[168:171], v2 offset:2048
    v_perm_b32 v217, v69, v65, s49
    v_mfma_f32_16x16x32_bf16 v[220:223], v[96:99], a[8:11], v[220:223]
    v_exp_f32 v70, v70
    v_mfma_f32_16x16x32_bf16 v[220:223], v[100:103], a[12:15], v[220:223]
    ds_write_addtid_b32 v217 offset:14112
    v_perm_b32 v218, v70, v66, s49
    v_mfma_f32_16x16x32_bf16 v[48:51], a[128:131], v[136:139], 0
    v_exp_f32 v71, v71
    v_mfma_f32_16x16x32_bf16 v[48:51], a[136:139], v[140:143], v[48:51]
    ds_write_addtid_b32 v218 offset:20352
    v_perm_b32 v219, v71, v67, s49
    v_mfma_f32_16x16x32_bf16 v[48:51], a[144:147], v[144:147], v[48:51]
    v_exp_f32 v220, v220
    v_mfma_f32_16x16x32_bf16 v[48:51], a[152:155], v[148:151], v[48:51]
    ds_write_addtid_b32 v219 offset:26528
    ds_read_b128 v[116:119], v0 offset:4864
    v_mfma_f32_16x16x32_bf16 v[68:71], v[88:91], a[16:19], v[252:255]
    s_add_u32 s22, s22, 4096
    v_exp_f32 v221, v221
    v_mfma_f32_16x16x32_bf16 v[68:71], v[92:95], a[20:23], v[68:71]
    ds_read_b128 v[172:175], v2 offset:2304
    v_mul_f32 v60, v21, v60
    v_mfma_f32_16x16x32_bf16 v[68:71], v[96:99], a[24:27], v[68:71]
    v_exp_f32 v222, v222
    v_mfma_f32_16x16x32_bf16 v[68:71], v[100:103], a[28:31], v[68:71]
    ds_read_b128 v[176:179], v2 offset:2560
    v_mul_f32 v61, v21, v61
    v_mfma_f32_16x16x32_bf16 v[52:55], a[132:135], v[136:139], 0
    v_exp_f32 v223, v223
    v_mfma_f32_16x16x32_bf16 v[52:55], a[140:143], v[140:143], v[52:55]
    ds_read_b128 v[24:27], v18 offset:512
    v_mul_f32 v62, v21, v62
    v_mfma_f32_16x16x32_bf16 v[52:55], a[148:151], v[144:147], v[52:55]
    s_waitcnt lgkmcnt(3)
    v_exp_f32 v68, v68
    v_mfma_f32_16x16x32_bf16 v[52:55], a[156:159], v[148:151], v[52:55]
    ds_read_b128 v[180:183], v2 offset:2816
    v_perm_b32 v216, v68, v220, s49
    v_smfmac_f32_16x16x64_bf16 v[40:43], v[32:35], v[112:119], v1
    ds_write_addtid_b32 v216 offset:8192
    v_mul_f32 v63, v21, v63
    v_mfma_f32_16x16x32_bf16 v[64:67], v[88:91], a[32:35], v[252:255]
    v_exp_f32 v69, v69
    v_mfma_f32_16x16x32_bf16 v[64:67], v[92:95], a[36:39], v[64:67]
    ds_read_b128 v[184:187], v3 offset:2048
    v_perm_b32 v217, v69, v221, s49
    v_mfma_f32_16x16x32_bf16 v[64:67], v[96:99], a[40:43], v[64:67]
    v_exp_f32 v70, v70
    v_mfma_f32_16x16x32_bf16 v[64:67], v[100:103], a[44:47], v[64:67]
    ds_write_addtid_b32 v217 offset:14368
    v_perm_b32 v218, v70, v222, s49
    v_mfma_f32_16x16x32_bf16 v[48:51], a[160:163], v[168:171], v[48:51]
    s_waitcnt lgkmcnt(5)
    v_exp_f32 v71, v71
    v_mfma_f32_16x16x32_bf16 v[48:51], a[168:171], v[172:175], v[48:51]
    ds_write_addtid_b32 v218 offset:20608
    v_perm_b32 v219, v71, v223, s49
    v_mfma_f32_16x16x32_bf16 v[48:51], a[176:179], v[176:179], v[48:51]
    s_waitcnt lgkmcnt(4)
    v_exp_f32 v64, v64
    v_mfma_f32_16x16x32_bf16 v[48:51], a[184:187], v[180:183], v[48:51]
    ds_write_addtid_b32 v219 offset:26784
    ds_read_b128 v[120:123], v0 offset:5120
    v_mfma_f32_16x16x32_bf16 v[68:71], v[88:91], a[48:51], v[252:255]
    v_exp_f32 v65, v65
    v_mfma_f32_16x16x32_bf16 v[68:71], v[92:95], a[52:55], v[68:71]
    ds_read_b128 v[188:191], v3 offset:2304
    v_cvt_pk_bf16_f32 v30, v60, v61
    v_mfma_f32_16x16x32_bf16 v[68:71], v[96:99], a[56:59], v[68:71]
    v_exp_f32 v66, v66
    v_mfma_f32_16x16x32_bf16 v[68:71], v[100:103], a[60:63], v[68:71]
    ds_read_b128 v[192:195], v3 offset:2560
    v_cvt_pk_bf16_f32 v31, v62, v63
    v_mfma_f32_16x16x32_bf16 v[52:55], a[164:167], v[168:171], v[52:55]
    s_add_u32 m0, s23, 0
    v_exp_f32 v67, v67
    v_mfma_f32_16x16x32_bf16 v[52:55], a[172:175], v[172:175], v[52:55]
    buffer_store_dwordx4 v[28:31], v11, s[8:11], s22 offen nt
    buffer_load_dwordx4 v10, s[4:7], s22 offen nt lds
    v_add_f32 v24, v24, v25
    v_add_f32 v26, v26, v27
    v_add_f32 v24, v24, v26
    v_mfma_f32_16x16x32_bf16 v[52:55], a[180:183], v[176:179], v[52:55]
    v_exp_f32 v68, v68
    v_mfma_f32_16x16x32_bf16 v[52:55], a[188:191], v[180:183], v[52:55]
    ds_read_b128 v[196:199], v3 offset:2816
    v_perm_b32 v216, v68, v64, s49
    ds_read_b128 v[72:75], v5 offset:6144
    v_mfma_f32_16x16x32_bf16 v[220:223], v[88:91], a[64:67], v[252:255]
    ds_write_addtid_b32 v216 offset:19712
    v_exp_f32 v69, v69
    v_mfma_f32_16x16x32_bf16 v[220:223], v[92:95], a[68:71], v[220:223]
    ds_read_b128 v[224:227], v4 offset:2048
    v_perm_b32 v217, v69, v65, s49
    v_mfma_f32_16x16x32_bf16 v[220:223], v[96:99], a[72:75], v[220:223]
    s_waitcnt lgkmcnt(10)
    v_exp_f32 v70, v70
    v_mfma_f32_16x16x32_bf16 v[220:223], v[100:103], a[76:79], v[220:223]
    ds_write_addtid_b32 v217 offset:25888
    v_perm_b32 v218, v70, v66, s49
    v_mfma_f32_16x16x32_bf16 v[48:51], a[192:195], v[184:187], v[48:51]
    s_waitcnt lgkmcnt(5)
    v_exp_f32 v71, v71
    v_mfma_f32_16x16x32_bf16 v[48:51], a[200:203], v[188:191], v[48:51]
    ds_write_addtid_b32 v218 offset:32128
    v_perm_b32 v219, v71, v67, s49
    v_mfma_f32_16x16x32_bf16 v[48:51], a[208:211], v[192:195], v[48:51]
    s_waitcnt lgkmcnt(5)
    v_exp_f32 v220, v220
    v_mfma_f32_16x16x32_bf16 v[48:51], a[216:219], v[196:199], v[48:51]
    ds_write_addtid_b32 v219 offset:38304
    ds_read_b128 v[124:127], v0 offset:5376
    v_mfma_f32_16x16x32_bf16 v[68:71], v[88:91], a[80:83], v[252:255]
    s_add_u32 s22, s22, 4096
    v_exp_f32 v221, v221
    v_mfma_f32_16x16x32_bf16 v[68:71], v[92:95], a[84:87], v[68:71]
    v_rcp_f32 v22, v24
    v_mfma_f32_16x16x32_bf16 v[68:71], v[96:99], a[88:91], v[68:71]
    v_exp_f32 v222, v222
    v_mfma_f32_16x16x32_bf16 v[68:71], v[100:103], a[92:95], v[68:71]
    ds_read_b128 v[228:231], v4 offset:2304
    v_bitop3_b32 v17, v17, v22, s29 bitop3:0xe8
    v_mfma_f32_16x16x32_bf16 v[52:55], a[196:199], v[184:187], v[52:55]
    v_exp_f32 v223, v223
    v_mfma_f32_16x16x32_bf16 v[52:55], a[204:207], v[188:191], v[52:55]
    ds_read_b128 v[232:235], v4 offset:2560
    v_mov_b32 v23, v22
    v_mfma_f32_16x16x32_bf16 v[52:55], a[212:215], v[192:195], v[52:55]
    s_waitcnt lgkmcnt(2)
    v_exp_f32 v68, v68
    v_mfma_f32_16x16x32_bf16 v[52:55], a[220:223], v[196:199], v[52:55]
    ds_read_b128 v[236:239], v4 offset:2816
    v_perm_b32 v216, v68, v220, s49
    v_smfmac_f32_16x16x64_bf16 v[40:43], v[36:39], v[120:127], v1
    ds_write_addtid_b32 v216 offset:19968
    ds_read_b128 v[76:79], v6 offset:6144
    v_mfma_f32_16x16x32_bf16 v[64:67], v[88:91], a[96:99], v[252:255]
    v_exp_f32 v69, v69
    v_mfma_f32_16x16x32_bf16 v[64:67], v[92:95], a[100:103], v[64:67]
    ds_read_b128 v[80:83], v7 offset:6144
    v_perm_b32 v217, v69, v221, s49
    v_mfma_f32_16x16x32_bf16 v[64:67], v[96:99], a[104:107], v[64:67]
    v_exp_f32 v70, v70
    v_mfma_f32_16x16x32_bf16 v[64:67], v[100:103], a[108:111], v[64:67]
    ds_write_addtid_b32 v217 offset:26144
    v_perm_b32 v218, v70, v222, s49
    v_mfma_f32_16x16x32_bf16 v[48:51], a[224:227], v[224:227], v[48:51]
    s_waitcnt lgkmcnt(5)
    v_exp_f32 v71, v71
    v_mfma_f32_16x16x32_bf16 v[48:51], a[232:235], v[228:231], v[48:51]
    ds_write_addtid_b32 v218 offset:32384
    v_perm_b32 v219, v71, v223, s49
    v_mfma_f32_16x16x32_bf16 v[48:51], a[240:243], v[232:235], v[48:51]
    s_waitcnt lgkmcnt(5)
    v_exp_f32 v64, v64
    v_mfma_f32_16x16x32_bf16 v[48:51], a[248:251], v[236:239], v[48:51]
    ds_write_addtid_b32 v219 offset:38560
    ds_read_b128 v[128:131], v0 offset:5632
    v_mfma_f32_16x16x32_bf16 v[68:71], v[88:91], a[112:115], v[252:255]
    v_exp_f32 v65, v65
    v_mfma_f32_16x16x32_bf16 v[68:71], v[92:95], a[116:119], v[68:71]
    v_permlane32_swap_b32 v22, v23
    v_mfma_f32_16x16x32_bf16 v[68:71], v[96:99], a[120:123], v[68:71]
    v_exp_f32 v66, v66
    v_mfma_f32_16x16x32_bf16 v[68:71], v[100:103], a[124:127], v[68:71]
    ds_read_b128 v[84:87], v8 offset:6144
    v_mul_f32 v48, v22, v48
    v_mfma_f32_16x16x32_bf16 v[52:55], a[228:231], v[224:227], v[52:55]
    v_exp_f32 v67, v67
    v_mfma_f32_16x16x32_bf16 v[52:55], a[236:239], v[228:231], v[52:55]
    v_mul_f32 v49, v22, v49
L_pad10_b:
    s_cbranch_execz L_hret_b
    v_mul_f32 v50, v22, v50
    v_mfma_f32_16x16x32_bf16 v[52:55], a[244:247], v[232:235], v[52:55]
    v_exp_f32 v68, v68
    v_mfma_f32_16x16x32_bf16 v[52:55], a[252:255], v[236:239], v[52:55]
    s_waitcnt lgkmcnt(5)
    v_mul_f32 v51, v22, v51
    v_perm_b32 v216, v68, v64, s49
    v_cvt_pk_bf16_f32 v28, v48, v49
    v_mfma_f32_16x16x32_bf16 v[220:223], v[72:75], a[0:3], v[252:255]
    ds_write_addtid_b32 v216 offset:20224
    v_exp_f32 v69, v69
    v_mfma_f32_16x16x32_bf16 v[220:223], v[76:79], a[4:7], v[220:223]
    ds_read_b128 v[168:171], v2 offset:3072
    v_perm_b32 v217, v69, v65, s49
    v_mfma_f32_16x16x32_bf16 v[220:223], v[80:83], a[8:11], v[220:223]
    s_waitcnt lgkmcnt(2)
    v_exp_f32 v70, v70
    v_mfma_f32_16x16x32_bf16 v[220:223], v[84:87], a[12:15], v[220:223]
    ds_write_addtid_b32 v217 offset:26400
    v_perm_b32 v218, v70, v66, s49
    v_mfma_f32_16x16x32_bf16 v[56:59], a[128:131], v[152:155], 0
    v_exp_f32 v71, v71
    v_mfma_f32_16x16x32_bf16 v[56:59], a[136:139], v[156:159], v[56:59]
    ds_write_addtid_b32 v218 offset:32640
    v_perm_b32 v219, v71, v67, s49
    v_mfma_f32_16x16x32_bf16 v[56:59], a[144:147], v[160:163], v[56:59]
    v_exp_f32 v220, v220
    v_mfma_f32_16x16x32_bf16 v[56:59], a[152:155], v[164:167], v[56:59]
    ds_write_addtid_b32 v219 offset:38816
    ds_read_b128 v[132:135], v0 offset:5888
    v_mfma_f32_16x16x32_bf16 v[68:71], v[72:75], a[16:19], v[252:255]
    v_exp_f32 v221, v221
    v_mfma_f32_16x16x32_bf16 v[68:71], v[76:79], a[20:23], v[68:71]
    ds_read_b128 v[172:175], v2 offset:3328
    v_mul_f32 v52, v22, v52
    v_mfma_f32_16x16x32_bf16 v[68:71], v[80:83], a[24:27], v[68:71]
    v_exp_f32 v222, v222
    v_mfma_f32_16x16x32_bf16 v[68:71], v[84:87], a[28:31], v[68:71]
    ds_read_b128 v[176:179], v2 offset:3584
    v_mul_f32 v53, v22, v53
    v_mfma_f32_16x16x32_bf16 v[60:63], a[132:135], v[152:155], 0
    v_exp_f32 v223, v223
    v_mfma_f32_16x16x32_bf16 v[60:63], a[140:143], v[156:159], v[60:63]
    ds_read_b128 v[184:187], v3 offset:3072
    v_mul_f32 v54, v22, v54
    v_mfma_f32_16x16x32_bf16 v[60:63], a[148:151], v[160:163], v[60:63]
    s_waitcnt lgkmcnt(3)
    v_exp_f32 v68, v68
    v_mfma_f32_16x16x32_bf16 v[60:63], a[156:159], v[164:167], v[60:63]
    ds_read_b128 v[180:183], v2 offset:3840
    v_perm_b32 v216, v68, v220, s49
    v_smfmac_f32_16x16x64_bf16 v[40:43], v[36:39], v[128:135], v1
    ds_write_addtid_b32 v216 offset:14336
    v_mul_f32 v55, v22, v55
    v_mfma_f32_16x16x32_bf16 v[64:67], v[72:75], a[32:35], v[252:255]
    v_exp_f32 v69, v69
    v_mfma_f32_16x16x32_bf16 v[64:67], v[76:79], a[36:39], v[64:67]
    ds_read_b128 v[188:191], v3 offset:3328
    v_perm_b32 v217, v69, v221, s49
    v_mfma_f32_16x16x32_bf16 v[64:67], v[80:83], a[40:43], v[64:67]
    v_exp_f32 v70, v70
    v_mfma_f32_16x16x32_bf16 v[64:67], v[84:87], a[44:47], v[64:67]
    ds_write_addtid_b32 v217 offset:20512
    v_perm_b32 v218, v70, v222, s49
    v_mfma_f32_16x16x32_bf16 v[56:59], a[160:163], v[168:171], v[56:59]
    s_waitcnt lgkmcnt(5)
    v_exp_f32 v71, v71
    v_mfma_f32_16x16x32_bf16 v[56:59], a[168:171], v[172:175], v[56:59]
    ds_write_addtid_b32 v218 offset:26752
    v_perm_b32 v219, v71, v223, s49
    v_add_f32 v40, v40, v41
    v_mfma_f32_16x16x32_bf16 v[56:59], a[176:179], v[176:179], v[56:59]
    s_waitcnt lgkmcnt(4)
    v_exp_f32 v64, v64
    v_mfma_f32_16x16x32_bf16 v[56:59], a[184:187], v[180:183], v[56:59]
    ds_write_addtid_b32 v219 offset:32928
    ds_read_b128 v[136:139], v0 offset:0
    v_mfma_f32_16x16x32_bf16 v[68:71], v[72:75], a[48:51], v[252:255]
    v_exp_f32 v65, v65
    v_mfma_f32_16x16x32_bf16 v[68:71], v[76:79], a[52:55], v[68:71]
    ds_write_b32 v12, v40 offset:1024
    v_mfma_f32_16x16x32_bf16 v[68:71], v[80:83], a[56:59], v[68:71]
    s_waitcnt vmcnt(6)
    v_exp_f32 v66, v66
    v_mfma_f32_16x16x32_bf16 v[68:71], v[84:87], a[60:63], v[68:71]
    ds_add_u32 v14, v16
    v_mfma_f32_16x16x32_bf16 v[60:63], a[164:167], v[168:171], v[60:63]
    s_add_u32 s24, s24, 1
    v_exp_f32 v67, v67
    v_mfma_f32_16x16x32_bf16 v[60:63], a[172:175], v[172:175], v[60:63]
    ds_read_b128 v[192:195], v3 offset:3584
    v_cvt_pk_bf16_f32 v29, v50, v51
    v_mfma_f32_16x16x32_bf16 v[60:63], a[180:183], v[176:179], v[60:63]
    v_exp_f32 v68, v68
    v_mfma_f32_16x16x32_bf16 v[60:63], a[188:191], v[180:183], v[60:63]
    ds_read_b128 v[196:199], v3 offset:3840
    v_perm_b32 v216, v68, v64, s49
    v_cvt_pk_bf16_f32 v30, v52, v53
    v_mfma_f32_16x16x32_bf16 v[220:223], v[72:75], a[64:67], v[252:255]
    ds_write_addtid_b32 v216 offset:14592
    v_exp_f32 v69, v69
    v_mfma_f32_16x16x32_bf16 v[220:223], v[76:79], a[68:71], v[220:223]
    ds_read_b128 v[224:227], v4 offset:3072
    v_perm_b32 v217, v69, v65, s49
    v_mfma_f32_16x16x32_bf16 v[220:223], v[80:83], a[72:75], v[220:223]
    v_exp_f32 v70, v70
    v_mfma_f32_16x16x32_bf16 v[220:223], v[84:87], a[76:79], v[220:223]
    ds_write_addtid_b32 v217 offset:20768
    v_perm_b32 v218, v70, v66, s49
    v_mfma_f32_16x16x32_bf16 v[56:59], a[192:195], v[184:187], v[56:59]
    s_waitcnt lgkmcnt(4)
    v_exp_f32 v71, v71
    v_mfma_f32_16x16x32_bf16 v[56:59], a[200:203], v[188:191], v[56:59]
    ds_write_addtid_b32 v218 offset:27008
    v_perm_b32 v219, v71, v67, s49
    v_mfma_f32_16x16x32_bf16 v[56:59], a[208:211], v[192:195], v[56:59]
    s_waitcnt lgkmcnt(4)
    v_exp_f32 v220, v220
    v_mfma_f32_16x16x32_bf16 v[56:59], a[216:219], v[196:199], v[56:59]
    ds_write_addtid_b32 v219 offset:33184
    ds_read_b128 v[140:143], v0 offset:256
    v_mfma_f32_16x16x32_bf16 v[68:71], v[72:75], a[80:83], v[252:255]
    v_exp_f32 v221, v221
    v_mfma_f32_16x16x32_bf16 v[68:71], v[76:79], a[84:87], v[68:71]
    ds_read_b128 v[228:231], v4 offset:3328
    v_cvt_pk_bf16_f32 v31, v54, v55
    v_mfma_f32_16x16x32_bf16 v[68:71], v[80:83], a[88:91], v[68:71]
    v_exp_f32 v222, v222
    v_mfma_f32_16x16x32_bf16 v[68:71], v[84:87], a[92:95], v[68:71]
    ds_read_b128 v[232:235], v4 offset:3584
    ds_read_b128 v[88:91], v5 offset:7168
    v_mfma_f32_16x16x32_bf16 v[60:63], a[196:199], v[184:187], v[60:63]
    v_exp_f32 v223, v223
    v_mfma_f32_16x16x32_bf16 v[60:63], a[204:207], v[188:191], v[60:63]
    ds_read_b128 v[92:95], v6 offset:7168
    ds_read_b128 v[96:99], v7 offset:7168
    v_mfma_f32_16x16x32_bf16 v[60:63], a[212:215], v[192:195], v[60:63]
    s_waitcnt lgkmcnt(5)
    v_exp_f32 v68, v68
    v_mfma_f32_16x16x32_bf16 v[60:63], a[220:223], v[196:199], v[60:63]
    ds_read_b128 v[236:239], v4 offset:3840
    v_perm_b32 v216, v68, v220, s49
    v_smfmac_f32_16x16x64_bf16 v[44:47], v[32:35], v[136:143], v1
    ds_write_addtid_b32 v216 offset:14848
    ds_read_b128 v[100:103], v8 offset:7168
    v_mfma_f32_16x16x32_bf16 v[64:67], v[72:75], a[96:99], v[252:255]
    v_exp_f32 v69, v69
    v_mfma_f32_16x16x32_bf16 v[64:67], v[76:79], a[100:103], v[64:67]
    ds_read_b32 v19, v15
    v_perm_b32 v217, v69, v221, s49
    v_mfma_f32_16x16x32_bf16 v[64:67], v[80:83], a[104:107], v[64:67]
    v_exp_f32 v70, v70
    v_mfma_f32_16x16x32_bf16 v[64:67], v[84:87], a[108:111], v[64:67]
    ds_write_addtid_b32 v217 offset:21024
    v_perm_b32 v218, v70, v222, s49
    v_mfma_f32_16x16x32_bf16 v[56:59], a[224:227], v[224:227], v[56:59]
    s_waitcnt lgkmcnt(8)
    v_exp_f32 v71, v71
    v_mfma_f32_16x16x32_bf16 v[56:59], a[232:235], v[228:231], v[56:59]
    ds_write_addtid_b32 v218 offset:27264
    v_perm_b32 v219, v71, v223, s49
    v_mfma_f32_16x16x32_bf16 v[56:59], a[240:243], v[232:235], v[56:59]
    s_waitcnt lgkmcnt(5)
    v_exp_f32 v64, v64
    v_mfma_f32_16x16x32_bf16 v[56:59], a[248:251], v[236:239], v[56:59]
    ds_write_addtid_b32 v219 offset:33440
    ds_read_b128 v[144:147], v0 offset:512
    v_mfma_f32_16x16x32_bf16 v[68:71], v[72:75], a[112:115], v[252:255]
    v_exp_f32 v65, v65
    v_mfma_f32_16x16x32_bf16 v[68:71], v[76:79], a[116:119], v[68:71]
    v_mul_f32 v56, v23, v56
    v_mul_f32 v57, v23, v57
    v_mfma_f32_16x16x32_bf16 v[68:71], v[80:83], a[120:123], v[68:71]
    v_exp_f32 v66, v66
    v_mfma_f32_16x16x32_bf16 v[68:71], v[84:87], a[124:127], v[68:71]
    s_waitcnt lgkmcnt(4)
    v_cmp_gt_u32 vcc, s24, v19
    v_mul_f32 v58, v23, v58
    v_mfma_f32_16x16x32_bf16 v[60:63], a[228:231], v[224:227], v[60:63]
    s_add_u32 m0, s23, 1024
    v_exp_f32 v67, v67
    v_mfma_f32_16x16x32_bf16 v[60:63], a[236:239], v[228:231], v[60:63]
    buffer_store_dwordx4 v[28:31], v11, s[8:11], s22 offen nt
    buffer_load_dwordx4 v10, s[4:7], s22 offen nt lds
    v_mul_f32 v59, v23, v59
    v_mov_b64 v[40:41], 0
    s_cbranch_vccnz L_retry3_b
L_back3_b:
    v_mfma_f32_16x16x32_bf16 v[60:63], a[244:247], v[232:235], v[60:63]
    v_exp_f32 v68, v68
    v_mfma_f32_16x16x32_bf16 v[60:63], a[252:255], v[236:239], v[60:63]
    v_cvt_pk_bf16_f32 v28, v56, v57
    v_perm_b32 v216, v68, v64, s49
    v_cvt_pk_bf16_f32 v29, v58, v59
    v_mfma_f32_16x16x32_bf16 v[220:223], v[88:91], a[0:3], v[252:255]
    ds_write_addtid_b32 v216 offset:14080
    v_exp_f32 v69, v69
    v_mfma_f32_16x16x32_bf16 v[220:223], v[92:95], a[4:7], v[220:223]
    ds_read_b128 v[168:171], v2 offset:4096
    v_perm_b32 v217, v69, v65, s49
    v_mfma_f32_16x16x32_bf16 v[220:223], v[96:99], a[8:11], v[220:223]
    v_exp_f32 v70, v70
    v_mfma_f32_16x16x32_bf16 v[220:223], v[100:103], a[12:15], v[220:223]
    ds_write_addtid_b32 v217 offset:20256
    v_perm_b32 v218, v70, v66, s49
    v_mfma_f32_16x16x32_bf16 v[48:51], a[128:131], v[104:107], 0
    v_exp_f32 v71, v71
    v_mfma_f32_16x16x32_bf16 v[48:51], a[136:139], v[108:111], v[48:51]
    ds_write_addtid_b32 v218 offset:26496
    v_perm_b32 v219, v71, v67, s49
    v_mfma_f32_16x16x32_bf16 v[48:51], a[144:147], v[112:115], v[48:51]
    v_exp_f32 v220, v220
    v_mfma_f32_16x16x32_bf16 v[48:51], a[152:155], v[116:119], v[48:51]
    ds_write_addtid_b32 v219 offset:32672
    ds_read_b128 v[148:151], v0 offset:768
    v_mfma_f32_16x16x32_bf16 v[68:71], v[88:91], a[16:19], v[252:255]
    s_add_u32 s22, s22, 4096
    v_exp_f32 v221, v221
    v_mfma_f32_16x16x32_bf16 v[68:71], v[92:95], a[20:23], v[68:71]
    ds_read_b128 v[172:175], v2 offset:4352
    v_mul_f32 v60, v23, v60
    v_mfma_f32_16x16x32_bf16 v[68:71], v[96:99], a[24:27], v[68:71]
    v_exp_f32 v222, v222
    v_mfma_f32_16x16x32_bf16 v[68:71], v[100:103], a[28:31], v[68:71]
    ds_read_b128 v[176:179], v2 offset:4608
    v_mul_f32 v61, v23, v61
    v_mfma_f32_16x16x32_bf16 v[52:55], a[132:135], v[104:107], 0
    v_exp_f32 v223, v223
    v_mfma_f32_16x16x32_bf16 v[52:55], a[140:143], v[108:111], v[52:55]
    ds_read_b128 v[24:27], v18 offset:1024
    v_mul_f32 v62, v23, v62
    v_mfma_f32_16x16x32_bf16 v[52:55], a[148:151], v[112:115], v[52:55]
    s_waitcnt lgkmcnt(3)
    v_exp_f32 v68, v68
    v_mfma_f32_16x16x32_bf16 v[52:55], a[156:159], v[116:119], v[52:55]
    ds_read_b128 v[180:183], v2 offset:4864
    v_perm_b32 v216, v68, v220, s49
    v_smfmac_f32_16x16x64_bf16 v[44:47], v[32:35], v[144:151], v1
    ds_write_addtid_b32 v216 offset:14336
    v_mul_f32 v63, v23, v63
    v_mfma_f32_16x16x32_bf16 v[64:67], v[88:91], a[32:35], v[252:255]
    v_exp_f32 v69, v69
    v_mfma_f32_16x16x32_bf16 v[64:67], v[92:95], a[36:39], v[64:67]
    ds_read_b128 v[184:187], v3 offset:4096
    v_perm_b32 v217, v69, v221, s49
    v_mfma_f32_16x16x32_bf16 v[64:67], v[96:99], a[40:43], v[64:67]
    v_exp_f32 v70, v70
    v_mfma_f32_16x16x32_bf16 v[64:67], v[100:103], a[44:47], v[64:67]
    ds_write_addtid_b32 v217 offset:20512
    v_perm_b32 v218, v70, v222, s49
    v_mfma_f32_16x16x32_bf16 v[48:51], a[160:163], v[168:171], v[48:51]
    s_waitcnt lgkmcnt(5)
    v_exp_f32 v71, v71
    v_mfma_f32_16x16x32_bf16 v[48:51], a[168:171], v[172:175], v[48:51]
    ds_write_addtid_b32 v218 offset:26752
    v_perm_b32 v219, v71, v223, s49
    v_mfma_f32_16x16x32_bf16 v[48:51], a[176:179], v[176:179], v[48:51]
    s_waitcnt lgkmcnt(4)
    v_exp_f32 v64, v64
    v_mfma_f32_16x16x32_bf16 v[48:51], a[184:187], v[180:183], v[48:51]
    ds_write_addtid_b32 v219 offset:32928
    ds_read_b128 v[152:155], v0 offset:1024
    v_mfma_f32_16x16x32_bf16 v[68:71], v[88:91], a[48:51], v[252:255]
    v_exp_f32 v65, v65
    v_mfma_f32_16x16x32_bf16 v[68:71], v[92:95], a[52:55], v[68:71]
    ds_read_b128 v[188:191], v3 offset:4352
    v_cvt_pk_bf16_f32 v30, v60, v61
    v_mfma_f32_16x16x32_bf16 v[68:71], v[96:99], a[56:59], v[68:71]
    v_exp_f32 v66, v66
    v_mfma_f32_16x16x32_bf16 v[68:71], v[100:103], a[60:63], v[68:71]
    ds_read_b128 v[192:195], v3 offset:4608
    v_cvt_pk_bf16_f32 v31, v62, v63
    v_mfma_f32_16x16x32_bf16 v[52:55], a[164:167], v[168:171], v[52:55]
    s_add_u32 m0, s23, 2048
    v_exp_f32 v67, v67
    v_mfma_f32_16x16x32_bf16 v[52:55], a[172:175], v[172:175], v[52:55]
    buffer_store_dwordx4 v[28:31], v11, s[8:11], s22 offen nt
    buffer_load_dwordx4 v10, s[4:7], s22 offen nt lds
    v_add_f32 v24, v24, v25
    v_add_f32 v26, v26, v27
    v_add_f32 v24, v24, v26
    v_mfma_f32_16x16x32_bf16 v[52:55], a[180:183], v[176:179], v[52:55]
    v_exp_f32 v68, v68
    v_mfma_f32_16x16x32_bf16 v[52:55], a[188:191], v[180:183], v[52:55]
    ds_read_b128 v[196:199], v3 offset:4864
    v_perm_b32 v216, v68, v64, s49
    ds_read_b128 v[72:75], v5 offset:8192
    v_mfma_f32_16x16x32_bf16 v[220:223], v[88:91], a[64:67], v[252:255]
    ds_write_addtid_b32 v216 offset:13568
    v_exp_f32 v69, v69
    v_mfma_f32_16x16x32_bf16 v[220:223], v[92:95], a[68:71], v[220:223]
    ds_read_b128 v[224:227], v4 offset:4096
    v_perm_b32 v217, v69, v65, s49
    v_mfma_f32_16x16x32_bf16 v[220:223], v[96:99], a[72:75], v[220:223]
    s_waitcnt lgkmcnt(10)
    v_exp_f32 v70, v70
    v_mfma_f32_16x16x32_bf16 v[220:223], v[100:103], a[76:79], v[220:223]
    ds_write_addtid_b32 v217 offset:19744
    v_perm_b32 v218, v70, v66, s49
    v_mfma_f32_16x16x32_bf16 v[48:51], a[192:195], v[184:187], v[48:51]
    s_waitcnt lgkmcnt(5)
    v_exp_f32 v71, v71
    v_mfma_f32_16x16x32_bf16 v[48:51], a[200:203], v[188:191], v[48:51]
    ds_write_addtid_b32 v218 offset:25984
    v_perm_b32 v219, v71, v67, s49
    v_mfma_f32_16x16x32_bf16 v[48:51], a[208:211], v[192:195], v[48:51]
    s_waitcnt lgkmcnt(5)
    v_exp_f32 v220, v220
    v_mfma_f32_16x16x32_bf16 v[48:51], a[216:219], v[196:199], v[48:51]
    ds_write_addtid_b32 v219 offset:32160
    ds_read_b128 v[156:159], v0 offset:1280
    v_mfma_f32_16x16x32_bf16 v[68:71], v[88:91], a[80:83], v[252:255]
    s_add_u32 s22, s22, 4096
    v_exp_f32 v221, v221
    v_mfma_f32_16x16x32_bf16 v[68:71], v[92:95], a[84:87], v[68:71]
    v_rcp_f32 v20, v24
    v_mfma_f32_16x16x32_bf16 v[68:71], v[96:99], a[88:91], v[68:71]
    v_exp_f32 v222, v222
    v_mfma_f32_16x16x32_bf16 v[68:71], v[100:103], a[92:95], v[68:71]
    ds_read_b128 v[228:231], v4 offset:4352
    v_bitop3_b32 v17, v17, v20, s29 bitop3:0xe8
    v_mfma_f32_16x16x32_bf16 v[52:55], a[196:199], v[184:187], v[52:55]
    v_exp_f32 v223, v223
    v_mfma_f32_16x16x32_bf16 v[52:55], a[204:207], v[188:191], v[52:55]
    ds_read_b128 v[232:235], v4 offset:4608
    v_mov_b32 v21, v20
    v_mfma_f32_16x16x32_bf16 v[52:55], a[212:215], v[192:195], v[52:55]
    s_waitcnt lgkmcnt(2)
    v_exp_f32 v68, v68
    v_mfma_f32_16x16x32_bf16 v[52:55], a[220:223], v[196:199], v[52:55]
    ds_read_b128 v[236:239], v4 offset:4864
    v_perm_b32 v216, v68, v220, s49
    v_smfmac_f32_16x16x64_bf16 v[44:47], v[36:39], v[152:159], v1
    ds_write_addtid_b32 v216 offset:13824
    ds_read_b128 v[76:79], v6 offset:8192
    v_mfma_f32_16x16x32_bf16 v[64:67], v[88:91], a[96:99], v[252:255]
    v_exp_f32 v69, v69
    v_mfma_f32_16x16x32_bf16 v[64:67], v[92:95], a[100:103], v[64:67]
    ds_read_b128 v[80:83], v7 offset:8192
    v_perm_b32 v217, v69, v221, s49
    v_mfma_f32_16x16x32_bf16 v[64:67], v[96:99], a[104:107], v[64:67]
    v_exp_f32 v70, v70
    v_mfma_f32_16x16x32_bf16 v[64:67], v[100:103], a[108:111], v[64:67]
    ds_write_addtid_b32 v217 offset:20000
    v_perm_b32 v218, v70, v222, s49
    v_mfma_f32_16x16x32_bf16 v[48:51], a[224:227], v[224:227], v[48:51]
    s_waitcnt lgkmcnt(5)
    v_exp_f32 v71, v71
    v_mfma_f32_16x16x32_bf16 v[48:51], a[232:235], v[228:231], v[48:51]
    ds_write_addtid_b32 v218 offset:26240
    v_perm_b32 v219, v71, v223, s49
    v_mfma_f32_16x16x32_bf16 v[48:51], a[240:243], v[232:235], v[48:51]
    s_waitcnt lgkmcnt(5)
    v_exp_f32 v64, v64
    v_mfma_f32_16x16x32_bf16 v[48:51], a[248:251], v[236:239], v[48:51]
    ds_write_addtid_b32 v219 offset:32416
    ds_read_b128 v[160:163], v0 offset:1536
    v_mfma_f32_16x16x32_bf16 v[68:71], v[88:91], a[112:115], v[252:255]
    v_exp_f32 v65, v65
    v_mfma_f32_16x16x32_bf16 v[68:71], v[92:95], a[116:119], v[68:71]
    v_permlane32_swap_b32 v20, v21
    v_mfma_f32_16x16x32_bf16 v[68:71], v[96:99], a[120:123], v[68:71]
    v_exp_f32 v66, v66
    v_mfma_f32_16x16x32_bf16 v[68:71], v[100:103], a[124:127], v[68:71]
    ds_read_b128 v[84:87], v8 offset:8192
    v_mul_f32 v48, v20, v48
    v_mfma_f32_16x16x32_bf16 v[52:55], a[228:231], v[224:227], v[52:55]
    v_exp_f32 v67, v67
    v_mfma_f32_16x16x32_bf16 v[52:55], a[236:239], v[228:231], v[52:55]
    s_waitcnt lgkmcnt(5)
    v_mul_f32 v49, v20, v49
    v_mul_f32 v50, v20, v50
    v_mfma_f32_16x16x32_bf16 v[52:55], a[244:247], v[232:235], v[52:55]
    s_add_u32 s25, s25, 1
    v_exp_f32 v68, v68
    v_mfma_f32_16x16x32_bf16 v[52:55], a[252:255], v[236:239], v[52:55]
    v_mul_f32 v51, v20, v51
    v_perm_b32 v216, v68, v64, s49
    v_cvt_pk_bf16_f32 v28, v48, v49
    s_cbranch_scc0 L_loop_b
    ds_add_u32 v14, v16
    ds_write_addtid_b32 v216 offset:14080
    ds_read_b128 v[168:171], v2 offset:5120
    ds_read_b128 v[172:175], v2 offset:5376
    v_exp_f32 v69, v69
    v_mfma_f32_16x16x32_bf16 v[56:59], a[128:131], v[120:123], 0
    ds_read_b128 v[176:179], v2 offset:5632
    v_perm_b32 v217, v69, v65, s49
    v_exp_f32 v70, v70
    v_mfma_f32_16x16x32_bf16 v[56:59], a[136:139], v[124:127], v[56:59]
    ds_write_addtid_b32 v217 offset:20256
    v_perm_b32 v218, v70, v66, s49
    v_exp_f32 v71, v71
    v_mfma_f32_16x16x32_bf16 v[56:59], a[144:147], v[128:131], v[56:59]
    ds_write_addtid_b32 v218 offset:26496
    v_perm_b32 v219, v71, v67, s49
    v_mfma_f32_16x16x32_bf16 v[56:59], a[152:155], v[132:135], v[56:59]
    ds_write_addtid_b32 v219 offset:32672
    ds_read_b128 v[164:167], v0 offset:1792
    v_mfma_f32_16x16x32_bf16 v[60:63], a[132:135], v[120:123], 0
    s_add_u32 s24, s24, 1
    ds_read_b128 v[180:183], v2 offset:5888
    v_mul_f32 v52, v20, v52
    v_mfma_f32_16x16x32_bf16 v[60:63], a[140:143], v[124:127], v[60:63]
    ds_read_b128 v[184:187], v3 offset:5120
    v_mul_f32 v53, v20, v53
    v_mfma_f32_16x16x32_bf16 v[60:63], a[148:151], v[128:131], v[60:63]
    ds_read_b128 v[188:191], v3 offset:5376
    v_mul_f32 v54, v20, v54
    v_mfma_f32_16x16x32_bf16 v[60:63], a[156:159], v[132:135], v[60:63]
    s_waitcnt lgkmcnt(9)
    ds_read_b128 v[192:195], v3 offset:5632
    v_mul_f32 v55, v20, v55
    v_mfma_f32_16x16x32_bf16 v[56:59], a[160:163], v[168:171], v[56:59]
    s_waitcnt lgkmcnt(9)
    ds_read_b128 v[196:199], v3 offset:5888
    v_cvt_pk_bf16_f32 v29, v50, v51
    v_mfma_f32_16x16x32_bf16 v[56:59], a[168:171], v[172:175], v[56:59]
    s_waitcnt lgkmcnt(9)
    ds_read_b128 v[72:75], v4 offset:5120
    v_cvt_pk_bf16_f32 v30, v52, v53
    v_mfma_f32_16x16x32_bf16 v[56:59], a[176:179], v[176:179], v[56:59]
    s_waitcnt lgkmcnt(5)
    ds_read_b128 v[76:79], v4 offset:5376
    v_cvt_pk_bf16_f32 v31, v54, v55
    v_smfmac_f32_16x16x64_bf16 v[44:47], v[36:39], v[160:167], v1
    v_mfma_f32_16x16x32_bf16 v[56:59], a[184:187], v[180:183], v[56:59]
    ds_read_b128 v[80:83], v4 offset:5632
    v_mfma_f32_16x16x32_bf16 v[60:63], a[164:167], v[168:171], v[60:63]
    ds_read_b128 v[84:87], v4 offset:5888
    v_mfma_f32_16x16x32_bf16 v[60:63], a[172:175], v[172:175], v[60:63]
    v_add_f32 v44, v44, v45
    v_mfma_f32_16x16x32_bf16 v[60:63], a[180:183], v[176:179], v[60:63]
    ds_write_b32 v12, v44 offset:0
    ds_add_u32 v14, v16
    v_mfma_f32_16x16x32_bf16 v[60:63], a[188:191], v[180:183], v[60:63]
    s_waitcnt lgkmcnt(9)
    ds_read_b32 v19, v15
    buffer_store_dwordx4 v[28:31], v11, s[8:11], s22 offen nt
    s_add_u32 s22, s22, 4096
    v_mfma_f32_16x16x32_bf16 v[56:59], a[192:195], v[184:187], v[56:59]
    s_waitcnt lgkmcnt(9)
    v_mfma_f32_16x16x32_bf16 v[56:59], a[200:203], v[188:191], v[56:59]
    s_waitcnt lgkmcnt(8)
    v_mfma_f32_16x16x32_bf16 v[56:59], a[208:211], v[192:195], v[56:59]
    s_waitcnt lgkmcnt(7)
    v_mfma_f32_16x16x32_bf16 v[56:59], a[216:219], v[196:199], v[56:59]
    v_mfma_f32_16x16x32_bf16 v[60:63], a[196:199], v[184:187], v[60:63]
    s_waitcnt lgkmcnt(0)
    v_cmp_gt_u32 vcc, s24, v19
    v_mfma_f32_16x16x32_bf16 v[60:63], a[204:207], v[188:191], v[60:63]
    s_cbranch_vccnz L_retry189_b
L_back189_b:
    v_mfma_f32_16x16x32_bf16 v[60:63], a[212:215], v[192:195], v[60:63]
    ds_read_b128 v[88:91], v2 offset:0
    v_mfma_f32_16x16x32_bf16 v[60:63], a[220:223], v[196:199], v[60:63]
    ds_read_b128 v[92:95], v2 offset:256
    v_mfma_f32_16x16x32_bf16 v[56:59], a[224:227], v[72:75], v[56:59]
    ds_read_b128 v[96:99], v2 offset:512
    v_mfma_f32_16x16x32_bf16 v[56:59], a[232:235], v[76:79], v[56:59]
    ds_read_b128 v[100:103], v2 offset:768
    v_mfma_f32_16x16x32_bf16 v[56:59], a[240:243], v[80:83], v[56:59]
    ds_read_b128 v[168:171], v3 offset:0
    v_mfma_f32_16x16x32_bf16 v[56:59], a[248:251], v[84:87], v[56:59]
    ds_read_b128 v[172:175], v3 offset:256
    v_mfma_f32_16x16x32_bf16 v[60:63], a[228:231], v[72:75], v[60:63]
    ds_read_b128 v[176:179], v3 offset:512
    v_mfma_f32_16x16x32_bf16 v[60:63], a[236:239], v[76:79], v[60:63]
    ds_read_b128 v[180:183], v3 offset:768
    v_mfma_f32_16x16x32_bf16 v[60:63], a[244:247], v[80:83], v[60:63]
    ds_read_b128 v[184:187], v4 offset:0
    v_mfma_f32_16x16x32_bf16 v[60:63], a[252:255], v[84:87], v[60:63]
    ds_read_b128 v[188:191], v4 offset:256
    v_mfma_f32_16x16x32_bf16 v[48:51], a[128:131], v[136:139], 0
    ds_read_b128 v[192:195], v4 offset:512
    v_mfma_f32_16x16x32_bf16 v[48:51], a[136:139], v[140:143], v[48:51]
    ds_read_b128 v[196:199], v4 offset:768
    v_mfma_f32_16x16x32_bf16 v[48:51], a[144:147], v[144:147], v[48:51]
    v_mul_f32 v56, v21, v56
    v_mfma_f32_16x16x32_bf16 v[48:51], a[152:155], v[148:151], v[48:51]
    v_mul_f32 v57, v21, v57
    v_mfma_f32_16x16x32_bf16 v[52:55], a[132:135], v[136:139], 0
    v_mul_f32 v58, v21, v58
    v_mfma_f32_16x16x32_bf16 v[52:55], a[140:143], v[140:143], v[52:55]
    v_mul_f32 v59, v21, v59
    v_mfma_f32_16x16x32_bf16 v[52:55], a[148:151], v[144:147], v[52:55]
    s_add_u32 s24, s24, 1
    ds_read_b32 v19, v15
    v_mul_f32 v60, v21, v60
    v_mfma_f32_16x16x32_bf16 v[52:55], a[156:159], v[148:151], v[52:55]
    s_waitcnt lgkmcnt(12)
    v_mul_f32 v61, v21, v61
    v_mfma_f32_16x16x32_bf16 v[48:51], a[160:163], v[88:91], v[48:51]
    s_waitcnt lgkmcnt(11)
    v_mul_f32 v62, v21, v62
    v_mfma_f32_16x16x32_bf16 v[48:51], a[168:171], v[92:95], v[48:51]
    s_waitcnt lgkmcnt(10)
    v_mul_f32 v63, v21, v63
    v_mfma_f32_16x16x32_bf16 v[48:51], a[176:179], v[96:99], v[48:51]
    s_waitcnt lgkmcnt(9)
    v_cvt_pk_bf16_f32 v28, v56, v57
    v_mfma_f32_16x16x32_bf16 v[48:51], a[184:187], v[100:103], v[48:51]
    s_waitcnt lgkmcnt(0)
    v_cmp_gt_u32 vcc, s24, v19
    v_cvt_pk_bf16_f32 v29, v58, v59
    v_mfma_f32_16x16x32_bf16 v[52:55], a[164:167], v[88:91], v[52:55]
    s_cbranch_vccnz L_retry191_b
L_back191_b:
    v_cvt_pk_bf16_f32 v30, v60, v61
    v_mfma_f32_16x16x32_bf16 v[52:55], a[172:175], v[92:95], v[52:55]
    ds_read_b128 v[24:27], v18 offset:0
    v_cvt_pk_bf16_f32 v31, v62, v63
    v_mfma_f32_16x16x32_bf16 v[52:55], a[180:183], v[96:99], v[52:55]
    ds_read_b128 v[72:75], v2 offset:1024
    v_mfma_f32_16x16x32_bf16 v[52:55], a[188:191], v[100:103], v[52:55]
    ds_read_b128 v[76:79], v2 offset:1280
    buffer_store_dwordx4 v[28:31], v11, s[8:11], s22 offen nt
    s_add_u32 s22, s22, 4096
    v_mfma_f32_16x16x32_bf16 v[48:51], a[192:195], v[168:171], v[48:51]
    ds_read_b128 v[80:83], v2 offset:1536
    v_mfma_f32_16x16x32_bf16 v[48:51], a[200:203], v[172:175], v[48:51]
    ds_read_b128 v[84:87], v2 offset:1792
    v_mfma_f32_16x16x32_bf16 v[48:51], a[208:211], v[176:179], v[48:51]
    ds_read_b128 v[88:91], v3 offset:1024
    v_mfma_f32_16x16x32_bf16 v[48:51], a[216:219], v[180:183], v[48:51]
    ds_read_b128 v[92:95], v3 offset:1280
    v_mfma_f32_16x16x32_bf16 v[52:55], a[196:199], v[168:171], v[52:55]
    ds_read_b128 v[96:99], v3 offset:1536
    v_mfma_f32_16x16x32_bf16 v[52:55], a[204:207], v[172:175], v[52:55]
    s_waitcnt lgkmcnt(7)
    ds_read_b128 v[100:103], v3 offset:1792
    v_add_f32 v24, v24, v25
    v_add_f32 v26, v26, v27
    v_mfma_f32_16x16x32_bf16 v[52:55], a[212:215], v[176:179], v[52:55]
    v_add_f32 v24, v24, v26
    v_mfma_f32_16x16x32_bf16 v[52:55], a[220:223], v[180:183], v[52:55]
    v_mfma_f32_16x16x32_bf16 v[48:51], a[224:227], v[184:187], v[48:51]
    ds_read_b128 v[168:171], v4 offset:1024
    v_rcp_f32 v22, v24
    v_mfma_f32_16x16x32_bf16 v[48:51], a[232:235], v[188:191], v[48:51]
    ds_read_b128 v[172:175], v4 offset:1280
    v_mfma_f32_16x16x32_bf16 v[48:51], a[240:243], v[192:195], v[48:51]
    ds_read_b128 v[176:179], v4 offset:1536
    v_bitop3_b32 v17, v17, v22, s29 bitop3:0xe8
    v_mov_b32 v23, v22
    v_mfma_f32_16x16x32_bf16 v[48:51], a[248:251], v[196:199], v[48:51]
    ds_read_b128 v[180:183], v4 offset:1792
    v_mfma_f32_16x16x32_bf16 v[52:55], a[228:231], v[184:187], v[52:55]
    v_mfma_f32_16x16x32_bf16 v[52:55], a[236:239], v[188:191], v[52:55]
    v_mfma_f32_16x16x32_bf16 v[52:55], a[244:247], v[192:195], v[52:55]
    v_permlane32_swap_b32 v22, v23
    v_mfma_f32_16x16x32_bf16 v[52:55], a[252:255], v[196:199], v[52:55]
    v_mfma_f32_16x16x32_bf16 v[56:59], a[128:131], v[152:155], 0
    v_mfma_f32_16x16x32_bf16 v[56:59], a[136:139], v[156:159], v[56:59]
    v_mfma_f32_16x16x32_bf16 v[56:59], a[144:147], v[160:163], v[56:59]
    v_mul_f32 v48, v22, v48
    v_mfma_f32_16x16x32_bf16 v[56:59], a[152:155], v[164:167], v[56:59]
    v_mul_f32 v49, v22, v49
    v_mfma_f32_16x16x32_bf16 v[60:63], a[132:135], v[152:155], 0
    v_mul_f32 v50, v22, v50
    v_mfma_f32_16x16x32_bf16 v[60:63], a[140:143], v[156:159], v[60:63]
    v_mul_f32 v51, v22, v51
    v_mfma_f32_16x16x32_bf16 v[60:63], a[148:151], v[160:163], v[60:63]
    v_mul_f32 v52, v22, v52
    v_mfma_f32_16x16x32_bf16 v[60:63], a[156:159], v[164:167], v[60:63]
    s_waitcnt lgkmcnt(11)
    v_mul_f32 v53, v22, v53
    v_mfma_f32_16x16x32_bf16 v[56:59], a[160:163], v[72:75], v[56:59]
    s_waitcnt lgkmcnt(10)
    v_mul_f32 v54, v22, v54
    v_mfma_f32_16x16x32_bf16 v[56:59], a[168:171], v[76:79], v[56:59]
    s_waitcnt lgkmcnt(9)
    v_mul_f32 v55, v22, v55
    v_mfma_f32_16x16x32_bf16 v[56:59], a[176:179], v[80:83], v[56:59]
    s_waitcnt lgkmcnt(8)
    v_cvt_pk_bf16_f32 v28, v48, v49
    v_mfma_f32_16x16x32_bf16 v[56:59], a[184:187], v[84:87], v[56:59]
    v_cvt_pk_bf16_f32 v29, v50, v51
    v_mfma_f32_16x16x32_bf16 v[60:63], a[164:167], v[72:75], v[60:63]
    v_cvt_pk_bf16_f32 v30, v52, v53
    v_mfma_f32_16x16x32_bf16 v[60:63], a[172:175], v[76:79], v[60:63]
    v_cvt_pk_bf16_f32 v31, v54, v55
    v_mfma_f32_16x16x32_bf16 v[60:63], a[180:183], v[80:83], v[60:63]
    v_mfma_f32_16x16x32_bf16 v[60:63], a[188:191], v[84:87], v[60:63]
    s_waitcnt lgkmcnt(7)
    buffer_store_dwordx4 v[28:31], v11, s[8:11], s22 offen nt
    s_add_u32 s22, s22, 4096
    v_mfma_f32_16x16x32_bf16 v[56:59], a[192:195], v[88:91], v[56:59]
    s_waitcnt lgkmcnt(6)
    v_mfma_f32_16x16x32_bf16 v[56:59], a[200:203], v[92:95], v[56:59]
    s_waitcnt lgkmcnt(5)
    v_mfma_f32_16x16x32_bf16 v[56:59], a[208:211], v[96:99], v[56:59]
    s_waitcnt lgkmcnt(4)
    v_mfma_f32_16x16x32_bf16 v[56:59], a[216:219], v[100:103], v[56:59]
    v_mfma_f32_16x16x32_bf16 v[60:63], a[196:199], v[88:91], v[60:63]
    v_mfma_f32_16x16x32_bf16 v[60:63], a[204:207], v[92:95], v[60:63]
    v_mfma_f32_16x16x32_bf16 v[60:63], a[212:215], v[96:99], v[60:63]
    v_mfma_f32_16x16x32_bf16 v[60:63], a[220:223], v[100:103], v[60:63]
    s_waitcnt lgkmcnt(3)
    v_mfma_f32_16x16x32_bf16 v[56:59], a[224:227], v[168:171], v[56:59]
    s_waitcnt lgkmcnt(2)
    v_mfma_f32_16x16x32_bf16 v[56:59], a[232:235], v[172:175], v[56:59]
    s_waitcnt lgkmcnt(1)
    v_mfma_f32_16x16x32_bf16 v[56:59], a[240:243], v[176:179], v[56:59]
    s_waitcnt lgkmcnt(0)
L_pad11_b:
    s_cbranch_execz L_hret_b
    v_mfma_f32_16x16x32_bf16 v[56:59], a[248:251], v[180:183], v[56:59]
    v_mfma_f32_16x16x32_bf16 v[60:63], a[228:231], v[168:171], v[60:63]
    v_mfma_f32_16x16x32_bf16 v[60:63], a[236:239], v[172:175], v[60:63]
    v_mul_f32 v56, v23, v56
    v_mul_f32 v57, v23, v57
    v_mfma_f32_16x16x32_bf16 v[60:63], a[244:247], v[176:179], v[60:63]
    v_mul_f32 v58, v23, v58
    v_mul_f32 v59, v23, v59
    v_mfma_f32_16x16x32_bf16 v[60:63], a[252:255], v[180:183], v[60:63]
    v_cvt_pk_bf16_f32 v28, v56, v57
    v_cvt_pk_bf16_f32 v29, v58, v59
    s_nop 5
    v_mul_f32 v60, v23, v60
    v_mul_f32 v61, v23, v61
    v_mul_f32 v62, v23, v62
    v_mul_f32 v63, v23, v63
    v_cvt_pk_bf16_f32 v30, v60, v61
    v_cvt_pk_bf16_f32 v31, v62, v63
    buffer_store_dwordx4 v[28:31], v11, s[8:11], s22 offen nt
    s_add_u32 s22, s22, 4096
    v_and_b32 v17, 0x60000000, v17
    v_cmp_ne_u32 vcc, 0x40000000, v17
    s_nop 1
    s_cbranch_vccnz L_slow_b
L_end_b:
    s_endpgm
L_retry1_b:
    ds_read_b32 v19, v15
    s_waitcnt lgkmcnt(0)
    v_cmp_gt_u32 vcc, s24, v19
    s_cbranch_vccnz L_retry1_b
    s_branch L_back1_b
L_retry101_b:
    ds_read_b32 v19, v15
    s_waitcnt lgkmcnt(0)
    v_cmp_gt_u32 vcc, s24, v19
    s_cbranch_vccnz L_retry101_b
    s_branch L_back101_b
L_retry103_b:
    ds_read_b32 v19, v15
    s_waitcnt lgkmcnt(0)
    v_cmp_gt_u32 vcc, s24, v19
    s_cbranch_vccnz L_retry103_b
    s_branch L_back103_b
L_retry105_b:
    ds_read_b32 v19, v15
    s_waitcnt lgkmcnt(0)
    v_cmp_gt_u32 vcc, s24, v19
    s_cbranch_vccnz L_retry105_b
    s_branch L_back105_b
L_retry107_b:
    ds_read_b32 v19, v15
    s_waitcnt lgkmcnt(0)
    v_cmp_gt_u32 vcc, s24, v19
    s_cbranch_vccnz L_retry107_b
    s_branch L_back107_b
L_retry109_b:
    ds_read_b32 v19, v15
    s_waitcnt lgkmcnt(0)
    v_cmp_gt_u32 vcc, s24, v19
    s_cbranch_vccnz L_retry109_b
    s_branch L_back109_b
L_retry11_b:
    ds_read_b32 v19, v15
    s_waitcnt lgkmcnt(0)
    v_cmp_gt_u32 vcc, s24, v19
    s_cbranch_vccnz L_retry11_b
    s_branch L_back11_b
L_retry111_b:
    ds_read_b32 v19, v15
    s_waitcnt lgkmcnt(0)
    v_cmp_gt_u32 vcc, s24, v19
    s_cbranch_vccnz L_retry111_b
    s_branch L_back111_b
L_retry113_b:
    ds_read_b32 v19, v15
    s_waitcnt lgkmcnt(0)
    v_cmp_gt_u32 vcc, s24, v19
    s_cbranch_vccnz L_retry113_b
    s_branch L_back113_b
L_retry115_b:
    ds_read_b32 v19, v15
    s_waitcnt lgkmcnt(0)
    v_cmp_gt_u32 vcc, s24, v19
    s_cbranch_vccnz L_retry115_b
    s_branch L_back115_b
L_retry189_b:
    ds_read_b32 v19, v15
    s_waitcnt lgkmcnt(0)
    v_cmp_gt_u32 vcc, s24, v19
    s_cbranch_vccnz L_retry189_b
    s_branch L_back189_b
L_retry191_b:
    ds_read_b32 v19, v15
    s_waitcnt lgkmcnt(0)
    v_cmp_gt_u32 vcc, s24, v19
    s_cbranch_vccnz L_retry191_b
    s_branch L_back191_b
L_retry3_b:
    ds_read_b32 v19, v15
    s_waitcnt lgkmcnt(0)
    v_cmp_gt_u32 vcc, s24, v19
    s_cbranch_vccnz L_retry3_b
    s_branch L_back3_b
L_retry5_b:
    ds_read_b32 v19, v15
    s_waitcnt lgkmcnt(0)
    v_cmp_gt_u32 vcc, s24, v19
    s_cbranch_vccnz L_retry5_b
    s_branch L_back5_b
L_retry7_b:
    ds_read_b32 v19, v15
    s_waitcnt lgkmcnt(0)
    v_cmp_gt_u32 vcc, s24, v19
    s_cbranch_vccnz L_retry7_b
    s_branch L_back7_b
L_retry9_b:
    ds_read_b32 v19, v15
    s_waitcnt lgkmcnt(0)
    v_cmp_gt_u32 vcc, s24, v19
    s_cbranch_vccnz L_retry9_b
    s_branch L_back9_b
L_retry97_b:
    ds_read_b32 v19, v15
    s_waitcnt lgkmcnt(0)
    v_cmp_gt_u32 vcc, s24, v19
    s_cbranch_vccnz L_retry97_b
    s_branch L_back97_b
L_retry99_b:
    ds_read_b32 v19, v15
    s_waitcnt lgkmcnt(0)
    v_cmp_gt_u32 vcc, s24, v19
    s_cbranch_vccnz L_retry99_b
    s_branch L_back99_b
L_last_b:
L_slow_b:
    s_waitcnt vmcnt(0) lgkmcnt(0)
    s_barrier
    v_mbcnt_lo_u32_b32 v21, -1, 0
    v_mbcnt_hi_u32_b32 v21, -1, v21
    v_lshrrev_b32 v22, 4, v21
    v_and_b32 v23, 15, v21
    v_lshlrev_b32 v240, 8, v23
    v_lshl_add_u32 v240, v22, 4, v240
    v_lshlrev_b32 v242, 6, v23
    s_lshl_b32 s26, s20, 4
    v_lshl_add_u32 v241, v22, 2, v242
    v_add_u32 v241, s26, v241
    s_mov_b32 s21, 0
    s_mov_b32 s22, 0
    s_mov_b32 s38, 0xffff0000
    s_xor_b32 s26, s20, 0
    s_lshl_b32 s26, s26, 13
    s_add_u32 s26, s26, 57344
    v_lshl_add_u32 v1, v21, 4, s26
    s_xor_b32 s26, s20, 1
    s_lshl_b32 s26, s26, 13
    s_add_u32 s26, s26, 57344
    v_lshl_add_u32 v2, v21, 4, s26
    s_and_b32 s26, s20, 2
    s_xor_b32 s26, s26, 2
    s_lshl_b32 s26, s26, 13
    s_add_u32 s26, s26, 57344
    v_lshl_add_u32 v3, v21, 4, s26
    s_and_b32 s26, s20, 2
    s_xor_b32 s26, s26, 3
    s_lshl_b32 s26, s26, 13
    s_add_u32 s26, s26, 57344
    v_lshl_add_u32 v4, v21, 4, s26
    s_xor_b32 s27, s56, 0
    buffer_load_dwordx4 a[0:3], v240, s[12:15], s27 offen offset:0
    s_xor_b32 s27, s56, 0
    buffer_load_dwordx4 a[4:7], v240, s[12:15], s27 offen offset:64
    s_xor_b32 s27, s56, 0
    buffer_load_dwordx4 a[8:11], v240, s[12:15], s27 offen offset:128
    s_xor_b32 s27, s56, 0
    buffer_load_dwordx4 a[12:15], v240, s[12:15], s27 offen offset:192
    s_xor_b32 s27, s56, 4096
    buffer_load_dwordx4 a[16:19], v240, s[12:15], s27 offen offset:0
    s_xor_b32 s27, s56, 4096
    buffer_load_dwordx4 a[20:23], v240, s[12:15], s27 offen offset:64
    s_xor_b32 s27, s56, 4096
    buffer_load_dwordx4 a[24:27], v240, s[12:15], s27 offen offset:128
    s_xor_b32 s27, s56, 4096
    buffer_load_dwordx4 a[28:31], v240, s[12:15], s27 offen offset:192
    s_xor_b32 s27, s56, 8192
    buffer_load_dwordx4 a[32:35], v240, s[12:15], s27 offen offset:0
    s_xor_b32 s27, s56, 8192
    buffer_load_dwordx4 a[36:39], v240, s[12:15], s27 offen offset:64
    s_xor_b32 s27, s56, 8192
    buffer_load_dwordx4 a[40:43], v240, s[12:15], s27 offen offset:128
    s_xor_b32 s27, s56, 8192
    buffer_load_dwordx4 a[44:47], v240, s[12:15], s27 offen offset:192
    s_xor_b32 s27, s56, 12288
    buffer_load_dwordx4 a[48:51], v240, s[12:15], s27 offen offset:0
    s_xor_b32 s27, s56, 12288
    buffer_load_dwordx4 a[52:55], v240, s[12:15], s27 offen offset:64
    s_xor_b32 s27, s56, 12288
    buffer_load_dwordx4 a[56:59], v240, s[12:15], s27 offen offset:128
    s_xor_b32 s27, s56, 12288
    buffer_load_dwordx4 a[60:63], v240, s[12:15], s27 offen offset:192
    s_xor_b32 s27, s56, 16384
    buffer_load_dwordx4 a[64:67], v240, s[12:15], s27 offen offset:0
    s_xor_b32 s27, s56, 16384
    buffer_load_dwordx4 a[68:71], v240, s[12:15], s27 offen offset:64
    s_xor_b32 s27, s56, 16384
    buffer_load_dwordx4 a[72:75], v240, s[12:15], s27 offen offset:128
    s_xor_b32 s27, s56, 16384
    buffer_load_dwordx4 a[76:79], v240, s[12:15], s27 offen offset:192
    s_xor_b32 s27, s56, 20480
    buffer_load_dwordx4 a[80:83], v240, s[12:15], s27 offen offset:0
    s_xor_b32 s27, s56, 20480
    buffer_load_dwordx4 a[84:87], v240, s[12:15], s27 offen offset:64
    s_xor_b32 s27, s56, 20480
    buffer_load_dwordx4 a[88:91], v240, s[12:15], s27 offen offset:128
    s_xor_b32 s27, s56, 20480
    buffer_load_dwordx4 a[92:95], v240, s[12:15], s27 offen offset:192
    s_xor_b32 s27, s56, 24576
    buffer_load_dwordx4 a[96:99], v240, s[12:15], s27 offen offset:0
    s_xor_b32 s27, s56, 24576
    buffer_load_dwordx4 a[100:103], v240, s[12:15], s27 offen offset:64
    s_xor_b32 s27, s56, 24576
    buffer_load_dwordx4 a[104:107], v240, s[12:15], s27 offen offset:128
    s_xor_b32 s27, s56, 24576
    buffer_load_dwordx4 a[108:111], v240, s[12:15], s27 offen offset:192
    s_xor_b32 s27, s56, 28672
    buffer_load_dwordx4 a[112:115], v240, s[12:15], s27 offen offset:0
    s_xor_b32 s27, s56, 28672
    buffer_load_dwordx4 a[116:119], v240, s[12:15], s27 offen offset:64
    s_xor_b32 s27, s56, 28672
    buffer_load_dwordx4 a[120:123], v240, s[12:15], s27 offen offset:128
    s_xor_b32 s27, s56, 28672
    buffer_load_dwordx4 a[124:127], v240, s[12:15], s27 offen offset:192
    s_waitcnt vmcnt(31)
    v_accvgpr_read_b32 v26, a0
    v_accvgpr_read_b32 v27, a1
    v_lshlrev_b32 v24, 16, v26
    v_lshlrev_b32 v28, 16, v27
    v_and_b32 v25, s38, v26
    v_and_b32 v29, s38, v27
    v_pk_mul_f32 v[24:25], v[24:25], s[36:37]
    v_pk_mul_f32 v[28:29], v[28:29], s[36:37]
    v_cvt_pk_bf16_f32 v24, v24, v25
    v_cvt_pk_bf16_f32 v28, v28, v29
    v_accvgpr_write_b32 a0, v24
    v_accvgpr_write_b32 a1, v28
    v_accvgpr_read_b32 v26, a2
    v_accvgpr_read_b32 v27, a3
    v_lshlrev_b32 v24, 16, v26
    v_lshlrev_b32 v28, 16, v27
    v_and_b32 v25, s38, v26
    v_and_b32 v29, s38, v27
    v_pk_mul_f32 v[24:25], v[24:25], s[36:37]
    v_pk_mul_f32 v[28:29], v[28:29], s[36:37]
    v_cvt_pk_bf16_f32 v24, v24, v25
    v_cvt_pk_bf16_f32 v28, v28, v29
    v_accvgpr_write_b32 a2, v24
    v_accvgpr_write_b32 a3, v28
    s_waitcnt vmcnt(30)
    v_accvgpr_read_b32 v26, a4
    v_accvgpr_read_b32 v27, a5
    v_lshlrev_b32 v24, 16, v26
    v_lshlrev_b32 v28, 16, v27
    v_and_b32 v25, s38, v26
    v_and_b32 v29, s38, v27
    v_pk_mul_f32 v[24:25], v[24:25], s[36:37]
    v_pk_mul_f32 v[28:29], v[28:29], s[36:37]
    v_cvt_pk_bf16_f32 v24, v24, v25
    v_cvt_pk_bf16_f32 v28, v28, v29
    v_accvgpr_write_b32 a4, v24
    v_accvgpr_write_b32 a5, v28
    v_accvgpr_read_b32 v26, a6
    v_accvgpr_read_b32 v27, a7
    v_lshlrev_b32 v24, 16, v26
    v_lshlrev_b32 v28, 16, v27
    v_and_b32 v25, s38, v26
    v_and_b32 v29, s38, v27
    v_pk_mul_f32 v[24:25], v[24:25], s[36:37]
    v_pk_mul_f32 v[28:29], v[28:29], s[36:37]
    v_cvt_pk_bf16_f32 v24, v24, v25
    v_cvt_pk_bf16_f32 v28, v28, v29
    v_accvgpr_write_b32 a6, v24
    v_accvgpr_write_b32 a7, v28
    s_waitcnt vmcnt(29)
    v_accvgpr_read_b32 v26, a8
    v_accvgpr_read_b32 v27, a9
    v_lshlrev_b32 v24, 16, v26
    v_lshlrev_b32 v28, 16, v27
    v_and_b32 v25, s38, v26
    v_and_b32 v29, s38, v27
    v_pk_mul_f32 v[24:25], v[24:25], s[36:37]
    v_pk_mul_f32 v[28:29], v[28:29], s[36:37]
    v_cvt_pk_bf16_f32 v24, v24, v25
    v_cvt_pk_bf16_f32 v28, v28, v29
    v_accvgpr_write_b32 a8, v24
    v_accvgpr_write_b32 a9, v28
    v_accvgpr_read_b32 v26, a10
    v_accvgpr_read_b32 v27, a11
    v_lshlrev_b32 v24, 16, v26
    v_lshlrev_b32 v28, 16, v27
    v_and_b32 v25, s38, v26
    v_and_b32 v29, s38, v27
    v_pk_mul_f32 v[24:25], v[24:25], s[36:37]
    v_pk_mul_f32 v[28:29], v[28:29], s[36:37]
    v_cvt_pk_bf16_f32 v24, v24, v25
    v_cvt_pk_bf16_f32 v28, v28, v29
    v_accvgpr_write_b32 a10, v24
    v_accvgpr_write_b32 a11, v28
    s_waitcnt vmcnt(28)
    v_accvgpr_read_b32 v26, a12
    v_accvgpr_read_b32 v27, a13
    v_lshlrev_b32 v24, 16, v26
    v_lshlrev_b32 v28, 16, v27
    v_and_b32 v25, s38, v26
    v_and_b32 v29, s38, v27
    v_pk_mul_f32 v[24:25], v[24:25], s[36:37]
    v_pk_mul_f32 v[28:29], v[28:29], s[36:37]
    v_cvt_pk_bf16_f32 v24, v24, v25
    v_cvt_pk_bf16_f32 v28, v28, v29
    v_accvgpr_write_b32 a12, v24
    v_accvgpr_write_b32 a13, v28
    v_accvgpr_read_b32 v26, a14
    v_accvgpr_read_b32 v27, a15
    v_lshlrev_b32 v24, 16, v26
    v_lshlrev_b32 v28, 16, v27
    v_and_b32 v25, s38, v26
    v_and_b32 v29, s38, v27
    v_pk_mul_f32 v[24:25], v[24:25], s[36:37]
    v_pk_mul_f32 v[28:29], v[28:29], s[36:37]
    v_cvt_pk_bf16_f32 v24, v24, v25
    v_cvt_pk_bf16_f32 v28, v28, v29
    v_accvgpr_write_b32 a14, v24
    v_accvgpr_write_b32 a15, v28
    s_waitcnt vmcnt(27)
    v_accvgpr_read_b32 v26, a16
    v_accvgpr_read_b32 v27, a17
    v_lshlrev_b32 v24, 16, v26
    v_lshlrev_b32 v28, 16, v27
    v_and_b32 v25, s38, v26
    v_and_b32 v29, s38, v27
    v_pk_mul_f32 v[24:25], v[24:25], s[36:37]
    v_pk_mul_f32 v[28:29], v[28:29], s[36:37]
    v_cvt_pk_bf16_f32 v24, v24, v25
    v_cvt_pk_bf16_f32 v28, v28, v29
    v_accvgpr_write_b32 a16, v24
    v_accvgpr_write_b32 a17, v28
    v_accvgpr_read_b32 v26, a18
    v_accvgpr_read_b32 v27, a19
    v_lshlrev_b32 v24, 16, v26
    v_lshlrev_b32 v28, 16, v27
    v_and_b32 v25, s38, v26
    v_and_b32 v29, s38, v27
    v_pk_mul_f32 v[24:25], v[24:25], s[36:37]
    v_pk_mul_f32 v[28:29], v[28:29], s[36:37]
    v_cvt_pk_bf16_f32 v24, v24, v25
    v_cvt_pk_bf16_f32 v28, v28, v29
    v_accvgpr_write_b32 a18, v24
    v_accvgpr_write_b32 a19, v28
    s_waitcnt vmcnt(26)
    v_accvgpr_read_b32 v26, a20
    v_accvgpr_read_b32 v27, a21
    v_lshlrev_b32 v24, 16, v26
    v_lshlrev_b32 v28, 16, v27
    v_and_b32 v25, s38, v26
    v_and_b32 v29, s38, v27
    v_pk_mul_f32 v[24:25], v[24:25], s[36:37]
    v_pk_mul_f32 v[28:29], v[28:29], s[36:37]
    v_cvt_pk_bf16_f32 v24, v24, v25
    v_cvt_pk_bf16_f32 v28, v28, v29
    v_accvgpr_write_b32 a20, v24
    v_accvgpr_write_b32 a21, v28
    v_accvgpr_read_b32 v26, a22
    v_accvgpr_read_b32 v27, a23
    v_lshlrev_b32 v24, 16, v26
    v_lshlrev_b32 v28, 16, v27
    v_and_b32 v25, s38, v26
    v_and_b32 v29, s38, v27
    v_pk_mul_f32 v[24:25], v[24:25], s[36:37]
    v_pk_mul_f32 v[28:29], v[28:29], s[36:37]
    v_cvt_pk_bf16_f32 v24, v24, v25
    v_cvt_pk_bf16_f32 v28, v28, v29
    v_accvgpr_write_b32 a22, v24
    v_accvgpr_write_b32 a23, v28
    s_waitcnt vmcnt(25)
    v_accvgpr_read_b32 v26, a24
    v_accvgpr_read_b32 v27, a25
    v_lshlrev_b32 v24, 16, v26
    v_lshlrev_b32 v28, 16, v27
    v_and_b32 v25, s38, v26
    v_and_b32 v29, s38, v27
    v_pk_mul_f32 v[24:25], v[24:25], s[36:37]
    v_pk_mul_f32 v[28:29], v[28:29], s[36:37]
    v_cvt_pk_bf16_f32 v24, v24, v25
    v_cvt_pk_bf16_f32 v28, v28, v29
    v_accvgpr_write_b32 a24, v24
    v_accvgpr_write_b32 a25, v28
    v_accvgpr_read_b32 v26, a26
    v_accvgpr_read_b32 v27, a27
    v_lshlrev_b32 v24, 16, v26
    v_lshlrev_b32 v28, 16, v27
    v_and_b32 v25, s38, v26
    v_and_b32 v29, s38, v27
    v_pk_mul_f32 v[24:25], v[24:25], s[36:37]
    v_pk_mul_f32 v[28:29], v[28:29], s[36:37]
    v_cvt_pk_bf16_f32 v24, v24, v25
    v_cvt_pk_bf16_f32 v28, v28, v29
    v_accvgpr_write_b32 a26, v24
    v_accvgpr_write_b32 a27, v28
    s_waitcnt vmcnt(24)
    v_accvgpr_read_b32 v26, a28
    v_accvgpr_read_b32 v27, a29
    v_lshlrev_b32 v24, 16, v26
    v_lshlrev_b32 v28, 16, v27
    v_and_b32 v25, s38, v26
    v_and_b32 v29, s38, v27
    v_pk_mul_f32 v[24:25], v[24:25], s[36:37]
    v_pk_mul_f32 v[28:29], v[28:29], s[36:37]
    v_cvt_pk_bf16_f32 v24, v24, v25
    v_cvt_pk_bf16_f32 v28, v28, v29
    v_accvgpr_write_b32 a28, v24
    v_accvgpr_write_b32 a29, v28
    v_accvgpr_read_b32 v26, a30
    v_accvgpr_read_b32 v27, a31
    v_lshlrev_b32 v24, 16, v26
    v_lshlrev_b32 v28, 16, v27
    v_and_b32 v25, s38, v26
    v_and_b32 v29, s38, v27
    v_pk_mul_f32 v[24:25], v[24:25], s[36:37]
    v_pk_mul_f32 v[28:29], v[28:29], s[36:37]
    v_cvt_pk_bf16_f32 v24, v24, v25
    v_cvt_pk_bf16_f32 v28, v28, v29
    v_accvgpr_write_b32 a30, v24
    v_accvgpr_write_b32 a31, v28
    s_waitcnt vmcnt(23)
    v_accvgpr_read_b32 v26, a32
    v_accvgpr_read_b32 v27, a33
    v_lshlrev_b32 v24, 16, v26
    v_lshlrev_b32 v28, 16, v27
    v_and_b32 v25, s38, v26
    v_and_b32 v29, s38, v27
    v_pk_mul_f32 v[24:25], v[24:25], s[36:37]
    v_pk_mul_f32 v[28:29], v[28:29], s[36:37]
    v_cvt_pk_bf16_f32 v24, v24, v25
    v_cvt_pk_bf16_f32 v28, v28, v29
    v_accvgpr_write_b32 a32, v24
    v_accvgpr_write_b32 a33, v28
    v_accvgpr_read_b32 v26, a34
    v_accvgpr_read_b32 v27, a35
    v_lshlrev_b32 v24, 16, v26
    v_lshlrev_b32 v28, 16, v27
    v_and_b32 v25, s38, v26
    v_and_b32 v29, s38, v27
    v_pk_mul_f32 v[24:25], v[24:25], s[36:37]
    v_pk_mul_f32 v[28:29], v[28:29], s[36:37]
    v_cvt_pk_bf16_f32 v24, v24, v25
    v_cvt_pk_bf16_f32 v28, v28, v29
    v_accvgpr_write_b32 a34, v24
    v_accvgpr_write_b32 a35, v28
    s_waitcnt vmcnt(22)
    v_accvgpr_read_b32 v26, a36
    v_accvgpr_read_b32 v27, a37
    v_lshlrev_b32 v24, 16, v26
    v_lshlrev_b32 v28, 16, v27
    v_and_b32 v25, s38, v26
    v_and_b32 v29, s38, v27
    v_pk_mul_f32 v[24:25], v[24:25], s[36:37]
    v_pk_mul_f32 v[28:29], v[28:29], s[36:37]
    v_cvt_pk_bf16_f32 v24, v24, v25
    v_cvt_pk_bf16_f32 v28, v28, v29
    v_accvgpr_write_b32 a36, v24
    v_accvgpr_write_b32 a37, v28
    v_accvgpr_read_b32 v26, a38
    v_accvgpr_read_b32 v27, a39
    v_lshlrev_b32 v24, 16, v26
    v_lshlrev_b32 v28, 16, v27
    v_and_b32 v25, s38, v26
    v_and_b32 v29, s38, v27
    v_pk_mul_f32 v[24:25], v[24:25], s[36:37]
    v_pk_mul_f32 v[28:29], v[28:29], s[36:37]
    v_cvt_pk_bf16_f32 v24, v24, v25
    v_cvt_pk_bf16_f32 v28, v28, v29
    v_accvgpr_write_b32 a38, v24
    v_accvgpr_write_b32 a39, v28
    s_waitcnt vmcnt(21)
    v_accvgpr_read_b32 v26, a40
    v_accvgpr_read_b32 v27, a41
    v_lshlrev_b32 v24, 16, v26
    v_lshlrev_b32 v28, 16, v27
    v_and_b32 v25, s38, v26
    v_and_b32 v29, s38, v27
    v_pk_mul_f32 v[24:25], v[24:25], s[36:37]
    v_pk_mul_f32 v[28:29], v[28:29], s[36:37]
    v_cvt_pk_bf16_f32 v24, v24, v25
    v_cvt_pk_bf16_f32 v28, v28, v29
    v_accvgpr_write_b32 a40, v24
    v_accvgpr_write_b32 a41, v28
    v_accvgpr_read_b32 v26, a42
    v_accvgpr_read_b32 v27, a43
    v_lshlrev_b32 v24, 16, v26
    v_lshlrev_b32 v28, 16, v27
    v_and_b32 v25, s38, v26
    v_and_b32 v29, s38, v27
    v_pk_mul_f32 v[24:25], v[24:25], s[36:37]
    v_pk_mul_f32 v[28:29], v[28:29], s[36:37]
    v_cvt_pk_bf16_f32 v24, v24, v25
    v_cvt_pk_bf16_f32 v28, v28, v29
    v_accvgpr_write_b32 a42, v24
    v_accvgpr_write_b32 a43, v28
    s_waitcnt vmcnt(20)
    v_accvgpr_read_b32 v26, a44
    v_accvgpr_read_b32 v27, a45
    v_lshlrev_b32 v24, 16, v26
    v_lshlrev_b32 v28, 16, v27
    v_and_b32 v25, s38, v26
    v_and_b32 v29, s38, v27
    v_pk_mul_f32 v[24:25], v[24:25], s[36:37]
    v_pk_mul_f32 v[28:29], v[28:29], s[36:37]
    v_cvt_pk_bf16_f32 v24, v24, v25
    v_cvt_pk_bf16_f32 v28, v28, v29
    v_accvgpr_write_b32 a44, v24
    v_accvgpr_write_b32 a45, v28
    v_accvgpr_read_b32 v26, a46
    v_accvgpr_read_b32 v27, a47
    v_lshlrev_b32 v24, 16, v26
    v_lshlrev_b32 v28, 16, v27
    v_and_b32 v25, s38, v26
    v_and_b32 v29, s38, v27
    v_pk_mul_f32 v[24:25], v[24:25], s[36:37]
    v_pk_mul_f32 v[28:29], v[28:29], s[36:37]
    v_cvt_pk_bf16_f32 v24, v24, v25
    v_cvt_pk_bf16_f32 v28, v28, v29
    v_accvgpr_write_b32 a46, v24
    v_accvgpr_write_b32 a47, v28
    s_waitcnt vmcnt(19)
    v_accvgpr_read_b32 v26, a48
    v_accvgpr_read_b32 v27, a49
    v_lshlrev_b32 v24, 16, v26
    v_lshlrev_b32 v28, 16, v27
    v_and_b32 v25, s38, v26
    v_and_b32 v29, s38, v27
    v_pk_mul_f32 v[24:25], v[24:25], s[36:37]
    v_pk_mul_f32 v[28:29], v[28:29], s[36:37]
    v_cvt_pk_bf16_f32 v24, v24, v25
    v_cvt_pk_bf16_f32 v28, v28, v29
    v_accvgpr_write_b32 a48, v24
    v_accvgpr_write_b32 a49, v28
    v_accvgpr_read_b32 v26, a50
    v_accvgpr_read_b32 v27, a51
    v_lshlrev_b32 v24, 16, v26
    v_lshlrev_b32 v28, 16, v27
    v_and_b32 v25, s38, v26
    v_and_b32 v29, s38, v27
    v_pk_mul_f32 v[24:25], v[24:25], s[36:37]
    v_pk_mul_f32 v[28:29], v[28:29], s[36:37]
    v_cvt_pk_bf16_f32 v24, v24, v25
    v_cvt_pk_bf16_f32 v28, v28, v29
    v_accvgpr_write_b32 a50, v24
    v_accvgpr_write_b32 a51, v28
    s_waitcnt vmcnt(18)
    v_accvgpr_read_b32 v26, a52
    v_accvgpr_read_b32 v27, a53
    v_lshlrev_b32 v24, 16, v26
    v_lshlrev_b32 v28, 16, v27
    v_and_b32 v25, s38, v26
    v_and_b32 v29, s38, v27
    v_pk_mul_f32 v[24:25], v[24:25], s[36:37]
    v_pk_mul_f32 v[28:29], v[28:29], s[36:37]
    v_cvt_pk_bf16_f32 v24, v24, v25
    v_cvt_pk_bf16_f32 v28, v28, v29
    v_accvgpr_write_b32 a52, v24
    v_accvgpr_write_b32 a53, v28
    v_accvgpr_read_b32 v26, a54
    v_accvgpr_read_b32 v27, a55
    v_lshlrev_b32 v24, 16, v26
    v_lshlrev_b32 v28, 16, v27
    v_and_b32 v25, s38, v26
    v_and_b32 v29, s38, v27
    v_pk_mul_f32 v[24:25], v[24:25], s[36:37]
    v_pk_mul_f32 v[28:29], v[28:29], s[36:37]
    v_cvt_pk_bf16_f32 v24, v24, v25
    v_cvt_pk_bf16_f32 v28, v28, v29
    v_accvgpr_write_b32 a54, v24
    v_accvgpr_write_b32 a55, v28
    s_waitcnt vmcnt(17)
    v_accvgpr_read_b32 v26, a56
    v_accvgpr_read_b32 v27, a57
    v_lshlrev_b32 v24, 16, v26
    v_lshlrev_b32 v28, 16, v27
    v_and_b32 v25, s38, v26
    v_and_b32 v29, s38, v27
    v_pk_mul_f32 v[24:25], v[24:25], s[36:37]
    v_pk_mul_f32 v[28:29], v[28:29], s[36:37]
    v_cvt_pk_bf16_f32 v24, v24, v25
    v_cvt_pk_bf16_f32 v28, v28, v29
    v_accvgpr_write_b32 a56, v24
    v_accvgpr_write_b32 a57, v28
    v_accvgpr_read_b32 v26, a58
    v_accvgpr_read_b32 v27, a59
    v_lshlrev_b32 v24, 16, v26
    v_lshlrev_b32 v28, 16, v27
    v_and_b32 v25, s38, v26
    v_and_b32 v29, s38, v27
    v_pk_mul_f32 v[24:25], v[24:25], s[36:37]
    v_pk_mul_f32 v[28:29], v[28:29], s[36:37]
    v_cvt_pk_bf16_f32 v24, v24, v25
    v_cvt_pk_bf16_f32 v28, v28, v29
    v_accvgpr_write_b32 a58, v24
    v_accvgpr_write_b32 a59, v28
    s_waitcnt vmcnt(16)
    v_accvgpr_read_b32 v26, a60
    v_accvgpr_read_b32 v27, a61
    v_lshlrev_b32 v24, 16, v26
    v_lshlrev_b32 v28, 16, v27
    v_and_b32 v25, s38, v26
    v_and_b32 v29, s38, v27
    v_pk_mul_f32 v[24:25], v[24:25], s[36:37]
    v_pk_mul_f32 v[28:29], v[28:29], s[36:37]
    v_cvt_pk_bf16_f32 v24, v24, v25
    v_cvt_pk_bf16_f32 v28, v28, v29
    v_accvgpr_write_b32 a60, v24
    v_accvgpr_write_b32 a61, v28
    v_accvgpr_read_b32 v26, a62
    v_accvgpr_read_b32 v27, a63
    v_lshlrev_b32 v24, 16, v26
    v_lshlrev_b32 v28, 16, v27
    v_and_b32 v25, s38, v26
    v_and_b32 v29, s38, v27
    v_pk_mul_f32 v[24:25], v[24:25], s[36:37]
    v_pk_mul_f32 v[28:29], v[28:29], s[36:37]
    v_cvt_pk_bf16_f32 v24, v24, v25
    v_cvt_pk_bf16_f32 v28, v28, v29
    v_accvgpr_write_b32 a62, v24
    v_accvgpr_write_b32 a63, v28
    s_waitcnt vmcnt(15)
    v_accvgpr_read_b32 v26, a64
    v_accvgpr_read_b32 v27, a65
    v_lshlrev_b32 v24, 16, v26
    v_lshlrev_b32 v28, 16, v27
    v_and_b32 v25, s38, v26
    v_and_b32 v29, s38, v27
    v_pk_mul_f32 v[24:25], v[24:25], s[36:37]
    v_pk_mul_f32 v[28:29], v[28:29], s[36:37]
    v_cvt_pk_bf16_f32 v24, v24, v25
    v_cvt_pk_bf16_f32 v28, v28, v29
    v_accvgpr_write_b32 a64, v24
    v_accvgpr_write_b32 a65, v28
    v_accvgpr_read_b32 v26, a66
    v_accvgpr_read_b32 v27, a67
    v_lshlrev_b32 v24, 16, v26
    v_lshlrev_b32 v28, 16, v27
    v_and_b32 v25, s38, v26
    v_and_b32 v29, s38, v27
    v_pk_mul_f32 v[24:25], v[24:25], s[36:37]
    v_pk_mul_f32 v[28:29], v[28:29], s[36:37]
    v_cvt_pk_bf16_f32 v24, v24, v25
    v_cvt_pk_bf16_f32 v28, v28, v29
    v_accvgpr_write_b32 a66, v24
    v_accvgpr_write_b32 a67, v28
    s_waitcnt vmcnt(14)
    v_accvgpr_read_b32 v26, a68
    v_accvgpr_read_b32 v27, a69
    v_lshlrev_b32 v24, 16, v26
    v_lshlrev_b32 v28, 16, v27
    v_and_b32 v25, s38, v26
    v_and_b32 v29, s38, v27
    v_pk_mul_f32 v[24:25], v[24:25], s[36:37]
    v_pk_mul_f32 v[28:29], v[28:29], s[36:37]
    v_cvt_pk_bf16_f32 v24, v24, v25
    v_cvt_pk_bf16_f32 v28, v28, v29
    v_accvgpr_write_b32 a68, v24
    v_accvgpr_write_b32 a69, v28
    v_accvgpr_read_b32 v26, a70
    v_accvgpr_read_b32 v27, a71
    v_lshlrev_b32 v24, 16, v26
    v_lshlrev_b32 v28, 16, v27
    v_and_b32 v25, s38, v26
    v_and_b32 v29, s38, v27
    v_pk_mul_f32 v[24:25], v[24:25], s[36:37]
    v_pk_mul_f32 v[28:29], v[28:29], s[36:37]
    v_cvt_pk_bf16_f32 v24, v24, v25
    v_cvt_pk_bf16_f32 v28, v28, v29
    v_accvgpr_write_b32 a70, v24
    v_accvgpr_write_b32 a71, v28
    s_waitcnt vmcnt(13)
    v_accvgpr_read_b32 v26, a72
    v_accvgpr_read_b32 v27, a73
    v_lshlrev_b32 v24, 16, v26
    v_lshlrev_b32 v28, 16, v27
    v_and_b32 v25, s38, v26
    v_and_b32 v29, s38, v27
    v_pk_mul_f32 v[24:25], v[24:25], s[36:37]
    v_pk_mul_f32 v[28:29], v[28:29], s[36:37]
    v_cvt_pk_bf16_f32 v24, v24, v25
    v_cvt_pk_bf16_f32 v28, v28, v29
    v_accvgpr_write_b32 a72, v24
    v_accvgpr_write_b32 a73, v28
    v_accvgpr_read_b32 v26, a74
    v_accvgpr_read_b32 v27, a75
    v_lshlrev_b32 v24, 16, v26
    v_lshlrev_b32 v28, 16, v27
    v_and_b32 v25, s38, v26
    v_and_b32 v29, s38, v27
    v_pk_mul_f32 v[24:25], v[24:25], s[36:37]
    v_pk_mul_f32 v[28:29], v[28:29], s[36:37]
    v_cvt_pk_bf16_f32 v24, v24, v25
    v_cvt_pk_bf16_f32 v28, v28, v29
    v_accvgpr_write_b32 a74, v24
    v_accvgpr_write_b32 a75, v28
    s_waitcnt vmcnt(12)
    v_accvgpr_read_b32 v26, a76
    v_accvgpr_read_b32 v27, a77
    v_lshlrev_b32 v24, 16, v26
    v_lshlrev_b32 v28, 16, v27
    v_and_b32 v25, s38, v26
    v_and_b32 v29, s38, v27
    v_pk_mul_f32 v[24:25], v[24:25], s[36:37]
    v_pk_mul_f32 v[28:29], v[28:29], s[36:37]
    v_cvt_pk_bf16_f32 v24, v24, v25
    v_cvt_pk_bf16_f32 v28, v28, v29
    v_accvgpr_write_b32 a76, v24
    v_accvgpr_write_b32 a77, v28
    v_accvgpr_read_b32 v26, a78
    v_accvgpr_read_b32 v27, a79
    v_lshlrev_b32 v24, 16, v26
    v_lshlrev_b32 v28, 16, v27
    v_and_b32 v25, s38, v26
    v_and_b32 v29, s38, v27
    v_pk_mul_f32 v[24:25], v[24:25], s[36:37]
    v_pk_mul_f32 v[28:29], v[28:29], s[36:37]
    v_cvt_pk_bf16_f32 v24, v24, v25
    v_cvt_pk_bf16_f32 v28, v28, v29
    v_accvgpr_write_b32 a78, v24
    v_accvgpr_write_b32 a79, v28
    s_waitcnt vmcnt(11)
    v_accvgpr_read_b32 v26, a80
    v_accvgpr_read_b32 v27, a81
    v_lshlrev_b32 v24, 16, v26
    v_lshlrev_b32 v28, 16, v27
    v_and_b32 v25, s38, v26
    v_and_b32 v29, s38, v27
    v_pk_mul_f32 v[24:25], v[24:25], s[36:37]
    v_pk_mul_f32 v[28:29], v[28:29], s[36:37]
    v_cvt_pk_bf16_f32 v24, v24, v25
    v_cvt_pk_bf16_f32 v28, v28, v29
    v_accvgpr_write_b32 a80, v24
    v_accvgpr_write_b32 a81, v28
    v_accvgpr_read_b32 v26, a82
    v_accvgpr_read_b32 v27, a83
    v_lshlrev_b32 v24, 16, v26
    v_lshlrev_b32 v28, 16, v27
    v_and_b32 v25, s38, v26
    v_and_b32 v29, s38, v27
    v_pk_mul_f32 v[24:25], v[24:25], s[36:37]
    v_pk_mul_f32 v[28:29], v[28:29], s[36:37]
    v_cvt_pk_bf16_f32 v24, v24, v25
    v_cvt_pk_bf16_f32 v28, v28, v29
    v_accvgpr_write_b32 a82, v24
    v_accvgpr_write_b32 a83, v28
    s_waitcnt vmcnt(10)
    v_accvgpr_read_b32 v26, a84
    v_accvgpr_read_b32 v27, a85
    v_lshlrev_b32 v24, 16, v26
    v_lshlrev_b32 v28, 16, v27
    v_and_b32 v25, s38, v26
    v_and_b32 v29, s38, v27
    v_pk_mul_f32 v[24:25], v[24:25], s[36:37]
    v_pk_mul_f32 v[28:29], v[28:29], s[36:37]
    v_cvt_pk_bf16_f32 v24, v24, v25
    v_cvt_pk_bf16_f32 v28, v28, v29
    v_accvgpr_write_b32 a84, v24
    v_accvgpr_write_b32 a85, v28
    v_accvgpr_read_b32 v26, a86
    v_accvgpr_read_b32 v27, a87
    v_lshlrev_b32 v24, 16, v26
    v_lshlrev_b32 v28, 16, v27
    v_and_b32 v25, s38, v26
    v_and_b32 v29, s38, v27
    v_pk_mul_f32 v[24:25], v[24:25], s[36:37]
    v_pk_mul_f32 v[28:29], v[28:29], s[36:37]
    v_cvt_pk_bf16_f32 v24, v24, v25
    v_cvt_pk_bf16_f32 v28, v28, v29
    v_accvgpr_write_b32 a86, v24
    v_accvgpr_write_b32 a87, v28
    s_waitcnt vmcnt(9)
    v_accvgpr_read_b32 v26, a88
    v_accvgpr_read_b32 v27, a89
    v_lshlrev_b32 v24, 16, v26
    v_lshlrev_b32 v28, 16, v27
    v_and_b32 v25, s38, v26
    v_and_b32 v29, s38, v27
    v_pk_mul_f32 v[24:25], v[24:25], s[36:37]
    v_pk_mul_f32 v[28:29], v[28:29], s[36:37]
    v_cvt_pk_bf16_f32 v24, v24, v25
    v_cvt_pk_bf16_f32 v28, v28, v29
    v_accvgpr_write_b32 a88, v24
    v_accvgpr_write_b32 a89, v28
    v_accvgpr_read_b32 v26, a90
    v_accvgpr_read_b32 v27, a91
    v_lshlrev_b32 v24, 16, v26
    v_lshlrev_b32 v28, 16, v27
    v_and_b32 v25, s38, v26
    v_and_b32 v29, s38, v27
    v_pk_mul_f32 v[24:25], v[24:25], s[36:37]
    v_pk_mul_f32 v[28:29], v[28:29], s[36:37]
    v_cvt_pk_bf16_f32 v24, v24, v25
    v_cvt_pk_bf16_f32 v28, v28, v29
    v_accvgpr_write_b32 a90, v24
    v_accvgpr_write_b32 a91, v28
    s_waitcnt vmcnt(8)
    v_accvgpr_read_b32 v26, a92
    v_accvgpr_read_b32 v27, a93
    v_lshlrev_b32 v24, 16, v26
    v_lshlrev_b32 v28, 16, v27
    v_and_b32 v25, s38, v26
    v_and_b32 v29, s38, v27
    v_pk_mul_f32 v[24:25], v[24:25], s[36:37]
    v_pk_mul_f32 v[28:29], v[28:29], s[36:37]
    v_cvt_pk_bf16_f32 v24, v24, v25
    v_cvt_pk_bf16_f32 v28, v28, v29
    v_accvgpr_write_b32 a92, v24
    v_accvgpr_write_b32 a93, v28
    v_accvgpr_read_b32 v26, a94
    v_accvgpr_read_b32 v27, a95
    v_lshlrev_b32 v24, 16, v26
    v_lshlrev_b32 v28, 16, v27
    v_and_b32 v25, s38, v26
    v_and_b32 v29, s38, v27
    v_pk_mul_f32 v[24:25], v[24:25], s[36:37]
    v_pk_mul_f32 v[28:29], v[28:29], s[36:37]
    v_cvt_pk_bf16_f32 v24, v24, v25
    v_cvt_pk_bf16_f32 v28, v28, v29
    v_accvgpr_write_b32 a94, v24
    v_accvgpr_write_b32 a95, v28
    s_waitcnt vmcnt(7)
    v_accvgpr_read_b32 v26, a96
    v_accvgpr_read_b32 v27, a97
    v_lshlrev_b32 v24, 16, v26
    v_lshlrev_b32 v28, 16, v27
    v_and_b32 v25, s38, v26
    v_and_b32 v29, s38, v27
    v_pk_mul_f32 v[24:25], v[24:25], s[36:37]
    v_pk_mul_f32 v[28:29], v[28:29], s[36:37]
    v_cvt_pk_bf16_f32 v24, v24, v25
    v_cvt_pk_bf16_f32 v28, v28, v29
    v_accvgpr_write_b32 a96, v24
    v_accvgpr_write_b32 a97, v28
    v_accvgpr_read_b32 v26, a98
    v_accvgpr_read_b32 v27, a99
    v_lshlrev_b32 v24, 16, v26
    v_lshlrev_b32 v28, 16, v27
    v_and_b32 v25, s38, v26
    v_and_b32 v29, s38, v27
    v_pk_mul_f32 v[24:25], v[24:25], s[36:37]
    v_pk_mul_f32 v[28:29], v[28:29], s[36:37]
    v_cvt_pk_bf16_f32 v24, v24, v25
    v_cvt_pk_bf16_f32 v28, v28, v29
    v_accvgpr_write_b32 a98, v24
    v_accvgpr_write_b32 a99, v28
    s_waitcnt vmcnt(6)
    v_accvgpr_read_b32 v26, a100
    v_accvgpr_read_b32 v27, a101
    v_lshlrev_b32 v24, 16, v26
    v_lshlrev_b32 v28, 16, v27
    v_and_b32 v25, s38, v26
    v_and_b32 v29, s38, v27
    v_pk_mul_f32 v[24:25], v[24:25], s[36:37]
    v_pk_mul_f32 v[28:29], v[28:29], s[36:37]
    v_cvt_pk_bf16_f32 v24, v24, v25
    v_cvt_pk_bf16_f32 v28, v28, v29
    v_accvgpr_write_b32 a100, v24
    v_accvgpr_write_b32 a101, v28
    v_accvgpr_read_b32 v26, a102
    v_accvgpr_read_b32 v27, a103
    v_lshlrev_b32 v24, 16, v26
    v_lshlrev_b32 v28, 16, v27
    v_and_b32 v25, s38, v26
    v_and_b32 v29, s38, v27
    v_pk_mul_f32 v[24:25], v[24:25], s[36:37]
    v_pk_mul_f32 v[28:29], v[28:29], s[36:37]
    v_cvt_pk_bf16_f32 v24, v24, v25
    v_cvt_pk_bf16_f32 v28, v28, v29
    v_accvgpr_write_b32 a102, v24
    v_accvgpr_write_b32 a103, v28
    s_waitcnt vmcnt(5)
    v_accvgpr_read_b32 v26, a104
    v_accvgpr_read_b32 v27, a105
    v_lshlrev_b32 v24, 16, v26
    v_lshlrev_b32 v28, 16, v27
    v_and_b32 v25, s38, v26
    v_and_b32 v29, s38, v27
    v_pk_mul_f32 v[24:25], v[24:25], s[36:37]
    v_pk_mul_f32 v[28:29], v[28:29], s[36:37]
    v_cvt_pk_bf16_f32 v24, v24, v25
    v_cvt_pk_bf16_f32 v28, v28, v29
    v_accvgpr_write_b32 a104, v24
    v_accvgpr_write_b32 a105, v28
    v_accvgpr_read_b32 v26, a106
    v_accvgpr_read_b32 v27, a107
    v_lshlrev_b32 v24, 16, v26
    v_lshlrev_b32 v28, 16, v27
    v_and_b32 v25, s38, v26
    v_and_b32 v29, s38, v27
    v_pk_mul_f32 v[24:25], v[24:25], s[36:37]
    v_pk_mul_f32 v[28:29], v[28:29], s[36:37]
    v_cvt_pk_bf16_f32 v24, v24, v25
    v_cvt_pk_bf16_f32 v28, v28, v29
    v_accvgpr_write_b32 a106, v24
    v_accvgpr_write_b32 a107, v28
    s_waitcnt vmcnt(4)
    v_accvgpr_read_b32 v26, a108
    v_accvgpr_read_b32 v27, a109
    v_lshlrev_b32 v24, 16, v26
    v_lshlrev_b32 v28, 16, v27
    v_and_b32 v25, s38, v26
    v_and_b32 v29, s38, v27
    v_pk_mul_f32 v[24:25], v[24:25], s[36:37]
    v_pk_mul_f32 v[28:29], v[28:29], s[36:37]
    v_cvt_pk_bf16_f32 v24, v24, v25
    v_cvt_pk_bf16_f32 v28, v28, v29
    v_accvgpr_write_b32 a108, v24
    v_accvgpr_write_b32 a109, v28
    v_accvgpr_read_b32 v26, a110
    v_accvgpr_read_b32 v27, a111
    v_lshlrev_b32 v24, 16, v26
    v_lshlrev_b32 v28, 16, v27
    v_and_b32 v25, s38, v26
    v_and_b32 v29, s38, v27
    v_pk_mul_f32 v[24:25], v[24:25], s[36:37]
    v_pk_mul_f32 v[28:29], v[28:29], s[36:37]
    v_cvt_pk_bf16_f32 v24, v24, v25
    v_cvt_pk_bf16_f32 v28, v28, v29
    v_accvgpr_write_b32 a110, v24
    v_accvgpr_write_b32 a111, v28
    s_waitcnt vmcnt(3)
    v_accvgpr_read_b32 v26, a112
    v_accvgpr_read_b32 v27, a113
    v_lshlrev_b32 v24, 16, v26
    v_lshlrev_b32 v28, 16, v27
    v_and_b32 v25, s38, v26
    v_and_b32 v29, s38, v27
    v_pk_mul_f32 v[24:25], v[24:25], s[36:37]
    v_pk_mul_f32 v[28:29], v[28:29], s[36:37]
    v_cvt_pk_bf16_f32 v24, v24, v25
    v_cvt_pk_bf16_f32 v28, v28, v29
    v_accvgpr_write_b32 a112, v24
    v_accvgpr_write_b32 a113, v28
    v_accvgpr_read_b32 v26, a114
    v_accvgpr_read_b32 v27, a115
    v_lshlrev_b32 v24, 16, v26
    v_lshlrev_b32 v28, 16, v27
    v_and_b32 v25, s38, v26
    v_and_b32 v29, s38, v27
    v_pk_mul_f32 v[24:25], v[24:25], s[36:37]
    v_pk_mul_f32 v[28:29], v[28:29], s[36:37]
    v_cvt_pk_bf16_f32 v24, v24, v25
    v_cvt_pk_bf16_f32 v28, v28, v29
    v_accvgpr_write_b32 a114, v24
    v_accvgpr_write_b32 a115, v28
    s_waitcnt vmcnt(2)
    v_accvgpr_read_b32 v26, a116
    v_accvgpr_read_b32 v27, a117
    v_lshlrev_b32 v24, 16, v26
    v_lshlrev_b32 v28, 16, v27
    v_and_b32 v25, s38, v26
    v_and_b32 v29, s38, v27
    v_pk_mul_f32 v[24:25], v[24:25], s[36:37]
    v_pk_mul_f32 v[28:29], v[28:29], s[36:37]
    v_cvt_pk_bf16_f32 v24, v24, v25
    v_cvt_pk_bf16_f32 v28, v28, v29
    v_accvgpr_write_b32 a116, v24
    v_accvgpr_write_b32 a117, v28
    v_accvgpr_read_b32 v26, a118
    v_accvgpr_read_b32 v27, a119
    v_lshlrev_b32 v24, 16, v26
    v_lshlrev_b32 v28, 16, v27
    v_and_b32 v25, s38, v26
    v_and_b32 v29, s38, v27
    v_pk_mul_f32 v[24:25], v[24:25], s[36:37]
    v_pk_mul_f32 v[28:29], v[28:29], s[36:37]
    v_cvt_pk_bf16_f32 v24, v24, v25
    v_cvt_pk_bf16_f32 v28, v28, v29
    v_accvgpr_write_b32 a118, v24
    v_accvgpr_write_b32 a119, v28
    s_waitcnt vmcnt(1)
    v_accvgpr_read_b32 v26, a120
    v_accvgpr_read_b32 v27, a121
    v_lshlrev_b32 v24, 16, v26
    v_lshlrev_b32 v28, 16, v27
    v_and_b32 v25, s38, v26
    v_and_b32 v29, s38, v27
    v_pk_mul_f32 v[24:25], v[24:25], s[36:37]
    v_pk_mul_f32 v[28:29], v[28:29], s[36:37]
    v_cvt_pk_bf16_f32 v24, v24, v25
    v_cvt_pk_bf16_f32 v28, v28, v29
    v_accvgpr_write_b32 a120, v24
    v_accvgpr_write_b32 a121, v28
    v_accvgpr_read_b32 v26, a122
    v_accvgpr_read_b32 v27, a123
    v_lshlrev_b32 v24, 16, v26
    v_lshlrev_b32 v28, 16, v27
    v_and_b32 v25, s38, v26
    v_and_b32 v29, s38, v27
    v_pk_mul_f32 v[24:25], v[24:25], s[36:37]
    v_pk_mul_f32 v[28:29], v[28:29], s[36:37]
    v_cvt_pk_bf16_f32 v24, v24, v25
    v_cvt_pk_bf16_f32 v28, v28, v29
    v_accvgpr_write_b32 a122, v24
    v_accvgpr_write_b32 a123, v28
    s_waitcnt vmcnt(0)
    v_accvgpr_read_b32 v26, a124
    v_accvgpr_read_b32 v27, a125
    v_lshlrev_b32 v24, 16, v26
    v_lshlrev_b32 v28, 16, v27
    v_and_b32 v25, s38, v26
    v_and_b32 v29, s38, v27
    v_pk_mul_f32 v[24:25], v[24:25], s[36:37]
    v_pk_mul_f32 v[28:29], v[28:29], s[36:37]
    v_cvt_pk_bf16_f32 v24, v24, v25
    v_cvt_pk_bf16_f32 v28, v28, v29
    v_accvgpr_write_b32 a124, v24
    v_accvgpr_write_b32 a125, v28
    v_accvgpr_read_b32 v26, a126
    v_accvgpr_read_b32 v27, a127
    v_lshlrev_b32 v24, 16, v26
    v_lshlrev_b32 v28, 16, v27
    v_and_b32 v25, s38, v26
    v_and_b32 v29, s38, v27
    v_pk_mul_f32 v[24:25], v[24:25], s[36:37]
    v_pk_mul_f32 v[28:29], v[28:29], s[36:37]
    v_cvt_pk_bf16_f32 v24, v24, v25
    v_cvt_pk_bf16_f32 v28, v28, v29
    v_accvgpr_write_b32 a126, v24
    v_accvgpr_write_b32 a127, v28
L_slow_loop_b:
    s_add_u32 s26, s21, 4096
    buffer_load_dwordx4 v[72:75], v240, s[4:7], s21 offen offset:0
    buffer_load_dwordx4 v[76:79], v240, s[4:7], s21 offen offset:64
    buffer_load_dwordx4 v[80:83], v240, s[4:7], s21 offen offset:128
    buffer_load_dwordx4 v[84:87], v240, s[4:7], s21 offen offset:192
    buffer_load_dwordx4 v[88:91], v240, s[4:7], s26 offen offset:0
    buffer_load_dwordx4 v[92:95], v240, s[4:7], s26 offen offset:64
    buffer_load_dwordx4 v[96:99], v240, s[4:7], s26 offen offset:128
    buffer_load_dwordx4 v[100:103], v240, s[4:7], s26 offen offset:192
    s_waitcnt vmcnt(7)
    v_mfma_f32_16x16x32_bf16 v[176:179], a[0:3], v[72:75], 0
    s_waitcnt vmcnt(6)
    v_mfma_f32_16x16x32_bf16 v[176:179], a[4:7], v[76:79], v[176:179]
    s_waitcnt vmcnt(5)
    v_mfma_f32_16x16x32_bf16 v[176:179], a[8:11], v[80:83], v[176:179]
    s_waitcnt vmcnt(4)
    v_mfma_f32_16x16x32_bf16 v[176:179], a[12:15], v[84:87], v[176:179]
    v_mfma_f32_16x16x32_bf16 v[180:183], a[16:19], v[72:75], 0
    v_mfma_f32_16x16x32_bf16 v[180:183], a[20:23], v[76:79], v[180:183]
    v_mfma_f32_16x16x32_bf16 v[180:183], a[24:27], v[80:83], v[180:183]
    v_mfma_f32_16x16x32_bf16 v[180:183], a[28:31], v[84:87], v[180:183]
    v_mfma_f32_16x16x32_bf16 v[184:187], a[32:35], v[72:75], 0
    v_mfma_f32_16x16x32_bf16 v[184:187], a[36:39], v[76:79], v[184:187]
    v_mfma_f32_16x16x32_bf16 v[184:187], a[40:43], v[80:83], v[184:187]
    v_mfma_f32_16x16x32_bf16 v[184:187], a[44:47], v[84:87], v[184:187]
    v_mfma_f32_16x16x32_bf16 v[188:191], a[48:51], v[72:75], 0
    v_mfma_f32_16x16x32_bf16 v[188:191], a[52:55], v[76:79], v[188:191]
    v_mfma_f32_16x16x32_bf16 v[188:191], a[56:59], v[80:83], v[188:191]
    v_mfma_f32_16x16x32_bf16 v[188:191], a[60:63], v[84:87], v[188:191]
    v_mfma_f32_16x16x32_bf16 v[192:195], a[64:67], v[72:75], 0
    v_mfma_f32_16x16x32_bf16 v[192:195], a[68:71], v[76:79], v[192:195]
    v_mfma_f32_16x16x32_bf16 v[192:195], a[72:75], v[80:83], v[192:195]
    v_mfma_f32_16x16x32_bf16 v[192:195], a[76:79], v[84:87], v[192:195]
    v_mfma_f32_16x16x32_bf16 v[196:199], a[80:83], v[72:75], 0
    v_mfma_f32_16x16x32_bf16 v[196:199], a[84:87], v[76:79], v[196:199]
    v_mfma_f32_16x16x32_bf16 v[196:199], a[88:91], v[80:83], v[196:199]
    v_mfma_f32_16x16x32_bf16 v[196:199], a[92:95], v[84:87], v[196:199]
    v_mfma_f32_16x16x32_bf16 v[200:203], a[96:99], v[72:75], 0
    v_mfma_f32_16x16x32_bf16 v[200:203], a[100:103], v[76:79], v[200:203]
    v_mfma_f32_16x16x32_bf16 v[200:203], a[104:107], v[80:83], v[200:203]
    v_mfma_f32_16x16x32_bf16 v[200:203], a[108:111], v[84:87], v[200:203]
    v_mfma_f32_16x16x32_bf16 v[204:207], a[112:115], v[72:75], 0
    v_mfma_f32_16x16x32_bf16 v[204:207], a[116:119], v[76:79], v[204:207]
    v_mfma_f32_16x16x32_bf16 v[204:207], a[120:123], v[80:83], v[204:207]
    v_mfma_f32_16x16x32_bf16 v[204:207], a[124:127], v[84:87], v[204:207]
    s_waitcnt vmcnt(3)
    v_mfma_f32_16x16x32_bf16 v[208:211], a[0:3], v[88:91], 0
    s_waitcnt vmcnt(2)
    v_mfma_f32_16x16x32_bf16 v[208:211], a[4:7], v[92:95], v[208:211]
    s_waitcnt vmcnt(1)
    v_mfma_f32_16x16x32_bf16 v[208:211], a[8:11], v[96:99], v[208:211]
    s_waitcnt vmcnt(0)
    v_mfma_f32_16x16x32_bf16 v[208:211], a[12:15], v[100:103], v[208:211]
    v_mfma_f32_16x16x32_bf16 v[212:215], a[16:19], v[88:91], 0
    v_mfma_f32_16x16x32_bf16 v[212:215], a[20:23], v[92:95], v[212:215]
    v_mfma_f32_16x16x32_bf16 v[212:215], a[24:27], v[96:99], v[212:215]
    v_mfma_f32_16x16x32_bf16 v[212:215], a[28:31], v[100:103], v[212:215]
    v_mfma_f32_16x16x32_bf16 v[216:219], a[32:35], v[88:91], 0
    v_mfma_f32_16x16x32_bf16 v[216:219], a[36:39], v[92:95], v[216:219]
    v_mfma_f32_16x16x32_bf16 v[216:219], a[40:43], v[96:99], v[216:219]
    v_mfma_f32_16x16x32_bf16 v[216:219], a[44:47], v[100:103], v[216:219]
    v_mfma_f32_16x16x32_bf16 v[220:223], a[48:51], v[88:91], 0
    v_mfma_f32_16x16x32_bf16 v[220:223], a[52:55], v[92:95], v[220:223]
    v_mfma_f32_16x16x32_bf16 v[220:223], a[56:59], v[96:99], v[220:223]
    v_mfma_f32_16x16x32_bf16 v[220:223], a[60:63], v[100:103], v[220:223]
    v_mfma_f32_16x16x32_bf16 v[224:227], a[64:67], v[88:91], 0
    v_mfma_f32_16x16x32_bf16 v[224:227], a[68:71], v[92:95], v[224:227]
    v_mfma_f32_16x16x32_bf16 v[224:227], a[72:75], v[96:99], v[224:227]
    v_mfma_f32_16x16x32_bf16 v[224:227], a[76:79], v[100:103], v[224:227]
    v_mfma_f32_16x16x32_bf16 v[228:231], a[80:83], v[88:91], 0
    v_mfma_f32_16x16x32_bf16 v[228:231], a[84:87], v[92:95], v[228:231]
    v_mfma_f32_16x16x32_bf16 v[228:231], a[88:91], v[96:99], v[228:231]
    v_mfma_f32_16x16x32_bf16 v[228:231], a[92:95], v[100:103], v[228:231]
    v_mfma_f32_16x16x32_bf16 v[232:235], a[96:99], v[88:91], 0
    v_mfma_f32_16x16x32_bf16 v[232:235], a[100:103], v[92:95], v[232:235]
    v_mfma_f32_16x16x32_bf16 v[232:235], a[104:107], v[96:99], v[232:235]
    v_mfma_f32_16x16x32_bf16 v[232:235], a[108:111], v[100:103], v[232:235]
    v_mfma_f32_16x16x32_bf16 v[236:239], a[112:115], v[88:91], 0
    v_mfma_f32_16x16x32_bf16 v[236:239], a[116:119], v[92:95], v[236:239]
    v_mfma_f32_16x16x32_bf16 v[236:239], a[120:123], v[96:99], v[236:239]
    v_mfma_f32_16x16x32_bf16 v[236:239], a[124:127], v[100:103], v[236:239]
    v_max_f32 v244, v176, v177
    v_max3_f32 v244, v244, v178, v179
    v_max3_f32 v244, v244, v180, v181
    v_max3_f32 v244, v244, v182, v183
    v_max3_f32 v244, v244, v184, v185
    v_max3_f32 v244, v244, v186, v187
    v_max3_f32 v244, v244, v188, v189
    v_max3_f32 v244, v244, v190, v191
    v_max3_f32 v244, v244, v192, v193
    v_max3_f32 v244, v244, v194, v195
    v_max3_f32 v244, v244, v196, v197
    v_max3_f32 v244, v244, v198, v199
    v_max3_f32 v244, v244, v200, v201
    v_max3_f32 v244, v244, v202, v203
    v_max3_f32 v244, v244, v204, v205
    v_max3_f32 v244, v244, v206, v207
    ds_write_b32 v241, v244 offset:0
    v_max_f32 v245, v208, v209
    v_max3_f32 v245, v245, v210, v211
    v_max3_f32 v245, v245, v212, v213
    v_max3_f32 v245, v245, v214, v215
    v_max3_f32 v245, v245, v216, v217
    v_max3_f32 v245, v245, v218, v219
    v_max3_f32 v245, v245, v220, v221
    v_max3_f32 v245, v245, v222, v223
    v_max3_f32 v245, v245, v224, v225
    v_max3_f32 v245, v245, v226, v227
    v_max3_f32 v245, v245, v228, v229
    v_max3_f32 v245, v245, v230, v231
    v_max3_f32 v245, v245, v232, v233
    v_max3_f32 v245, v245, v234, v235
    v_max3_f32 v245, v245, v236, v237
    v_max3_f32 v245, v245, v238, v239
    ds_write_b32 v241, v245 offset:1024
    s_waitcnt lgkmcnt(0)
    s_barrier
    ds_read_b128 v[136:139], v242 offset:0
    ds_read_b128 v[140:143], v242 offset:16
    ds_read_b128 v[144:147], v242 offset:32
    ds_read_b128 v[148:151], v242 offset:48
    s_waitcnt lgkmcnt(3)
    v_max_f32 v244, v136, v137
    v_max3_f32 v244, v244, v138, v139
    s_waitcnt lgkmcnt(2)
    v_max3_f32 v244, v244, v140, v141
    v_max3_f32 v244, v244, v142, v143
    s_waitcnt lgkmcnt(1)
    v_max3_f32 v244, v244, v144, v145
    v_max3_f32 v244, v244, v146, v147
    s_waitcnt lgkmcnt(0)
    v_max3_f32 v244, v244, v148, v149
    v_max3_f32 v244, v244, v150, v151
    ds_read_b128 v[136:139], v242 offset:1024
    ds_read_b128 v[140:143], v242 offset:1040
    ds_read_b128 v[144:147], v242 offset:1056
    ds_read_b128 v[148:151], v242 offset:1072
    s_waitcnt lgkmcnt(3)
    v_max_f32 v245, v136, v137
    v_max3_f32 v245, v245, v138, v139
    s_waitcnt lgkmcnt(2)
    v_max3_f32 v245, v245, v140, v141
    v_max3_f32 v245, v245, v142, v143
    s_waitcnt lgkmcnt(1)
    v_max3_f32 v245, v245, v144, v145
    v_max3_f32 v245, v245, v146, v147
    s_waitcnt lgkmcnt(0)
    v_max3_f32 v245, v245, v148, v149
    v_max3_f32 v245, v245, v150, v151
    v_sub_f32 v176, v176, v244
    v_sub_f32 v177, v177, v244
    v_sub_f32 v178, v178, v244
    v_sub_f32 v179, v179, v244
    v_sub_f32 v180, v180, v244
    v_sub_f32 v181, v181, v244
    v_sub_f32 v182, v182, v244
    v_sub_f32 v183, v183, v244
    v_sub_f32 v184, v184, v244
    v_sub_f32 v185, v185, v244
    v_sub_f32 v186, v186, v244
    v_sub_f32 v187, v187, v244
    v_sub_f32 v188, v188, v244
    v_sub_f32 v189, v189, v244
    v_sub_f32 v190, v190, v244
    v_sub_f32 v191, v191, v244
    v_sub_f32 v192, v192, v244
    v_sub_f32 v193, v193, v244
    v_sub_f32 v194, v194, v244
    v_sub_f32 v195, v195, v244
    v_sub_f32 v196, v196, v244
    v_sub_f32 v197, v197, v244
    v_sub_f32 v198, v198, v244
    v_sub_f32 v199, v199, v244
    v_sub_f32 v200, v200, v244
    v_sub_f32 v201, v201, v244
    v_sub_f32 v202, v202, v244
    v_sub_f32 v203, v203, v244
    v_sub_f32 v204, v204, v244
    v_sub_f32 v205, v205, v244
    v_sub_f32 v206, v206, v244
    v_sub_f32 v207, v207, v244
    v_exp_f32 v176, v176
    v_exp_f32 v177, v177
    v_exp_f32 v178, v178
    v_exp_f32 v179, v179
    v_exp_f32 v180, v180
    v_exp_f32 v181, v181
    v_exp_f32 v182, v182
    v_exp_f32 v183, v183
    v_exp_f32 v184, v184
    v_exp_f32 v185, v185
    v_exp_f32 v186, v186
    v_exp_f32 v187, v187
    v_exp_f32 v188, v188
    v_exp_f32 v189, v189
    v_exp_f32 v190, v190
    v_exp_f32 v191, v191
    v_exp_f32 v192, v192
    v_exp_f32 v193, v193
    v_exp_f32 v194, v194
    v_exp_f32 v195, v195
    v_exp_f32 v196, v196
    v_exp_f32 v197, v197
    v_exp_f32 v198, v198
    v_exp_f32 v199, v199
    v_exp_f32 v200, v200
    v_exp_f32 v201, v201
    v_exp_f32 v202, v202
    v_exp_f32 v203, v203
    v_exp_f32 v204, v204
    v_exp_f32 v205, v205
    v_exp_f32 v206, v206
    v_exp_f32 v207, v207
    v_cvt_pk_bf16_f32 v104, v176, v177
    v_cvt_pk_bf16_f32 v105, v178, v179
    v_cvt_pk_bf16_f32 v106, v180, v181
    v_cvt_pk_bf16_f32 v107, v182, v183
    v_cvt_pk_bf16_f32 v108, v184, v185
    v_cvt_pk_bf16_f32 v109, v186, v187
    v_cvt_pk_bf16_f32 v110, v188, v189
    v_cvt_pk_bf16_f32 v111, v190, v191
    v_cvt_pk_bf16_f32 v112, v192, v193
    v_cvt_pk_bf16_f32 v113, v194, v195
    v_cvt_pk_bf16_f32 v114, v196, v197
    v_cvt_pk_bf16_f32 v115, v198, v199
    v_cvt_pk_bf16_f32 v116, v200, v201
    v_cvt_pk_bf16_f32 v117, v202, v203
    v_cvt_pk_bf16_f32 v118, v204, v205
    v_cvt_pk_bf16_f32 v119, v206, v207
    ds_write_b128 v1, v[104:107] offset:0
    v_mfma_f32_16x16x32_bf16 v[40:43], v[32:35], v[104:107], 0
    ds_write_b128 v1, v[108:111] offset:1024
    v_mfma_f32_16x16x32_bf16 v[40:43], v[32:35], v[108:111], v[40:43]
    ds_write_b128 v1, v[112:115] offset:2048
    v_mfma_f32_16x16x32_bf16 v[40:43], v[32:35], v[112:115], v[40:43]
    ds_write_b128 v1, v[116:119] offset:3072
    v_mfma_f32_16x16x32_bf16 v[40:43], v[32:35], v[116:119], v[40:43]
    v_sub_f32 v208, v208, v245
    v_sub_f32 v209, v209, v245
    v_sub_f32 v210, v210, v245
    v_sub_f32 v211, v211, v245
    v_sub_f32 v212, v212, v245
    v_sub_f32 v213, v213, v245
    v_sub_f32 v214, v214, v245
    v_sub_f32 v215, v215, v245
    v_sub_f32 v216, v216, v245
    v_sub_f32 v217, v217, v245
    v_sub_f32 v218, v218, v245
    v_sub_f32 v219, v219, v245
    v_sub_f32 v220, v220, v245
    v_sub_f32 v221, v221, v245
    v_sub_f32 v222, v222, v245
    v_sub_f32 v223, v223, v245
    v_sub_f32 v224, v224, v245
    v_sub_f32 v225, v225, v245
    v_sub_f32 v226, v226, v245
    v_sub_f32 v227, v227, v245
    v_sub_f32 v228, v228, v245
    v_sub_f32 v229, v229, v245
    v_sub_f32 v230, v230, v245
    v_sub_f32 v231, v231, v245
    v_sub_f32 v232, v232, v245
    v_sub_f32 v233, v233, v245
    v_sub_f32 v234, v234, v245
    v_sub_f32 v235, v235, v245
    v_sub_f32 v236, v236, v245
    v_sub_f32 v237, v237, v245
    v_sub_f32 v238, v238, v245
    v_sub_f32 v239, v239, v245
    v_exp_f32 v208, v208
    v_exp_f32 v209, v209
    v_exp_f32 v210, v210
    v_exp_f32 v211, v211
    v_exp_f32 v212, v212
    v_exp_f32 v213, v213
    v_exp_f32 v214, v214
    v_exp_f32 v215, v215
    v_exp_f32 v216, v216
    v_exp_f32 v217, v217
    v_exp_f32 v218, v218
    v_exp_f32 v219, v219
    v_exp_f32 v220, v220
    v_exp_f32 v221, v221
    v_exp_f32 v222, v222
    v_exp_f32 v223, v223
    v_exp_f32 v224, v224
    v_exp_f32 v225, v225
    v_exp_f32 v226, v226
    v_exp_f32 v227, v227
    v_exp_f32 v228, v228
    v_exp_f32 v229, v229
    v_exp_f32 v230, v230
    v_exp_f32 v231, v231
    v_exp_f32 v232, v232
    v_exp_f32 v233, v233
    v_exp_f32 v234, v234
    v_exp_f32 v235, v235
    v_exp_f32 v236, v236
    v_exp_f32 v237, v237
    v_exp_f32 v238, v238
    v_exp_f32 v239, v239
    v_cvt_pk_bf16_f32 v120, v208, v209
    v_cvt_pk_bf16_f32 v121, v210, v211
    v_cvt_pk_bf16_f32 v122, v212, v213
    v_cvt_pk_bf16_f32 v123, v214, v215
    v_cvt_pk_bf16_f32 v124, v216, v217
    v_cvt_pk_bf16_f32 v125, v218, v219
    v_cvt_pk_bf16_f32 v126, v220, v221
    v_cvt_pk_bf16_f32 v127, v222, v223
    v_cvt_pk_bf16_f32 v128, v224, v225
    v_cvt_pk_bf16_f32 v129, v226, v227
    v_cvt_pk_bf16_f32 v130, v228, v229
    v_cvt_pk_bf16_f32 v131, v230, v231
    v_cvt_pk_bf16_f32 v132, v232, v233
    v_cvt_pk_bf16_f32 v133, v234, v235
    v_cvt_pk_bf16_f32 v134, v236, v237
    v_cvt_pk_bf16_f32 v135, v238, v239
    ds_write_b128 v1, v[120:123] offset:4096
    v_mfma_f32_16x16x32_bf16 v[40:43], v[36:39], v[120:123], v[40:43]
    ds_write_b128 v1, v[124:127] offset:5120
    v_mfma_f32_16x16x32_bf16 v[40:43], v[36:39], v[124:127], v[40:43]
    ds_write_b128 v1, v[128:131] offset:6144
    v_mfma_f32_16x16x32_bf16 v[40:43], v[36:39], v[128:131], v[40:43]
    ds_write_b128 v1, v[132:135] offset:7168
    v_mfma_f32_16x16x32_bf16 v[40:43], v[36:39], v[132:135], v[40:43]
    s_nop 7
    ds_write_b32 v12, v40
    s_waitcnt lgkmcnt(0)
    s_barrier
    ds_read_b128 v[176:179], v2 offset:0
    ds_read_b128 v[180:183], v2 offset:1024
    ds_read_b128 v[184:187], v2 offset:2048
    ds_read_b128 v[188:191], v2 offset:3072
    ds_read_b128 v[192:195], v3 offset:0
    ds_read_b128 v[196:199], v3 offset:1024
    ds_read_b128 v[200:203], v3 offset:2048
    ds_read_b128 v[204:207], v3 offset:3072
    ds_read_b128 v[208:211], v4 offset:0
    ds_read_b128 v[212:215], v4 offset:1024
    ds_read_b128 v[216:219], v4 offset:2048
    ds_read_b128 v[220:223], v4 offset:3072
    ds_read_b128 v[24:27], v13 offset:0
    v_mfma_f32_16x16x32_bf16 v[48:51], a[128:131], v[104:107], 0
    v_mfma_f32_16x16x32_bf16 v[52:55], a[132:135], v[104:107], 0
    v_mfma_f32_16x16x32_bf16 v[48:51], a[136:139], v[108:111], v[48:51]
    v_mfma_f32_16x16x32_bf16 v[52:55], a[140:143], v[108:111], v[52:55]
    v_mfma_f32_16x16x32_bf16 v[48:51], a[144:147], v[112:115], v[48:51]
    v_mfma_f32_16x16x32_bf16 v[52:55], a[148:151], v[112:115], v[52:55]
    v_mfma_f32_16x16x32_bf16 v[48:51], a[152:155], v[116:119], v[48:51]
    v_mfma_f32_16x16x32_bf16 v[52:55], a[156:159], v[116:119], v[52:55]
    s_waitcnt lgkmcnt(12)
    v_mfma_f32_16x16x32_bf16 v[48:51], a[160:163], v[176:179], v[48:51]
    v_mfma_f32_16x16x32_bf16 v[52:55], a[164:167], v[176:179], v[52:55]
    s_waitcnt lgkmcnt(11)
    v_mfma_f32_16x16x32_bf16 v[48:51], a[168:171], v[180:183], v[48:51]
    v_mfma_f32_16x16x32_bf16 v[52:55], a[172:175], v[180:183], v[52:55]
    s_waitcnt lgkmcnt(10)
    v_mfma_f32_16x16x32_bf16 v[48:51], a[176:179], v[184:187], v[48:51]
    v_mfma_f32_16x16x32_bf16 v[52:55], a[180:183], v[184:187], v[52:55]
    s_waitcnt lgkmcnt(9)
    v_mfma_f32_16x16x32_bf16 v[48:51], a[184:187], v[188:191], v[48:51]
    v_mfma_f32_16x16x32_bf16 v[52:55], a[188:191], v[188:191], v[52:55]
    s_waitcnt lgkmcnt(8)
    v_mfma_f32_16x16x32_bf16 v[48:51], a[192:195], v[192:195], v[48:51]
    v_mfma_f32_16x16x32_bf16 v[52:55], a[196:199], v[192:195], v[52:55]
    s_waitcnt lgkmcnt(7)
    v_mfma_f32_16x16x32_bf16 v[48:51], a[200:203], v[196:199], v[48:51]
    v_mfma_f32_16x16x32_bf16 v[52:55], a[204:207], v[196:199], v[52:55]
    s_waitcnt lgkmcnt(6)
    v_mfma_f32_16x16x32_bf16 v[48:51], a[208:211], v[200:203], v[48:51]
    v_mfma_f32_16x16x32_bf16 v[52:55], a[212:215], v[200:203], v[52:55]
    s_waitcnt lgkmcnt(5)
    v_mfma_f32_16x16x32_bf16 v[48:51], a[216:219], v[204:207], v[48:51]
    v_mfma_f32_16x16x32_bf16 v[52:55], a[220:223], v[204:207], v[52:55]
    s_waitcnt lgkmcnt(4)
    v_mfma_f32_16x16x32_bf16 v[48:51], a[224:227], v[208:211], v[48:51]
    v_mfma_f32_16x16x32_bf16 v[52:55], a[228:231], v[208:211], v[52:55]
    s_waitcnt lgkmcnt(3)
    v_mfma_f32_16x16x32_bf16 v[48:51], a[232:235], v[212:215], v[48:51]
    v_mfma_f32_16x16x32_bf16 v[52:55], a[236:239], v[212:215], v[52:55]
    s_waitcnt lgkmcnt(2)
    v_mfma_f32_16x16x32_bf16 v[48:51], a[240:243], v[216:219], v[48:51]
    v_mfma_f32_16x16x32_bf16 v[52:55], a[244:247], v[216:219], v[52:55]
    s_waitcnt lgkmcnt(1)
    v_mfma_f32_16x16x32_bf16 v[48:51], a[248:251], v[220:223], v[48:51]
    v_mfma_f32_16x16x32_bf16 v[52:55], a[252:255], v[220:223], v[52:55]
    s_waitcnt lgkmcnt(0)
    v_add_f32 v24, v24, v25
    v_add_f32 v26, v26, v27
    v_add_f32 v24, v24, v26
    v_rcp_f32 v20, v24
    s_nop 1
    v_mul_f32 v48, v20, v48
    v_mul_f32 v49, v20, v49
    v_mul_f32 v50, v20, v50
    v_mul_f32 v51, v20, v51
    v_mul_f32 v52, v20, v52
    v_mul_f32 v53, v20, v53
    v_mul_f32 v54, v20, v54
    v_mul_f32 v55, v20, v55
    v_cvt_pk_bf16_f32 v28, v48, v49
    v_cvt_pk_bf16_f32 v29, v50, v51
    v_cvt_pk_bf16_f32 v30, v52, v53
    v_cvt_pk_bf16_f32 v31, v54, v55
    buffer_store_dwordx4 v[28:31], v11, s[8:11], s22 offen
    s_add_u32 s22, s22, 4096
    s_waitcnt vmcnt(0)
    ds_read_b128 v[176:179], v2 offset:4096
    ds_read_b128 v[180:183], v2 offset:5120
    ds_read_b128 v[184:187], v2 offset:6144
    ds_read_b128 v[188:191], v2 offset:7168
    ds_read_b128 v[192:195], v3 offset:4096
    ds_read_b128 v[196:199], v3 offset:5120
    ds_read_b128 v[200:203], v3 offset:6144
    ds_read_b128 v[204:207], v3 offset:7168
    ds_read_b128 v[208:211], v4 offset:4096
    ds_read_b128 v[212:215], v4 offset:5120
    ds_read_b128 v[216:219], v4 offset:6144
    ds_read_b128 v[220:223], v4 offset:7168
    ds_read_b128 v[24:27], v13 offset:256
    v_mfma_f32_16x16x32_bf16 v[48:51], a[128:131], v[120:123], 0
    v_mfma_f32_16x16x32_bf16 v[52:55], a[132:135], v[120:123], 0
    v_mfma_f32_16x16x32_bf16 v[48:51], a[136:139], v[124:127], v[48:51]
    v_mfma_f32_16x16x32_bf16 v[52:55], a[140:143], v[124:127], v[52:55]
    v_mfma_f32_16x16x32_bf16 v[48:51], a[144:147], v[128:131], v[48:51]
    v_mfma_f32_16x16x32_bf16 v[52:55], a[148:151], v[128:131], v[52:55]
    v_mfma_f32_16x16x32_bf16 v[48:51], a[152:155], v[132:135], v[48:51]
    v_mfma_f32_16x16x32_bf16 v[52:55], a[156:159], v[132:135], v[52:55]
    s_waitcnt lgkmcnt(12)
    v_mfma_f32_16x16x32_bf16 v[48:51], a[160:163], v[176:179], v[48:51]
    v_mfma_f32_16x16x32_bf16 v[52:55], a[164:167], v[176:179], v[52:55]
    s_waitcnt lgkmcnt(11)
    v_mfma_f32_16x16x32_bf16 v[48:51], a[168:171], v[180:183], v[48:51]
    v_mfma_f32_16x16x32_bf16 v[52:55], a[172:175], v[180:183], v[52:55]
    s_waitcnt lgkmcnt(10)
    v_mfma_f32_16x16x32_bf16 v[48:51], a[176:179], v[184:187], v[48:51]
    v_mfma_f32_16x16x32_bf16 v[52:55], a[180:183], v[184:187], v[52:55]
    s_waitcnt lgkmcnt(9)
    v_mfma_f32_16x16x32_bf16 v[48:51], a[184:187], v[188:191], v[48:51]
    v_mfma_f32_16x16x32_bf16 v[52:55], a[188:191], v[188:191], v[52:55]
    s_waitcnt lgkmcnt(8)
    v_mfma_f32_16x16x32_bf16 v[48:51], a[192:195], v[192:195], v[48:51]
    v_mfma_f32_16x16x32_bf16 v[52:55], a[196:199], v[192:195], v[52:55]
    s_waitcnt lgkmcnt(7)
    v_mfma_f32_16x16x32_bf16 v[48:51], a[200:203], v[196:199], v[48:51]
    v_mfma_f32_16x16x32_bf16 v[52:55], a[204:207], v[196:199], v[52:55]
    s_waitcnt lgkmcnt(6)
    v_mfma_f32_16x16x32_bf16 v[48:51], a[208:211], v[200:203], v[48:51]
    v_mfma_f32_16x16x32_bf16 v[52:55], a[212:215], v[200:203], v[52:55]
    s_waitcnt lgkmcnt(5)
    v_mfma_f32_16x16x32_bf16 v[48:51], a[216:219], v[204:207], v[48:51]
    v_mfma_f32_16x16x32_bf16 v[52:55], a[220:223], v[204:207], v[52:55]
    s_waitcnt lgkmcnt(4)
    v_mfma_f32_16x16x32_bf16 v[48:51], a[224:227], v[208:211], v[48:51]
    v_mfma_f32_16x16x32_bf16 v[52:55], a[228:231], v[208:211], v[52:55]
    s_waitcnt lgkmcnt(3)
    v_mfma_f32_16x16x32_bf16 v[48:51], a[232:235], v[212:215], v[48:51]
    v_mfma_f32_16x16x32_bf16 v[52:55], a[236:239], v[212:215], v[52:55]
    s_waitcnt lgkmcnt(2)
    v_mfma_f32_16x16x32_bf16 v[48:51], a[240:243], v[216:219], v[48:51]
    v_mfma_f32_16x16x32_bf16 v[52:55], a[244:247], v[216:219], v[52:55]
    s_waitcnt lgkmcnt(1)
    v_mfma_f32_16x16x32_bf16 v[48:51], a[248:251], v[220:223], v[48:51]
    v_mfma_f32_16x16x32_bf16 v[52:55], a[252:255], v[220:223], v[52:55]
    s_waitcnt lgkmcnt(0)
    v_add_f32 v24, v24, v25
    v_add_f32 v26, v26, v27
    v_add_f32 v24, v24, v26
    v_rcp_f32 v20, v24
    s_nop 1
    v_mul_f32 v48, v20, v48
    v_mul_f32 v49, v20, v49
    v_mul_f32 v50, v20, v50
    v_mul_f32 v51, v20, v51
    v_mul_f32 v52, v20, v52
    v_mul_f32 v53, v20, v53
    v_mul_f32 v54, v20, v54
    v_mul_f32 v55, v20, v55
    v_cvt_pk_bf16_f32 v28, v48, v49
    v_cvt_pk_bf16_f32 v29, v50, v51
    v_cvt_pk_bf16_f32 v30, v52, v53
    v_cvt_pk_bf16_f32 v31, v54, v55
    buffer_store_dwordx4 v[28:31], v11, s[8:11], s22 offen
    s_add_u32 s22, s22, 4096
    s_waitcnt vmcnt(0)
    s_add_u32 s21, s21, 8192
    s_cmp_lt_u32 s21, 376832
    s_nop 7
    s_cbranch_scc1 L_slow_loop_b
    s_branch L_end_b
.section .rodata,"a"
.p2align 6
.amdhsa_kernel standalone__gqa_softmax__near_ridge_kernel
  .amdhsa_next_free_vgpr 512
  .amdhsa_next_free_sgpr 102
  .amdhsa_accum_offset 256
  .amdhsa_group_segment_fixed_size 0
  .amdhsa_kernarg_size 48
  .amdhsa_user_sgpr_count 2
  .amdhsa_user_sgpr_kernarg_segment_ptr 1
  .amdhsa_system_sgpr_workgroup_id_x 1
.end_amdhsa_kernel
```
